```python
import torch

def _softmax(x, axis=-1):
    return torch.softmax(x, dim=axis)
def _gelu(x):
    return torch.nn.functional.gelu(x, approximate="tanh")
def _silu(x):
    return torch.nn.functional.silu(x)
def _sigmoid(x):
    return torch.sigmoid(x)
def _layernorm(x, axis=-1, eps=1e-5):
    m = x.mean(dim=axis, keepdim=True)
    v = x.var(dim=axis, keepdim=True, unbiased=False)
    return (x - m) / torch.sqrt(v + eps)
def _scatter_add(tgt, idx, src, axis=0):
    return tgt.clone().index_add_(axis, idx, src)
def _segment_sum(src, seg, n):
    out = torch.zeros((n,) + src.shape[1:], dtype=src.dtype)
    return out.index_add_(0, seg, src)
def _pad(x, pw):
    flat = tuple(v for pair in reversed(pw) for v in pair)
    return torch.nn.functional.pad(x, flat)

kernel_name = 'concat_heads__mha_block_cached__mha_block_cached__near_ridge'

def setup_inputs():

    _w = (lambda a: (lambda t: t.to(torch.bfloat16) if t.is_floating_point() else t)(torch.as_tensor(a)))
    def _A_setup():
        B, Sq, D = 8, 128, 448
        H, Sk, Dh = 16, 1024, 256
        return {
            "x": _w((lambda *s: torch.randn(*s, dtype=torch.bfloat16) * 0.8)(B, Sq, D)),
            "k_cache": _w((lambda *s: torch.randn(*s, dtype=torch.bfloat16) * 0.8)(B, H, Sk, Dh)),
            "v_cache": _w((lambda *s: torch.randn(*s, dtype=torch.bfloat16) * 0.05)(B, H, Sk, Dh)),
            "wq": _w((lambda *s: torch.randn(*s, dtype=torch.bfloat16) * 0.8)(D, H * Dh) * (D ** -0.5)),
            "wo": _w((lambda *s: torch.randn(*s, dtype=torch.bfloat16) * 0.05)(H * Dh, D) * ((H * Dh) ** -0.5)),
        }
    _A_in = _A_setup()

    def _B_setup():
        B, Sq, D = 8, 128, 448
        H, Sk, Dh = 16, 1024, 256
        return {
            "x": _w((lambda *s: torch.randn(*s, dtype=torch.bfloat16) * 0.8)(B, Sq, D)),
            "k_cache": _w((lambda *s: torch.randn(*s, dtype=torch.bfloat16) * 0.8)(B, H, Sk, Dh)),
            "v_cache": _w((lambda *s: torch.randn(*s, dtype=torch.bfloat16) * 0.05)(B, H, Sk, Dh)),
            "wq": _w((lambda *s: torch.randn(*s, dtype=torch.bfloat16) * 0.8)(D, H * Dh) * (D ** -0.5)),
            "wo": _w((lambda *s: torch.randn(*s, dtype=torch.bfloat16) * 0.05)(H * Dh, D) * ((H * Dh) ** -0.5)),
        }
    _B_in = _B_setup()

    return {
        "A_x": _A_in["x"],
        "A_k_cache": _A_in["k_cache"],
        "A_v_cache": _A_in["v_cache"],
        "A_wq": _A_in["wq"],
        "A_wo": _A_in["wo"],
        "B_x": _B_in["x"],
        "B_k_cache": _B_in["k_cache"],
        "B_v_cache": _B_in["v_cache"],
        "B_wq": _B_in["wq"],
        "B_wo": _B_in["wo"],
    }

def reference(A_x, A_k_cache, A_v_cache, A_wq, A_wo, B_x, B_k_cache, B_v_cache, B_wq, B_wo):
    def _A_ref(x, k_cache, v_cache, wq, wo):
        B, Sq, D = x.shape
        H, Dh = 16, 256
        q = (lambda x, *d: x.permute(*d))((x @ wq).reshape(B, Sq, H, Dh), 0, 2, 1, 3)
        scores = torch.einsum("bhqd,bhkd->bhqk", q, k_cache) * (Dh ** -0.5)
        p = _softmax(scores, axis=-1)
        o = torch.einsum("bhqk,bhkd->bhqd", p, v_cache)
        return (lambda x, *d: x.permute(*d))(o, 0, 2, 1, 3).reshape(B, Sq, H * Dh) @ wo

    def _B_ref(x, k_cache, v_cache, wq, wo):
        B, Sq, D = x.shape
        H, Dh = 16, 256
        q = (lambda x, *d: x.permute(*d))((x @ wq).reshape(B, Sq, H, Dh), 0, 2, 1, 3)
        scores = torch.einsum("bhqd,bhkd->bhqk", q, k_cache) * (Dh ** -0.5)
        p = _softmax(scores, axis=-1)
        o = torch.einsum("bhqk,bhkd->bhqd", p, v_cache)
        return (lambda x, *d: x.permute(*d))(o, 0, 2, 1, 3).reshape(B, Sq, H * Dh) @ wo

    a = _A_ref(A_x, A_k_cache, A_v_cache, A_wq, A_wo)
    b = _B_ref(B_x, B_k_cache, B_v_cache, B_wq, B_wo)
    return torch.concatenate([a, b], axis=-1)
```

```asm
; @launch grid=(256,1,1) block=(256,1,1) lds=163840
.amdgcn_target "amdgcn-amd-amdhsa--gfx950"
.text
.globl concat_heads__mha_block_cached__mha_block_cached__near_ridge_kernel
.p2align 8
.type concat_heads__mha_block_cached__mha_block_cached__near_ridge_kernel,@function
concat_heads__mha_block_cached__mha_block_cached__near_ridge_kernel:

    s_cmp_ge_u32 s2, 256
    s_cbranch_scc1 L_end_main
    s_load_dwordx16 s[40:55], s[0:1], 0
    s_load_dwordx4 s[56:59], s[0:1], 64
    s_bfe_u32 s3, s2, 0x20001
    s_and_b32 s36, s2, 1
    s_lshl_b32 s3, s3, 2
    s_bfe_u32 s86, s2, 0x20003
    s_or_b32 s34, s86, s3
    s_lshr_b32 s35, s2, 5
    s_mov_b32 s62, 768
    s_mov_b32 s69, 3145728
    v_and_b32 v40, 63, v0
    v_lshrrev_b32 v41, 6, v0
    v_lshrrev_b32 v42, 5, v40
    v_readfirstlane_b32 s28, v41
    v_and_b32 v43, 31, v40
    v_lshrrev_b32 v49, 3, v40
    s_lshl_b32 s29, s28, 12
    v_lshl_add_u32 v49, v41, 5, v49
    v_mul_u32_u24 v49, 896, v49
    v_and_b32 v45, 7, v40
    v_lshrrev_b32 v46, 4, v40
    v_xor_b32 v47, v45, v46
    v_lshl_add_u32 v26, v47, 4, v49
    v_xor_b32 v27, 64, v26
    v_lshl_add_u32 v44, v41, 3, v42
    v_and_b32 v47, 1, v41
    v_lshl_or_b32 v47, v47, 2, v42
    v_lshlrev_b32 v47, 1, v47
    v_xor_b32 v47, v43, v47
    v_lshlrev_b32 v47, 4, v47
    v_lshl_add_u32 v24, v44, 13, v47
    v_xor_b32 v25, 64, v24
    s_mul_i32 s87, s35, 114688
    s_lshl_b32 s3, s34, 9
    s_mov_b32 s6, 114688
    s_mov_b32 s7, 0x20000
    s_sub_u32 s18, 3670016, s3
    s_mov_b32 s19, 0x20000
    s_waitcnt lgkmcnt(0)
    s_cmp_eq_u32 s36, 0
    s_cselect_b32 s40, s40, s50
    s_cselect_b32 s41, s41, s51
    s_cselect_b32 s46, s46, s56
    s_cselect_b32 s47, s47, s57
    s_add_u32 s4, s40, s87
    s_addc_u32 s5, s41, 0
    s_add_u32 s16, s46, s3
    s_addc_u32 s17, s47, 0
    s_add_u32 m0, s29, 65536
    s_add_u32 s30, s62, 0
    buffer_load_dwordx4 v26, s[4:7], s30 offen offset:0  lds
    s_add_u32 s30, s62, 6144
    buffer_load_dwordx4 v27, s[4:7], s30 offen offset:1024  lds
    s_add_u32 s30, s62, 12288
    buffer_load_dwordx4 v26, s[4:7], s30 offen offset:2048  lds
    s_add_u32 s30, s62, 18432
    buffer_load_dwordx4 v27, s[4:7], s30 offen offset:3072  lds
    s_add_u32 m0, s29, 0
    s_add_u32 s30, s69, 0
    buffer_load_dwordx4 v24, s[16:19], s30 offen offset:0  lds
    s_add_u32 s30, s69, 15360
    buffer_load_dwordx4 v25, s[16:19], s30 offen offset:1024  lds
    s_add_u32 s30, s69, 30720
    buffer_load_dwordx4 v24, s[16:19], s30 offen offset:2048  lds
    s_add_u32 s30, s69, 46080
    buffer_load_dwordx4 v25, s[16:19], s30 offen offset:3072  lds
    s_add_u32 m0, s29, 49152
    s_add_u32 s30, s69, 262144
    buffer_load_dwordx4 v24, s[16:19], s30 offen offset:0  lds
    s_add_u32 s30, s69, 277504
    buffer_load_dwordx4 v25, s[16:19], s30 offen offset:1024  lds
    s_add_u32 s30, s69, 292864
    buffer_load_dwordx4 v24, s[16:19], s30 offen offset:2048  lds
    s_add_u32 s30, s69, 308224
    buffer_load_dwordx4 v25, s[16:19], s30 offen offset:3072  lds
    s_cmp_eq_u32 s36, 0
    s_cselect_b32 s42, s42, s52
    s_cselect_b32 s43, s43, s53
    s_cselect_b32 s44, s44, s54
    s_cselect_b32 s45, s45, s55
    s_cselect_b32 s48, s48, s58
    s_cselect_b32 s49, s49, s59
    s_load_dwordx2 s[50:51], s[0:1], 80
    s_load_dwordx4 s[52:55], s[0:1], 88
    s_mul_i32 s86, s86, 3
    s_lshr_b32 s86, s86, 1
    s_add_u32 s86, s86, s35
    s_lshl_b32 s63, s86, 7
    s_cmp_ge_u32 s63, 768
    s_cselect_b32 s3, 768, 0
    s_sub_u32 s63, s63, s3
    s_add_u32 s64, s63, 128
    s_cmp_ge_u32 s64, 768
    s_cselect_b32 s3, 768, 0
    s_sub_u32 s64, s64, s3
    s_add_u32 s65, s64, 128
    s_cmp_ge_u32 s65, 768
    s_cselect_b32 s3, 768, 0
    s_sub_u32 s65, s65, s3
    s_add_u32 s66, s65, 128
    s_cmp_ge_u32 s66, 768
    s_cselect_b32 s3, 768, 0
    s_sub_u32 s66, s66, s3
    s_add_u32 s67, s66, 128
    s_cmp_ge_u32 s67, 768
    s_cselect_b32 s3, 768, 0
    s_sub_u32 s67, s67, s3
    s_add_u32 s68, s67, 128
    s_cmp_ge_u32 s68, 768
    s_cselect_b32 s3, 768, 0
    s_sub_u32 s68, s68, s3
    s_lshl_b32 s70, s63, 12
    s_lshl_b32 s71, s64, 12
    s_lshl_b32 s72, s65, 12
    s_lshl_b32 s73, s66, 12
    s_lshl_b32 s74, s67, 12
    s_lshl_b32 s75, s68, 12
    v_lshl_add_u32 v21, v44, 9, v47
    v_xor_b32 v22, 64, v21
    v_lshlrev_b32 v47, 1, v46
    v_xor_b32 v47, v45, v47
    v_lshl_add_u32 v23, v47, 4, v49
    v_lshl_or_b32 v47, v41, 2, v42
    v_xor_b32 v47, v43, v47
    v_lshlrev_b32 v47, 4, v47
    v_lshl_add_u32 v19, v44, 9, v47
    v_xor_b32 v20, 0x20, v19
    s_lshl_b32 s37, s35, 4
    s_add_u32 s37, s37, s34
    s_lshl_b32 s3, s37, 19
    s_add_u32 s8, s42, s3
    s_addc_u32 s9, s43, 0
    s_mov_b32 s10, 524288
    s_mov_b32 s11, 0x20000
    s_add_u32 s12, s44, s3
    s_addc_u32 s13, s45, 0
    s_mov_b32 s14, 524288
    s_mov_b32 s15, 0x20000
    s_getpc_b64 s[88:89]
L_pc:
    s_lshr_b32 s90, s2, 3
    s_lshl_b32 s90, s90, 2
    s_add_u32 s90, s90, s28
    s_mul_i32 s90, s90, 6
    v_min_u32 v52, 5, v40
    v_add_u32 v52, s90, v52
    v_lshlrev_b32 v52, 7, v52
    v_min_u32 v52, L_code_end-L_pc-4, v52
    v_mov_b32 v53, s89
    v_add_co_u32 v52, vcc, s88, v52
    s_nop 1
    v_addc_co_u32 v53, vcc, 0, v53, vcc
    global_load_dword v54, v[52:53], off
    s_mul_i32 s3, s34, 229376
    s_add_u32 s20, s48, s3
    s_addc_u32 s21, s49, 0
    s_mov_b32 s22, 229376
    s_mov_b32 s23, 0x20000
    s_mov_b32 s86, 0
    s_lshl_b32 s76, s86, 7
    s_cmp_ge_u32 s76, 896
    s_cselect_b32 s3, 896, 0
    s_sub_u32 s76, s76, s3
    s_add_u32 s77, s76, 128
    s_cmp_ge_u32 s77, 896
    s_cselect_b32 s3, 896, 0
    s_sub_u32 s77, s77, s3
    s_add_u32 s78, s77, 128
    s_cmp_ge_u32 s78, 896
    s_cselect_b32 s3, 896, 0
    s_sub_u32 s78, s78, s3
    s_add_u32 s79, s78, 128
    s_cmp_ge_u32 s79, 896
    s_cselect_b32 s3, 896, 0
    s_sub_u32 s79, s79, s3
    s_add_u32 s80, s79, 128
    s_cmp_ge_u32 s80, 896
    s_cselect_b32 s3, 896, 0
    s_sub_u32 s80, s80, s3
    s_add_u32 s81, s80, 128
    s_cmp_ge_u32 s81, 896
    s_cselect_b32 s3, 896, 0
    s_sub_u32 s81, s81, s3
    s_add_u32 s82, s81, 128
    s_cmp_ge_u32 s82, 896
    s_cselect_b32 s3, 896, 0
    s_sub_u32 s82, s82, s3
    s_mov_b32 s32, 0x3db8aa3b
    s_mov_b32 s33, 0x3db8aa3b
    s_mov_b32 s31, 0x41000000
    v_and_b32 v44, 15, v40
    v_and_b32 v45, 3, v44
    v_lshrrev_b32 v47, 2, v44
    v_lshl_add_u32 v45, v47, 3, v45
    v_xor_b32 v47, v46, v44
    v_lshlrev_b32 v47, 4, v47
    v_lshl_add_u32 v7, v45, 9, v47
    v_xor_b32 v8, 64, v7
    v_xor_b32 v9, 128, v7
    v_xor_b32 v10, 192, v7
    v_bfe_u32 v45, v40, 2, 2
    v_lshl_add_u32 v47, v46, 3, v45
    v_bfe_u32 v48, v40, 2, 3
    v_lshlrev_b32 v48, 5, v48
    v_and_b32 v45, 3, v40
    v_lshl_add_u32 v48, v45, 3, v48
    v_lshl_add_u32 v11, v47, 9, v48
    v_xor_b32 v12, 32, v11
    v_xor_b32 v13, 64, v11
    v_xor_b32 v14, 96, v11
    v_xor_b32 v15, 128, v11
    v_xor_b32 v16, 160, v11
    v_xor_b32 v17, 192, v11
    v_xor_b32 v18, 224, v11
    v_bfe_u32 v47, v40, 3, 2
    v_xor_b32 v47, v41, v47
    v_lshlrev_b32 v47, 5, v47
    v_lshl_add_u32 v47, v45, 3, v47
    v_lshrrev_b32 v48, 2, v40
    v_lshl_add_u32 v2, v48, 7, v47
    v_lshrrev_b32 v45, 1, v44
    v_xor_b32 v45, v46, v45
    v_lshlrev_b32 v45, 4, v45
    v_lshl_add_u32 v45, v44, 7, v45
    v_lshl_add_u32 v28, v41, 12, v45
    v_xor_b32 v29, 64, v28
    v_mov_b32 v44, 0x3f803f80
    v_accvgpr_write_b32 a28, v44
    v_accvgpr_write_b32 a29, v44
    v_accvgpr_write_b32 a30, v44
    v_accvgpr_write_b32 a31, v44
    v_mov_b32 v56, 0
    v_mov_b32 v57, 0
    v_mov_b32 v58, 0
    v_mov_b32 v59, 0
    v_mov_b32 v60, 0
    v_mov_b32 v61, 0
    v_mov_b32 v62, 0
    v_mov_b32 v63, 0
    s_waitcnt lgkmcnt(0)
    s_lshl_b32 s86, s36, 3
    s_add_u32 s86, s86, s35
    s_mul_i32 s3, s86, 1835008
    s_add_u32 s24, s54, s3
    s_addc_u32 s25, s55, 0
    s_mov_b32 s26, 1835008
    s_mov_b32 s27, 0x20000
    s_add_u32 s3, s28, 0
    s_and_b32 s3, s3, 3
    s_lshl_b32 s3, s3, 2
    s_add_u32 s3, s3, s28
    s_mul_i32 s56, s3, 114688
    s_add_u32 s3, s28, 1
    s_and_b32 s3, s3, 3
    s_lshl_b32 s3, s3, 2
    s_add_u32 s3, s3, s28
    s_mul_i32 s57, s3, 114688
    s_add_u32 s3, s28, 2
    s_and_b32 s3, s3, 3
    s_lshl_b32 s3, s3, 2
    s_add_u32 s3, s3, s28
    s_mul_i32 s58, s3, 114688
    s_add_u32 s3, s28, 3
    s_and_b32 s3, s3, 3
    s_lshl_b32 s3, s3, 2
    s_add_u32 s3, s3, s28
    s_mul_i32 s59, s3, 114688
    s_lshr_b32 s3, s34, 2
    s_sub_u32 s3, s3, s28
    s_and_b32 s3, s3, 3
    s_add_u32 s60, s3, 1
    s_lshl_b32 s86, s86, 2
    s_add_u32 s86, s86, s28
    s_lshl_b32 s3, s86, 13
    s_add_u32 s3, s3, 29360128
    s_add_u32 s92, s54, s3
    s_addc_u32 s93, s55, 0
    s_mov_b32 s94, 8192
    s_mov_b32 s95, 0x20000
    s_lshl_b32 s3, s86, 2
    s_add_u32 s96, s52, s3
    s_addc_u32 s97, s53, 0
    s_mov_b32 s98, 4
    s_mov_b32 s99, 0x20000
    s_mul_i32 s3, s28, 5
    s_xor_b32 s3, s3, s34
    s_lshl_b32 s37, s3, 8
    s_waitcnt vmcnt(5)
    s_barrier
    v_add_u32 v30, 65536, v28
    v_add_u32 v31, 65536, v29
    ds_read_b128 a[32:35], v30 offset:0
    ds_read_b128 a[36:39], v30 offset:2048
    ds_read_b128 a[40:43], v31 offset:0
    ds_read_b128 a[44:47], v31 offset:2048
    ds_read_b64_tr_b16 a[0:1], v11 offset:0
    ds_read_b64_tr_b16 a[2:3], v11 offset:2048
    ds_read_b64_tr_b16 a[4:5], v12 offset:0
    ds_read_b64_tr_b16 a[6:7], v12 offset:2048
    ds_read_b64_tr_b16 a[8:9], v13 offset:0
    ds_read_b64_tr_b16 a[10:11], v13 offset:2048
    ds_read_b64_tr_b16 a[12:13], v14 offset:0
    ds_read_b64_tr_b16 a[14:15], v14 offset:2048
    s_waitcnt lgkmcnt(6)
    v_mfma_f32_16x16x32_bf16 v[128:131], a[0:3], a[32:35], 0
    ds_read_b64_tr_b16 a[16:17], v15 offset:0
    s_add_u32 m0, s29, 98304
    s_add_u32 s30, s63, 0
    v_mfma_f32_16x16x32_bf16 v[132:135], a[0:3], a[36:39], 0
    ds_read_b64_tr_b16 a[18:19], v15 offset:2048
    buffer_load_dwordx4 v26, s[4:7], s30 offen offset:0  lds
    s_waitcnt lgkmcnt(4)
    v_mfma_f32_16x16x32_bf16 v[136:139], a[4:7], a[32:35], 0
    ds_read_b64_tr_b16 a[0:1], v16 offset:0
    s_add_u32 s30, s63, 6144
    buffer_load_dwordx4 v27, s[4:7], s30 offen offset:1024  lds
    v_mfma_f32_16x16x32_bf16 v[140:143], a[4:7], a[36:39], 0
    ds_read_b64_tr_b16 a[2:3], v16 offset:2048
    s_add_u32 s30, s63, 12288
    buffer_load_dwordx4 v26, s[4:7], s30 offen offset:2048  lds
    v_mfma_f32_16x16x32_bf16 v[144:147], a[8:11], a[32:35], 0
    ds_read_b64_tr_b16 a[4:5], v17 offset:0
    s_add_u32 s30, s63, 18432
    buffer_load_dwordx4 v27, s[4:7], s30 offen offset:3072  lds
    v_mfma_f32_16x16x32_bf16 v[148:151], a[8:11], a[36:39], 0
    ds_read_b64_tr_b16 a[6:7], v17 offset:2048
    s_add_u32 m0, s29, 16384
    s_waitcnt lgkmcnt(4)
    v_mfma_f32_16x16x32_bf16 v[152:155], a[12:15], a[32:35], 0
    ds_read_b64_tr_b16 a[8:9], v18 offset:0
    s_add_u32 s30, s70, 0
    buffer_load_dwordx4 v24, s[16:19], s30 offen offset:0  lds
    v_mfma_f32_16x16x32_bf16 v[156:159], a[12:15], a[36:39], 0
    ds_read_b64_tr_b16 a[10:11], v18 offset:2048
    s_add_u32 s30, s70, 15360
    buffer_load_dwordx4 v25, s[16:19], s30 offen offset:1024  lds
    v_mfma_f32_16x16x32_bf16 v[160:163], a[16:19], a[32:35], 0
    ds_read_b64_tr_b16 a[12:13], v11 offset:256
    s_add_u32 s30, s70, 30720
    buffer_load_dwordx4 v24, s[16:19], s30 offen offset:2048  lds
    v_mfma_f32_16x16x32_bf16 v[164:167], a[16:19], a[36:39], 0
    ds_read_b64_tr_b16 a[14:15], v11 offset:2304
    s_add_u32 s30, s70, 46080
    s_waitcnt lgkmcnt(4)
    v_mfma_f32_16x16x32_bf16 v[168:171], a[0:3], a[32:35], 0
    ds_read_b64_tr_b16 a[16:17], v12 offset:256
    buffer_load_dwordx4 v25, s[16:19], s30 offen offset:3072  lds
    v_mfma_f32_16x16x32_bf16 v[172:175], a[0:3], a[36:39], 0
    ds_read_b64_tr_b16 a[18:19], v12 offset:2304
    s_add_u32 m0, s29, 32768
    s_add_u32 s30, s70, 262144
    v_mfma_f32_16x16x32_bf16 v[176:179], a[4:7], a[32:35], 0
    ds_read_b64_tr_b16 a[0:1], v13 offset:256
    buffer_load_dwordx4 v24, s[16:19], s30 offen offset:0  lds
    v_mfma_f32_16x16x32_bf16 v[180:183], a[4:7], a[36:39], 0
    ds_read_b64_tr_b16 a[2:3], v13 offset:2304
    s_add_u32 s30, s70, 277504
    s_waitcnt lgkmcnt(4)
    v_mfma_f32_16x16x32_bf16 v[184:187], a[8:11], a[32:35], 0
    ds_read_b64_tr_b16 a[4:5], v14 offset:256
    buffer_load_dwordx4 v25, s[16:19], s30 offen offset:1024  lds
    v_mfma_f32_16x16x32_bf16 v[188:191], a[8:11], a[36:39], 0
    ds_read_b64_tr_b16 a[6:7], v14 offset:2304
    s_add_u32 s30, s70, 292864
    buffer_load_dwordx4 v24, s[16:19], s30 offen offset:2048  lds
    v_mfma_f32_16x16x32_bf16 v[192:195], a[12:15], a[32:35], 0
    ds_read_b64_tr_b16 a[8:9], v15 offset:256
    s_add_u32 s30, s70, 308224
    buffer_load_dwordx4 v25, s[16:19], s30 offen offset:3072  lds
    v_mfma_f32_16x16x32_bf16 v[196:199], a[12:15], a[36:39], 0
    ds_read_b64_tr_b16 a[10:11], v15 offset:2304
    s_waitcnt lgkmcnt(4)
    v_mfma_f32_16x16x32_bf16 v[200:203], a[16:19], a[32:35], 0
    ds_read_b64_tr_b16 a[12:13], v16 offset:256
    v_mfma_f32_16x16x32_bf16 v[204:207], a[16:19], a[36:39], 0
    ds_read_b64_tr_b16 a[14:15], v16 offset:2304
    v_mfma_f32_16x16x32_bf16 v[208:211], a[0:3], a[32:35], 0
    ds_read_b64_tr_b16 a[16:17], v17 offset:256
    v_mfma_f32_16x16x32_bf16 v[212:215], a[0:3], a[36:39], 0
    ds_read_b64_tr_b16 a[18:19], v17 offset:2304
    s_waitcnt lgkmcnt(4)
    v_mfma_f32_16x16x32_bf16 v[216:219], a[4:7], a[32:35], 0
    ds_read_b64_tr_b16 a[0:1], v18 offset:256
    s_mov_b32 s100, 0
    buffer_load_dword v4, off, s[8:11], s100 nt
    v_mfma_f32_16x16x32_bf16 v[220:223], a[4:7], a[36:39], 0
    ds_read_b64_tr_b16 a[2:3], v18 offset:2304
    v_mfma_f32_16x16x32_bf16 v[224:227], a[8:11], a[32:35], 0
    s_waitcnt vmcnt(14)
    s_barrier
    ds_read_b64_tr_b16 a[4:5], v11 offset:49152
    v_mfma_f32_16x16x32_bf16 v[228:231], a[8:11], a[36:39], 0
    ds_read_b64_tr_b16 a[6:7], v11 offset:51200
    s_waitcnt lgkmcnt(4)
    v_mfma_f32_16x16x32_bf16 v[232:235], a[12:15], a[32:35], 0
    ds_read_b64_tr_b16 a[8:9], v12 offset:49152
    v_mfma_f32_16x16x32_bf16 v[236:239], a[12:15], a[36:39], 0
    ds_read_b64_tr_b16 a[10:11], v12 offset:51200
    v_mfma_f32_16x16x32_bf16 v[240:243], a[16:19], a[32:35], 0
    ds_read_b64_tr_b16 a[12:13], v13 offset:49152
    v_mfma_f32_16x16x32_bf16 v[244:247], a[16:19], a[36:39], 0
    ds_read_b64_tr_b16 a[14:15], v13 offset:51200
    s_waitcnt lgkmcnt(4)
    v_mfma_f32_16x16x32_bf16 v[248:251], a[0:3], a[32:35], 0
    ds_read_b64_tr_b16 a[16:17], v14 offset:49152
    v_mfma_f32_16x16x32_bf16 v[252:255], a[0:3], a[36:39], 0
    ds_read_b64_tr_b16 a[18:19], v14 offset:51200
    v_mfma_f32_16x16x32_bf16 v[128:131], a[4:7], a[40:43], v[128:131]
    ds_read_b64_tr_b16 a[0:1], v15 offset:49152
    v_mfma_f32_16x16x32_bf16 v[132:135], a[4:7], a[44:47], v[132:135]
    ds_read_b64_tr_b16 a[2:3], v15 offset:51200
    s_waitcnt lgkmcnt(4)
    v_mfma_f32_16x16x32_bf16 v[136:139], a[8:11], a[40:43], v[136:139]
    ds_read_b64_tr_b16 a[4:5], v16 offset:49152
    v_mfma_f32_16x16x32_bf16 v[140:143], a[8:11], a[44:47], v[140:143]
    ds_read_b64_tr_b16 a[6:7], v16 offset:51200
    v_mfma_f32_16x16x32_bf16 v[144:147], a[12:15], a[40:43], v[144:147]
    ds_read_b64_tr_b16 a[8:9], v17 offset:49152
    v_mfma_f32_16x16x32_bf16 v[148:151], a[12:15], a[44:47], v[148:151]
    ds_read_b64_tr_b16 a[10:11], v17 offset:51200
    s_waitcnt lgkmcnt(4)
    v_mfma_f32_16x16x32_bf16 v[152:155], a[16:19], a[40:43], v[152:155]
    ds_read_b64_tr_b16 a[12:13], v18 offset:49152
    v_mfma_f32_16x16x32_bf16 v[156:159], a[16:19], a[44:47], v[156:159]
    ds_read_b64_tr_b16 a[14:15], v18 offset:51200
    v_mfma_f32_16x16x32_bf16 v[160:163], a[0:3], a[40:43], v[160:163]
    ds_read_b64_tr_b16 a[16:17], v11 offset:49408
    v_mfma_f32_16x16x32_bf16 v[164:167], a[0:3], a[44:47], v[164:167]
    ds_read_b64_tr_b16 a[18:19], v11 offset:51456
    s_waitcnt lgkmcnt(4)
    v_mfma_f32_16x16x32_bf16 v[168:171], a[4:7], a[40:43], v[168:171]
    ds_read_b64_tr_b16 a[0:1], v12 offset:49408
    v_mfma_f32_16x16x32_bf16 v[172:175], a[4:7], a[44:47], v[172:175]
    ds_read_b64_tr_b16 a[2:3], v12 offset:51456
    v_mfma_f32_16x16x32_bf16 v[176:179], a[8:11], a[40:43], v[176:179]
    ds_read_b64_tr_b16 a[4:5], v13 offset:49408
    v_mfma_f32_16x16x32_bf16 v[180:183], a[8:11], a[44:47], v[180:183]
    ds_read_b64_tr_b16 a[6:7], v13 offset:51456
    s_waitcnt lgkmcnt(4)
    v_mfma_f32_16x16x32_bf16 v[184:187], a[12:15], a[40:43], v[184:187]
    ds_read_b64_tr_b16 a[8:9], v14 offset:49408
    v_mfma_f32_16x16x32_bf16 v[188:191], a[12:15], a[44:47], v[188:191]
    ds_read_b64_tr_b16 a[10:11], v14 offset:51456
    v_mfma_f32_16x16x32_bf16 v[192:195], a[16:19], a[40:43], v[192:195]
    ds_read_b64_tr_b16 a[12:13], v15 offset:49408
    v_mfma_f32_16x16x32_bf16 v[196:199], a[16:19], a[44:47], v[196:199]
    ds_read_b64_tr_b16 a[14:15], v15 offset:51456
    s_waitcnt lgkmcnt(4)
    v_mfma_f32_16x16x32_bf16 v[200:203], a[0:3], a[40:43], v[200:203]
    ds_read_b64_tr_b16 a[16:17], v16 offset:49408
    v_mfma_f32_16x16x32_bf16 v[204:207], a[0:3], a[44:47], v[204:207]
    ds_read_b64_tr_b16 a[18:19], v16 offset:51456
    v_mfma_f32_16x16x32_bf16 v[208:211], a[4:7], a[40:43], v[208:211]
    ds_read_b64_tr_b16 a[0:1], v17 offset:49408
    v_mfma_f32_16x16x32_bf16 v[212:215], a[4:7], a[44:47], v[212:215]
    ds_read_b64_tr_b16 a[2:3], v17 offset:51456
    s_waitcnt lgkmcnt(4)
    v_mfma_f32_16x16x32_bf16 v[216:219], a[8:11], a[40:43], v[216:219]
    ds_read_b64_tr_b16 a[4:5], v18 offset:49408
    s_mov_b32 s100, 0
    buffer_load_dword v4, off, s[12:15], s100 nt
    v_mfma_f32_16x16x32_bf16 v[220:223], a[8:11], a[44:47], v[220:223]
    ds_read_b64_tr_b16 a[6:7], v18 offset:51456
    v_mfma_f32_16x16x32_bf16 v[224:227], a[12:15], a[40:43], v[224:227]
    s_waitcnt vmcnt(6)
    s_barrier
    v_add_u32 v30, 98304, v28
    v_add_u32 v31, 98304, v29
    ds_read_b128 a[48:51], v30 offset:0
    ds_read_b128 a[52:55], v30 offset:2048
    ds_read_b128 a[56:59], v31 offset:0
    ds_read_b128 a[60:63], v31 offset:2048
    ds_read_b64_tr_b16 a[8:9], v11 offset:16384
    v_mfma_f32_16x16x32_bf16 v[228:231], a[12:15], a[44:47], v[228:231]
    ds_read_b64_tr_b16 a[10:11], v11 offset:18432
    s_add_u32 m0, s29, 81920
    s_waitcnt lgkmcnt(8)
    v_mfma_f32_16x16x32_bf16 v[232:235], a[16:19], a[40:43], v[232:235]
    ds_read_b64_tr_b16 a[12:13], v12 offset:16384
    s_add_u32 s30, s64, 0
    buffer_load_dwordx4 v26, s[4:7], s30 offen offset:0  lds
    v_mfma_f32_16x16x32_bf16 v[236:239], a[16:19], a[44:47], v[236:239]
    ds_read_b64_tr_b16 a[14:15], v12 offset:18432
    s_add_u32 s30, s64, 6144
    buffer_load_dwordx4 v27, s[4:7], s30 offen offset:1024  lds
    v_mfma_f32_16x16x32_bf16 v[240:243], a[0:3], a[40:43], v[240:243]
    ds_read_b64_tr_b16 a[16:17], v13 offset:16384
    s_add_u32 s30, s64, 12288
    buffer_load_dwordx4 v26, s[4:7], s30 offen offset:2048  lds
    v_mfma_f32_16x16x32_bf16 v[244:247], a[0:3], a[44:47], v[244:247]
    ds_read_b64_tr_b16 a[18:19], v13 offset:18432
    s_add_u32 s30, s64, 18432
    s_waitcnt lgkmcnt(4)
    v_mfma_f32_16x16x32_bf16 v[248:251], a[4:7], a[40:43], v[248:251]
    ds_read_b64_tr_b16 a[0:1], v14 offset:16384
    buffer_load_dwordx4 v27, s[4:7], s30 offen offset:3072  lds
    v_mfma_f32_16x16x32_bf16 v[252:255], a[4:7], a[44:47], v[252:255]
    ds_read_b64_tr_b16 a[2:3], v14 offset:18432
    s_add_u32 m0, s29, 65536
    s_add_u32 s30, s71, 0
    v_mfma_f32_16x16x32_bf16 v[128:131], a[8:11], a[48:51], v[128:131]
    ds_read_b64_tr_b16 a[4:5], v15 offset:16384
    buffer_load_dwordx4 v24, s[16:19], s30 offen offset:0  lds
    v_mfma_f32_16x16x32_bf16 v[132:135], a[8:11], a[52:55], v[132:135]
    ds_read_b64_tr_b16 a[6:7], v15 offset:18432
    s_add_u32 s30, s71, 15360
    s_waitcnt lgkmcnt(4)
    v_mfma_f32_16x16x32_bf16 v[136:139], a[12:15], a[48:51], v[136:139]
    ds_read_b64_tr_b16 a[8:9], v16 offset:16384
    buffer_load_dwordx4 v25, s[16:19], s30 offen offset:1024  lds
    v_mfma_f32_16x16x32_bf16 v[140:143], a[12:15], a[52:55], v[140:143]
    ds_read_b64_tr_b16 a[10:11], v16 offset:18432
    s_add_u32 s30, s71, 30720
    buffer_load_dwordx4 v24, s[16:19], s30 offen offset:2048  lds
    v_mfma_f32_16x16x32_bf16 v[144:147], a[16:19], a[48:51], v[144:147]
    ds_read_b64_tr_b16 a[12:13], v17 offset:16384
    s_add_u32 s30, s71, 46080
    buffer_load_dwordx4 v25, s[16:19], s30 offen offset:3072  lds
    v_mfma_f32_16x16x32_bf16 v[148:151], a[16:19], a[52:55], v[148:151]
    ds_read_b64_tr_b16 a[14:15], v17 offset:18432
    s_add_u32 m0, s29, 0
    s_waitcnt lgkmcnt(4)
    v_mfma_f32_16x16x32_bf16 v[152:155], a[0:3], a[48:51], v[152:155]
    ds_read_b64_tr_b16 a[16:17], v18 offset:16384
    s_mov_b32 s30, 0
    buffer_load_dwordx4 v19, s[8:11], s30 offen offset:0 nt lds
    v_mfma_f32_16x16x32_bf16 v[156:159], a[0:3], a[52:55], v[156:159]
    ds_read_b64_tr_b16 a[18:19], v18 offset:18432
    buffer_load_dwordx4 v20, s[8:11], s30 offen offset:1024 nt lds
    v_mfma_f32_16x16x32_bf16 v[160:163], a[4:7], a[48:51], v[160:163]
    ds_read_b64_tr_b16 a[0:1], v11 offset:16640
    buffer_load_dwordx4 v19, s[8:11], s30 offen offset:2048 nt lds
    v_mfma_f32_16x16x32_bf16 v[164:167], a[4:7], a[52:55], v[164:167]
    ds_read_b64_tr_b16 a[2:3], v11 offset:18688
    buffer_load_dwordx4 v20, s[8:11], s30 offen offset:3072 nt lds
    s_waitcnt lgkmcnt(4)
    v_mfma_f32_16x16x32_bf16 v[168:171], a[8:11], a[48:51], v[168:171]
    ds_read_b64_tr_b16 a[4:5], v12 offset:16640
    v_mfma_f32_16x16x32_bf16 v[172:175], a[8:11], a[52:55], v[172:175]
    ds_read_b64_tr_b16 a[6:7], v12 offset:18688
    v_mfma_f32_16x16x32_bf16 v[176:179], a[12:15], a[48:51], v[176:179]
    ds_read_b64_tr_b16 a[8:9], v13 offset:16640
    v_mfma_f32_16x16x32_bf16 v[180:183], a[12:15], a[52:55], v[180:183]
    ds_read_b64_tr_b16 a[10:11], v13 offset:18688
    s_waitcnt lgkmcnt(4)
    v_mfma_f32_16x16x32_bf16 v[184:187], a[16:19], a[48:51], v[184:187]
    ds_read_b64_tr_b16 a[12:13], v14 offset:16640
    v_mfma_f32_16x16x32_bf16 v[188:191], a[16:19], a[52:55], v[188:191]
    ds_read_b64_tr_b16 a[14:15], v14 offset:18688
    v_mfma_f32_16x16x32_bf16 v[192:195], a[0:3], a[48:51], v[192:195]
    ds_read_b64_tr_b16 a[16:17], v15 offset:16640
    v_mfma_f32_16x16x32_bf16 v[196:199], a[0:3], a[52:55], v[196:199]
    ds_read_b64_tr_b16 a[18:19], v15 offset:18688
    s_waitcnt lgkmcnt(4)
    v_mfma_f32_16x16x32_bf16 v[200:203], a[4:7], a[48:51], v[200:203]
    ds_read_b64_tr_b16 a[0:1], v16 offset:16640
    v_mfma_f32_16x16x32_bf16 v[204:207], a[4:7], a[52:55], v[204:207]
    ds_read_b64_tr_b16 a[2:3], v16 offset:18688
    v_mfma_f32_16x16x32_bf16 v[208:211], a[8:11], a[48:51], v[208:211]
    ds_read_b64_tr_b16 a[4:5], v17 offset:16640
    v_mfma_f32_16x16x32_bf16 v[212:215], a[8:11], a[52:55], v[212:215]
    ds_read_b64_tr_b16 a[6:7], v17 offset:18688
    s_waitcnt lgkmcnt(4)
    v_mfma_f32_16x16x32_bf16 v[216:219], a[12:15], a[48:51], v[216:219]
    ds_read_b64_tr_b16 a[8:9], v18 offset:16640
    v_mfma_f32_16x16x32_bf16 v[220:223], a[12:15], a[52:55], v[220:223]
    ds_read_b64_tr_b16 a[10:11], v18 offset:18688
    v_mfma_f32_16x16x32_bf16 v[224:227], a[16:19], a[48:51], v[224:227]
    s_waitcnt vmcnt(14)
    s_barrier
    ds_read_b64_tr_b16 a[12:13], v11 offset:32768
    v_mfma_f32_16x16x32_bf16 v[228:231], a[16:19], a[52:55], v[228:231]
    ds_read_b64_tr_b16 a[14:15], v11 offset:34816
    s_waitcnt lgkmcnt(4)
    v_mfma_f32_16x16x32_bf16 v[232:235], a[0:3], a[48:51], v[232:235]
    ds_read_b64_tr_b16 a[16:17], v12 offset:32768
    s_add_u32 m0, s29, 49152
    v_mfma_f32_16x16x32_bf16 v[236:239], a[0:3], a[52:55], v[236:239]
    ds_read_b64_tr_b16 a[18:19], v12 offset:34816
    s_add_u32 s30, s71, 262144
    v_mfma_f32_16x16x32_bf16 v[240:243], a[4:7], a[48:51], v[240:243]
    ds_read_b64_tr_b16 a[0:1], v13 offset:32768
    buffer_load_dwordx4 v24, s[16:19], s30 offen offset:0  lds
    v_mfma_f32_16x16x32_bf16 v[244:247], a[4:7], a[52:55], v[244:247]
    ds_read_b64_tr_b16 a[2:3], v13 offset:34816
    s_waitcnt lgkmcnt(4)
    v_mfma_f32_16x16x32_bf16 v[248:251], a[8:11], a[48:51], v[248:251]
    ds_read_b64_tr_b16 a[4:5], v14 offset:32768
    s_add_u32 s30, s71, 277504
    v_mfma_f32_16x16x32_bf16 v[252:255], a[8:11], a[52:55], v[252:255]
    ds_read_b64_tr_b16 a[6:7], v14 offset:34816
    buffer_load_dwordx4 v25, s[16:19], s30 offen offset:1024  lds
    v_mfma_f32_16x16x32_bf16 v[128:131], a[12:15], a[56:59], v[128:131]
    ds_read_b64_tr_b16 a[8:9], v15 offset:32768
    s_add_u32 s30, s71, 292864
    v_mfma_f32_16x16x32_bf16 v[132:135], a[12:15], a[60:63], v[132:135]
    ds_read_b64_tr_b16 a[10:11], v15 offset:34816
    s_waitcnt lgkmcnt(4)
    v_mfma_f32_16x16x32_bf16 v[136:139], a[16:19], a[56:59], v[136:139]
    ds_read_b64_tr_b16 a[12:13], v16 offset:32768
    buffer_load_dwordx4 v24, s[16:19], s30 offen offset:2048  lds
    v_mfma_f32_16x16x32_bf16 v[140:143], a[16:19], a[60:63], v[140:143]
    ds_read_b64_tr_b16 a[14:15], v16 offset:34816
    s_add_u32 s30, s71, 308224
    v_mfma_f32_16x16x32_bf16 v[144:147], a[0:3], a[56:59], v[144:147]
    ds_read_b64_tr_b16 a[16:17], v17 offset:32768
    buffer_load_dwordx4 v25, s[16:19], s30 offen offset:3072  lds
    v_mfma_f32_16x16x32_bf16 v[148:151], a[0:3], a[60:63], v[148:151]
    ds_read_b64_tr_b16 a[18:19], v17 offset:34816
    s_waitcnt lgkmcnt(4)
    v_mfma_f32_16x16x32_bf16 v[152:155], a[4:7], a[56:59], v[152:155]
    ds_read_b64_tr_b16 a[0:1], v18 offset:32768
    v_mfma_f32_16x16x32_bf16 v[156:159], a[4:7], a[60:63], v[156:159]
    ds_read_b64_tr_b16 a[2:3], v18 offset:34816
    v_mfma_f32_16x16x32_bf16 v[160:163], a[8:11], a[56:59], v[160:163]
    ds_read_b64_tr_b16 a[4:5], v11 offset:33024
    v_mov_b32 v48, 0
    v_mov_b32 v49, 0
    v_mfma_f32_16x16x32_bf16 v[164:167], a[8:11], a[60:63], v[164:167]
    ds_read_b64_tr_b16 a[6:7], v11 offset:35072
    v_mov_b32 v50, 0
    s_waitcnt lgkmcnt(4)
    v_mfma_f32_16x16x32_bf16 v[168:171], a[12:15], a[56:59], v[168:171]
    ds_read_b64_tr_b16 a[8:9], v12 offset:33024
    v_mov_b32 v51, 0
    v_lshlrev_b32 v52, 4, v40
    v_mfma_f32_16x16x32_bf16 v[172:175], a[12:15], a[60:63], v[172:175]
    ds_read_b64_tr_b16 a[10:11], v12 offset:35072
    s_cmp_lg_u32 s37, 0
    s_cbranch_scc1 L_noclr
    buffer_store_dwordx4 v[48:51], v52, s[92:95], 0 offen offset:0 sc1
    buffer_store_dwordx4 v[48:51], v52, s[92:95], 0 offen offset:1024 sc1
    buffer_store_dwordx4 v[48:51], v52, s[92:95], 0 offen offset:2048 sc1
    buffer_store_dwordx4 v[48:51], v52, s[92:95], 0 offen offset:3072 sc1
    v_add_u32 v52, 4096, v52
    buffer_store_dwordx4 v[48:51], v52, s[92:95], 0 offen offset:0 sc1
    buffer_store_dwordx4 v[48:51], v52, s[92:95], 0 offen offset:1024 sc1
    buffer_store_dwordx4 v[48:51], v52, s[92:95], 0 offen offset:2048 sc1
    buffer_store_dwordx4 v[48:51], v52, s[92:95], 0 offen offset:3072 sc1
L_noclr:
    v_mfma_f32_16x16x32_bf16 v[176:179], a[16:19], a[56:59], v[176:179]
    ds_read_b64_tr_b16 a[12:13], v13 offset:33024
    v_mfma_f32_16x16x32_bf16 v[180:183], a[16:19], a[60:63], v[180:183]
    ds_read_b64_tr_b16 a[14:15], v13 offset:35072
    s_waitcnt lgkmcnt(4)
    v_mfma_f32_16x16x32_bf16 v[184:187], a[0:3], a[56:59], v[184:187]
    ds_read_b64_tr_b16 a[16:17], v14 offset:33024
    v_mfma_f32_16x16x32_bf16 v[188:191], a[0:3], a[60:63], v[188:191]
    ds_read_b64_tr_b16 a[18:19], v14 offset:35072
    v_mfma_f32_16x16x32_bf16 v[192:195], a[4:7], a[56:59], v[192:195]
    ds_read_b64_tr_b16 a[0:1], v15 offset:33024
    v_mfma_f32_16x16x32_bf16 v[196:199], a[4:7], a[60:63], v[196:199]
    ds_read_b64_tr_b16 a[2:3], v15 offset:35072
    s_waitcnt lgkmcnt(4)
    v_mfma_f32_16x16x32_bf16 v[200:203], a[8:11], a[56:59], v[200:203]
    ds_read_b64_tr_b16 a[4:5], v16 offset:33024
    v_mfma_f32_16x16x32_bf16 v[204:207], a[8:11], a[60:63], v[204:207]
    ds_read_b64_tr_b16 a[6:7], v16 offset:35072
    v_mfma_f32_16x16x32_bf16 v[208:211], a[12:15], a[56:59], v[208:211]
    ds_read_b64_tr_b16 a[8:9], v17 offset:33024
    v_mfma_f32_16x16x32_bf16 v[212:215], a[12:15], a[60:63], v[212:215]
    ds_read_b64_tr_b16 a[10:11], v17 offset:35072
    s_waitcnt lgkmcnt(4)
    v_mfma_f32_16x16x32_bf16 v[216:219], a[16:19], a[56:59], v[216:219]
    ds_read_b64_tr_b16 a[12:13], v18 offset:33024
    v_mfma_f32_16x16x32_bf16 v[220:223], a[16:19], a[60:63], v[220:223]
    ds_read_b64_tr_b16 a[14:15], v18 offset:35072
    v_mfma_f32_16x16x32_bf16 v[224:227], a[0:3], a[56:59], v[224:227]
    s_waitcnt vmcnt(8)
    s_barrier
    v_add_u32 v11, 0x10000, v11
    v_add_u32 v12, 0x10000, v12
    v_add_u32 v13, 0x10000, v13
    v_add_u32 v14, 0x10000, v14
    v_add_u32 v15, 0x10000, v15
    v_add_u32 v16, 0x10000, v16
    v_add_u32 v17, 0x10000, v17
    v_add_u32 v18, 0x10000, v18
    v_add_u32 v30, 81920, v28
    v_add_u32 v31, 81920, v29
    ds_read_b128 a[64:67], v30 offset:0
    ds_read_b128 a[68:71], v30 offset:2048
    ds_read_b128 a[72:75], v31 offset:0
    ds_read_b128 a[76:79], v31 offset:2048
    ds_read_b64_tr_b16 a[16:17], v11 offset:0
    v_mfma_f32_16x16x32_bf16 v[228:231], a[0:3], a[60:63], v[228:231]
    ds_read_b64_tr_b16 a[18:19], v11 offset:2048
    s_add_u32 m0, s29, 114688
    s_waitcnt lgkmcnt(8)
    v_mfma_f32_16x16x32_bf16 v[232:235], a[4:7], a[56:59], v[232:235]
    ds_read_b64_tr_b16 a[0:1], v12 offset:0
    s_add_u32 s30, s65, 0
    buffer_load_dwordx4 v26, s[4:7], s30 offen offset:0  lds
    v_mfma_f32_16x16x32_bf16 v[236:239], a[4:7], a[60:63], v[236:239]
    ds_read_b64_tr_b16 a[2:3], v12 offset:2048
    s_add_u32 s30, s65, 6144
    buffer_load_dwordx4 v27, s[4:7], s30 offen offset:1024  lds
    v_mfma_f32_16x16x32_bf16 v[240:243], a[8:11], a[56:59], v[240:243]
    ds_read_b64_tr_b16 a[4:5], v13 offset:0
    s_add_u32 s30, s65, 12288
    buffer_load_dwordx4 v26, s[4:7], s30 offen offset:2048  lds
    v_mfma_f32_16x16x32_bf16 v[244:247], a[8:11], a[60:63], v[244:247]
    ds_read_b64_tr_b16 a[6:7], v13 offset:2048
    s_add_u32 s30, s65, 18432
    s_waitcnt lgkmcnt(4)
    v_mfma_f32_16x16x32_bf16 v[248:251], a[12:15], a[56:59], v[248:251]
    ds_read_b64_tr_b16 a[8:9], v14 offset:0
    buffer_load_dwordx4 v27, s[4:7], s30 offen offset:3072  lds
    v_mfma_f32_16x16x32_bf16 v[252:255], a[12:15], a[60:63], v[252:255]
    ds_read_b64_tr_b16 a[10:11], v14 offset:2048
    s_add_u32 m0, s29, 147456
    s_add_u32 s30, s72, 0
    v_mfma_f32_16x16x32_bf16 v[128:131], a[16:19], a[64:67], v[128:131]
    ds_read_b64_tr_b16 a[12:13], v15 offset:0
    buffer_load_dwordx4 v24, s[16:19], s30 offen offset:0  lds
    v_mfma_f32_16x16x32_bf16 v[132:135], a[16:19], a[68:71], v[132:135]
    ds_read_b64_tr_b16 a[14:15], v15 offset:2048
    s_add_u32 s30, s72, 15360
    s_waitcnt lgkmcnt(4)
    v_mfma_f32_16x16x32_bf16 v[136:139], a[0:3], a[64:67], v[136:139]
    ds_read_b64_tr_b16 a[16:17], v16 offset:0
    buffer_load_dwordx4 v25, s[16:19], s30 offen offset:1024  lds
    v_mfma_f32_16x16x32_bf16 v[140:143], a[0:3], a[68:71], v[140:143]
    ds_read_b64_tr_b16 a[18:19], v16 offset:2048
    s_add_u32 s30, s72, 30720
    buffer_load_dwordx4 v24, s[16:19], s30 offen offset:2048  lds
    v_mfma_f32_16x16x32_bf16 v[144:147], a[4:7], a[64:67], v[144:147]
    ds_read_b64_tr_b16 a[0:1], v17 offset:0
    s_add_u32 s30, s72, 46080
    buffer_load_dwordx4 v25, s[16:19], s30 offen offset:3072  lds
    v_mfma_f32_16x16x32_bf16 v[148:151], a[4:7], a[68:71], v[148:151]
    ds_read_b64_tr_b16 a[2:3], v17 offset:2048
    s_add_u32 m0, s29, 16384
    s_waitcnt lgkmcnt(4)
    v_mfma_f32_16x16x32_bf16 v[152:155], a[8:11], a[64:67], v[152:155]
    ds_read_b64_tr_b16 a[4:5], v18 offset:0
    s_mov_b32 s30, 16384
    buffer_load_dwordx4 v19, s[8:11], s30 offen offset:0 nt lds
    v_mfma_f32_16x16x32_bf16 v[156:159], a[8:11], a[68:71], v[156:159]
    ds_read_b64_tr_b16 a[6:7], v18 offset:2048
    buffer_load_dwordx4 v20, s[8:11], s30 offen offset:1024 nt lds
    v_mfma_f32_16x16x32_bf16 v[160:163], a[12:15], a[64:67], v[160:163]
    ds_read_b64_tr_b16 a[8:9], v11 offset:256
    buffer_load_dwordx4 v19, s[8:11], s30 offen offset:2048 nt lds
    v_mfma_f32_16x16x32_bf16 v[164:167], a[12:15], a[68:71], v[164:167]
    ds_read_b64_tr_b16 a[10:11], v11 offset:2304
    buffer_load_dwordx4 v20, s[8:11], s30 offen offset:3072 nt lds
    s_waitcnt lgkmcnt(4)
    v_mfma_f32_16x16x32_bf16 v[168:171], a[16:19], a[64:67], v[168:171]
    ds_read_b64_tr_b16 a[12:13], v12 offset:256
    v_mfma_f32_16x16x32_bf16 v[172:175], a[16:19], a[68:71], v[172:175]
    ds_read_b64_tr_b16 a[14:15], v12 offset:2304
    v_mfma_f32_16x16x32_bf16 v[176:179], a[0:3], a[64:67], v[176:179]
    ds_read_b64_tr_b16 a[16:17], v13 offset:256
    v_mfma_f32_16x16x32_bf16 v[180:183], a[0:3], a[68:71], v[180:183]
    ds_read_b64_tr_b16 a[18:19], v13 offset:2304
    s_waitcnt lgkmcnt(4)
    v_mfma_f32_16x16x32_bf16 v[184:187], a[4:7], a[64:67], v[184:187]
    ds_read_b64_tr_b16 a[0:1], v14 offset:256
    v_mfma_f32_16x16x32_bf16 v[188:191], a[4:7], a[68:71], v[188:191]
    ds_read_b64_tr_b16 a[2:3], v14 offset:2304
    v_mfma_f32_16x16x32_bf16 v[192:195], a[8:11], a[64:67], v[192:195]
    ds_read_b64_tr_b16 a[4:5], v15 offset:256
    v_mfma_f32_16x16x32_bf16 v[196:199], a[8:11], a[68:71], v[196:199]
    ds_read_b64_tr_b16 a[6:7], v15 offset:2304
    s_waitcnt lgkmcnt(4)
    v_mfma_f32_16x16x32_bf16 v[200:203], a[12:15], a[64:67], v[200:203]
    ds_read_b64_tr_b16 a[8:9], v16 offset:256
    v_mfma_f32_16x16x32_bf16 v[204:207], a[12:15], a[68:71], v[204:207]
    ds_read_b64_tr_b16 a[10:11], v16 offset:2304
    v_mfma_f32_16x16x32_bf16 v[208:211], a[16:19], a[64:67], v[208:211]
    ds_read_b64_tr_b16 a[12:13], v17 offset:256
    v_mfma_f32_16x16x32_bf16 v[212:215], a[16:19], a[68:71], v[212:215]
    ds_read_b64_tr_b16 a[14:15], v17 offset:2304
    s_waitcnt lgkmcnt(4)
    v_mfma_f32_16x16x32_bf16 v[216:219], a[0:3], a[64:67], v[216:219]
    ds_read_b64_tr_b16 a[16:17], v18 offset:256
    v_mfma_f32_16x16x32_bf16 v[220:223], a[0:3], a[68:71], v[220:223]
    ds_read_b64_tr_b16 a[18:19], v18 offset:2304
    v_mfma_f32_16x16x32_bf16 v[224:227], a[4:7], a[64:67], v[224:227]
    s_waitcnt vmcnt(12)
    s_barrier
    v_add_u32 v11, 0xffffc000, v11
    v_add_u32 v12, 0xffffc000, v12
    v_add_u32 v13, 0xffffc000, v13
    v_add_u32 v14, 0xffffc000, v14
    v_add_u32 v15, 0xffffc000, v15
    v_add_u32 v16, 0xffffc000, v16
    v_add_u32 v17, 0xffffc000, v17
    v_add_u32 v18, 0xffffc000, v18
    ds_read_b64_tr_b16 a[0:1], v11 offset:0
    v_mfma_f32_16x16x32_bf16 v[228:231], a[4:7], a[68:71], v[228:231]
    ds_read_b64_tr_b16 a[2:3], v11 offset:2048
    s_waitcnt lgkmcnt(4)
    v_mfma_f32_16x16x32_bf16 v[232:235], a[8:11], a[64:67], v[232:235]
    ds_read_b64_tr_b16 a[4:5], v12 offset:0
    s_add_u32 m0, s29, 32768
    v_mfma_f32_16x16x32_bf16 v[236:239], a[8:11], a[68:71], v[236:239]
    ds_read_b64_tr_b16 a[6:7], v12 offset:2048
    s_add_u32 s30, s66, 0
    v_mfma_f32_16x16x32_bf16 v[240:243], a[12:15], a[64:67], v[240:243]
    ds_read_b64_tr_b16 a[8:9], v13 offset:0
    buffer_load_dwordx4 v26, s[4:7], s30 offen offset:0  lds
    v_mfma_f32_16x16x32_bf16 v[244:247], a[12:15], a[68:71], v[244:247]
    ds_read_b64_tr_b16 a[10:11], v13 offset:2048
    s_waitcnt lgkmcnt(4)
    v_mfma_f32_16x16x32_bf16 v[248:251], a[16:19], a[64:67], v[248:251]
    ds_read_b64_tr_b16 a[12:13], v14 offset:0
    s_add_u32 s30, s66, 6144
    v_mfma_f32_16x16x32_bf16 v[252:255], a[16:19], a[68:71], v[252:255]
    ds_read_b64_tr_b16 a[14:15], v14 offset:2048
    buffer_load_dwordx4 v27, s[4:7], s30 offen offset:1024  lds
    v_mfma_f32_16x16x32_bf16 v[128:131], a[0:3], a[72:75], v[128:131]
    ds_read_b64_tr_b16 a[16:17], v15 offset:0
    s_add_u32 s30, s66, 12288
    v_mfma_f32_16x16x32_bf16 v[132:135], a[0:3], a[76:79], v[132:135]
    ds_read_b64_tr_b16 a[18:19], v15 offset:2048
    s_waitcnt lgkmcnt(4)
    v_mfma_f32_16x16x32_bf16 v[136:139], a[4:7], a[72:75], v[136:139]
    ds_read_b64_tr_b16 a[0:1], v16 offset:0
    buffer_load_dwordx4 v26, s[4:7], s30 offen offset:2048  lds
    v_mfma_f32_16x16x32_bf16 v[140:143], a[4:7], a[76:79], v[140:143]
    ds_read_b64_tr_b16 a[2:3], v16 offset:2048
    s_add_u32 s30, s66, 18432
    v_mfma_f32_16x16x32_bf16 v[144:147], a[8:11], a[72:75], v[144:147]
    ds_read_b64_tr_b16 a[4:5], v17 offset:0
    buffer_load_dwordx4 v27, s[4:7], s30 offen offset:3072  lds
    v_mfma_f32_16x16x32_bf16 v[148:151], a[8:11], a[76:79], v[148:151]
    ds_read_b64_tr_b16 a[6:7], v17 offset:2048
    s_waitcnt lgkmcnt(4)
    v_mfma_f32_16x16x32_bf16 v[152:155], a[12:15], a[72:75], v[152:155]
    ds_read_b64_tr_b16 a[8:9], v18 offset:0
    s_add_u32 m0, s29, 98304
    v_mfma_f32_16x16x32_bf16 v[156:159], a[12:15], a[76:79], v[156:159]
    ds_read_b64_tr_b16 a[10:11], v18 offset:2048
    s_add_u32 s30, s72, 262144
    v_mfma_f32_16x16x32_bf16 v[160:163], a[16:19], a[72:75], v[160:163]
    ds_read_b64_tr_b16 a[12:13], v11 offset:256
    buffer_load_dwordx4 v24, s[16:19], s30 offen offset:0  lds
    v_mfma_f32_16x16x32_bf16 v[164:167], a[16:19], a[76:79], v[164:167]
    ds_read_b64_tr_b16 a[14:15], v11 offset:2304
    s_waitcnt lgkmcnt(4)
    v_mfma_f32_16x16x32_bf16 v[168:171], a[0:3], a[72:75], v[168:171]
    ds_read_b64_tr_b16 a[16:17], v12 offset:256
    s_add_u32 s30, s72, 277504
    v_mfma_f32_16x16x32_bf16 v[172:175], a[0:3], a[76:79], v[172:175]
    ds_read_b64_tr_b16 a[18:19], v12 offset:2304
    buffer_load_dwordx4 v25, s[16:19], s30 offen offset:1024  lds
    v_mfma_f32_16x16x32_bf16 v[176:179], a[4:7], a[72:75], v[176:179]
    ds_read_b64_tr_b16 a[0:1], v13 offset:256
    s_add_u32 s30, s72, 292864
    v_mfma_f32_16x16x32_bf16 v[180:183], a[4:7], a[76:79], v[180:183]
    ds_read_b64_tr_b16 a[2:3], v13 offset:2304
    s_waitcnt lgkmcnt(4)
    v_mfma_f32_16x16x32_bf16 v[184:187], a[8:11], a[72:75], v[184:187]
    ds_read_b64_tr_b16 a[4:5], v14 offset:256
    buffer_load_dwordx4 v24, s[16:19], s30 offen offset:2048  lds
    v_mfma_f32_16x16x32_bf16 v[188:191], a[8:11], a[76:79], v[188:191]
    ds_read_b64_tr_b16 a[6:7], v14 offset:2304
    s_add_u32 s30, s72, 308224
    v_mfma_f32_16x16x32_bf16 v[192:195], a[12:15], a[72:75], v[192:195]
    ds_read_b64_tr_b16 a[8:9], v15 offset:256
    buffer_load_dwordx4 v25, s[16:19], s30 offen offset:3072  lds
    v_mfma_f32_16x16x32_bf16 v[196:199], a[12:15], a[76:79], v[196:199]
    ds_read_b64_tr_b16 a[10:11], v15 offset:2304
    s_waitcnt lgkmcnt(4)
    v_mfma_f32_16x16x32_bf16 v[200:203], a[16:19], a[72:75], v[200:203]
    ds_read_b64_tr_b16 a[12:13], v16 offset:256
    v_mfma_f32_16x16x32_bf16 v[204:207], a[16:19], a[76:79], v[204:207]
    ds_read_b64_tr_b16 a[14:15], v16 offset:2304
    v_mfma_f32_16x16x32_bf16 v[208:211], a[0:3], a[72:75], v[208:211]
    ds_read_b64_tr_b16 a[16:17], v17 offset:256
    v_mfma_f32_16x16x32_bf16 v[212:215], a[0:3], a[76:79], v[212:215]
    ds_read_b64_tr_b16 a[18:19], v17 offset:2304
    s_waitcnt lgkmcnt(4)
    v_mfma_f32_16x16x32_bf16 v[216:219], a[4:7], a[72:75], v[216:219]
    ds_read_b64_tr_b16 a[0:1], v18 offset:256
    v_mfma_f32_16x16x32_bf16 v[220:223], a[4:7], a[76:79], v[220:223]
    ds_read_b64_tr_b16 a[2:3], v18 offset:2304
    v_mfma_f32_16x16x32_bf16 v[224:227], a[8:11], a[72:75], v[224:227]
    s_waitcnt vmcnt(12)
    s_barrier
    v_add_u32 v11, 0xc000, v11
    v_add_u32 v12, 0xc000, v12
    v_add_u32 v13, 0xc000, v13
    v_add_u32 v14, 0xc000, v14
    v_add_u32 v15, 0xc000, v15
    v_add_u32 v16, 0xc000, v16
    v_add_u32 v17, 0xc000, v17
    v_add_u32 v18, 0xc000, v18
    v_add_u32 v30, 114688, v28
    v_add_u32 v31, 114688, v29
    ds_read_b128 a[80:83], v30 offset:0
    ds_read_b128 a[84:87], v30 offset:2048
    ds_read_b128 a[88:91], v31 offset:0
    ds_read_b128 a[92:95], v31 offset:2048
    ds_read_b64_tr_b16 a[4:5], v11 offset:49152
    v_mfma_f32_16x16x32_bf16 v[228:231], a[8:11], a[76:79], v[228:231]
    ds_read_b64_tr_b16 a[6:7], v11 offset:51200
    s_waitcnt lgkmcnt(8)
    v_mfma_f32_16x16x32_bf16 v[232:235], a[12:15], a[72:75], v[232:235]
    ds_read_b64_tr_b16 a[8:9], v12 offset:49152
    s_add_u32 m0, s29, 81920
    v_mfma_f32_16x16x32_bf16 v[236:239], a[12:15], a[76:79], v[236:239]
    ds_read_b64_tr_b16 a[10:11], v12 offset:51200
    s_add_u32 s30, s67, 0
    v_mfma_f32_16x16x32_bf16 v[240:243], a[16:19], a[72:75], v[240:243]
    ds_read_b64_tr_b16 a[12:13], v13 offset:49152
    buffer_load_dwordx4 v26, s[4:7], s30 offen offset:0  lds
    v_mfma_f32_16x16x32_bf16 v[244:247], a[16:19], a[76:79], v[244:247]
    ds_read_b64_tr_b16 a[14:15], v13 offset:51200
    s_waitcnt lgkmcnt(4)
    v_mfma_f32_16x16x32_bf16 v[248:251], a[0:3], a[72:75], v[248:251]
    ds_read_b64_tr_b16 a[16:17], v14 offset:49152
    s_add_u32 s30, s67, 6144
    v_mfma_f32_16x16x32_bf16 v[252:255], a[0:3], a[76:79], v[252:255]
    ds_read_b64_tr_b16 a[18:19], v14 offset:51200
    buffer_load_dwordx4 v27, s[4:7], s30 offen offset:1024  lds
    v_mfma_f32_16x16x32_bf16 v[128:131], a[4:7], a[80:83], v[128:131]
    ds_read_b64_tr_b16 a[0:1], v15 offset:49152
    s_add_u32 s30, s67, 12288
    v_mfma_f32_16x16x32_bf16 v[132:135], a[4:7], a[84:87], v[132:135]
    ds_read_b64_tr_b16 a[2:3], v15 offset:51200
    s_waitcnt lgkmcnt(4)
    v_mfma_f32_16x16x32_bf16 v[136:139], a[8:11], a[80:83], v[136:139]
    ds_read_b64_tr_b16 a[4:5], v16 offset:49152
    buffer_load_dwordx4 v26, s[4:7], s30 offen offset:2048  lds
    v_mfma_f32_16x16x32_bf16 v[140:143], a[8:11], a[84:87], v[140:143]
    ds_read_b64_tr_b16 a[6:7], v16 offset:51200
    s_add_u32 s30, s67, 18432
    v_mfma_f32_16x16x32_bf16 v[144:147], a[12:15], a[80:83], v[144:147]
    ds_read_b64_tr_b16 a[8:9], v17 offset:49152
    buffer_load_dwordx4 v27, s[4:7], s30 offen offset:3072  lds
    v_mfma_f32_16x16x32_bf16 v[148:151], a[12:15], a[84:87], v[148:151]
    ds_read_b64_tr_b16 a[10:11], v17 offset:51200
    s_waitcnt lgkmcnt(4)
    v_mfma_f32_16x16x32_bf16 v[152:155], a[16:19], a[80:83], v[152:155]
    ds_read_b64_tr_b16 a[12:13], v18 offset:49152
    s_add_u32 m0, s29, 131072
    v_mfma_f32_16x16x32_bf16 v[156:159], a[16:19], a[84:87], v[156:159]
    ds_read_b64_tr_b16 a[14:15], v18 offset:51200
    s_add_u32 s30, s73, 0
    v_mfma_f32_16x16x32_bf16 v[160:163], a[0:3], a[80:83], v[160:163]
    ds_read_b64_tr_b16 a[16:17], v11 offset:49408
    buffer_load_dwordx4 v24, s[16:19], s30 offen offset:0  lds
    v_mfma_f32_16x16x32_bf16 v[164:167], a[0:3], a[84:87], v[164:167]
    ds_read_b64_tr_b16 a[18:19], v11 offset:51456
    s_waitcnt lgkmcnt(4)
    v_mfma_f32_16x16x32_bf16 v[168:171], a[4:7], a[80:83], v[168:171]
    ds_read_b64_tr_b16 a[0:1], v12 offset:49408
    s_add_u32 s30, s73, 15360
    v_mfma_f32_16x16x32_bf16 v[172:175], a[4:7], a[84:87], v[172:175]
    ds_read_b64_tr_b16 a[2:3], v12 offset:51456
    buffer_load_dwordx4 v25, s[16:19], s30 offen offset:1024  lds
    v_mfma_f32_16x16x32_bf16 v[176:179], a[8:11], a[80:83], v[176:179]
    ds_read_b64_tr_b16 a[4:5], v13 offset:49408
    s_add_u32 s30, s73, 30720
    v_mfma_f32_16x16x32_bf16 v[180:183], a[8:11], a[84:87], v[180:183]
    ds_read_b64_tr_b16 a[6:7], v13 offset:51456
    s_waitcnt lgkmcnt(4)
    v_mfma_f32_16x16x32_bf16 v[184:187], a[12:15], a[80:83], v[184:187]
    ds_read_b64_tr_b16 a[8:9], v14 offset:49408
    buffer_load_dwordx4 v24, s[16:19], s30 offen offset:2048  lds
    v_mfma_f32_16x16x32_bf16 v[188:191], a[12:15], a[84:87], v[188:191]
    ds_read_b64_tr_b16 a[10:11], v14 offset:51456
    s_add_u32 s30, s73, 46080
    v_mfma_f32_16x16x32_bf16 v[192:195], a[16:19], a[80:83], v[192:195]
    ds_read_b64_tr_b16 a[12:13], v15 offset:49408
    buffer_load_dwordx4 v25, s[16:19], s30 offen offset:3072  lds
    v_mfma_f32_16x16x32_bf16 v[196:199], a[16:19], a[84:87], v[196:199]
    ds_read_b64_tr_b16 a[14:15], v15 offset:51456
    s_waitcnt lgkmcnt(4)
    v_mfma_f32_16x16x32_bf16 v[200:203], a[0:3], a[80:83], v[200:203]
    ds_read_b64_tr_b16 a[16:17], v16 offset:49408
    s_add_u32 m0, s29, 65536
    v_mfma_f32_16x16x32_bf16 v[204:207], a[0:3], a[84:87], v[204:207]
    ds_read_b64_tr_b16 a[18:19], v16 offset:51456
    s_mov_b32 s30, 0
    v_mfma_f32_16x16x32_bf16 v[208:211], a[4:7], a[80:83], v[208:211]
    ds_read_b64_tr_b16 a[0:1], v17 offset:49408
    buffer_load_dwordx4 v21, s[12:15], s30 offen offset:0 nt lds
    v_mfma_f32_16x16x32_bf16 v[212:215], a[4:7], a[84:87], v[212:215]
    ds_read_b64_tr_b16 a[2:3], v17 offset:51456
    s_waitcnt lgkmcnt(4)
    v_mfma_f32_16x16x32_bf16 v[216:219], a[8:11], a[80:83], v[216:219]
    ds_read_b64_tr_b16 a[4:5], v18 offset:49408
    buffer_load_dwordx4 v22, s[12:15], s30 offen offset:1024 nt lds
    v_mfma_f32_16x16x32_bf16 v[220:223], a[8:11], a[84:87], v[220:223]
    ds_read_b64_tr_b16 a[6:7], v18 offset:51456
    buffer_load_dwordx4 v21, s[12:15], s30 offen offset:2048 nt lds
    v_mfma_f32_16x16x32_bf16 v[224:227], a[12:15], a[80:83], v[224:227]
    buffer_load_dwordx4 v22, s[12:15], s30 offen offset:3072 nt lds
    v_mfma_f32_16x16x32_bf16 v[228:231], a[12:15], a[84:87], v[228:231]
    s_waitcnt lgkmcnt(2)
    v_mfma_f32_16x16x32_bf16 v[232:235], a[16:19], a[80:83], v[232:235]
    v_mfma_f32_16x16x32_bf16 v[236:239], a[16:19], a[84:87], v[236:239]
    v_mfma_f32_16x16x32_bf16 v[240:243], a[0:3], a[80:83], v[240:243]
    v_mfma_f32_16x16x32_bf16 v[244:247], a[0:3], a[84:87], v[244:247]
    s_waitcnt lgkmcnt(0)
    v_mfma_f32_16x16x32_bf16 v[248:251], a[4:7], a[80:83], v[248:251]
    v_mfma_f32_16x16x32_bf16 v[252:255], a[4:7], a[84:87], v[252:255]
    s_waitcnt vmcnt(12)
    s_barrier
    v_add_u32 v30, 32768, v28
    v_add_u32 v31, 32768, v29
    ds_read_b128 a[96:99], v30 offset:0
    ds_read_b128 a[100:103], v30 offset:2048
    ds_read_b128 a[104:107], v31 offset:0
    ds_read_b128 a[108:111], v31 offset:2048
    ds_read_b64_tr_b16 a[8:9], v11 offset:0
    ds_read_b64_tr_b16 a[10:11], v11 offset:2048
    ds_read_b64_tr_b16 a[12:13], v12 offset:0
    ds_read_b64_tr_b16 a[14:15], v12 offset:2048
    ds_read_b64_tr_b16 a[16:17], v13 offset:0
    ds_read_b64_tr_b16 a[18:19], v13 offset:2048
    ds_read_b64_tr_b16 a[0:1], v14 offset:0
    ds_read_b64_tr_b16 a[2:3], v14 offset:2048
    s_waitcnt lgkmcnt(6)
    v_mfma_f32_16x16x32_bf16 v[128:131], a[8:11], a[88:91], v[128:131]
    ds_read_b64_tr_b16 a[4:5], v15 offset:0
    s_add_u32 m0, s29, 49152
    v_mfma_f32_16x16x32_bf16 v[132:135], a[8:11], a[92:95], v[132:135]
    ds_read_b64_tr_b16 a[6:7], v15 offset:2048
    s_waitcnt lgkmcnt(4)
    v_mfma_f32_16x16x32_bf16 v[136:139], a[12:15], a[88:91], v[136:139]
    ds_read_b64_tr_b16 a[8:9], v16 offset:0
    s_add_u32 s30, s68, 0
    v_mfma_f32_16x16x32_bf16 v[140:143], a[12:15], a[92:95], v[140:143]
    ds_read_b64_tr_b16 a[10:11], v16 offset:2048
    buffer_load_dwordx4 v26, s[4:7], s30 offen offset:0  lds
    v_mfma_f32_16x16x32_bf16 v[144:147], a[16:19], a[88:91], v[144:147]
    ds_read_b64_tr_b16 a[12:13], v17 offset:0
    s_add_u32 s30, s68, 6144
    v_mfma_f32_16x16x32_bf16 v[148:151], a[16:19], a[92:95], v[148:151]
    ds_read_b64_tr_b16 a[14:15], v17 offset:2048
    s_waitcnt lgkmcnt(4)
    v_mfma_f32_16x16x32_bf16 v[152:155], a[0:3], a[88:91], v[152:155]
    ds_read_b64_tr_b16 a[16:17], v18 offset:0
    buffer_load_dwordx4 v27, s[4:7], s30 offen offset:1024  lds
    v_mfma_f32_16x16x32_bf16 v[156:159], a[0:3], a[92:95], v[156:159]
    ds_read_b64_tr_b16 a[18:19], v18 offset:2048
    s_add_u32 s30, s68, 12288
    v_mfma_f32_16x16x32_bf16 v[160:163], a[4:7], a[88:91], v[160:163]
    ds_read_b64_tr_b16 a[0:1], v11 offset:256
    buffer_load_dwordx4 v26, s[4:7], s30 offen offset:2048  lds
    v_mfma_f32_16x16x32_bf16 v[164:167], a[4:7], a[92:95], v[164:167]
    ds_read_b64_tr_b16 a[2:3], v11 offset:2304
    s_waitcnt lgkmcnt(4)
    v_mfma_f32_16x16x32_bf16 v[168:171], a[8:11], a[88:91], v[168:171]
    ds_read_b64_tr_b16 a[4:5], v12 offset:256
    s_add_u32 s30, s68, 18432
    v_mfma_f32_16x16x32_bf16 v[172:175], a[8:11], a[92:95], v[172:175]
    ds_read_b64_tr_b16 a[6:7], v12 offset:2304
    buffer_load_dwordx4 v27, s[4:7], s30 offen offset:3072  lds
    v_mfma_f32_16x16x32_bf16 v[176:179], a[12:15], a[88:91], v[176:179]
    ds_read_b64_tr_b16 a[8:9], v13 offset:256
    s_add_u32 m0, s29, 114688
    v_mfma_f32_16x16x32_bf16 v[180:183], a[12:15], a[92:95], v[180:183]
    ds_read_b64_tr_b16 a[10:11], v13 offset:2304
    s_waitcnt lgkmcnt(4)
    v_mfma_f32_16x16x32_bf16 v[184:187], a[16:19], a[88:91], v[184:187]
    ds_read_b64_tr_b16 a[12:13], v14 offset:256
    s_add_u32 s30, s73, 262144
    v_mfma_f32_16x16x32_bf16 v[188:191], a[16:19], a[92:95], v[188:191]
    ds_read_b64_tr_b16 a[14:15], v14 offset:2304
    buffer_load_dwordx4 v24, s[16:19], s30 offen offset:0  lds
    v_mfma_f32_16x16x32_bf16 v[192:195], a[0:3], a[88:91], v[192:195]
    ds_read_b64_tr_b16 a[16:17], v15 offset:256
    s_add_u32 s30, s73, 277504
    v_mfma_f32_16x16x32_bf16 v[196:199], a[0:3], a[92:95], v[196:199]
    ds_read_b64_tr_b16 a[18:19], v15 offset:2304
    s_waitcnt lgkmcnt(4)
    v_mfma_f32_16x16x32_bf16 v[200:203], a[4:7], a[88:91], v[200:203]
    ds_read_b64_tr_b16 a[0:1], v16 offset:256
    buffer_load_dwordx4 v25, s[16:19], s30 offen offset:1024  lds
    v_mfma_f32_16x16x32_bf16 v[204:207], a[4:7], a[92:95], v[204:207]
    ds_read_b64_tr_b16 a[2:3], v16 offset:2304
    s_add_u32 s30, s73, 292864
    v_mfma_f32_16x16x32_bf16 v[208:211], a[8:11], a[88:91], v[208:211]
    ds_read_b64_tr_b16 a[4:5], v17 offset:256
    buffer_load_dwordx4 v24, s[16:19], s30 offen offset:2048  lds
    v_mfma_f32_16x16x32_bf16 v[212:215], a[8:11], a[92:95], v[212:215]
    ds_read_b64_tr_b16 a[6:7], v17 offset:2304
    s_waitcnt lgkmcnt(4)
    v_mfma_f32_16x16x32_bf16 v[216:219], a[12:15], a[88:91], v[216:219]
    ds_read_b64_tr_b16 a[8:9], v18 offset:256
    s_add_u32 s30, s73, 308224
    v_mfma_f32_16x16x32_bf16 v[220:223], a[12:15], a[92:95], v[220:223]
    ds_read_b64_tr_b16 a[10:11], v18 offset:2304
    buffer_load_dwordx4 v25, s[16:19], s30 offen offset:3072  lds
    v_mfma_f32_16x16x32_bf16 v[224:227], a[16:19], a[88:91], v[224:227]
    v_mfma_f32_16x16x32_bf16 v[228:231], a[16:19], a[92:95], v[228:231]
    s_waitcnt lgkmcnt(2)
    v_mfma_f32_16x16x32_bf16 v[232:235], a[0:3], a[88:91], v[232:235]
    v_mfma_f32_16x16x32_bf16 v[236:239], a[0:3], a[92:95], v[236:239]
    v_mfma_f32_16x16x32_bf16 v[240:243], a[4:7], a[88:91], v[240:243]
    v_mfma_f32_16x16x32_bf16 v[244:247], a[4:7], a[92:95], v[244:247]
    s_waitcnt lgkmcnt(0)
    v_mfma_f32_16x16x32_bf16 v[248:251], a[8:11], a[88:91], v[248:251]
    v_mfma_f32_16x16x32_bf16 v[252:255], a[8:11], a[92:95], v[252:255]
    s_waitcnt vmcnt(12)
    s_barrier
    v_add_u32 v30, 81920, v28
    v_add_u32 v31, 81920, v29
    ds_read_b128 a[112:115], v30 offset:0
    ds_read_b128 a[116:119], v30 offset:2048
    ds_read_b128 a[120:123], v31 offset:0
    ds_read_b128 a[124:127], v31 offset:2048
    ds_read_b64_tr_b16 a[12:13], v11 offset:32768
    ds_read_b64_tr_b16 a[14:15], v11 offset:34816
    ds_read_b64_tr_b16 a[16:17], v12 offset:32768
    ds_read_b64_tr_b16 a[18:19], v12 offset:34816
    ds_read_b64_tr_b16 a[0:1], v13 offset:32768
    ds_read_b64_tr_b16 a[2:3], v13 offset:34816
    ds_read_b64_tr_b16 a[4:5], v14 offset:32768
    ds_read_b64_tr_b16 a[6:7], v14 offset:34816
    s_waitcnt lgkmcnt(6)
    v_mfma_f32_16x16x32_bf16 v[128:131], a[12:15], a[96:99], v[128:131]
    ds_read_b64_tr_b16 a[8:9], v15 offset:32768
    s_add_u32 m0, s29, 98304
    v_mfma_f32_16x16x32_bf16 v[132:135], a[12:15], a[100:103], v[132:135]
    ds_read_b64_tr_b16 a[10:11], v15 offset:34816
    s_waitcnt lgkmcnt(4)
    v_mfma_f32_16x16x32_bf16 v[136:139], a[16:19], a[96:99], v[136:139]
    ds_read_b64_tr_b16 a[12:13], v16 offset:32768
    s_add_u32 s30, s74, 0
    v_mfma_f32_16x16x32_bf16 v[140:143], a[16:19], a[100:103], v[140:143]
    ds_read_b64_tr_b16 a[14:15], v16 offset:34816
    buffer_load_dwordx4 v24, s[16:19], s30 offen offset:0  lds
    v_mfma_f32_16x16x32_bf16 v[144:147], a[0:3], a[96:99], v[144:147]
    ds_read_b64_tr_b16 a[16:17], v17 offset:32768
    s_add_u32 s30, s74, 15360
    v_mfma_f32_16x16x32_bf16 v[148:151], a[0:3], a[100:103], v[148:151]
    ds_read_b64_tr_b16 a[18:19], v17 offset:34816
    s_waitcnt lgkmcnt(4)
    v_mfma_f32_16x16x32_bf16 v[152:155], a[4:7], a[96:99], v[152:155]
    ds_read_b64_tr_b16 a[0:1], v18 offset:32768
    buffer_load_dwordx4 v25, s[16:19], s30 offen offset:1024  lds
    v_mfma_f32_16x16x32_bf16 v[156:159], a[4:7], a[100:103], v[156:159]
    ds_read_b64_tr_b16 a[2:3], v18 offset:34816
    s_add_u32 s30, s74, 30720
    v_mfma_f32_16x16x32_bf16 v[160:163], a[8:11], a[96:99], v[160:163]
    ds_read_b64_tr_b16 a[4:5], v11 offset:33024
    buffer_load_dwordx4 v24, s[16:19], s30 offen offset:2048  lds
    v_mfma_f32_16x16x32_bf16 v[164:167], a[8:11], a[100:103], v[164:167]
    ds_read_b64_tr_b16 a[6:7], v11 offset:35072
    s_waitcnt lgkmcnt(4)
    v_mfma_f32_16x16x32_bf16 v[168:171], a[12:15], a[96:99], v[168:171]
    ds_read_b64_tr_b16 a[8:9], v12 offset:33024
    s_add_u32 s30, s74, 46080
    v_mfma_f32_16x16x32_bf16 v[172:175], a[12:15], a[100:103], v[172:175]
    ds_read_b64_tr_b16 a[10:11], v12 offset:35072
    buffer_load_dwordx4 v25, s[16:19], s30 offen offset:3072  lds
    v_mfma_f32_16x16x32_bf16 v[176:179], a[16:19], a[96:99], v[176:179]
    ds_read_b64_tr_b16 a[12:13], v13 offset:33024
    s_add_u32 m0, s29, 32768
    v_mfma_f32_16x16x32_bf16 v[180:183], a[16:19], a[100:103], v[180:183]
    ds_read_b64_tr_b16 a[14:15], v13 offset:35072
    s_waitcnt lgkmcnt(4)
    v_mfma_f32_16x16x32_bf16 v[184:187], a[0:3], a[96:99], v[184:187]
    ds_read_b64_tr_b16 a[16:17], v14 offset:33024
    s_mov_b32 s30, 32768
    v_mfma_f32_16x16x32_bf16 v[188:191], a[0:3], a[100:103], v[188:191]
    ds_read_b64_tr_b16 a[18:19], v14 offset:35072
    buffer_load_dwordx4 v19, s[8:11], s30 offen offset:0 nt lds
    v_mfma_f32_16x16x32_bf16 v[192:195], a[4:7], a[96:99], v[192:195]
    ds_read_b64_tr_b16 a[0:1], v15 offset:33024
    buffer_load_dwordx4 v20, s[8:11], s30 offen offset:1024 nt lds
    v_mfma_f32_16x16x32_bf16 v[196:199], a[4:7], a[100:103], v[196:199]
    ds_read_b64_tr_b16 a[2:3], v15 offset:35072
    s_waitcnt lgkmcnt(4)
    v_mfma_f32_16x16x32_bf16 v[200:203], a[8:11], a[96:99], v[200:203]
    ds_read_b64_tr_b16 a[4:5], v16 offset:33024
    buffer_load_dwordx4 v19, s[8:11], s30 offen offset:2048 nt lds
    v_mfma_f32_16x16x32_bf16 v[204:207], a[8:11], a[100:103], v[204:207]
    ds_read_b64_tr_b16 a[6:7], v16 offset:35072
    buffer_load_dwordx4 v20, s[8:11], s30 offen offset:3072 nt lds
    v_mfma_f32_16x16x32_bf16 v[208:211], a[12:15], a[96:99], v[208:211]
    ds_read_b64_tr_b16 a[8:9], v17 offset:33024
    v_mfma_f32_16x16x32_bf16 v[212:215], a[12:15], a[100:103], v[212:215]
    ds_read_b64_tr_b16 a[10:11], v17 offset:35072
    s_waitcnt lgkmcnt(4)
    v_mfma_f32_16x16x32_bf16 v[216:219], a[16:19], a[96:99], v[216:219]
    ds_read_b64_tr_b16 a[12:13], v18 offset:33024
    v_mfma_f32_16x16x32_bf16 v[220:223], a[16:19], a[100:103], v[220:223]
    ds_read_b64_tr_b16 a[14:15], v18 offset:35072
    v_mfma_f32_16x16x32_bf16 v[224:227], a[0:3], a[96:99], v[224:227]
    v_mfma_f32_16x16x32_bf16 v[228:231], a[0:3], a[100:103], v[228:231]
    s_waitcnt lgkmcnt(2)
    v_mfma_f32_16x16x32_bf16 v[232:235], a[4:7], a[96:99], v[232:235]
    v_mfma_f32_16x16x32_bf16 v[236:239], a[4:7], a[100:103], v[236:239]
    v_mfma_f32_16x16x32_bf16 v[240:243], a[8:11], a[96:99], v[240:243]
    v_mfma_f32_16x16x32_bf16 v[244:247], a[8:11], a[100:103], v[244:247]
    s_waitcnt lgkmcnt(0)
    v_mfma_f32_16x16x32_bf16 v[248:251], a[12:15], a[96:99], v[248:251]
    v_mfma_f32_16x16x32_bf16 v[252:255], a[12:15], a[100:103], v[252:255]
    s_waitcnt vmcnt(8)
    s_barrier
    v_add_u32 v30, 49152, v28
    v_add_u32 v31, 49152, v29
    ds_read_b128 a[128:131], v30 offset:0
    ds_read_b128 a[132:135], v30 offset:2048
    ds_read_b128 a[136:139], v31 offset:0
    ds_read_b128 a[140:143], v31 offset:2048
    ds_read_b64_tr_b16 a[16:17], v11 offset:16384
    ds_read_b64_tr_b16 a[18:19], v11 offset:18432
    ds_read_b64_tr_b16 a[0:1], v12 offset:16384
    ds_read_b64_tr_b16 a[2:3], v12 offset:18432
    ds_read_b64_tr_b16 a[4:5], v13 offset:16384
    ds_read_b64_tr_b16 a[6:7], v13 offset:18432
    ds_read_b64_tr_b16 a[8:9], v14 offset:16384
    ds_read_b64_tr_b16 a[10:11], v14 offset:18432
    s_waitcnt lgkmcnt(6)
    v_mfma_f32_16x16x32_bf16 v[128:131], a[16:19], a[104:107], v[128:131]
    ds_read_b64_tr_b16 a[12:13], v15 offset:16384
    s_add_u32 m0, s29, 131072
    v_mfma_f32_16x16x32_bf16 v[132:135], a[16:19], a[108:111], v[132:135]
    ds_read_b64_tr_b16 a[14:15], v15 offset:18432
    s_waitcnt lgkmcnt(4)
    v_mfma_f32_16x16x32_bf16 v[136:139], a[0:3], a[104:107], v[136:139]
    ds_read_b64_tr_b16 a[16:17], v16 offset:16384
    s_add_u32 s30, s74, 262144
    v_mfma_f32_16x16x32_bf16 v[140:143], a[0:3], a[108:111], v[140:143]
    ds_read_b64_tr_b16 a[18:19], v16 offset:18432
    buffer_load_dwordx4 v24, s[16:19], s30 offen offset:0  lds
    v_mfma_f32_16x16x32_bf16 v[144:147], a[4:7], a[104:107], v[144:147]
    ds_read_b64_tr_b16 a[0:1], v17 offset:16384
    s_add_u32 s30, s74, 277504
    v_mfma_f32_16x16x32_bf16 v[148:151], a[4:7], a[108:111], v[148:151]
    ds_read_b64_tr_b16 a[2:3], v17 offset:18432
    s_waitcnt lgkmcnt(4)
    v_mfma_f32_16x16x32_bf16 v[152:155], a[8:11], a[104:107], v[152:155]
    ds_read_b64_tr_b16 a[4:5], v18 offset:16384
    buffer_load_dwordx4 v25, s[16:19], s30 offen offset:1024  lds
    v_mfma_f32_16x16x32_bf16 v[156:159], a[8:11], a[108:111], v[156:159]
    ds_read_b64_tr_b16 a[6:7], v18 offset:18432
    s_add_u32 s30, s74, 292864
    v_mfma_f32_16x16x32_bf16 v[160:163], a[12:15], a[104:107], v[160:163]
    ds_read_b64_tr_b16 a[8:9], v11 offset:16640
    buffer_load_dwordx4 v24, s[16:19], s30 offen offset:2048  lds
    v_mfma_f32_16x16x32_bf16 v[164:167], a[12:15], a[108:111], v[164:167]
    ds_read_b64_tr_b16 a[10:11], v11 offset:18688
    s_waitcnt lgkmcnt(4)
    v_mfma_f32_16x16x32_bf16 v[168:171], a[16:19], a[104:107], v[168:171]
    ds_read_b64_tr_b16 a[12:13], v12 offset:16640
    s_add_u32 s30, s74, 308224
    v_mfma_f32_16x16x32_bf16 v[172:175], a[16:19], a[108:111], v[172:175]
    ds_read_b64_tr_b16 a[14:15], v12 offset:18688
    buffer_load_dwordx4 v25, s[16:19], s30 offen offset:3072  lds
    v_mfma_f32_16x16x32_bf16 v[176:179], a[0:3], a[104:107], v[176:179]
    ds_read_b64_tr_b16 a[16:17], v13 offset:16640
    s_add_u32 m0, s29, 81920
    v_mfma_f32_16x16x32_bf16 v[180:183], a[0:3], a[108:111], v[180:183]
    ds_read_b64_tr_b16 a[18:19], v13 offset:18688
    s_waitcnt lgkmcnt(4)
    v_mfma_f32_16x16x32_bf16 v[184:187], a[4:7], a[104:107], v[184:187]
    ds_read_b64_tr_b16 a[0:1], v14 offset:16640
    s_mov_b32 s30, 16384
    v_mfma_f32_16x16x32_bf16 v[188:191], a[4:7], a[108:111], v[188:191]
    ds_read_b64_tr_b16 a[2:3], v14 offset:18688
    buffer_load_dwordx4 v21, s[12:15], s30 offen offset:0 nt lds
    v_mfma_f32_16x16x32_bf16 v[192:195], a[8:11], a[104:107], v[192:195]
    ds_read_b64_tr_b16 a[4:5], v15 offset:16640
    buffer_load_dwordx4 v22, s[12:15], s30 offen offset:1024 nt lds
    v_mfma_f32_16x16x32_bf16 v[196:199], a[8:11], a[108:111], v[196:199]
    ds_read_b64_tr_b16 a[6:7], v15 offset:18688
    s_waitcnt lgkmcnt(4)
    v_mfma_f32_16x16x32_bf16 v[200:203], a[12:15], a[104:107], v[200:203]
    ds_read_b64_tr_b16 a[8:9], v16 offset:16640
    buffer_load_dwordx4 v21, s[12:15], s30 offen offset:2048 nt lds
    v_mfma_f32_16x16x32_bf16 v[204:207], a[12:15], a[108:111], v[204:207]
    ds_read_b64_tr_b16 a[10:11], v16 offset:18688
    buffer_load_dwordx4 v22, s[12:15], s30 offen offset:3072 nt lds
    v_mfma_f32_16x16x32_bf16 v[208:211], a[16:19], a[104:107], v[208:211]
    ds_read_b64_tr_b16 a[12:13], v17 offset:16640
    v_mfma_f32_16x16x32_bf16 v[212:215], a[16:19], a[108:111], v[212:215]
    ds_read_b64_tr_b16 a[14:15], v17 offset:18688
    s_waitcnt lgkmcnt(4)
    v_mfma_f32_16x16x32_bf16 v[216:219], a[0:3], a[104:107], v[216:219]
    ds_read_b64_tr_b16 a[16:17], v18 offset:16640
    v_mfma_f32_16x16x32_bf16 v[220:223], a[0:3], a[108:111], v[220:223]
    ds_read_b64_tr_b16 a[18:19], v18 offset:18688
    v_mfma_f32_16x16x32_bf16 v[224:227], a[4:7], a[104:107], v[224:227]
    v_mfma_f32_16x16x32_bf16 v[228:231], a[4:7], a[108:111], v[228:231]
    s_waitcnt lgkmcnt(2)
    v_mfma_f32_16x16x32_bf16 v[232:235], a[8:11], a[104:107], v[232:235]
    v_mfma_f32_16x16x32_bf16 v[236:239], a[8:11], a[108:111], v[236:239]
    v_mfma_f32_16x16x32_bf16 v[240:243], a[12:15], a[104:107], v[240:243]
    v_mfma_f32_16x16x32_bf16 v[244:247], a[12:15], a[108:111], v[244:247]
    s_waitcnt lgkmcnt(0)
    v_mfma_f32_16x16x32_bf16 v[248:251], a[16:19], a[104:107], v[248:251]
    v_mfma_f32_16x16x32_bf16 v[252:255], a[16:19], a[108:111], v[252:255]
    s_waitcnt vmcnt(12)
    s_barrier
    ds_read_b64_tr_b16 a[0:1], v11 offset:0
    ds_read_b64_tr_b16 a[2:3], v11 offset:2048
    ds_read_b64_tr_b16 a[4:5], v12 offset:0
    ds_read_b64_tr_b16 a[6:7], v12 offset:2048
    ds_read_b64_tr_b16 a[8:9], v13 offset:0
    ds_read_b64_tr_b16 a[10:11], v13 offset:2048
    ds_read_b64_tr_b16 a[12:13], v14 offset:0
    ds_read_b64_tr_b16 a[14:15], v14 offset:2048
    s_waitcnt lgkmcnt(6)
    v_mfma_f32_16x16x32_bf16 v[128:131], a[0:3], a[112:115], v[128:131]
    ds_read_b64_tr_b16 a[16:17], v15 offset:0
    s_add_u32 m0, s29, 114688
    v_mfma_f32_16x16x32_bf16 v[132:135], a[0:3], a[116:119], v[132:135]
    ds_read_b64_tr_b16 a[18:19], v15 offset:2048
    s_waitcnt lgkmcnt(4)
    v_mfma_f32_16x16x32_bf16 v[136:139], a[4:7], a[112:115], v[136:139]
    ds_read_b64_tr_b16 a[0:1], v16 offset:0
    s_add_u32 s30, s75, 0
    v_mfma_f32_16x16x32_bf16 v[140:143], a[4:7], a[116:119], v[140:143]
    ds_read_b64_tr_b16 a[2:3], v16 offset:2048
    buffer_load_dwordx4 v24, s[16:19], s30 offen offset:0  lds
    v_mfma_f32_16x16x32_bf16 v[144:147], a[8:11], a[112:115], v[144:147]
    ds_read_b64_tr_b16 a[4:5], v17 offset:0
    s_add_u32 s30, s75, 15360
    v_mfma_f32_16x16x32_bf16 v[148:151], a[8:11], a[116:119], v[148:151]
    ds_read_b64_tr_b16 a[6:7], v17 offset:2048
    s_waitcnt lgkmcnt(4)
    v_mfma_f32_16x16x32_bf16 v[152:155], a[12:15], a[112:115], v[152:155]
    ds_read_b64_tr_b16 a[8:9], v18 offset:0
    buffer_load_dwordx4 v25, s[16:19], s30 offen offset:1024  lds
    v_mfma_f32_16x16x32_bf16 v[156:159], a[12:15], a[116:119], v[156:159]
    ds_read_b64_tr_b16 a[10:11], v18 offset:2048
    s_add_u32 s30, s75, 30720
    v_mfma_f32_16x16x32_bf16 v[160:163], a[16:19], a[112:115], v[160:163]
    ds_read_b64_tr_b16 a[12:13], v11 offset:256
    buffer_load_dwordx4 v24, s[16:19], s30 offen offset:2048  lds
    v_mfma_f32_16x16x32_bf16 v[164:167], a[16:19], a[116:119], v[164:167]
    ds_read_b64_tr_b16 a[14:15], v11 offset:2304
    s_waitcnt lgkmcnt(4)
    v_mfma_f32_16x16x32_bf16 v[168:171], a[0:3], a[112:115], v[168:171]
    ds_read_b64_tr_b16 a[16:17], v12 offset:256
    s_add_u32 s30, s75, 46080
    v_mfma_f32_16x16x32_bf16 v[172:175], a[0:3], a[116:119], v[172:175]
    ds_read_b64_tr_b16 a[18:19], v12 offset:2304
    buffer_load_dwordx4 v25, s[16:19], s30 offen offset:3072  lds
    v_mfma_f32_16x16x32_bf16 v[176:179], a[4:7], a[112:115], v[176:179]
    ds_read_b64_tr_b16 a[0:1], v13 offset:256
    s_add_u32 m0, s29, 49152
    v_mfma_f32_16x16x32_bf16 v[180:183], a[4:7], a[116:119], v[180:183]
    ds_read_b64_tr_b16 a[2:3], v13 offset:2304
    s_waitcnt lgkmcnt(4)
    v_mfma_f32_16x16x32_bf16 v[184:187], a[8:11], a[112:115], v[184:187]
    ds_read_b64_tr_b16 a[4:5], v14 offset:256
    s_mov_b32 s30, 49152
    v_mfma_f32_16x16x32_bf16 v[188:191], a[8:11], a[116:119], v[188:191]
    ds_read_b64_tr_b16 a[6:7], v14 offset:2304
    buffer_load_dwordx4 v19, s[8:11], s30 offen offset:0 nt lds
    v_mfma_f32_16x16x32_bf16 v[192:195], a[12:15], a[112:115], v[192:195]
    ds_read_b64_tr_b16 a[8:9], v15 offset:256
    buffer_load_dwordx4 v20, s[8:11], s30 offen offset:1024 nt lds
    v_mfma_f32_16x16x32_bf16 v[196:199], a[12:15], a[116:119], v[196:199]
    ds_read_b64_tr_b16 a[10:11], v15 offset:2304
    s_waitcnt lgkmcnt(4)
    v_mfma_f32_16x16x32_bf16 v[200:203], a[16:19], a[112:115], v[200:203]
    ds_read_b64_tr_b16 a[12:13], v16 offset:256
    buffer_load_dwordx4 v19, s[8:11], s30 offen offset:2048 nt lds
    v_mfma_f32_16x16x32_bf16 v[204:207], a[16:19], a[116:119], v[204:207]
    ds_read_b64_tr_b16 a[14:15], v16 offset:2304
    buffer_load_dwordx4 v20, s[8:11], s30 offen offset:3072 nt lds
    v_mfma_f32_16x16x32_bf16 v[208:211], a[0:3], a[112:115], v[208:211]
    ds_read_b64_tr_b16 a[16:17], v17 offset:256
    v_mfma_f32_16x16x32_bf16 v[212:215], a[0:3], a[116:119], v[212:215]
    ds_read_b64_tr_b16 a[18:19], v17 offset:2304
    s_waitcnt lgkmcnt(4)
    v_mfma_f32_16x16x32_bf16 v[216:219], a[4:7], a[112:115], v[216:219]
    ds_read_b64_tr_b16 a[0:1], v18 offset:256
    v_mfma_f32_16x16x32_bf16 v[220:223], a[4:7], a[116:119], v[220:223]
    ds_read_b64_tr_b16 a[2:3], v18 offset:2304
    v_mfma_f32_16x16x32_bf16 v[224:227], a[8:11], a[112:115], v[224:227]
    v_mfma_f32_16x16x32_bf16 v[228:231], a[8:11], a[116:119], v[228:231]
    s_waitcnt lgkmcnt(2)
    v_mfma_f32_16x16x32_bf16 v[232:235], a[12:15], a[112:115], v[232:235]
    v_mfma_f32_16x16x32_bf16 v[236:239], a[12:15], a[116:119], v[236:239]
    v_mfma_f32_16x16x32_bf16 v[240:243], a[16:19], a[112:115], v[240:243]
    v_mfma_f32_16x16x32_bf16 v[244:247], a[16:19], a[116:119], v[244:247]
    s_waitcnt lgkmcnt(0)
    v_mfma_f32_16x16x32_bf16 v[248:251], a[0:3], a[112:115], v[248:251]
    v_mfma_f32_16x16x32_bf16 v[252:255], a[0:3], a[116:119], v[252:255]
    s_waitcnt vmcnt(12)
    s_barrier
    ds_read_b64_tr_b16 a[4:5], v11 offset:32768
    ds_read_b64_tr_b16 a[6:7], v11 offset:34816
    ds_read_b64_tr_b16 a[8:9], v12 offset:32768
    ds_read_b64_tr_b16 a[10:11], v12 offset:34816
    ds_read_b64_tr_b16 a[12:13], v13 offset:32768
    ds_read_b64_tr_b16 a[14:15], v13 offset:34816
    ds_read_b64_tr_b16 a[16:17], v14 offset:32768
    ds_read_b64_tr_b16 a[18:19], v14 offset:34816
    s_waitcnt lgkmcnt(6)
    v_mfma_f32_16x16x32_bf16 v[128:131], a[4:7], a[120:123], v[128:131]
    ds_read_b64_tr_b16 a[0:1], v15 offset:32768
    s_add_u32 m0, s29, 147456
    v_mfma_f32_16x16x32_bf16 v[132:135], a[4:7], a[124:127], v[132:135]
    ds_read_b64_tr_b16 a[2:3], v15 offset:34816
    s_waitcnt lgkmcnt(4)
    v_mfma_f32_16x16x32_bf16 v[136:139], a[8:11], a[120:123], v[136:139]
    ds_read_b64_tr_b16 a[4:5], v16 offset:32768
    s_add_u32 s30, s75, 262144
    v_mfma_f32_16x16x32_bf16 v[140:143], a[8:11], a[124:127], v[140:143]
    ds_read_b64_tr_b16 a[6:7], v16 offset:34816
    buffer_load_dwordx4 v24, s[16:19], s30 offen offset:0  lds
    v_mfma_f32_16x16x32_bf16 v[144:147], a[12:15], a[120:123], v[144:147]
    ds_read_b64_tr_b16 a[8:9], v17 offset:32768
    s_add_u32 s30, s75, 277504
    v_mfma_f32_16x16x32_bf16 v[148:151], a[12:15], a[124:127], v[148:151]
    ds_read_b64_tr_b16 a[10:11], v17 offset:34816
    s_waitcnt lgkmcnt(4)
    v_mfma_f32_16x16x32_bf16 v[152:155], a[16:19], a[120:123], v[152:155]
    ds_read_b64_tr_b16 a[12:13], v18 offset:32768
    buffer_load_dwordx4 v25, s[16:19], s30 offen offset:1024  lds
    v_mfma_f32_16x16x32_bf16 v[156:159], a[16:19], a[124:127], v[156:159]
    ds_read_b64_tr_b16 a[14:15], v18 offset:34816
    s_add_u32 s30, s75, 292864
    v_mfma_f32_16x16x32_bf16 v[160:163], a[0:3], a[120:123], v[160:163]
    ds_read_b64_tr_b16 a[16:17], v11 offset:33024
    buffer_load_dwordx4 v24, s[16:19], s30 offen offset:2048  lds
    v_mfma_f32_16x16x32_bf16 v[164:167], a[0:3], a[124:127], v[164:167]
    ds_read_b64_tr_b16 a[18:19], v11 offset:35072
    s_waitcnt lgkmcnt(4)
    v_mfma_f32_16x16x32_bf16 v[168:171], a[4:7], a[120:123], v[168:171]
    ds_read_b64_tr_b16 a[0:1], v12 offset:33024
    s_add_u32 s30, s75, 308224
    v_mfma_f32_16x16x32_bf16 v[172:175], a[4:7], a[124:127], v[172:175]
    ds_read_b64_tr_b16 a[2:3], v12 offset:35072
    buffer_load_dwordx4 v25, s[16:19], s30 offen offset:3072  lds
    v_mfma_f32_16x16x32_bf16 v[176:179], a[8:11], a[120:123], v[176:179]
    ds_read_b64_tr_b16 a[4:5], v13 offset:33024
    s_add_u32 m0, s29, 98304
    v_mfma_f32_16x16x32_bf16 v[180:183], a[8:11], a[124:127], v[180:183]
    ds_read_b64_tr_b16 a[6:7], v13 offset:35072
    s_waitcnt lgkmcnt(4)
    v_mfma_f32_16x16x32_bf16 v[184:187], a[12:15], a[120:123], v[184:187]
    ds_read_b64_tr_b16 a[8:9], v14 offset:33024
    s_mov_b32 s30, 32768
    v_mfma_f32_16x16x32_bf16 v[188:191], a[12:15], a[124:127], v[188:191]
    ds_read_b64_tr_b16 a[10:11], v14 offset:35072
    buffer_load_dwordx4 v21, s[12:15], s30 offen offset:0 nt lds
    v_mfma_f32_16x16x32_bf16 v[192:195], a[16:19], a[120:123], v[192:195]
    ds_read_b64_tr_b16 a[12:13], v15 offset:33024
    buffer_load_dwordx4 v22, s[12:15], s30 offen offset:1024 nt lds
    v_mfma_f32_16x16x32_bf16 v[196:199], a[16:19], a[124:127], v[196:199]
    ds_read_b64_tr_b16 a[14:15], v15 offset:35072
    s_waitcnt lgkmcnt(4)
    v_mfma_f32_16x16x32_bf16 v[200:203], a[0:3], a[120:123], v[200:203]
    ds_read_b64_tr_b16 a[16:17], v16 offset:33024
    buffer_load_dwordx4 v21, s[12:15], s30 offen offset:2048 nt lds
    v_mfma_f32_16x16x32_bf16 v[204:207], a[0:3], a[124:127], v[204:207]
    ds_read_b64_tr_b16 a[18:19], v16 offset:35072
    buffer_load_dwordx4 v22, s[12:15], s30 offen offset:3072 nt lds
    v_mfma_f32_16x16x32_bf16 v[208:211], a[4:7], a[120:123], v[208:211]
    ds_read_b64_tr_b16 a[0:1], v17 offset:33024
    v_mfma_f32_16x16x32_bf16 v[212:215], a[4:7], a[124:127], v[212:215]
    ds_read_b64_tr_b16 a[2:3], v17 offset:35072
    s_waitcnt lgkmcnt(4)
    v_mfma_f32_16x16x32_bf16 v[216:219], a[8:11], a[120:123], v[216:219]
    ds_read_b64_tr_b16 a[4:5], v18 offset:33024
    v_mfma_f32_16x16x32_bf16 v[220:223], a[8:11], a[124:127], v[220:223]
    ds_read_b64_tr_b16 a[6:7], v18 offset:35072
    v_mfma_f32_16x16x32_bf16 v[224:227], a[12:15], a[120:123], v[224:227]
    v_mfma_f32_16x16x32_bf16 v[228:231], a[12:15], a[124:127], v[228:231]
    s_waitcnt lgkmcnt(2)
    v_mfma_f32_16x16x32_bf16 v[232:235], a[16:19], a[120:123], v[232:235]
    v_mfma_f32_16x16x32_bf16 v[236:239], a[16:19], a[124:127], v[236:239]
    v_mfma_f32_16x16x32_bf16 v[240:243], a[0:3], a[120:123], v[240:243]
    v_mfma_f32_16x16x32_bf16 v[244:247], a[0:3], a[124:127], v[244:247]
    s_waitcnt lgkmcnt(0)
    v_mfma_f32_16x16x32_bf16 v[248:251], a[4:7], a[120:123], v[248:251]
    v_mfma_f32_16x16x32_bf16 v[252:255], a[4:7], a[124:127], v[252:255]
    s_waitcnt vmcnt(12)
    s_barrier
    ds_read_b64_tr_b16 a[8:9], v11 offset:16384
    ds_read_b64_tr_b16 a[10:11], v11 offset:18432
    ds_read_b64_tr_b16 a[12:13], v12 offset:16384
    ds_read_b64_tr_b16 a[14:15], v12 offset:18432
    ds_read_b64_tr_b16 a[16:17], v13 offset:16384
    ds_read_b64_tr_b16 a[18:19], v13 offset:18432
    ds_read_b64_tr_b16 a[0:1], v14 offset:16384
    ds_read_b64_tr_b16 a[2:3], v14 offset:18432
    s_waitcnt lgkmcnt(6)
    v_mfma_f32_16x16x32_bf16 v[128:131], a[8:11], a[128:131], v[128:131]
    ds_read_b64_tr_b16 a[4:5], v15 offset:16384
    s_add_u32 m0, s29, 131072
    v_mfma_f32_16x16x32_bf16 v[132:135], a[8:11], a[132:135], v[132:135]
    ds_read_b64_tr_b16 a[6:7], v15 offset:18432
    s_waitcnt lgkmcnt(4)
    v_mfma_f32_16x16x32_bf16 v[136:139], a[12:15], a[128:131], v[136:139]
    ds_read_b64_tr_b16 a[8:9], v16 offset:16384
    s_mov_b32 s30, 65536
    v_mfma_f32_16x16x32_bf16 v[140:143], a[12:15], a[132:135], v[140:143]
    ds_read_b64_tr_b16 a[10:11], v16 offset:18432
    buffer_load_dwordx4 v19, s[8:11], s30 offen offset:0 nt lds
    v_mfma_f32_16x16x32_bf16 v[144:147], a[16:19], a[128:131], v[144:147]
    ds_read_b64_tr_b16 a[12:13], v17 offset:16384
    buffer_load_dwordx4 v20, s[8:11], s30 offen offset:1024 nt lds
    v_mfma_f32_16x16x32_bf16 v[148:151], a[16:19], a[132:135], v[148:151]
    ds_read_b64_tr_b16 a[14:15], v17 offset:18432
    s_waitcnt lgkmcnt(4)
    v_mfma_f32_16x16x32_bf16 v[152:155], a[0:3], a[128:131], v[152:155]
    ds_read_b64_tr_b16 a[16:17], v18 offset:16384
    buffer_load_dwordx4 v19, s[8:11], s30 offen offset:2048 nt lds
    v_mfma_f32_16x16x32_bf16 v[156:159], a[0:3], a[132:135], v[156:159]
    ds_read_b64_tr_b16 a[18:19], v18 offset:18432
    buffer_load_dwordx4 v20, s[8:11], s30 offen offset:3072 nt lds
    v_mfma_f32_16x16x32_bf16 v[160:163], a[4:7], a[128:131], v[160:163]
    ds_read_b64_tr_b16 a[0:1], v11 offset:16640
    v_mfma_f32_16x16x32_bf16 v[164:167], a[4:7], a[132:135], v[164:167]
    ds_read_b64_tr_b16 a[2:3], v11 offset:18688
    s_waitcnt lgkmcnt(4)
    v_mfma_f32_16x16x32_bf16 v[168:171], a[8:11], a[128:131], v[168:171]
    ds_read_b64_tr_b16 a[4:5], v12 offset:16640
    v_mfma_f32_16x16x32_bf16 v[172:175], a[8:11], a[132:135], v[172:175]
    ds_read_b64_tr_b16 a[6:7], v12 offset:18688
    v_mfma_f32_16x16x32_bf16 v[176:179], a[12:15], a[128:131], v[176:179]
    ds_read_b64_tr_b16 a[8:9], v13 offset:16640
    v_mfma_f32_16x16x32_bf16 v[180:183], a[12:15], a[132:135], v[180:183]
    ds_read_b64_tr_b16 a[10:11], v13 offset:18688
    s_waitcnt lgkmcnt(4)
    v_mfma_f32_16x16x32_bf16 v[184:187], a[16:19], a[128:131], v[184:187]
    ds_read_b64_tr_b16 a[12:13], v14 offset:16640
    v_mfma_f32_16x16x32_bf16 v[188:191], a[16:19], a[132:135], v[188:191]
    ds_read_b64_tr_b16 a[14:15], v14 offset:18688
    v_mfma_f32_16x16x32_bf16 v[192:195], a[0:3], a[128:131], v[192:195]
    ds_read_b64_tr_b16 a[16:17], v15 offset:16640
    v_mfma_f32_16x16x32_bf16 v[196:199], a[0:3], a[132:135], v[196:199]
    ds_read_b64_tr_b16 a[18:19], v15 offset:18688
    s_waitcnt lgkmcnt(4)
    v_mfma_f32_16x16x32_bf16 v[200:203], a[4:7], a[128:131], v[200:203]
    ds_read_b64_tr_b16 a[0:1], v16 offset:16640
    v_mfma_f32_16x16x32_bf16 v[204:207], a[4:7], a[132:135], v[204:207]
    ds_read_b64_tr_b16 a[2:3], v16 offset:18688
    v_mfma_f32_16x16x32_bf16 v[208:211], a[8:11], a[128:131], v[208:211]
    ds_read_b64_tr_b16 a[4:5], v17 offset:16640
    v_mfma_f32_16x16x32_bf16 v[212:215], a[8:11], a[132:135], v[212:215]
    ds_read_b64_tr_b16 a[6:7], v17 offset:18688
    s_waitcnt lgkmcnt(4)
    v_mfma_f32_16x16x32_bf16 v[216:219], a[12:15], a[128:131], v[216:219]
    ds_read_b64_tr_b16 a[8:9], v18 offset:16640
    v_mfma_f32_16x16x32_bf16 v[220:223], a[12:15], a[132:135], v[220:223]
    ds_read_b64_tr_b16 a[10:11], v18 offset:18688
    v_mfma_f32_16x16x32_bf16 v[224:227], a[16:19], a[128:131], v[224:227]
    v_mfma_f32_16x16x32_bf16 v[228:231], a[16:19], a[132:135], v[228:231]
    s_waitcnt lgkmcnt(2)
    v_mfma_f32_16x16x32_bf16 v[232:235], a[0:3], a[128:131], v[232:235]
    v_mfma_f32_16x16x32_bf16 v[236:239], a[0:3], a[132:135], v[236:239]
    v_mfma_f32_16x16x32_bf16 v[240:243], a[4:7], a[128:131], v[240:243]
    v_mfma_f32_16x16x32_bf16 v[244:247], a[4:7], a[132:135], v[244:247]
    s_waitcnt lgkmcnt(0)
    v_mfma_f32_16x16x32_bf16 v[248:251], a[8:11], a[128:131], v[248:251]
    v_mfma_f32_16x16x32_bf16 v[252:255], a[8:11], a[132:135], v[252:255]
    s_waitcnt vmcnt(8)
    s_barrier
    ds_read_b64_tr_b16 a[12:13], v11 offset:49152
    ds_read_b64_tr_b16 a[14:15], v11 offset:51200
    ds_read_b64_tr_b16 a[16:17], v12 offset:49152
    ds_read_b64_tr_b16 a[18:19], v12 offset:51200
    ds_read_b64_tr_b16 a[0:1], v13 offset:49152
    ds_read_b64_tr_b16 a[2:3], v13 offset:51200
    ds_read_b64_tr_b16 a[4:5], v14 offset:49152
    ds_read_b64_tr_b16 a[6:7], v14 offset:51200
    s_waitcnt lgkmcnt(6)
    v_mfma_f32_16x16x32_bf16 v[128:131], a[12:15], a[136:139], v[128:131]
    ds_read_b64_tr_b16 a[8:9], v15 offset:49152
    s_add_u32 m0, s29, 114688
    v_mfma_f32_16x16x32_bf16 v[132:135], a[12:15], a[140:143], v[132:135]
    ds_read_b64_tr_b16 a[10:11], v15 offset:51200
    s_waitcnt lgkmcnt(4)
    v_mfma_f32_16x16x32_bf16 v[136:139], a[16:19], a[136:139], v[136:139]
    ds_read_b64_tr_b16 a[12:13], v16 offset:49152
    s_mov_b32 s30, 49152
    v_mfma_f32_16x16x32_bf16 v[140:143], a[16:19], a[140:143], v[140:143]
    ds_read_b64_tr_b16 a[14:15], v16 offset:51200
    buffer_load_dwordx4 v21, s[12:15], s30 offen offset:0 nt lds
    v_mfma_f32_16x16x32_bf16 v[144:147], a[0:3], a[136:139], v[144:147]
    ds_read_b64_tr_b16 a[16:17], v17 offset:49152
    buffer_load_dwordx4 v22, s[12:15], s30 offen offset:1024 nt lds
    v_mfma_f32_16x16x32_bf16 v[148:151], a[0:3], a[140:143], v[148:151]
    ds_read_b64_tr_b16 a[18:19], v17 offset:51200
    s_waitcnt lgkmcnt(4)
    v_mfma_f32_16x16x32_bf16 v[152:155], a[4:7], a[136:139], v[152:155]
    ds_read_b64_tr_b16 a[0:1], v18 offset:49152
    buffer_load_dwordx4 v21, s[12:15], s30 offen offset:2048 nt lds
    v_mfma_f32_16x16x32_bf16 v[156:159], a[4:7], a[140:143], v[156:159]
    ds_read_b64_tr_b16 a[2:3], v18 offset:51200
    buffer_load_dwordx4 v22, s[12:15], s30 offen offset:3072 nt lds
    v_mul_f32 v128, s32, v128
    v_mfma_f32_16x16x32_bf16 v[160:163], a[8:11], a[136:139], v[160:163]
    ds_read_b64_tr_b16 a[4:5], v11 offset:49408
    v_mul_f32 v129, s32, v129
    v_cvt_pk_bf16_f32 v64, v128, v129
    v_mfma_f32_16x16x32_bf16 v[164:167], a[8:11], a[140:143], v[164:167]
    ds_read_b64_tr_b16 a[6:7], v11 offset:51456
    v_mul_f32 v130, s32, v130
    s_waitcnt lgkmcnt(4)
    v_mfma_f32_16x16x32_bf16 v[168:171], a[12:15], a[136:139], v[168:171]
    ds_read_b64_tr_b16 a[8:9], v12 offset:49408
    v_mul_f32 v131, s32, v131
    v_cvt_pk_bf16_f32 v65, v130, v131
    v_mfma_f32_16x16x32_bf16 v[172:175], a[12:15], a[140:143], v[172:175]
    ds_read_b64_tr_b16 a[10:11], v12 offset:51456
    v_mul_f32 v136, s32, v136
    v_mul_f32 v137, s32, v137
    v_mul_f32 v144, s32, v144
    v_mfma_f32_16x16x32_bf16 v[176:179], a[16:19], a[136:139], v[176:179]
    ds_read_b64_tr_b16 a[12:13], v13 offset:49408
    v_cvt_pk_bf16_f32 v66, v136, v137
    v_mul_f32 v138, s32, v138
    v_mul_f32 v145, s32, v145
    v_mfma_f32_16x16x32_bf16 v[180:183], a[16:19], a[140:143], v[180:183]
    ds_read_b64_tr_b16 a[14:15], v13 offset:51456
    v_mul_f32 v139, s32, v139
    v_cvt_pk_bf16_f32 v72, v144, v145
    s_waitcnt lgkmcnt(4)
    v_mfma_f32_16x16x32_bf16 v[184:187], a[0:3], a[136:139], v[184:187]
    ds_read_b64_tr_b16 a[16:17], v14 offset:49408
    v_cvt_pk_bf16_f32 v67, v138, v139
    v_mul_f32 v132, s32, v132
    v_mul_f32 v146, s32, v146
    v_mfma_f32_16x16x32_bf16 v[188:191], a[0:3], a[140:143], v[188:191]
    ds_read_b64_tr_b16 a[18:19], v14 offset:51456
    v_mul_f32 v133, s32, v133
    v_cvt_pk_bf16_f32 v68, v132, v133
    v_mul_f32 v147, s32, v147
    v_mul_f32 v160, s32, v160
    v_mfma_f32_16x16x32_bf16 v[192:195], a[4:7], a[136:139], v[192:195]
    ds_read_b64_tr_b16 a[0:1], v15 offset:49408
    v_mul_f32 v134, s32, v134
    v_mul_f32 v135, s32, v135
    v_cvt_pk_bf16_f32 v73, v146, v147
    v_mul_f32 v161, s32, v161
    v_mfma_f32_16x16x32_bf16 v[196:199], a[4:7], a[140:143], v[196:199]
    ds_read_b64_tr_b16 a[2:3], v15 offset:51456
    v_cvt_pk_bf16_f32 v69, v134, v135
    v_mul_f32 v152, s32, v152
    v_cvt_pk_bf16_f32 v80, v160, v161
    s_waitcnt lgkmcnt(4)
    v_mfma_f32_16x16x32_bf16 v[200:203], a[8:11], a[136:139], v[200:203]
    ds_read_b64_tr_b16 a[4:5], v16 offset:49408
    v_mul_f32 v140, s32, v140
    v_mul_f32 v141, s32, v141
    v_mul_f32 v153, s32, v153
    v_mul_f32 v162, s32, v162
    v_mfma_f32_16x16x32_bf16 v[204:207], a[8:11], a[140:143], v[204:207]
    ds_read_b64_tr_b16 a[6:7], v16 offset:51456
    v_cvt_pk_bf16_f32 v70, v140, v141
    v_mul_f32 v142, s32, v142
    v_cvt_pk_bf16_f32 v74, v152, v153
    v_mul_f32 v163, s32, v163
    v_mfma_f32_16x16x32_bf16 v[208:211], a[12:15], a[136:139], v[208:211]
    ds_read_b64_tr_b16 a[8:9], v17 offset:49408
    v_mul_f32 v143, s32, v143
    v_cvt_pk_bf16_f32 v71, v142, v143
    v_mul_f32 v154, s32, v154
    v_cvt_pk_bf16_f32 v81, v162, v163
    v_mfma_f32_16x16x32_bf16 v[212:215], a[12:15], a[140:143], v[212:215]
    ds_read_b64_tr_b16 a[10:11], v17 offset:51456
    v_permlane32_swap_b32 v64, v66
    v_mul_f32 v155, s32, v155
    v_mul_f32 v168, s32, v168
    s_waitcnt lgkmcnt(4)
    v_mfma_f32_16x16x32_bf16 v[216:219], a[16:19], a[136:139], v[216:219]
    ds_read_b64_tr_b16 a[12:13], v18 offset:49408
    v_permlane32_swap_b32 v65, v67
    v_permlane32_swap_b32 v68, v70
    v_cvt_pk_bf16_f32 v75, v154, v155
    v_mul_f32 v169, s32, v169
    v_mfma_f32_16x16x32_bf16 v[220:223], a[16:19], a[140:143], v[220:223]
    ds_read_b64_tr_b16 a[14:15], v18 offset:51456
    v_permlane32_swap_b32 v69, v71
    v_permlane16_swap_b32 v64, v66
    v_mul_f32 v148, s32, v148
    v_cvt_pk_bf16_f32 v82, v168, v169
    v_mul_f32 v192, s32, v192
    v_mfma_f32_16x16x32_bf16 v[224:227], a[0:3], a[136:139], v[224:227]
    v_permlane16_swap_b32 v65, v67
    v_permlane16_swap_b32 v68, v70
    v_permlane16_swap_b32 v69, v71
    v_mul_f32 v149, s32, v149
    v_mul_f32 v170, s32, v170
    v_mul_f32 v193, s32, v193
    v_mfma_f32_16x16x32_bf16 v[228:231], a[0:3], a[140:143], v[228:231]
    v_cvt_pk_bf16_f32 v76, v148, v149
    v_mul_f32 v150, s32, v150
    v_mul_f32 v151, s32, v151
    v_mul_f32 v171, s32, v171
    v_cvt_pk_bf16_f32 v96, v192, v193
    s_waitcnt lgkmcnt(2)
    v_mfma_f32_16x16x32_bf16 v[232:235], a[4:7], a[136:139], v[232:235]
    v_cvt_pk_bf16_f32 v77, v150, v151
    v_mul_f32 v156, s32, v156
    v_mul_f32 v157, s32, v157
    v_cvt_pk_bf16_f32 v78, v156, v157
    v_cvt_pk_bf16_f32 v83, v170, v171
    v_mul_f32 v194, s32, v194
    v_mfma_f32_16x16x32_bf16 v[236:239], a[4:7], a[140:143], v[236:239]
    v_mul_f32 v158, s32, v158
    v_mul_f32 v159, s32, v159
    v_cvt_pk_bf16_f32 v79, v158, v159
    v_permlane32_swap_b32 v72, v74
    v_mul_f32 v164, s32, v164
    v_mul_f32 v195, s32, v195
    v_mul_f32 v208, s32, v208
    v_mfma_f32_16x16x32_bf16 v[240:243], a[8:11], a[136:139], v[240:243]
    v_permlane32_swap_b32 v73, v75
    v_permlane32_swap_b32 v76, v78
    v_permlane32_swap_b32 v77, v79
    v_permlane16_swap_b32 v72, v74
    v_mul_f32 v165, s32, v165
    v_cvt_pk_bf16_f32 v97, v194, v195
    v_mul_f32 v209, s32, v209
    v_mfma_f32_16x16x32_bf16 v[244:247], a[8:11], a[140:143], v[244:247]
    v_permlane16_swap_b32 v73, v75
    v_permlane16_swap_b32 v76, v78
    v_permlane16_swap_b32 v77, v79
    v_cvt_pk_bf16_f32 v84, v164, v165
    v_mul_f32 v200, s32, v200
    v_cvt_pk_bf16_f32 v104, v208, v209
    s_waitcnt lgkmcnt(0)
    v_mfma_f32_16x16x32_bf16 v[248:251], a[12:15], a[136:139], v[248:251]
    v_mul_f32 v166, s32, v166
    v_mul_f32 v167, s32, v167
    v_cvt_pk_bf16_f32 v85, v166, v167
    v_mul_f32 v172, s32, v172
    v_mul_f32 v173, s32, v173
    v_mul_f32 v201, s32, v201
    v_mul_f32 v210, s32, v210
    v_mfma_f32_16x16x32_bf16 v[252:255], a[12:15], a[140:143], v[252:255]
    v_cvt_pk_bf16_f32 v86, v172, v173
    v_mul_f32 v174, s32, v174
    v_mul_f32 v175, s32, v175
    v_cvt_pk_bf16_f32 v87, v174, v175
    v_cvt_pk_bf16_f32 v98, v200, v201
    v_mul_f32 v211, s32, v211
    s_barrier
    ds_read_b128 a[16:19], v7 offset:0
    ds_read_b128 a[0:3], v7 offset:2048
    ds_read_b128 a[4:7], v8 offset:0
    ds_read_b128 a[8:11], v8 offset:2048
    s_waitcnt lgkmcnt(3)
    v_mfma_f32_16x16x32_bf16 v[40:43], a[16:19], v[64:67], v[56:59]
    ds_read_b128 a[12:15], v9 offset:0
    s_add_u32 m0, s29, 147456
    v_permlane32_swap_b32 v80, v82
    v_permlane32_swap_b32 v81, v83
    v_permlane32_swap_b32 v84, v86
    v_mul_f32 v202, s32, v202
    v_cvt_pk_bf16_f32 v105, v210, v211
    v_mfma_f32_16x16x32_bf16 v[44:47], a[16:19], v[68:71], v[60:63]
    s_mov_b32 s30, 81920
    v_permlane32_swap_b32 v85, v87
    v_permlane16_swap_b32 v80, v82
    v_permlane16_swap_b32 v81, v83
    v_mul_f32 v203, s32, v203
    v_mul_f32 v216, s32, v216
    s_waitcnt lgkmcnt(2)
    v_mfma_f32_16x16x32_bf16 v[48:51], a[0:3], v[64:67], v[56:59]
    ds_read_b128 a[16:19], v9 offset:2048
    buffer_load_dwordx4 v19, s[8:11], s30 offen offset:0 nt lds
    v_permlane16_swap_b32 v84, v86
    v_permlane16_swap_b32 v85, v87
    v_mul_f32 v176, s32, v176
    v_cvt_pk_bf16_f32 v99, v202, v203
    v_mul_f32 v217, s32, v217
    v_mfma_f32_16x16x32_bf16 v[52:55], a[0:3], v[68:71], v[60:63]
    v_mul_f32 v177, s32, v177
    v_cvt_pk_bf16_f32 v88, v176, v177
    v_mul_f32 v178, s32, v178
    v_mul_f32 v179, s32, v179
    v_cvt_pk_bf16_f32 v89, v178, v179
    v_mul_f32 v196, s32, v196
    v_cvt_pk_bf16_f32 v106, v216, v217
    v_mfma_f32_16x16x32_bf16 v[40:43], a[4:7], v[72:75], v[40:43]
    ds_read_b128 a[0:3], v10 offset:0
    v_mul_f32 v184, s32, v184
    v_mul_f32 v185, s32, v185
    v_cvt_pk_bf16_f32 v90, v184, v185
    v_mul_f32 v186, s32, v186
    v_mul_f32 v197, s32, v197
    v_mul_f32 v218, s32, v218
    v_mfma_f32_16x16x32_bf16 v[44:47], a[4:7], v[76:79], v[44:47]
    v_mul_f32 v187, s32, v187
    v_cvt_pk_bf16_f32 v91, v186, v187
    v_mul_f32 v180, s32, v180
    v_mul_f32 v181, s32, v181
    v_cvt_pk_bf16_f32 v100, v196, v197
    v_mul_f32 v219, s32, v219
    s_waitcnt lgkmcnt(2)
    v_mfma_f32_16x16x32_bf16 v[48:51], a[8:11], v[72:75], v[48:51]
    ds_read_b128 a[4:7], v10 offset:2048
    v_cvt_pk_bf16_f32 v92, v180, v181
    v_mul_f32 v182, s32, v182
    v_mul_f32 v183, s32, v183
    v_cvt_pk_bf16_f32 v93, v182, v183
    v_mul_f32 v198, s32, v198
    v_cvt_pk_bf16_f32 v107, v218, v219
    v_mfma_f32_16x16x32_bf16 v[52:55], a[8:11], v[76:79], v[52:55]
    buffer_load_dwordx4 v20, s[8:11], s30 offen offset:1024 nt lds
    v_mul_f32 v188, s32, v188
    v_mul_f32 v189, s32, v189
    v_cvt_pk_bf16_f32 v94, v188, v189
    v_mul_f32 v190, s32, v190
    v_mul_f32 v199, s32, v199
    v_mul_f32 v212, s32, v212
    v_mfma_f32_16x16x32_bf16 v[40:43], a[12:15], v[80:83], v[40:43]
    ds_read_b128 a[8:11], v7 offset:256
    v_mul_f32 v191, s32, v191
    v_cvt_pk_bf16_f32 v95, v190, v191
    v_permlane32_swap_b32 v88, v90
    v_permlane32_swap_b32 v89, v91
    v_cvt_pk_bf16_f32 v101, v198, v199
    v_mul_f32 v213, s32, v213
    v_mfma_f32_16x16x32_bf16 v[44:47], a[12:15], v[84:87], v[44:47]
    v_permlane32_swap_b32 v92, v94
    v_permlane32_swap_b32 v93, v95
    v_permlane16_swap_b32 v88, v90
    v_permlane16_swap_b32 v89, v91
    v_mul_f32 v204, s32, v204
    v_cvt_pk_bf16_f32 v108, v212, v213
    s_waitcnt lgkmcnt(2)
    v_mfma_f32_16x16x32_bf16 v[48:51], a[16:19], v[80:83], v[48:51]
    ds_read_b128 a[12:15], v7 offset:2304
    v_permlane16_swap_b32 v92, v94
    v_permlane16_swap_b32 v93, v95
    v_mul_f32 v205, s32, v205
    v_cvt_pk_bf16_f32 v102, v204, v205
    v_mul_f32 v206, s32, v206
    v_mul_f32 v214, s32, v214
    v_mfma_f32_16x16x32_bf16 v[52:55], a[16:19], v[84:87], v[52:55]
    v_mul_f32 v207, s32, v207
    v_cvt_pk_bf16_f32 v103, v206, v207
    v_permlane32_swap_b32 v96, v98
    v_permlane32_swap_b32 v97, v99
    v_permlane32_swap_b32 v100, v102
    v_permlane32_swap_b32 v101, v103
    v_mul_f32 v215, s32, v215
    v_mfma_f32_16x16x32_bf16 v[40:43], a[0:3], v[88:91], v[40:43]
    ds_read_b128 a[16:19], v8 offset:256
    v_permlane16_swap_b32 v96, v98
    v_permlane16_swap_b32 v97, v99
    v_permlane16_swap_b32 v100, v102
    v_permlane16_swap_b32 v101, v103
    v_cvt_pk_bf16_f32 v109, v214, v215
    v_mul_f32 v220, s32, v220
    v_mfma_f32_16x16x32_bf16 v[44:47], a[0:3], v[92:95], v[44:47]
    v_mul_f32 v221, s32, v221
    v_cvt_pk_bf16_f32 v110, v220, v221
    v_mul_f32 v222, s32, v222
    v_mul_f32 v223, s32, v223
    v_cvt_pk_bf16_f32 v111, v222, v223
    v_permlane32_swap_b32 v104, v106
    s_waitcnt lgkmcnt(2)
    v_mfma_f32_16x16x32_bf16 v[48:51], a[4:7], v[88:91], v[48:51]
    ds_read_b128 a[0:3], v8 offset:2304
    buffer_load_dwordx4 v19, s[8:11], s30 offen offset:2048 nt lds
    v_permlane32_swap_b32 v105, v107
    v_permlane32_swap_b32 v108, v110
    v_permlane32_swap_b32 v109, v111
    v_permlane16_swap_b32 v104, v106
    v_permlane16_swap_b32 v105, v107
    v_mfma_f32_16x16x32_bf16 v[52:55], a[4:7], v[92:95], v[52:55]
    v_permlane16_swap_b32 v108, v110
    v_permlane16_swap_b32 v109, v111
    v_mul_f32 v224, s32, v224
    v_mul_f32 v225, s32, v225
    v_cvt_pk_bf16_f32 v112, v224, v225
    v_mul_f32 v226, s32, v226
    v_mul_f32 v240, s32, v240
    v_mfma_f32_16x16x32_bf16 v[40:43], a[8:11], v[96:99], v[40:43]
    ds_read_b128 a[4:7], v9 offset:256
    v_mul_f32 v227, s32, v227
    v_cvt_pk_bf16_f32 v113, v226, v227
    v_mul_f32 v232, s32, v232
    v_mul_f32 v233, s32, v233
    v_cvt_pk_bf16_f32 v114, v232, v233
    v_mul_f32 v241, s32, v241
    v_mfma_f32_16x16x32_bf16 v[44:47], a[8:11], v[100:103], v[44:47]
    v_mul_f32 v234, s32, v234
    v_mul_f32 v235, s32, v235
    v_cvt_pk_bf16_f32 v115, v234, v235
    v_mul_f32 v228, s32, v228
    v_mul_f32 v229, s32, v229
    v_cvt_pk_bf16_f32 v120, v240, v241
    s_waitcnt lgkmcnt(2)
    v_mfma_f32_16x16x32_bf16 v[48:51], a[12:15], v[96:99], v[48:51]
    ds_read_b128 a[8:11], v9 offset:2304
    v_cvt_pk_bf16_f32 v116, v228, v229
    v_mul_f32 v230, s32, v230
    v_mul_f32 v231, s32, v231
    v_cvt_pk_bf16_f32 v117, v230, v231
    v_mul_f32 v236, s32, v236
    v_mul_f32 v242, s32, v242
    v_mfma_f32_16x16x32_bf16 v[52:55], a[12:15], v[100:103], v[52:55]
    v_mul_f32 v237, s32, v237
    v_cvt_pk_bf16_f32 v118, v236, v237
    v_mul_f32 v238, s32, v238
    v_mul_f32 v239, s32, v239
    v_cvt_pk_bf16_f32 v119, v238, v239
    v_permlane32_swap_b32 v112, v114
    v_mul_f32 v243, s32, v243
    v_mfma_f32_16x16x32_bf16 v[40:43], a[16:19], v[104:107], v[40:43]
    ds_read_b128 a[12:15], v10 offset:256
    v_permlane32_swap_b32 v113, v115
    v_permlane32_swap_b32 v116, v118
    v_permlane32_swap_b32 v117, v119
    v_permlane16_swap_b32 v112, v114
    v_permlane16_swap_b32 v113, v115
    v_cvt_pk_bf16_f32 v121, v242, v243
    v_mfma_f32_16x16x32_bf16 v[44:47], a[16:19], v[108:111], v[44:47]
    buffer_load_dwordx4 v20, s[8:11], s30 offen offset:3072 nt lds
    v_permlane16_swap_b32 v116, v118
    v_permlane16_swap_b32 v117, v119
    v_mul_f32 v248, s32, v248
    v_mul_f32 v249, s32, v249
    v_cvt_pk_bf16_f32 v122, v248, v249
    s_waitcnt lgkmcnt(2)
    v_mfma_f32_16x16x32_bf16 v[48:51], a[0:3], v[104:107], v[48:51]
    ds_read_b128 a[16:19], v10 offset:2304
    v_mul_f32 v250, s32, v250
    v_mul_f32 v251, s32, v251
    v_cvt_pk_bf16_f32 v123, v250, v251
    v_mul_f32 v244, s32, v244
    v_mul_f32 v245, s32, v245
    v_cvt_pk_bf16_f32 v124, v244, v245
    v_mfma_f32_16x16x32_bf16 v[52:55], a[0:3], v[108:111], v[52:55]
    v_mul_f32 v246, s32, v246
    v_mul_f32 v247, s32, v247
    v_cvt_pk_bf16_f32 v125, v246, v247
    v_mul_f32 v252, s32, v252
    v_mul_f32 v253, s32, v253
    v_cvt_pk_bf16_f32 v126, v252, v253
    v_mul_f32 v254, s32, v254
    v_mfma_f32_16x16x32_bf16 v[40:43], a[4:7], v[112:115], v[40:43]
    v_mul_f32 v255, s32, v255
    v_cvt_pk_bf16_f32 v127, v254, v255
    v_permlane32_swap_b32 v120, v122
    v_permlane32_swap_b32 v121, v123
    v_permlane32_swap_b32 v124, v126
    v_permlane32_swap_b32 v125, v127
    v_permlane16_swap_b32 v120, v122
    v_mfma_f32_16x16x32_bf16 v[44:47], a[4:7], v[116:119], v[44:47]
    v_permlane16_swap_b32 v121, v123
    v_permlane16_swap_b32 v124, v126
    v_permlane16_swap_b32 v125, v127
    s_waitcnt lgkmcnt(1)
    v_mfma_f32_16x16x32_bf16 v[48:51], a[8:11], v[112:115], v[48:51]
    v_mfma_f32_16x16x32_bf16 v[52:55], a[8:11], v[116:119], v[52:55]
    v_mfma_f32_16x16x32_bf16 v[40:43], a[12:15], v[120:123], v[40:43]
    v_mfma_f32_16x16x32_bf16 v[44:47], a[12:15], v[124:127], v[44:47]
    s_waitcnt lgkmcnt(0)
    v_mfma_f32_16x16x32_bf16 v[48:51], a[16:19], v[120:123], v[48:51]
    v_mfma_f32_16x16x32_bf16 v[52:55], a[16:19], v[124:127], v[52:55]
    s_nop 7
    v_max3_f32 v0, v40, v41, v42
    v_max3_f32 v1, v43, v48, v49
    v_max3_f32 v0, v0, v50, v51
    v_max_f32 v0, v0, v1
    v_mov_b32 v1, v0
    s_nop 1
    v_permlane32_swap_b32 v0, v1
    v_max_f32 v0, v0, v1
    v_mov_b32 v1, v0
    s_nop 1
    v_permlane16_swap_b32 v0, v1
    v_max_f32 v0, v0, v1
    v_sub_f32 v40, v40, v0
    v_sub_f32 v41, v41, v0
    v_sub_f32 v42, v42, v0
    v_sub_f32 v43, v43, v0
    v_sub_f32 v48, v48, v0
    v_sub_f32 v49, v49, v0
    v_sub_f32 v50, v50, v0
    v_sub_f32 v51, v51, v0
    v_sub_f32 v56, v56, v0
    v_sub_f32 v57, v57, v0
    v_sub_f32 v58, v58, v0
    v_sub_f32 v59, v59, v0
    v_max3_f32 v0, v44, v45, v46
    v_max3_f32 v1, v47, v52, v53
    v_max3_f32 v0, v0, v54, v55
    v_max_f32 v0, v0, v1
    v_mov_b32 v1, v0
    s_nop 1
    v_permlane32_swap_b32 v0, v1
    v_max_f32 v0, v0, v1
    v_mov_b32 v1, v0
    s_nop 1
    v_permlane16_swap_b32 v0, v1
    v_max_f32 v0, v0, v1
    v_sub_f32 v44, v44, v0
    v_sub_f32 v45, v45, v0
    v_sub_f32 v46, v46, v0
    v_sub_f32 v47, v47, v0
    v_sub_f32 v52, v52, v0
    v_sub_f32 v53, v53, v0
    v_sub_f32 v54, v54, v0
    v_sub_f32 v55, v55, v0
    v_sub_f32 v60, v60, v0
    v_sub_f32 v61, v61, v0
    v_sub_f32 v62, v62, v0
    v_sub_f32 v63, v63, v0
    v_exp_f32 v40, v40
    v_exp_f32 v41, v41
    v_exp_f32 v42, v42
    v_exp_f32 v43, v43
    v_cvt_pk_bf16_f32 v24, v40, v41
    v_exp_f32 v44, v44
    v_exp_f32 v45, v45
    v_cvt_pk_bf16_f32 v25, v42, v43
    v_exp_f32 v46, v46
    v_exp_f32 v47, v47
    v_cvt_pk_bf16_f32 v28, v44, v45
    s_nop 0
    v_cvt_pk_bf16_f32 v29, v46, v47
    s_barrier
    ds_read_b128 a[0:3], v7 offset:16384
    ds_read_b128 a[4:7], v8 offset:16384
    ds_read_b128 a[8:11], v9 offset:16384
    ds_read_b128 a[12:15], v10 offset:16384
    s_waitcnt lgkmcnt(3)
    v_mfma_f32_16x16x32_bf16 v[40:43], a[0:3], v[64:67], v[56:59]
    ds_read_b128 a[16:19], v7 offset:16640
    s_add_u32 m0, s29, 0
    v_mfma_f32_16x16x32_bf16 v[44:47], a[0:3], v[68:71], v[60:63]
    s_mov_b32 s30, 65536
    s_waitcnt lgkmcnt(2)
    v_mfma_f32_16x16x32_bf16 v[40:43], a[4:7], v[72:75], v[40:43]
    ds_read_b128 a[0:3], v8 offset:16640
    buffer_load_dwordx4 v21, s[12:15], s30 offen offset:0 nt lds
    v_mfma_f32_16x16x32_bf16 v[44:47], a[4:7], v[76:79], v[44:47]
    v_exp_f32 v48, v48
    v_mfma_f32_16x16x32_bf16 v[40:43], a[8:11], v[80:83], v[40:43]
    ds_read_b128 a[4:7], v9 offset:16640
    v_exp_f32 v49, v49
    v_mfma_f32_16x16x32_bf16 v[44:47], a[8:11], v[84:87], v[44:47]
    v_exp_f32 v50, v50
    s_waitcnt lgkmcnt(2)
    v_mfma_f32_16x16x32_bf16 v[40:43], a[12:15], v[88:91], v[40:43]
    ds_read_b128 a[8:11], v10 offset:16640
    v_exp_f32 v51, v51
    v_mfma_f32_16x16x32_bf16 v[44:47], a[12:15], v[92:95], v[44:47]
    v_cvt_pk_bf16_f32 v26, v48, v49
    v_exp_f32 v52, v52
    v_mfma_f32_16x16x32_bf16 v[40:43], a[16:19], v[96:99], v[40:43]
    ds_read_b128 a[12:15], v7 offset:18432
    v_exp_f32 v53, v53
    v_mfma_f32_16x16x32_bf16 v[44:47], a[16:19], v[100:103], v[44:47]
    v_cvt_pk_bf16_f32 v27, v50, v51
    s_waitcnt lgkmcnt(2)
    v_mfma_f32_16x16x32_bf16 v[40:43], a[0:3], v[104:107], v[40:43]
    ds_read_b128 a[16:19], v8 offset:18432
    v_exp_f32 v54, v54
    v_mfma_f32_16x16x32_bf16 v[44:47], a[0:3], v[108:111], v[44:47]
    v_exp_f32 v55, v55
    v_cvt_pk_bf16_f32 v30, v52, v53
    v_mfma_f32_16x16x32_bf16 v[40:43], a[4:7], v[112:115], v[40:43]
    ds_read_b128 a[0:3], v9 offset:18432
    s_nop 0
    v_cvt_pk_bf16_f32 v31, v54, v55
    v_mfma_f32_16x16x32_bf16 v[44:47], a[4:7], v[116:119], v[44:47]
    v_mbcnt_lo_u32_b32 v0, -1, 0
    s_waitcnt lgkmcnt(2)
    v_mfma_f32_16x16x32_bf16 v[40:43], a[8:11], v[120:123], v[40:43]
    ds_read_b128 a[4:7], v10 offset:18432
    v_mbcnt_hi_u32_b32 v0, -1, v0
    v_mfma_f32_16x16x32_bf16 v[44:47], a[8:11], v[124:127], v[44:47]
    buffer_load_dwordx4 v22, s[12:15], s30 offen offset:1024 nt lds
    v_lshlrev_b32 v0, 2, v0
    v_mfma_f32_16x16x32_bf16 v[48:51], a[12:15], v[64:67], v[56:59]
    ds_read_b128 a[8:11], v7 offset:18688
    v_mov_b32 v1, 1
    v_mfma_f32_16x16x32_bf16 v[52:55], a[12:15], v[68:71], v[60:63]
    buffer_store_dword v1, v0, s[96:99], s37 offen sc1
    s_waitcnt lgkmcnt(2)
    v_mfma_f32_16x16x32_bf16 v[48:51], a[16:19], v[72:75], v[48:51]
    ds_read_b128 a[12:15], v8 offset:18688
    v_mfma_f32_16x16x32_bf16 v[52:55], a[16:19], v[76:79], v[52:55]
    v_mfma_f32_16x16x32_bf16 v[48:51], a[0:3], v[80:83], v[48:51]
    ds_read_b128 a[16:19], v9 offset:18688
    v_mfma_f32_16x16x32_bf16 v[52:55], a[0:3], v[84:87], v[52:55]
    s_waitcnt lgkmcnt(2)
    v_mfma_f32_16x16x32_bf16 v[48:51], a[4:7], v[88:91], v[48:51]
    ds_read_b128 a[0:3], v10 offset:18688
    v_max3_f32 v0, v40, v41, v42
    v_mfma_f32_16x16x32_bf16 v[52:55], a[4:7], v[92:95], v[52:55]
    v_max3_f32 v1, v43, v44, v45
    v_max3_f32 v0, v0, v46, v47
    v_mfma_f32_16x16x32_bf16 v[48:51], a[8:11], v[96:99], v[48:51]
    v_mfma_f32_16x16x32_bf16 v[52:55], a[8:11], v[100:103], v[52:55]
    s_waitcnt lgkmcnt(1)
    v_mfma_f32_16x16x32_bf16 v[48:51], a[12:15], v[104:107], v[48:51]
    v_mfma_f32_16x16x32_bf16 v[52:55], a[12:15], v[108:111], v[52:55]
    v_mfma_f32_16x16x32_bf16 v[48:51], a[16:19], v[112:115], v[48:51]
    v_mfma_f32_16x16x32_bf16 v[52:55], a[16:19], v[116:119], v[52:55]
    s_waitcnt lgkmcnt(0)
    v_mfma_f32_16x16x32_bf16 v[48:51], a[0:3], v[120:123], v[48:51]
    v_mfma_f32_16x16x32_bf16 v[52:55], a[0:3], v[124:127], v[52:55]
    s_barrier
    v_add_u32 v11, 0xffff8000, v11
    v_add_u32 v12, 0xffff8000, v12
    v_add_u32 v13, 0xffff8000, v13
    v_add_u32 v14, 0xffff8000, v14
    v_add_u32 v15, 0xffff8000, v15
    v_add_u32 v16, 0xffff8000, v16
    v_add_u32 v17, 0xffff8000, v17
    v_add_u32 v18, 0xffff8000, v18
    ds_read_b64_tr_b16 a[4:5], v11 offset:0
    ds_read_b64_tr_b16 a[6:7], v11 offset:2048
    ds_read_b64_tr_b16 a[8:9], v12 offset:0
    ds_read_b64_tr_b16 a[10:11], v12 offset:2048
    ds_read_b64_tr_b16 a[12:13], v13 offset:0
    ds_read_b64_tr_b16 a[14:15], v13 offset:2048
    s_waitcnt lgkmcnt(4)
    v_mfma_f32_16x16x32_bf16 v[128:131], a[4:7], v[24:27], 0
    ds_read_b64_tr_b16 a[16:17], v14 offset:0
    buffer_load_dwordx4 v21, s[12:15], s30 offen offset:2048 nt lds
    v_mfma_f32_16x16x32_bf16 v[132:135], a[4:7], v[28:31], 0
    ds_read_b64_tr_b16 a[18:19], v14 offset:2048
    s_waitcnt lgkmcnt(4)
    v_mfma_f32_16x16x32_bf16 v[136:139], a[8:11], v[24:27], 0
    ds_read_b64_tr_b16 a[0:1], v15 offset:0
    v_mfma_f32_16x16x32_bf16 v[140:143], a[8:11], v[28:31], 0
    ds_read_b64_tr_b16 a[2:3], v15 offset:2048
    v_max3_f32 v1, v1, v48, v49
    v_max3_f32 v0, v0, v50, v51
    v_mfma_f32_16x16x32_bf16 a[20:23], a[28:31], v[24:27], 0
    ds_read_b64_tr_b16 a[4:5], v16 offset:0
    v_max3_f32 v1, v1, v52, v53
    v_max3_f32 v0, v0, v54, v55
    v_mfma_f32_16x16x32_bf16 a[24:27], a[28:31], v[28:31], 0
    ds_read_b64_tr_b16 a[6:7], v16 offset:2048
    v_max_f32 v0, v0, v1
    s_waitcnt lgkmcnt(4)
    v_mfma_f32_16x16x32_bf16 v[144:147], a[12:15], v[24:27], 0
    ds_read_b64_tr_b16 a[8:9], v17 offset:0
    buffer_load_dwordx4 v22, s[12:15], s30 offen offset:3072 nt lds
    v_cmp_lt_f32 vcc, s31, v0
    v_mfma_f32_16x16x32_bf16 v[148:151], a[12:15], v[28:31], 0
    ds_read_b64_tr_b16 a[10:11], v17 offset:2048
    s_cbranch_vccnz L_up_0
L_upb_0:
    v_mfma_f32_16x16x32_bf16 v[152:155], a[16:19], v[24:27], 0
    ds_read_b64_tr_b16 a[12:13], v18 offset:0
    v_exp_f32 v40, v40
    v_mfma_f32_16x16x32_bf16 v[156:159], a[16:19], v[28:31], 0
    ds_read_b64_tr_b16 a[14:15], v18 offset:2048
    s_waitcnt lgkmcnt(4)
    v_mfma_f32_16x16x32_bf16 v[160:163], a[0:3], v[24:27], 0
    ds_read_b64_tr_b16 a[16:17], v11 offset:256
    s_add_u32 m0, s29, 16384
    v_mfma_f32_16x16x32_bf16 v[164:167], a[0:3], v[28:31], 0
    ds_read_b64_tr_b16 a[18:19], v11 offset:2304
    s_add_u32 s30, s76, 0
    v_mfma_f32_16x16x32_bf16 v[168:171], a[4:7], v[24:27], 0
    ds_read_b64_tr_b16 a[0:1], v12 offset:256
    buffer_load_dwordx4 v23, s[20:23], s30 offen offset:0  lds
    v_mfma_f32_16x16x32_bf16 v[172:175], a[4:7], v[28:31], 0
    ds_read_b64_tr_b16 a[2:3], v12 offset:2304
    s_waitcnt lgkmcnt(4)
    v_mfma_f32_16x16x32_bf16 v[176:179], a[8:11], v[24:27], 0
    ds_read_b64_tr_b16 a[4:5], v13 offset:256
    v_exp_f32 v41, v41
    v_mfma_f32_16x16x32_bf16 v[180:183], a[8:11], v[28:31], 0
    ds_read_b64_tr_b16 a[6:7], v13 offset:2304
    s_add_u32 s30, s76, 6144
    v_mfma_f32_16x16x32_bf16 v[184:187], a[12:15], v[24:27], 0
    ds_read_b64_tr_b16 a[8:9], v14 offset:256
    buffer_load_dwordx4 v23, s[20:23], s30 offen offset:1024  lds
    v_mfma_f32_16x16x32_bf16 v[188:191], a[12:15], v[28:31], 0
    ds_read_b64_tr_b16 a[10:11], v14 offset:2304
    s_waitcnt lgkmcnt(4)
    v_mfma_f32_16x16x32_bf16 v[192:195], a[16:19], v[24:27], 0
    ds_read_b64_tr_b16 a[12:13], v15 offset:256
    v_exp_f32 v42, v42
    v_mfma_f32_16x16x32_bf16 v[196:199], a[16:19], v[28:31], 0
    ds_read_b64_tr_b16 a[14:15], v15 offset:2304
    v_exp_f32 v43, v43
    v_mfma_f32_16x16x32_bf16 v[200:203], a[0:3], v[24:27], 0
    ds_read_b64_tr_b16 a[16:17], v16 offset:256
    s_add_u32 s30, s76, 12288
    v_cvt_pk_bf16_f32 v32, v40, v41
    v_mfma_f32_16x16x32_bf16 v[204:207], a[0:3], v[28:31], 0
    ds_read_b64_tr_b16 a[18:19], v16 offset:2304
    s_waitcnt lgkmcnt(4)
    v_mfma_f32_16x16x32_bf16 v[208:211], a[4:7], v[24:27], 0
    ds_read_b64_tr_b16 a[0:1], v17 offset:256
    buffer_load_dwordx4 v23, s[20:23], s30 offen offset:2048  lds
    v_mfma_f32_16x16x32_bf16 v[212:215], a[4:7], v[28:31], 0
    ds_read_b64_tr_b16 a[2:3], v17 offset:2304
    v_exp_f32 v44, v44
    v_mfma_f32_16x16x32_bf16 v[216:219], a[8:11], v[24:27], 0
    ds_read_b64_tr_b16 a[4:5], v18 offset:256
    v_exp_f32 v45, v45
    v_mfma_f32_16x16x32_bf16 v[220:223], a[8:11], v[28:31], 0
    ds_read_b64_tr_b16 a[6:7], v18 offset:2304
    v_cvt_pk_bf16_f32 v33, v42, v43
    s_waitcnt lgkmcnt(4)
    v_mfma_f32_16x16x32_bf16 v[224:227], a[12:15], v[24:27], 0
    s_add_u32 s30, s76, 18432
    buffer_load_dwordx4 v23, s[20:23], s30 offen offset:3072  lds
    v_mfma_f32_16x16x32_bf16 v[228:231], a[12:15], v[28:31], 0
    v_exp_f32 v46, v46
    v_mfma_f32_16x16x32_bf16 v[232:235], a[16:19], v[24:27], 0
    v_exp_f32 v47, v47
    v_cvt_pk_bf16_f32 v36, v44, v45
    v_mfma_f32_16x16x32_bf16 v[236:239], a[16:19], v[28:31], 0
    s_nop 0
    v_cvt_pk_bf16_f32 v37, v46, v47
    s_waitcnt lgkmcnt(0)
    v_mfma_f32_16x16x32_bf16 v[240:243], a[0:3], v[24:27], 0
    v_mfma_f32_16x16x32_bf16 v[244:247], a[0:3], v[28:31], 0
    v_mfma_f32_16x16x32_bf16 v[248:251], a[4:7], v[24:27], 0
    v_mfma_f32_16x16x32_bf16 v[252:255], a[4:7], v[28:31], 0
    s_cbranch_vccnz L_rs_0
L_rsb_0:
    s_barrier
    ds_read_b128 a[8:11], v7 offset:32768
    ds_read_b128 a[12:15], v8 offset:32768
    ds_read_b128 a[16:19], v9 offset:32768
    ds_read_b128 a[0:3], v10 offset:32768
    s_waitcnt lgkmcnt(3)
    v_mfma_f32_16x16x32_bf16 v[40:43], a[8:11], v[64:67], v[56:59]
    ds_read_b128 a[4:7], v7 offset:33024
    s_add_u32 m0, s29, 65536
    v_mfma_f32_16x16x32_bf16 v[44:47], a[8:11], v[68:71], v[60:63]
    s_mov_b32 s30, 98304
    s_waitcnt lgkmcnt(2)
    v_mfma_f32_16x16x32_bf16 v[40:43], a[12:15], v[72:75], v[40:43]
    ds_read_b128 a[8:11], v8 offset:33024
    buffer_load_dwordx4 v19, s[8:11], s30 offen offset:0 nt lds
    v_mfma_f32_16x16x32_bf16 v[44:47], a[12:15], v[76:79], v[44:47]
    v_exp_f32 v48, v48
    v_mfma_f32_16x16x32_bf16 v[40:43], a[16:19], v[80:83], v[40:43]
    ds_read_b128 a[12:15], v9 offset:33024
    v_exp_f32 v49, v49
    v_mfma_f32_16x16x32_bf16 v[44:47], a[16:19], v[84:87], v[44:47]
    v_exp_f32 v50, v50
    s_waitcnt lgkmcnt(2)
    v_mfma_f32_16x16x32_bf16 v[40:43], a[0:3], v[88:91], v[40:43]
    ds_read_b128 a[16:19], v10 offset:33024
    v_exp_f32 v51, v51
    v_mfma_f32_16x16x32_bf16 v[44:47], a[0:3], v[92:95], v[44:47]
    v_cvt_pk_bf16_f32 v34, v48, v49
    v_exp_f32 v52, v52
    v_mfma_f32_16x16x32_bf16 v[40:43], a[4:7], v[96:99], v[40:43]
    ds_read_b128 a[0:3], v7 offset:34816
    v_exp_f32 v53, v53
    v_mfma_f32_16x16x32_bf16 v[44:47], a[4:7], v[100:103], v[44:47]
    v_cvt_pk_bf16_f32 v35, v50, v51
    s_waitcnt lgkmcnt(2)
    v_mfma_f32_16x16x32_bf16 v[40:43], a[8:11], v[104:107], v[40:43]
    ds_read_b128 a[4:7], v8 offset:34816
    buffer_load_dwordx4 v20, s[8:11], s30 offen offset:1024 nt lds
    v_mfma_f32_16x16x32_bf16 v[44:47], a[8:11], v[108:111], v[44:47]
    v_exp_f32 v54, v54
    v_mfma_f32_16x16x32_bf16 v[40:43], a[12:15], v[112:115], v[40:43]
    ds_read_b128 a[8:11], v9 offset:34816
    v_exp_f32 v55, v55
    v_mfma_f32_16x16x32_bf16 v[44:47], a[12:15], v[116:119], v[44:47]
    v_cvt_pk_bf16_f32 v38, v52, v53
    s_nop 0
    s_waitcnt lgkmcnt(2)
    v_mfma_f32_16x16x32_bf16 v[40:43], a[16:19], v[120:123], v[40:43]
    ds_read_b128 a[12:15], v10 offset:34816
    v_cvt_pk_bf16_f32 v39, v54, v55
    v_mfma_f32_16x16x32_bf16 v[44:47], a[16:19], v[124:127], v[44:47]
    v_mfma_f32_16x16x32_bf16 v[48:51], a[0:3], v[64:67], v[56:59]
    ds_read_b128 a[16:19], v7 offset:35072
    v_mfma_f32_16x16x32_bf16 v[52:55], a[0:3], v[68:71], v[60:63]
    s_waitcnt lgkmcnt(2)
    v_mfma_f32_16x16x32_bf16 v[48:51], a[4:7], v[72:75], v[48:51]
    ds_read_b128 a[0:3], v8 offset:35072
    v_mfma_f32_16x16x32_bf16 v[52:55], a[4:7], v[76:79], v[52:55]
    v_mfma_f32_16x16x32_bf16 v[48:51], a[8:11], v[80:83], v[48:51]
    ds_read_b128 a[4:7], v9 offset:35072
    buffer_load_dwordx4 v19, s[8:11], s30 offen offset:2048 nt lds
    v_mfma_f32_16x16x32_bf16 v[52:55], a[8:11], v[84:87], v[52:55]
    s_waitcnt lgkmcnt(2)
    v_mfma_f32_16x16x32_bf16 v[48:51], a[12:15], v[88:91], v[48:51]
    ds_read_b128 a[8:11], v10 offset:35072
    v_max3_f32 v0, v40, v41, v42
    v_mfma_f32_16x16x32_bf16 v[52:55], a[12:15], v[92:95], v[52:55]
    v_max3_f32 v1, v43, v44, v45
    v_max3_f32 v0, v0, v46, v47
    v_mfma_f32_16x16x32_bf16 v[48:51], a[16:19], v[96:99], v[48:51]
    v_mfma_f32_16x16x32_bf16 v[52:55], a[16:19], v[100:103], v[52:55]
    s_waitcnt lgkmcnt(1)
    v_mfma_f32_16x16x32_bf16 v[48:51], a[0:3], v[104:107], v[48:51]
    v_mfma_f32_16x16x32_bf16 v[52:55], a[0:3], v[108:111], v[52:55]
    v_mfma_f32_16x16x32_bf16 v[48:51], a[4:7], v[112:115], v[48:51]
    v_mfma_f32_16x16x32_bf16 v[52:55], a[4:7], v[116:119], v[52:55]
    s_waitcnt lgkmcnt(0)
    v_mfma_f32_16x16x32_bf16 v[48:51], a[8:11], v[120:123], v[48:51]
    v_mfma_f32_16x16x32_bf16 v[52:55], a[8:11], v[124:127], v[52:55]
    s_barrier
    ds_read_b64_tr_b16 a[12:13], v11 offset:16384
    ds_read_b64_tr_b16 a[14:15], v11 offset:18432
    ds_read_b64_tr_b16 a[16:17], v12 offset:16384
    ds_read_b64_tr_b16 a[18:19], v12 offset:18432
    ds_read_b64_tr_b16 a[0:1], v13 offset:16384
    ds_read_b64_tr_b16 a[2:3], v13 offset:18432
    s_waitcnt lgkmcnt(4)
    v_mfma_f32_16x16x32_bf16 v[128:131], a[12:15], v[32:35], v[128:131]
    ds_read_b64_tr_b16 a[4:5], v14 offset:16384
    buffer_load_dwordx4 v20, s[8:11], s30 offen offset:3072 nt lds
    v_mfma_f32_16x16x32_bf16 v[132:135], a[12:15], v[36:39], v[132:135]
    ds_read_b64_tr_b16 a[6:7], v14 offset:18432
    s_waitcnt lgkmcnt(4)
    v_mfma_f32_16x16x32_bf16 v[136:139], a[16:19], v[32:35], v[136:139]
    ds_read_b64_tr_b16 a[8:9], v15 offset:16384
    v_mfma_f32_16x16x32_bf16 v[140:143], a[16:19], v[36:39], v[140:143]
    ds_read_b64_tr_b16 a[10:11], v15 offset:18432
    v_max3_f32 v1, v1, v48, v49
    v_max3_f32 v0, v0, v50, v51
    v_mfma_f32_16x16x32_bf16 a[20:23], a[28:31], v[32:35], a[20:23]
    ds_read_b64_tr_b16 a[12:13], v16 offset:16384
    v_max3_f32 v1, v1, v52, v53
    v_max3_f32 v0, v0, v54, v55
    v_mfma_f32_16x16x32_bf16 a[24:27], a[28:31], v[36:39], a[24:27]
    ds_read_b64_tr_b16 a[14:15], v16 offset:18432
    v_max_f32 v0, v0, v1
    s_waitcnt lgkmcnt(4)
    v_mfma_f32_16x16x32_bf16 v[144:147], a[0:3], v[32:35], v[144:147]
    ds_read_b64_tr_b16 a[16:17], v17 offset:16384
    v_cmp_lt_f32 vcc, s31, v0
    s_cbranch_vccnz L_up_1
L_upb_1:
    v_mfma_f32_16x16x32_bf16 v[148:151], a[0:3], v[36:39], v[148:151]
    ds_read_b64_tr_b16 a[18:19], v17 offset:18432
    v_exp_f32 v40, v40
    v_mfma_f32_16x16x32_bf16 v[152:155], a[4:7], v[32:35], v[152:155]
    ds_read_b64_tr_b16 a[0:1], v18 offset:16384
    s_add_u32 m0, s29, 32768
    v_mfma_f32_16x16x32_bf16 v[156:159], a[4:7], v[36:39], v[156:159]
    ds_read_b64_tr_b16 a[2:3], v18 offset:18432
    s_waitcnt lgkmcnt(4)
    v_mfma_f32_16x16x32_bf16 v[160:163], a[8:11], v[32:35], v[160:163]
    ds_read_b64_tr_b16 a[4:5], v11 offset:16640
    s_mov_b32 s30, 81920
    v_mfma_f32_16x16x32_bf16 v[164:167], a[8:11], v[36:39], v[164:167]
    ds_read_b64_tr_b16 a[6:7], v11 offset:18688
    buffer_load_dwordx4 v21, s[12:15], s30 offen offset:0 nt lds
    v_mfma_f32_16x16x32_bf16 v[168:171], a[12:15], v[32:35], v[168:171]
    ds_read_b64_tr_b16 a[8:9], v12 offset:16640
    v_exp_f32 v41, v41
    v_mfma_f32_16x16x32_bf16 v[172:175], a[12:15], v[36:39], v[172:175]
    ds_read_b64_tr_b16 a[10:11], v12 offset:18688
    s_waitcnt lgkmcnt(4)
    v_mfma_f32_16x16x32_bf16 v[176:179], a[16:19], v[32:35], v[176:179]
    ds_read_b64_tr_b16 a[12:13], v13 offset:16640
    v_exp_f32 v42, v42
    v_mfma_f32_16x16x32_bf16 v[180:183], a[16:19], v[36:39], v[180:183]
    ds_read_b64_tr_b16 a[14:15], v13 offset:18688
    v_exp_f32 v43, v43
    v_mfma_f32_16x16x32_bf16 v[184:187], a[0:3], v[32:35], v[184:187]
    ds_read_b64_tr_b16 a[16:17], v14 offset:16640
    buffer_load_dwordx4 v22, s[12:15], s30 offen offset:1024 nt lds
    v_cvt_pk_bf16_f32 v24, v40, v41
    v_mfma_f32_16x16x32_bf16 v[188:191], a[0:3], v[36:39], v[188:191]
    ds_read_b64_tr_b16 a[18:19], v14 offset:18688
    s_waitcnt lgkmcnt(4)
    v_mfma_f32_16x16x32_bf16 v[192:195], a[4:7], v[32:35], v[192:195]
    ds_read_b64_tr_b16 a[0:1], v15 offset:16640
    v_exp_f32 v44, v44
    v_mfma_f32_16x16x32_bf16 v[196:199], a[4:7], v[36:39], v[196:199]
    ds_read_b64_tr_b16 a[2:3], v15 offset:18688
    v_exp_f32 v45, v45
    v_mfma_f32_16x16x32_bf16 v[200:203], a[8:11], v[32:35], v[200:203]
    ds_read_b64_tr_b16 a[4:5], v16 offset:16640
    v_cvt_pk_bf16_f32 v25, v42, v43
    v_mfma_f32_16x16x32_bf16 v[204:207], a[8:11], v[36:39], v[204:207]
    ds_read_b64_tr_b16 a[6:7], v16 offset:18688
    s_waitcnt lgkmcnt(4)
    v_mfma_f32_16x16x32_bf16 v[208:211], a[12:15], v[32:35], v[208:211]
    ds_read_b64_tr_b16 a[8:9], v17 offset:16640
    v_exp_f32 v46, v46
    v_mfma_f32_16x16x32_bf16 v[212:215], a[12:15], v[36:39], v[212:215]
    ds_read_b64_tr_b16 a[10:11], v17 offset:18688
    v_exp_f32 v47, v47
    v_mfma_f32_16x16x32_bf16 v[216:219], a[16:19], v[32:35], v[216:219]
    ds_read_b64_tr_b16 a[12:13], v18 offset:16640
    buffer_load_dwordx4 v21, s[12:15], s30 offen offset:2048 nt lds
    v_cvt_pk_bf16_f32 v28, v44, v45
    v_mfma_f32_16x16x32_bf16 v[220:223], a[16:19], v[36:39], v[220:223]
    ds_read_b64_tr_b16 a[14:15], v18 offset:18688
    s_nop 0
    s_waitcnt lgkmcnt(4)
    v_mfma_f32_16x16x32_bf16 v[224:227], a[0:3], v[32:35], v[224:227]
    v_cvt_pk_bf16_f32 v29, v46, v47
    v_mfma_f32_16x16x32_bf16 v[228:231], a[0:3], v[36:39], v[228:231]
    v_mfma_f32_16x16x32_bf16 v[232:235], a[4:7], v[32:35], v[232:235]
    v_mfma_f32_16x16x32_bf16 v[236:239], a[4:7], v[36:39], v[236:239]
    s_waitcnt lgkmcnt(0)
    v_mfma_f32_16x16x32_bf16 v[240:243], a[8:11], v[32:35], v[240:243]
    v_mfma_f32_16x16x32_bf16 v[244:247], a[8:11], v[36:39], v[244:247]
    v_mfma_f32_16x16x32_bf16 v[248:251], a[12:15], v[32:35], v[248:251]
    v_mfma_f32_16x16x32_bf16 v[252:255], a[12:15], v[36:39], v[252:255]
    s_cbranch_vccnz L_rs_1
L_rsb_1:
    s_waitcnt vmcnt(7)
    s_barrier
    ds_read_b128 a[16:19], v7 offset:49152
    ds_read_b128 a[0:3], v8 offset:49152
    ds_read_b128 a[4:7], v9 offset:49152
    ds_read_b128 a[8:11], v10 offset:49152
    s_waitcnt lgkmcnt(3)
    v_mfma_f32_16x16x32_bf16 v[40:43], a[16:19], v[64:67], v[56:59]
    ds_read_b128 a[12:15], v7 offset:49408
    buffer_load_dwordx4 v22, s[12:15], s30 offen offset:3072 nt lds
    v_mfma_f32_16x16x32_bf16 v[44:47], a[16:19], v[68:71], v[60:63]
    v_exp_f32 v48, v48
    s_waitcnt lgkmcnt(2)
    v_mfma_f32_16x16x32_bf16 v[40:43], a[0:3], v[72:75], v[40:43]
    ds_read_b128 a[16:19], v8 offset:49408
    v_exp_f32 v49, v49
    v_mfma_f32_16x16x32_bf16 v[44:47], a[0:3], v[76:79], v[44:47]
    v_exp_f32 v50, v50
    v_mfma_f32_16x16x32_bf16 v[40:43], a[4:7], v[80:83], v[40:43]
    ds_read_b128 a[0:3], v9 offset:49408
    v_exp_f32 v51, v51
    v_mfma_f32_16x16x32_bf16 v[44:47], a[4:7], v[84:87], v[44:47]
    v_cvt_pk_bf16_f32 v26, v48, v49
    s_waitcnt lgkmcnt(2)
    v_mfma_f32_16x16x32_bf16 v[40:43], a[8:11], v[88:91], v[40:43]
    ds_read_b128 a[4:7], v10 offset:49408
    v_exp_f32 v52, v52
    v_add_u32 v3, 16384, v2
    v_mfma_f32_16x16x32_bf16 v[44:47], a[8:11], v[92:95], v[44:47]
    v_exp_f32 v53, v53
    v_cvt_pk_bf16_f32 v27, v50, v51
    ds_read_b64_tr_b16 a[32:33], v3 offset:0
    v_mfma_f32_16x16x32_bf16 v[40:43], a[12:15], v[96:99], v[40:43]
    ds_read_b128 a[8:11], v7 offset:51200
    v_exp_f32 v54, v54
    ds_read_b64_tr_b16 a[34:35], v3 offset:2048
    v_mfma_f32_16x16x32_bf16 v[44:47], a[12:15], v[100:103], v[44:47]
    v_exp_f32 v55, v55
    ds_read_b64_tr_b16 a[36:37], v3 offset:4096
    s_waitcnt lgkmcnt(5)
    v_mfma_f32_16x16x32_bf16 v[40:43], a[16:19], v[104:107], v[40:43]
    ds_read_b128 a[12:15], v8 offset:51200
    s_add_u32 m0, s29, 81920
    v_cvt_pk_bf16_f32 v30, v52, v53
    ds_read_b64_tr_b16 a[38:39], v3 offset:6144
    v_mfma_f32_16x16x32_bf16 v[44:47], a[16:19], v[108:111], v[44:47]
    s_mov_b32 s30, 114688
    buffer_load_dwordx4 v19, s[8:11], s30 offen offset:0 nt lds
    s_nop 0
    ds_read_b64_tr_b16 a[40:41], v3 offset:8192
    v_mfma_f32_16x16x32_bf16 v[40:43], a[0:3], v[112:115], v[40:43]
    ds_read_b128 a[16:19], v9 offset:51200
    v_cvt_pk_bf16_f32 v31, v54, v55
    ds_read_b64_tr_b16 a[42:43], v3 offset:10240
    v_mfma_f32_16x16x32_bf16 v[44:47], a[0:3], v[116:119], v[44:47]
    ds_read_b64_tr_b16 a[44:45], v3 offset:12288
    ds_read_b64_tr_b16 a[46:47], v3 offset:14336
    s_waitcnt lgkmcnt(9)
    v_mfma_f32_16x16x32_bf16 v[40:43], a[4:7], v[120:123], v[40:43]
    ds_read_b128 a[0:3], v10 offset:51200
    v_mfma_f32_16x16x32_bf16 v[44:47], a[4:7], v[124:127], v[44:47]
    v_mfma_f32_16x16x32_bf16 v[48:51], a[8:11], v[64:67], v[56:59]
    ds_read_b128 a[4:7], v7 offset:51456
    v_mfma_f32_16x16x32_bf16 v[52:55], a[8:11], v[68:71], v[60:63]
    s_waitcnt lgkmcnt(5)
    v_mfma_f32_16x16x32_bf16 v[48:51], a[12:15], v[72:75], v[48:51]
    ds_read_b128 a[8:11], v8 offset:51456
    v_mfma_f32_16x16x32_bf16 v[52:55], a[12:15], v[76:79], v[52:55]
    v_mfma_f32_16x16x32_bf16 v[48:51], a[16:19], v[80:83], v[48:51]
    ds_read_b128 a[12:15], v9 offset:51456
    buffer_load_dwordx4 v20, s[8:11], s30 offen offset:1024 nt lds
    v_mfma_f32_16x16x32_bf16 v[52:55], a[16:19], v[84:87], v[52:55]
    s_waitcnt lgkmcnt(2)
    v_mfma_f32_16x16x32_bf16 v[48:51], a[0:3], v[88:91], v[48:51]
    ds_read_b128 a[16:19], v10 offset:51456
    v_max3_f32 v0, v40, v41, v42
    v_mfma_f32_16x16x32_bf16 v[52:55], a[0:3], v[92:95], v[52:55]
    v_max3_f32 v1, v43, v44, v45
    v_max3_f32 v0, v0, v46, v47
    v_mfma_f32_16x16x32_bf16 v[48:51], a[4:7], v[96:99], v[48:51]
    v_mfma_f32_16x16x32_bf16 v[52:55], a[4:7], v[100:103], v[52:55]
    s_waitcnt lgkmcnt(1)
    v_mfma_f32_16x16x32_bf16 v[48:51], a[8:11], v[104:107], v[48:51]
    v_mfma_f32_16x16x32_bf16 v[52:55], a[8:11], v[108:111], v[52:55]
    v_mfma_f32_16x16x32_bf16 v[48:51], a[12:15], v[112:115], v[48:51]
    v_mfma_f32_16x16x32_bf16 v[52:55], a[12:15], v[116:119], v[52:55]
    s_waitcnt lgkmcnt(0)
    v_mfma_f32_16x16x32_bf16 v[48:51], a[16:19], v[120:123], v[48:51]
    v_mfma_f32_16x16x32_bf16 v[52:55], a[16:19], v[124:127], v[52:55]
    s_barrier
    ds_read_b64_tr_b16 a[0:1], v11 offset:32768
    ds_read_b64_tr_b16 a[2:3], v11 offset:34816
    ds_read_b64_tr_b16 a[4:5], v12 offset:32768
    ds_read_b64_tr_b16 a[6:7], v12 offset:34816
    ds_read_b64_tr_b16 a[8:9], v13 offset:32768
    ds_read_b64_tr_b16 a[10:11], v13 offset:34816
    s_waitcnt lgkmcnt(4)
    v_mfma_f32_16x16x32_bf16 v[128:131], a[0:3], v[24:27], v[128:131]
    ds_read_b64_tr_b16 a[12:13], v14 offset:32768
    buffer_load_dwordx4 v19, s[8:11], s30 offen offset:2048 nt lds
    v_mfma_f32_16x16x32_bf16 v[132:135], a[0:3], v[28:31], v[132:135]
    ds_read_b64_tr_b16 a[14:15], v14 offset:34816
    s_waitcnt lgkmcnt(4)
    v_mfma_f32_16x16x32_bf16 v[136:139], a[4:7], v[24:27], v[136:139]
    ds_read_b64_tr_b16 a[16:17], v15 offset:32768
    v_mfma_f32_16x16x32_bf16 v[140:143], a[4:7], v[28:31], v[140:143]
    ds_read_b64_tr_b16 a[18:19], v15 offset:34816
    v_max3_f32 v1, v1, v48, v49
    v_max3_f32 v0, v0, v50, v51
    v_mfma_f32_16x16x32_bf16 a[20:23], a[28:31], v[24:27], a[20:23]
    ds_read_b64_tr_b16 a[0:1], v16 offset:32768
    buffer_load_dwordx4 v20, s[8:11], s30 offen offset:3072 nt lds
    v_max3_f32 v1, v1, v52, v53
    v_mfma_f32_16x16x32_bf16 a[24:27], a[28:31], v[28:31], a[24:27]
    ds_read_b64_tr_b16 a[2:3], v16 offset:34816
    v_max3_f32 v0, v0, v54, v55
    s_waitcnt lgkmcnt(4)
    v_mfma_f32_16x16x32_bf16 v[144:147], a[8:11], v[24:27], v[144:147]
    ds_read_b64_tr_b16 a[4:5], v17 offset:32768
    v_max_f32 v0, v0, v1
    v_cmp_lt_f32 vcc, s31, v0
    v_mfma_f32_16x16x32_bf16 v[148:151], a[8:11], v[28:31], v[148:151]
    ds_read_b64_tr_b16 a[6:7], v17 offset:34816
    s_cbranch_vccnz L_up_2
L_upb_2:
    v_mfma_f32_16x16x32_bf16 v[152:155], a[12:15], v[24:27], v[152:155]
    ds_read_b64_tr_b16 a[8:9], v18 offset:32768
    s_add_u32 m0, s29, 49152
    v_mfma_f32_16x16x32_bf16 v[156:159], a[12:15], v[28:31], v[156:159]
    ds_read_b64_tr_b16 a[10:11], v18 offset:34816
    s_waitcnt lgkmcnt(4)
    v_mfma_f32_16x16x32_bf16 v[160:163], a[16:19], v[24:27], v[160:163]
    ds_read_b64_tr_b16 a[12:13], v11 offset:33024
    s_mov_b32 s30, 98304
    v_mfma_f32_16x16x32_bf16 v[164:167], a[16:19], v[28:31], v[164:167]
    ds_read_b64_tr_b16 a[14:15], v11 offset:35072
    buffer_load_dwordx4 v21, s[12:15], s30 offen offset:0 nt lds
    v_mfma_f32_16x16x32_bf16 v[168:171], a[0:3], v[24:27], v[168:171]
    ds_read_b64_tr_b16 a[16:17], v12 offset:33024
    buffer_load_dwordx4 v22, s[12:15], s30 offen offset:1024 nt lds
    v_mfma_f32_16x16x32_bf16 v[172:175], a[0:3], v[28:31], v[172:175]
    ds_read_b64_tr_b16 a[18:19], v12 offset:35072
    s_waitcnt lgkmcnt(4)
    v_mfma_f32_16x16x32_bf16 v[176:179], a[4:7], v[24:27], v[176:179]
    ds_read_b64_tr_b16 a[0:1], v13 offset:33024
    v_exp_f32 v40, v40
    v_mfma_f32_16x16x32_bf16 v[180:183], a[4:7], v[28:31], v[180:183]
    ds_read_b64_tr_b16 a[2:3], v13 offset:35072
    v_exp_f32 v41, v41
    v_mfma_f32_16x16x32_bf16 v[184:187], a[8:11], v[24:27], v[184:187]
    ds_read_b64_tr_b16 a[4:5], v14 offset:33024
    s_add_u32 m0, s29, 16384
    v_mfma_f32_16x16x32_bf16 v[188:191], a[8:11], v[28:31], v[188:191]
    ds_read_b64_tr_b16 a[6:7], v14 offset:35072
    s_waitcnt lgkmcnt(4)
    v_mfma_f32_16x16x32_bf16 v[192:195], a[12:15], v[24:27], v[192:195]
    ds_read_b64_tr_b16 a[8:9], v15 offset:33024
    s_add_u32 s30, s76, 114688
    v_mfma_f32_16x16x32_bf16 v[196:199], a[12:15], v[28:31], v[196:199]
    ds_read_b64_tr_b16 a[10:11], v15 offset:35072
    buffer_load_dwordx4 v23, s[20:23], s30 offen offset:0  lds
    v_mfma_f32_16x16x32_bf16 v[200:203], a[16:19], v[24:27], v[200:203]
    ds_read_b64_tr_b16 a[12:13], v16 offset:33024
    s_add_u32 s30, s76, 120832
    v_mfma_f32_16x16x32_bf16 v[204:207], a[16:19], v[28:31], v[204:207]
    ds_read_b64_tr_b16 a[14:15], v16 offset:35072
    s_waitcnt lgkmcnt(4)
    v_mfma_f32_16x16x32_bf16 v[208:211], a[0:3], v[24:27], v[208:211]
    ds_read_b64_tr_b16 a[16:17], v17 offset:33024
    buffer_load_dwordx4 v23, s[20:23], s30 offen offset:1024  lds
    v_mfma_f32_16x16x32_bf16 v[212:215], a[0:3], v[28:31], v[212:215]
    ds_read_b64_tr_b16 a[18:19], v17 offset:35072
    v_exp_f32 v42, v42
    v_mfma_f32_16x16x32_bf16 v[216:219], a[4:7], v[24:27], v[216:219]
    ds_read_b64_tr_b16 a[0:1], v18 offset:33024
    s_add_u32 s30, s76, 126976
    v_mfma_f32_16x16x32_bf16 v[220:223], a[4:7], v[28:31], v[220:223]
    ds_read_b64_tr_b16 a[2:3], v18 offset:35072
    s_waitcnt lgkmcnt(4)
    v_mfma_f32_16x16x32_bf16 v[224:227], a[8:11], v[24:27], v[224:227]
    buffer_load_dwordx4 v23, s[20:23], s30 offen offset:2048  lds
    v_exp_f32 v43, v43
    v_mfma_f32_16x16x32_bf16 v[228:231], a[8:11], v[28:31], v[228:231]
    v_cvt_pk_bf16_f32 v32, v40, v41
    v_exp_f32 v44, v44
    v_mfma_f32_16x16x32_bf16 v[232:235], a[12:15], v[24:27], v[232:235]
    s_add_u32 s30, s76, 133120
    buffer_load_dwordx4 v23, s[20:23], s30 offen offset:3072  lds
    v_mfma_f32_16x16x32_bf16 v[236:239], a[12:15], v[28:31], v[236:239]
    v_exp_f32 v45, v45
    s_waitcnt lgkmcnt(0)
    v_mfma_f32_16x16x32_bf16 v[240:243], a[16:19], v[24:27], v[240:243]
    v_cvt_pk_bf16_f32 v33, v42, v43
    v_exp_f32 v46, v46
    v_mfma_f32_16x16x32_bf16 v[244:247], a[16:19], v[28:31], v[244:247]
    v_exp_f32 v47, v47
    v_cvt_pk_bf16_f32 v36, v44, v45
    v_mfma_f32_16x16x32_bf16 v[248:251], a[0:3], v[24:27], v[248:251]
    s_nop 0
    v_cvt_pk_bf16_f32 v37, v46, v47
    v_mfma_f32_16x16x32_bf16 v[252:255], a[0:3], v[28:31], v[252:255]
    s_cbranch_vccnz L_rs_2
L_rsb_2:
    s_barrier
    v_add_u32 v7, 0x18000, v7
    v_add_u32 v8, 0x18000, v8
    v_add_u32 v9, 0x18000, v9
    v_add_u32 v10, 0x18000, v10
    ds_read_b128 a[4:7], v7 offset:32768
    ds_read_b128 a[8:11], v8 offset:32768
    ds_read_b128 a[12:15], v9 offset:32768
    ds_read_b128 a[16:19], v10 offset:32768
    s_waitcnt lgkmcnt(3)
    v_mfma_f32_16x16x32_bf16 v[40:43], a[4:7], v[64:67], v[56:59]
    ds_read_b128 a[0:3], v7 offset:33024
    s_add_u32 m0, s29, 49152
    v_mfma_f32_16x16x32_bf16 v[44:47], a[4:7], v[68:71], v[60:63]
    s_mov_b32 s30, 98304
    s_waitcnt lgkmcnt(2)
    v_mfma_f32_16x16x32_bf16 v[40:43], a[8:11], v[72:75], v[40:43]
    ds_read_b128 a[4:7], v8 offset:33024
    buffer_load_dwordx4 v21, s[12:15], s30 offen offset:2048 nt lds
    v_mfma_f32_16x16x32_bf16 v[44:47], a[8:11], v[76:79], v[44:47]
    v_exp_f32 v48, v48
    v_mfma_f32_16x16x32_bf16 v[40:43], a[12:15], v[80:83], v[40:43]
    ds_read_b128 a[8:11], v9 offset:33024
    v_exp_f32 v49, v49
    v_mfma_f32_16x16x32_bf16 v[44:47], a[12:15], v[84:87], v[44:47]
    v_exp_f32 v50, v50
    s_waitcnt lgkmcnt(2)
    v_mfma_f32_16x16x32_bf16 v[40:43], a[16:19], v[88:91], v[40:43]
    ds_read_b128 a[12:15], v10 offset:33024
    v_exp_f32 v51, v51
    v_mfma_f32_16x16x32_bf16 v[44:47], a[16:19], v[92:95], v[44:47]
    buffer_load_dwordx4 v22, s[12:15], s30 offen offset:3072 nt lds
    v_cvt_pk_bf16_f32 v34, v48, v49
    v_mfma_f32_16x16x32_bf16 v[40:43], a[0:3], v[96:99], v[40:43]
    ds_read_b128 a[16:19], v7 offset:34816
    v_exp_f32 v52, v52
    v_mfma_f32_16x16x32_bf16 v[44:47], a[0:3], v[100:103], v[44:47]
    v_exp_f32 v53, v53
    s_waitcnt lgkmcnt(2)
    v_mfma_f32_16x16x32_bf16 v[40:43], a[4:7], v[104:107], v[40:43]
    ds_read_b128 a[0:3], v8 offset:34816
    v_cvt_pk_bf16_f32 v35, v50, v51
    v_mfma_f32_16x16x32_bf16 v[44:47], a[4:7], v[108:111], v[44:47]
    v_exp_f32 v54, v54
    v_mfma_f32_16x16x32_bf16 v[40:43], a[8:11], v[112:115], v[40:43]
    ds_read_b128 a[4:7], v9 offset:34816
    v_exp_f32 v55, v55
    v_mfma_f32_16x16x32_bf16 v[44:47], a[8:11], v[116:119], v[44:47]
    v_cvt_pk_bf16_f32 v38, v52, v53
    s_nop 0
    s_waitcnt lgkmcnt(2)
    v_mfma_f32_16x16x32_bf16 v[40:43], a[12:15], v[120:123], v[40:43]
    ds_read_b128 a[8:11], v10 offset:34816
    s_add_u32 m0, s29, 98304
    v_cvt_pk_bf16_f32 v39, v54, v55
    v_mfma_f32_16x16x32_bf16 v[44:47], a[12:15], v[124:127], v[44:47]
    s_mov_b32 s30, 131072
    buffer_load_dwordx4 v19, s[8:11], s30 offen offset:0 nt lds
    v_mfma_f32_16x16x32_bf16 v[48:51], a[16:19], v[64:67], v[56:59]
    ds_read_b128 a[12:15], v7 offset:35072
    v_mfma_f32_16x16x32_bf16 v[52:55], a[16:19], v[68:71], v[60:63]
    s_waitcnt lgkmcnt(2)
    v_mfma_f32_16x16x32_bf16 v[48:51], a[0:3], v[72:75], v[48:51]
    ds_read_b128 a[16:19], v8 offset:35072
    v_mfma_f32_16x16x32_bf16 v[52:55], a[0:3], v[76:79], v[52:55]
    v_mfma_f32_16x16x32_bf16 v[48:51], a[4:7], v[80:83], v[48:51]
    ds_read_b128 a[0:3], v9 offset:35072
    v_mfma_f32_16x16x32_bf16 v[52:55], a[4:7], v[84:87], v[52:55]
    buffer_load_dwordx4 v20, s[8:11], s30 offen offset:1024 nt lds
    s_waitcnt lgkmcnt(2)
    v_mfma_f32_16x16x32_bf16 v[48:51], a[8:11], v[88:91], v[48:51]
    ds_read_b128 a[4:7], v10 offset:35072
    v_max3_f32 v0, v40, v41, v42
    v_mfma_f32_16x16x32_bf16 v[52:55], a[8:11], v[92:95], v[52:55]
    v_max3_f32 v1, v43, v44, v45
    v_max3_f32 v0, v0, v46, v47
    v_mfma_f32_16x16x32_bf16 v[48:51], a[12:15], v[96:99], v[48:51]
    v_mfma_f32_16x16x32_bf16 v[52:55], a[12:15], v[100:103], v[52:55]
    s_waitcnt lgkmcnt(1)
    v_mfma_f32_16x16x32_bf16 v[48:51], a[16:19], v[104:107], v[48:51]
    v_mfma_f32_16x16x32_bf16 v[52:55], a[16:19], v[108:111], v[52:55]
    v_mfma_f32_16x16x32_bf16 v[48:51], a[0:3], v[112:115], v[48:51]
    v_mfma_f32_16x16x32_bf16 v[52:55], a[0:3], v[116:119], v[52:55]
    s_waitcnt lgkmcnt(0)
    v_mfma_f32_16x16x32_bf16 v[48:51], a[4:7], v[120:123], v[48:51]
    v_mfma_f32_16x16x32_bf16 v[52:55], a[4:7], v[124:127], v[52:55]
    s_barrier
    ds_read_b64_tr_b16 a[8:9], v11 offset:49152
    ds_read_b64_tr_b16 a[10:11], v11 offset:51200
    ds_read_b64_tr_b16 a[12:13], v12 offset:49152
    ds_read_b64_tr_b16 a[14:15], v12 offset:51200
    ds_read_b64_tr_b16 a[16:17], v13 offset:49152
    ds_read_b64_tr_b16 a[18:19], v13 offset:51200
    s_waitcnt lgkmcnt(4)
    v_mfma_f32_16x16x32_bf16 v[128:131], a[8:11], v[32:35], v[128:131]
    ds_read_b64_tr_b16 a[0:1], v14 offset:49152
    buffer_load_dwordx4 v19, s[8:11], s30 offen offset:2048 nt lds
    v_mfma_f32_16x16x32_bf16 v[132:135], a[8:11], v[36:39], v[132:135]
    ds_read_b64_tr_b16 a[2:3], v14 offset:51200
    s_waitcnt lgkmcnt(4)
    v_mfma_f32_16x16x32_bf16 v[136:139], a[12:15], v[32:35], v[136:139]
    ds_read_b64_tr_b16 a[4:5], v15 offset:49152
    v_mfma_f32_16x16x32_bf16 v[140:143], a[12:15], v[36:39], v[140:143]
    ds_read_b64_tr_b16 a[6:7], v15 offset:51200
    v_max3_f32 v1, v1, v48, v49
    v_max3_f32 v0, v0, v50, v51
    v_mfma_f32_16x16x32_bf16 a[20:23], a[28:31], v[32:35], a[20:23]
    ds_read_b64_tr_b16 a[8:9], v16 offset:49152
    v_max3_f32 v1, v1, v52, v53
    v_max3_f32 v0, v0, v54, v55
    v_mfma_f32_16x16x32_bf16 a[24:27], a[28:31], v[36:39], a[24:27]
    ds_read_b64_tr_b16 a[10:11], v16 offset:51200
    v_max_f32 v0, v0, v1
    s_waitcnt lgkmcnt(4)
    v_mfma_f32_16x16x32_bf16 v[144:147], a[16:19], v[32:35], v[144:147]
    ds_read_b64_tr_b16 a[12:13], v17 offset:49152
    v_cmp_lt_f32 vcc, s31, v0
    s_cbranch_vccnz L_up_3
L_upb_3:
    v_mfma_f32_16x16x32_bf16 v[148:151], a[16:19], v[36:39], v[148:151]
    ds_read_b64_tr_b16 a[14:15], v17 offset:51200
    v_exp_f32 v40, v40
    v_mfma_f32_16x16x32_bf16 v[152:155], a[0:3], v[32:35], v[152:155]
    ds_read_b64_tr_b16 a[16:17], v18 offset:49152
    v_exp_f32 v41, v41
    v_mfma_f32_16x16x32_bf16 v[156:159], a[0:3], v[36:39], v[156:159]
    ds_read_b64_tr_b16 a[18:19], v18 offset:51200
    s_waitcnt lgkmcnt(4)
    v_mfma_f32_16x16x32_bf16 v[160:163], a[4:7], v[32:35], v[160:163]
    ds_read_b64_tr_b16 a[0:1], v11 offset:49408
    buffer_load_dwordx4 v20, s[8:11], s30 offen offset:3072 nt lds
    v_mfma_f32_16x16x32_bf16 v[164:167], a[4:7], v[36:39], v[164:167]
    ds_read_b64_tr_b16 a[2:3], v11 offset:51456
    v_exp_f32 v42, v42
    v_mfma_f32_16x16x32_bf16 v[168:171], a[8:11], v[32:35], v[168:171]
    ds_read_b64_tr_b16 a[4:5], v12 offset:49408
    v_exp_f32 v43, v43
    v_mfma_f32_16x16x32_bf16 v[172:175], a[8:11], v[36:39], v[172:175]
    ds_read_b64_tr_b16 a[6:7], v12 offset:51456
    v_cvt_pk_bf16_f32 v24, v40, v41
    s_waitcnt lgkmcnt(4)
    v_mfma_f32_16x16x32_bf16 v[176:179], a[12:15], v[32:35], v[176:179]
    ds_read_b64_tr_b16 a[8:9], v13 offset:49408
    v_exp_f32 v44, v44
    v_mfma_f32_16x16x32_bf16 v[180:183], a[12:15], v[36:39], v[180:183]
    ds_read_b64_tr_b16 a[10:11], v13 offset:51456
    v_exp_f32 v45, v45
    v_mfma_f32_16x16x32_bf16 v[184:187], a[16:19], v[32:35], v[184:187]
    ds_read_b64_tr_b16 a[12:13], v14 offset:49408
    v_cvt_pk_bf16_f32 v25, v42, v43
    v_mfma_f32_16x16x32_bf16 v[188:191], a[16:19], v[36:39], v[188:191]
    ds_read_b64_tr_b16 a[14:15], v14 offset:51456
    s_waitcnt lgkmcnt(4)
    v_mfma_f32_16x16x32_bf16 v[192:195], a[0:3], v[32:35], v[192:195]
    ds_read_b64_tr_b16 a[16:17], v15 offset:49408
    v_exp_f32 v46, v46
    v_mfma_f32_16x16x32_bf16 v[196:199], a[0:3], v[36:39], v[196:199]
    ds_read_b64_tr_b16 a[18:19], v15 offset:51456
    v_exp_f32 v47, v47
    v_mfma_f32_16x16x32_bf16 v[200:203], a[4:7], v[32:35], v[200:203]
    ds_read_b64_tr_b16 a[0:1], v16 offset:49408
    s_add_u32 m0, s29, 131072
    v_cvt_pk_bf16_f32 v28, v44, v45
    v_mfma_f32_16x16x32_bf16 v[204:207], a[4:7], v[36:39], v[204:207]
    ds_read_b64_tr_b16 a[2:3], v16 offset:51456
    s_nop 0
    s_waitcnt lgkmcnt(4)
    v_mfma_f32_16x16x32_bf16 v[208:211], a[8:11], v[32:35], v[208:211]
    ds_read_b64_tr_b16 a[4:5], v17 offset:49408
    s_mov_b32 s30, 114688
    v_cvt_pk_bf16_f32 v29, v46, v47
    v_mfma_f32_16x16x32_bf16 v[212:215], a[8:11], v[36:39], v[212:215]
    ds_read_b64_tr_b16 a[6:7], v17 offset:51456
    buffer_load_dwordx4 v21, s[12:15], s30 offen offset:0 nt lds
    v_mfma_f32_16x16x32_bf16 v[216:219], a[12:15], v[32:35], v[216:219]
    ds_read_b64_tr_b16 a[8:9], v18 offset:49408
    v_mfma_f32_16x16x32_bf16 v[220:223], a[12:15], v[36:39], v[220:223]
    ds_read_b64_tr_b16 a[10:11], v18 offset:51456
    s_waitcnt lgkmcnt(4)
    v_mfma_f32_16x16x32_bf16 v[224:227], a[16:19], v[32:35], v[224:227]
    v_mfma_f32_16x16x32_bf16 v[228:231], a[16:19], v[36:39], v[228:231]
    v_mfma_f32_16x16x32_bf16 v[232:235], a[0:3], v[32:35], v[232:235]
    v_mfma_f32_16x16x32_bf16 v[236:239], a[0:3], v[36:39], v[236:239]
    s_waitcnt lgkmcnt(0)
    v_mfma_f32_16x16x32_bf16 v[240:243], a[4:7], v[32:35], v[240:243]
    v_mfma_f32_16x16x32_bf16 v[244:247], a[4:7], v[36:39], v[244:247]
    v_mfma_f32_16x16x32_bf16 v[248:251], a[8:11], v[32:35], v[248:251]
    v_mfma_f32_16x16x32_bf16 v[252:255], a[8:11], v[36:39], v[252:255]
    s_cbranch_vccnz L_rs_3
L_rsb_3:
    s_waitcnt vmcnt(7)
    s_barrier
    ds_read_b128 a[12:15], v7 offset:49152
    ds_read_b128 a[16:19], v8 offset:49152
    ds_read_b128 a[0:3], v9 offset:49152
    ds_read_b128 a[4:7], v10 offset:49152
    s_waitcnt lgkmcnt(3)
    v_mfma_f32_16x16x32_bf16 v[40:43], a[12:15], v[64:67], v[56:59]
    ds_read_b128 a[8:11], v7 offset:49408
    buffer_load_dwordx4 v22, s[12:15], s30 offen offset:1024 nt lds
    v_mfma_f32_16x16x32_bf16 v[44:47], a[12:15], v[68:71], v[60:63]
    v_exp_f32 v48, v48
    s_waitcnt lgkmcnt(2)
    v_mfma_f32_16x16x32_bf16 v[40:43], a[16:19], v[72:75], v[40:43]
    ds_read_b128 a[12:15], v8 offset:49408
    v_exp_f32 v49, v49
    v_mfma_f32_16x16x32_bf16 v[44:47], a[16:19], v[76:79], v[44:47]
    v_exp_f32 v50, v50
    v_mfma_f32_16x16x32_bf16 v[40:43], a[0:3], v[80:83], v[40:43]
    ds_read_b128 a[16:19], v9 offset:49408
    v_exp_f32 v51, v51
    v_mfma_f32_16x16x32_bf16 v[44:47], a[0:3], v[84:87], v[44:47]
    v_cvt_pk_bf16_f32 v26, v48, v49
    s_waitcnt lgkmcnt(2)
    v_mfma_f32_16x16x32_bf16 v[40:43], a[4:7], v[88:91], v[40:43]
    ds_read_b128 a[0:3], v10 offset:49408
    v_exp_f32 v52, v52
    v_add_u32 v3, 16384, v2
    v_mfma_f32_16x16x32_bf16 v[44:47], a[4:7], v[92:95], v[44:47]
    buffer_load_dwordx4 v21, s[12:15], s30 offen offset:2048 nt lds
    v_exp_f32 v53, v53
    ds_read_b64_tr_b16 a[48:49], v3 offset:0
    v_mfma_f32_16x16x32_bf16 v[40:43], a[8:11], v[96:99], v[40:43]
    ds_read_b128 a[4:7], v7 offset:51200
    v_cvt_pk_bf16_f32 v27, v50, v51
    ds_read_b64_tr_b16 a[50:51], v3 offset:2048
    v_mfma_f32_16x16x32_bf16 v[44:47], a[8:11], v[100:103], v[44:47]
    v_exp_f32 v54, v54
    ds_read_b64_tr_b16 a[52:53], v3 offset:4096
    s_waitcnt lgkmcnt(5)
    v_mfma_f32_16x16x32_bf16 v[40:43], a[12:15], v[104:107], v[40:43]
    ds_read_b128 a[8:11], v8 offset:51200
    v_exp_f32 v55, v55
    ds_read_b64_tr_b16 a[54:55], v3 offset:6144
    v_mfma_f32_16x16x32_bf16 v[44:47], a[12:15], v[108:111], v[44:47]
    v_cvt_pk_bf16_f32 v30, v52, v53
    s_nop 0
    v_cvt_pk_bf16_f32 v31, v54, v55
    ds_read_b64_tr_b16 a[56:57], v3 offset:8192
    v_mfma_f32_16x16x32_bf16 v[40:43], a[16:19], v[112:115], v[40:43]
    ds_read_b128 a[12:15], v9 offset:51200
    ds_read_b64_tr_b16 a[58:59], v3 offset:10240
    v_mfma_f32_16x16x32_bf16 v[44:47], a[16:19], v[116:119], v[44:47]
    ds_read_b64_tr_b16 a[60:61], v3 offset:12288
    ds_read_b64_tr_b16 a[62:63], v3 offset:14336
    s_waitcnt lgkmcnt(9)
    v_mfma_f32_16x16x32_bf16 v[40:43], a[0:3], v[120:123], v[40:43]
    ds_read_b128 a[16:19], v10 offset:51200
    buffer_load_dwordx4 v22, s[12:15], s30 offen offset:3072 nt lds
    v_mfma_f32_16x16x32_bf16 v[44:47], a[0:3], v[124:127], v[44:47]
    v_mfma_f32_16x16x32_bf16 v[48:51], a[4:7], v[64:67], v[56:59]
    ds_read_b128 a[0:3], v7 offset:51456
    v_mfma_f32_16x16x32_bf16 v[52:55], a[4:7], v[68:71], v[60:63]
    s_waitcnt lgkmcnt(5)
    v_mfma_f32_16x16x32_bf16 v[48:51], a[8:11], v[72:75], v[48:51]
    ds_read_b128 a[4:7], v8 offset:51456
    v_mfma_f32_16x16x32_bf16 v[52:55], a[8:11], v[76:79], v[52:55]
    v_mfma_f32_16x16x32_bf16 v[48:51], a[12:15], v[80:83], v[48:51]
    ds_read_b128 a[8:11], v9 offset:51456
    v_mfma_f32_16x16x32_bf16 v[52:55], a[12:15], v[84:87], v[52:55]
    s_add_u32 m0, s29, 114688
    s_waitcnt lgkmcnt(2)
    v_mfma_f32_16x16x32_bf16 v[48:51], a[16:19], v[88:91], v[48:51]
    ds_read_b128 a[12:15], v10 offset:51456
    s_mov_b32 s30, 147456
    v_mfma_f32_16x16x32_bf16 v[52:55], a[16:19], v[92:95], v[52:55]
    buffer_load_dwordx4 v19, s[8:11], s30 offen offset:0 nt lds
    v_max3_f32 v0, v40, v41, v42
    v_mfma_f32_16x16x32_bf16 v[48:51], a[0:3], v[96:99], v[48:51]
    v_max3_f32 v1, v43, v44, v45
    v_max3_f32 v0, v0, v46, v47
    v_mfma_f32_16x16x32_bf16 v[52:55], a[0:3], v[100:103], v[52:55]
    s_waitcnt lgkmcnt(1)
    v_mfma_f32_16x16x32_bf16 v[48:51], a[4:7], v[104:107], v[48:51]
    v_mfma_f32_16x16x32_bf16 v[52:55], a[4:7], v[108:111], v[52:55]
    v_mfma_f32_16x16x32_bf16 v[48:51], a[8:11], v[112:115], v[48:51]
    v_mfma_f32_16x16x32_bf16 v[52:55], a[8:11], v[116:119], v[52:55]
    s_waitcnt lgkmcnt(0)
    v_mfma_f32_16x16x32_bf16 v[48:51], a[12:15], v[120:123], v[48:51]
    v_mfma_f32_16x16x32_bf16 v[52:55], a[12:15], v[124:127], v[52:55]
    s_barrier
    v_add_u32 v11, 0xffff0000, v11
    v_add_u32 v12, 0xffff0000, v12
    v_add_u32 v13, 0xffff0000, v13
    v_add_u32 v14, 0xffff0000, v14
    v_add_u32 v15, 0xffff0000, v15
    v_add_u32 v16, 0xffff0000, v16
    v_add_u32 v17, 0xffff0000, v17
    v_add_u32 v18, 0xffff0000, v18
    ds_read_b64_tr_b16 a[16:17], v11 offset:0
    ds_read_b64_tr_b16 a[18:19], v11 offset:2048
    ds_read_b64_tr_b16 a[0:1], v12 offset:0
    ds_read_b64_tr_b16 a[2:3], v12 offset:2048
    ds_read_b64_tr_b16 a[4:5], v13 offset:0
    ds_read_b64_tr_b16 a[6:7], v13 offset:2048
    s_waitcnt lgkmcnt(4)
    v_mfma_f32_16x16x32_bf16 v[128:131], a[16:19], v[24:27], v[128:131]
    ds_read_b64_tr_b16 a[8:9], v14 offset:0
    buffer_load_dwordx4 v20, s[8:11], s30 offen offset:1024 nt lds
    v_mfma_f32_16x16x32_bf16 v[132:135], a[16:19], v[28:31], v[132:135]
    ds_read_b64_tr_b16 a[10:11], v14 offset:2048
    s_waitcnt lgkmcnt(4)
    v_mfma_f32_16x16x32_bf16 v[136:139], a[0:3], v[24:27], v[136:139]
    ds_read_b64_tr_b16 a[12:13], v15 offset:0
    v_mfma_f32_16x16x32_bf16 v[140:143], a[0:3], v[28:31], v[140:143]
    ds_read_b64_tr_b16 a[14:15], v15 offset:2048
    v_max3_f32 v1, v1, v48, v49
    v_max3_f32 v0, v0, v50, v51
    v_mfma_f32_16x16x32_bf16 a[20:23], a[28:31], v[24:27], a[20:23]
    ds_read_b64_tr_b16 a[16:17], v16 offset:0
    buffer_load_dwordx4 v19, s[8:11], s30 offen offset:2048 nt lds
    v_max3_f32 v1, v1, v52, v53
    v_mfma_f32_16x16x32_bf16 a[24:27], a[28:31], v[28:31], a[24:27]
    ds_read_b64_tr_b16 a[18:19], v16 offset:2048
    v_max3_f32 v0, v0, v54, v55
    s_waitcnt lgkmcnt(4)
    v_mfma_f32_16x16x32_bf16 v[144:147], a[4:7], v[24:27], v[144:147]
    ds_read_b64_tr_b16 a[0:1], v17 offset:0
    v_max_f32 v0, v0, v1
    v_cmp_lt_f32 vcc, s31, v0
    v_mfma_f32_16x16x32_bf16 v[148:151], a[4:7], v[28:31], v[148:151]
    ds_read_b64_tr_b16 a[2:3], v17 offset:2048
    s_cbranch_vccnz L_up_4
L_upb_4:
    v_mfma_f32_16x16x32_bf16 v[152:155], a[8:11], v[24:27], v[152:155]
    ds_read_b64_tr_b16 a[4:5], v18 offset:0
    buffer_load_dwordx4 v20, s[8:11], s30 offen offset:3072 nt lds
    v_mfma_f32_16x16x32_bf16 v[156:159], a[8:11], v[28:31], v[156:159]
    ds_read_b64_tr_b16 a[6:7], v18 offset:2048
    s_waitcnt lgkmcnt(4)
    v_mfma_f32_16x16x32_bf16 v[160:163], a[12:15], v[24:27], v[160:163]
    ds_read_b64_tr_b16 a[8:9], v11 offset:256
    v_exp_f32 v40, v40
    v_mfma_f32_16x16x32_bf16 v[164:167], a[12:15], v[28:31], v[164:167]
    ds_read_b64_tr_b16 a[10:11], v11 offset:2304
    v_exp_f32 v41, v41
    v_mfma_f32_16x16x32_bf16 v[168:171], a[16:19], v[24:27], v[168:171]
    ds_read_b64_tr_b16 a[12:13], v12 offset:256
    s_add_u32 m0, s29, 147456
    v_mfma_f32_16x16x32_bf16 v[172:175], a[16:19], v[28:31], v[172:175]
    ds_read_b64_tr_b16 a[14:15], v12 offset:2304
    s_waitcnt lgkmcnt(4)
    v_mfma_f32_16x16x32_bf16 v[176:179], a[0:3], v[24:27], v[176:179]
    ds_read_b64_tr_b16 a[16:17], v13 offset:256
    s_mov_b32 s30, 131072
    v_mfma_f32_16x16x32_bf16 v[180:183], a[0:3], v[28:31], v[180:183]
    ds_read_b64_tr_b16 a[18:19], v13 offset:2304
    buffer_load_dwordx4 v21, s[12:15], s30 offen offset:0 nt lds
    v_mfma_f32_16x16x32_bf16 v[184:187], a[4:7], v[24:27], v[184:187]
    ds_read_b64_tr_b16 a[0:1], v14 offset:256
    s_add_u32 m0, s29, 16384
    v_mfma_f32_16x16x32_bf16 v[188:191], a[4:7], v[28:31], v[188:191]
    ds_read_b64_tr_b16 a[2:3], v14 offset:2304
    s_waitcnt lgkmcnt(4)
    v_mfma_f32_16x16x32_bf16 v[192:195], a[8:11], v[24:27], v[192:195]
    ds_read_b64_tr_b16 a[4:5], v15 offset:256
    s_add_u32 s30, s77, 0
    v_mfma_f32_16x16x32_bf16 v[196:199], a[8:11], v[28:31], v[196:199]
    ds_read_b64_tr_b16 a[6:7], v15 offset:2304
    buffer_load_dwordx4 v23, s[20:23], s30 offen offset:0  lds
    v_mfma_f32_16x16x32_bf16 v[200:203], a[12:15], v[24:27], v[200:203]
    ds_read_b64_tr_b16 a[8:9], v16 offset:256
    s_add_u32 s30, s77, 6144
    v_mfma_f32_16x16x32_bf16 v[204:207], a[12:15], v[28:31], v[204:207]
    ds_read_b64_tr_b16 a[10:11], v16 offset:2304
    s_waitcnt lgkmcnt(4)
    v_mfma_f32_16x16x32_bf16 v[208:211], a[16:19], v[24:27], v[208:211]
    ds_read_b64_tr_b16 a[12:13], v17 offset:256
    buffer_load_dwordx4 v23, s[20:23], s30 offen offset:1024  lds
    v_mfma_f32_16x16x32_bf16 v[212:215], a[16:19], v[28:31], v[212:215]
    ds_read_b64_tr_b16 a[14:15], v17 offset:2304
    v_exp_f32 v42, v42
    v_mfma_f32_16x16x32_bf16 v[216:219], a[0:3], v[24:27], v[216:219]
    ds_read_b64_tr_b16 a[16:17], v18 offset:256
    s_add_u32 s30, s77, 12288
    v_mfma_f32_16x16x32_bf16 v[220:223], a[0:3], v[28:31], v[220:223]
    ds_read_b64_tr_b16 a[18:19], v18 offset:2304
    s_waitcnt lgkmcnt(4)
    v_mfma_f32_16x16x32_bf16 v[224:227], a[4:7], v[24:27], v[224:227]
    buffer_load_dwordx4 v23, s[20:23], s30 offen offset:2048  lds
    v_exp_f32 v43, v43
    v_mfma_f32_16x16x32_bf16 v[228:231], a[4:7], v[28:31], v[228:231]
    v_cvt_pk_bf16_f32 v32, v40, v41
    v_exp_f32 v44, v44
    v_mfma_f32_16x16x32_bf16 v[232:235], a[8:11], v[24:27], v[232:235]
    s_add_u32 s30, s77, 18432
    buffer_load_dwordx4 v23, s[20:23], s30 offen offset:3072  lds
    v_mfma_f32_16x16x32_bf16 v[236:239], a[8:11], v[28:31], v[236:239]
    v_exp_f32 v45, v45
    s_waitcnt lgkmcnt(0)
    v_mfma_f32_16x16x32_bf16 v[240:243], a[12:15], v[24:27], v[240:243]
    v_cvt_pk_bf16_f32 v33, v42, v43
    v_exp_f32 v46, v46
    v_mfma_f32_16x16x32_bf16 v[244:247], a[12:15], v[28:31], v[244:247]
    v_exp_f32 v47, v47
    v_cvt_pk_bf16_f32 v36, v44, v45
    v_mfma_f32_16x16x32_bf16 v[248:251], a[16:19], v[24:27], v[248:251]
    s_nop 0
    v_cvt_pk_bf16_f32 v37, v46, v47
    v_mfma_f32_16x16x32_bf16 v[252:255], a[16:19], v[28:31], v[252:255]
    s_cbranch_vccnz L_rs_4
L_rsb_4:
    v_add_u32 v7, 0xffff8000, v7
    v_add_u32 v8, 0xffff8000, v8
    v_add_u32 v9, 0xffff8000, v9
    v_add_u32 v10, 0xffff8000, v10
    ds_read_b128 a[0:3], v7 offset:0
    ds_read_b128 a[4:7], v8 offset:0
    ds_read_b128 a[8:11], v9 offset:0
    ds_read_b128 a[12:15], v10 offset:0
    s_waitcnt lgkmcnt(3)
    v_mfma_f32_16x16x32_bf16 v[40:43], a[0:3], v[64:67], v[56:59]
    ds_read_b128 a[16:19], v7 offset:256
    s_add_u32 m0, s29, 147456
    v_mfma_f32_16x16x32_bf16 v[44:47], a[0:3], v[68:71], v[60:63]
    s_mov_b32 s30, 131072
    s_waitcnt lgkmcnt(2)
    v_mfma_f32_16x16x32_bf16 v[40:43], a[4:7], v[72:75], v[40:43]
    ds_read_b128 a[0:3], v8 offset:256
    buffer_load_dwordx4 v22, s[12:15], s30 offen offset:1024 nt lds
    v_mfma_f32_16x16x32_bf16 v[44:47], a[4:7], v[76:79], v[44:47]
    v_exp_f32 v48, v48
    v_mfma_f32_16x16x32_bf16 v[40:43], a[8:11], v[80:83], v[40:43]
    ds_read_b128 a[4:7], v9 offset:256
    v_exp_f32 v49, v49
    v_mfma_f32_16x16x32_bf16 v[44:47], a[8:11], v[84:87], v[44:47]
    v_exp_f32 v50, v50
    s_waitcnt lgkmcnt(2)
    v_mfma_f32_16x16x32_bf16 v[40:43], a[12:15], v[88:91], v[40:43]
    ds_read_b128 a[8:11], v10 offset:256
    v_exp_f32 v51, v51
    v_mfma_f32_16x16x32_bf16 v[44:47], a[12:15], v[92:95], v[44:47]
    v_cvt_pk_bf16_f32 v34, v48, v49
    v_exp_f32 v52, v52
    v_mfma_f32_16x16x32_bf16 v[40:43], a[16:19], v[96:99], v[40:43]
    ds_read_b128 a[12:15], v7 offset:2048
    v_exp_f32 v53, v53
    v_mfma_f32_16x16x32_bf16 v[44:47], a[16:19], v[100:103], v[44:47]
    v_cvt_pk_bf16_f32 v35, v50, v51
    s_waitcnt lgkmcnt(2)
    v_mfma_f32_16x16x32_bf16 v[40:43], a[0:3], v[104:107], v[40:43]
    ds_read_b128 a[16:19], v8 offset:2048
    buffer_load_dwordx4 v21, s[12:15], s30 offen offset:2048 nt lds
    v_mfma_f32_16x16x32_bf16 v[44:47], a[0:3], v[108:111], v[44:47]
    v_exp_f32 v54, v54
    v_mfma_f32_16x16x32_bf16 v[40:43], a[4:7], v[112:115], v[40:43]
    ds_read_b128 a[0:3], v9 offset:2048
    v_exp_f32 v55, v55
    v_mfma_f32_16x16x32_bf16 v[44:47], a[4:7], v[116:119], v[44:47]
    v_cvt_pk_bf16_f32 v38, v52, v53
    s_nop 0
    s_waitcnt lgkmcnt(2)
    v_mfma_f32_16x16x32_bf16 v[40:43], a[8:11], v[120:123], v[40:43]
    ds_read_b128 a[4:7], v10 offset:2048
    v_cvt_pk_bf16_f32 v39, v54, v55
    v_mfma_f32_16x16x32_bf16 v[44:47], a[8:11], v[124:127], v[44:47]
    v_mfma_f32_16x16x32_bf16 v[48:51], a[12:15], v[64:67], v[56:59]
    ds_read_b128 a[8:11], v7 offset:2304
    v_mfma_f32_16x16x32_bf16 v[52:55], a[12:15], v[68:71], v[60:63]
    s_waitcnt lgkmcnt(2)
    v_mfma_f32_16x16x32_bf16 v[48:51], a[16:19], v[72:75], v[48:51]
    ds_read_b128 a[12:15], v8 offset:2304
    v_mfma_f32_16x16x32_bf16 v[52:55], a[16:19], v[76:79], v[52:55]
    v_mfma_f32_16x16x32_bf16 v[48:51], a[0:3], v[80:83], v[48:51]
    ds_read_b128 a[16:19], v9 offset:2304
    buffer_load_dwordx4 v22, s[12:15], s30 offen offset:3072 nt lds
    v_mfma_f32_16x16x32_bf16 v[52:55], a[0:3], v[84:87], v[52:55]
    s_waitcnt lgkmcnt(2)
    v_mfma_f32_16x16x32_bf16 v[48:51], a[4:7], v[88:91], v[48:51]
    ds_read_b128 a[0:3], v10 offset:2304
    v_max3_f32 v0, v40, v41, v42
    v_mfma_f32_16x16x32_bf16 v[52:55], a[4:7], v[92:95], v[52:55]
    v_max3_f32 v1, v43, v44, v45
    v_max3_f32 v0, v0, v46, v47
    v_mfma_f32_16x16x32_bf16 v[48:51], a[8:11], v[96:99], v[48:51]
    v_mfma_f32_16x16x32_bf16 v[52:55], a[8:11], v[100:103], v[52:55]
    s_waitcnt lgkmcnt(1)
    v_mfma_f32_16x16x32_bf16 v[48:51], a[12:15], v[104:107], v[48:51]
    v_mfma_f32_16x16x32_bf16 v[52:55], a[12:15], v[108:111], v[52:55]
    v_mfma_f32_16x16x32_bf16 v[48:51], a[16:19], v[112:115], v[48:51]
    v_mfma_f32_16x16x32_bf16 v[52:55], a[16:19], v[116:119], v[52:55]
    s_waitcnt lgkmcnt(0)
    v_mfma_f32_16x16x32_bf16 v[48:51], a[0:3], v[120:123], v[48:51]
    v_mfma_f32_16x16x32_bf16 v[52:55], a[0:3], v[124:127], v[52:55]
    s_barrier
    ds_read_b64_tr_b16 a[4:5], v11 offset:32768
    ds_read_b64_tr_b16 a[6:7], v11 offset:34816
    ds_read_b64_tr_b16 a[8:9], v12 offset:32768
    ds_read_b64_tr_b16 a[10:11], v12 offset:34816
    ds_read_b64_tr_b16 a[12:13], v13 offset:32768
    ds_read_b64_tr_b16 a[14:15], v13 offset:34816
    s_waitcnt lgkmcnt(4)
    v_mfma_f32_16x16x32_bf16 v[128:131], a[4:7], v[32:35], v[128:131]
    ds_read_b64_tr_b16 a[16:17], v14 offset:32768
    s_add_u32 m0, s29, 0
    v_mfma_f32_16x16x32_bf16 v[132:135], a[4:7], v[36:39], v[132:135]
    ds_read_b64_tr_b16 a[18:19], v14 offset:34816
    s_waitcnt lgkmcnt(4)
    v_mfma_f32_16x16x32_bf16 v[136:139], a[8:11], v[32:35], v[136:139]
    ds_read_b64_tr_b16 a[0:1], v15 offset:32768
    s_mov_b32 s30, 163840
    v_mfma_f32_16x16x32_bf16 v[140:143], a[8:11], v[36:39], v[140:143]
    ds_read_b64_tr_b16 a[2:3], v15 offset:34816
    buffer_load_dwordx4 v19, s[8:11], s30 offen offset:0 nt lds
    v_max3_f32 v1, v1, v48, v49
    v_mfma_f32_16x16x32_bf16 a[20:23], a[28:31], v[32:35], a[20:23]
    ds_read_b64_tr_b16 a[4:5], v16 offset:32768
    v_max3_f32 v0, v0, v50, v51
    v_max3_f32 v1, v1, v52, v53
    v_mfma_f32_16x16x32_bf16 a[24:27], a[28:31], v[36:39], a[24:27]
    ds_read_b64_tr_b16 a[6:7], v16 offset:34816
    v_max3_f32 v0, v0, v54, v55
    s_waitcnt lgkmcnt(4)
    v_mfma_f32_16x16x32_bf16 v[144:147], a[12:15], v[32:35], v[144:147]
    ds_read_b64_tr_b16 a[8:9], v17 offset:32768
    v_max_f32 v0, v0, v1
    v_cmp_lt_f32 vcc, s31, v0
    v_mfma_f32_16x16x32_bf16 v[148:151], a[12:15], v[36:39], v[148:151]
    ds_read_b64_tr_b16 a[10:11], v17 offset:34816
    s_cbranch_vccnz L_up_5
L_upb_5:
    v_mfma_f32_16x16x32_bf16 v[152:155], a[16:19], v[32:35], v[152:155]
    ds_read_b64_tr_b16 a[12:13], v18 offset:32768
    buffer_load_dwordx4 v20, s[8:11], s30 offen offset:1024 nt lds
    v_mfma_f32_16x16x32_bf16 v[156:159], a[16:19], v[36:39], v[156:159]
    ds_read_b64_tr_b16 a[14:15], v18 offset:34816
    s_waitcnt lgkmcnt(4)
    v_mfma_f32_16x16x32_bf16 v[160:163], a[0:3], v[32:35], v[160:163]
    ds_read_b64_tr_b16 a[16:17], v11 offset:33024
    v_exp_f32 v40, v40
    v_mfma_f32_16x16x32_bf16 v[164:167], a[0:3], v[36:39], v[164:167]
    ds_read_b64_tr_b16 a[18:19], v11 offset:35072
    v_exp_f32 v41, v41
    v_mfma_f32_16x16x32_bf16 v[168:171], a[4:7], v[32:35], v[168:171]
    ds_read_b64_tr_b16 a[0:1], v12 offset:33024
    v_exp_f32 v42, v42
    v_mfma_f32_16x16x32_bf16 v[172:175], a[4:7], v[36:39], v[172:175]
    ds_read_b64_tr_b16 a[2:3], v12 offset:35072
    s_waitcnt lgkmcnt(4)
    v_mfma_f32_16x16x32_bf16 v[176:179], a[8:11], v[32:35], v[176:179]
    ds_read_b64_tr_b16 a[4:5], v13 offset:33024
    v_exp_f32 v43, v43
    v_mfma_f32_16x16x32_bf16 v[180:183], a[8:11], v[36:39], v[180:183]
    ds_read_b64_tr_b16 a[6:7], v13 offset:35072
    v_cvt_pk_bf16_f32 v24, v40, v41
    v_mfma_f32_16x16x32_bf16 v[184:187], a[12:15], v[32:35], v[184:187]
    ds_read_b64_tr_b16 a[8:9], v14 offset:33024
    buffer_load_dwordx4 v19, s[8:11], s30 offen offset:2048 nt lds
    v_mfma_f32_16x16x32_bf16 v[188:191], a[12:15], v[36:39], v[188:191]
    ds_read_b64_tr_b16 a[10:11], v14 offset:35072
    s_waitcnt lgkmcnt(4)
    v_mfma_f32_16x16x32_bf16 v[192:195], a[16:19], v[32:35], v[192:195]
    ds_read_b64_tr_b16 a[12:13], v15 offset:33024
    v_exp_f32 v44, v44
    v_mfma_f32_16x16x32_bf16 v[196:199], a[16:19], v[36:39], v[196:199]
    ds_read_b64_tr_b16 a[14:15], v15 offset:35072
    v_exp_f32 v45, v45
    v_mfma_f32_16x16x32_bf16 v[200:203], a[0:3], v[32:35], v[200:203]
    ds_read_b64_tr_b16 a[16:17], v16 offset:33024
    v_cvt_pk_bf16_f32 v25, v42, v43
    v_mfma_f32_16x16x32_bf16 v[204:207], a[0:3], v[36:39], v[204:207]
    ds_read_b64_tr_b16 a[18:19], v16 offset:35072
    s_waitcnt lgkmcnt(4)
    v_mfma_f32_16x16x32_bf16 v[208:211], a[4:7], v[32:35], v[208:211]
    ds_read_b64_tr_b16 a[0:1], v17 offset:33024
    v_exp_f32 v46, v46
    v_mfma_f32_16x16x32_bf16 v[212:215], a[4:7], v[36:39], v[212:215]
    ds_read_b64_tr_b16 a[2:3], v17 offset:35072
    v_exp_f32 v47, v47
    v_mfma_f32_16x16x32_bf16 v[216:219], a[8:11], v[32:35], v[216:219]
    ds_read_b64_tr_b16 a[4:5], v18 offset:33024
    buffer_load_dwordx4 v20, s[8:11], s30 offen offset:3072 nt lds
    v_cvt_pk_bf16_f32 v28, v44, v45
    v_mfma_f32_16x16x32_bf16 v[220:223], a[8:11], v[36:39], v[220:223]
    ds_read_b64_tr_b16 a[6:7], v18 offset:35072
    s_nop 0
    s_waitcnt lgkmcnt(4)
    v_mfma_f32_16x16x32_bf16 v[224:227], a[12:15], v[32:35], v[224:227]
    v_cvt_pk_bf16_f32 v29, v46, v47
    v_mfma_f32_16x16x32_bf16 v[228:231], a[12:15], v[36:39], v[228:231]
    v_mfma_f32_16x16x32_bf16 v[232:235], a[16:19], v[32:35], v[232:235]
    v_mfma_f32_16x16x32_bf16 v[236:239], a[16:19], v[36:39], v[236:239]
    s_waitcnt lgkmcnt(0)
    v_mfma_f32_16x16x32_bf16 v[240:243], a[0:3], v[32:35], v[240:243]
    v_mfma_f32_16x16x32_bf16 v[244:247], a[0:3], v[36:39], v[244:247]
    v_mfma_f32_16x16x32_bf16 v[248:251], a[4:7], v[32:35], v[248:251]
    v_mfma_f32_16x16x32_bf16 v[252:255], a[4:7], v[36:39], v[252:255]
    s_cbranch_vccnz L_rs_5
L_rsb_5:
    s_waitcnt vmcnt(7)
    s_barrier
    ds_read_b128 a[8:11], v7 offset:16384
    ds_read_b128 a[12:15], v8 offset:16384
    ds_read_b128 a[16:19], v9 offset:16384
    ds_read_b128 a[0:3], v10 offset:16384
    s_waitcnt lgkmcnt(3)
    v_mfma_f32_16x16x32_bf16 v[40:43], a[8:11], v[64:67], v[56:59]
    ds_read_b128 a[4:7], v7 offset:16640
    s_add_u32 m0, s29, 65536
    v_mfma_f32_16x16x32_bf16 v[44:47], a[8:11], v[68:71], v[60:63]
    s_mov_b32 s30, 147456
    s_waitcnt lgkmcnt(2)
    v_mfma_f32_16x16x32_bf16 v[40:43], a[12:15], v[72:75], v[40:43]
    ds_read_b128 a[8:11], v8 offset:16640
    buffer_load_dwordx4 v21, s[12:15], s30 offen offset:0 nt lds
    v_mfma_f32_16x16x32_bf16 v[44:47], a[12:15], v[76:79], v[44:47]
    v_exp_f32 v48, v48
    v_mfma_f32_16x16x32_bf16 v[40:43], a[16:19], v[80:83], v[40:43]
    ds_read_b128 a[12:15], v9 offset:16640
    v_exp_f32 v49, v49
    v_mfma_f32_16x16x32_bf16 v[44:47], a[16:19], v[84:87], v[44:47]
    v_exp_f32 v50, v50
    s_waitcnt lgkmcnt(2)
    v_mfma_f32_16x16x32_bf16 v[40:43], a[0:3], v[88:91], v[40:43]
    ds_read_b128 a[16:19], v10 offset:16640
    v_exp_f32 v51, v51
    v_add_u32 v3, 16384, v2
    v_mfma_f32_16x16x32_bf16 v[44:47], a[0:3], v[92:95], v[44:47]
    buffer_load_dwordx4 v22, s[12:15], s30 offen offset:1024 nt lds
    v_cvt_pk_bf16_f32 v26, v48, v49
    ds_read_b64_tr_b16 a[64:65], v3 offset:0
    ds_read_b64_tr_b16 a[66:67], v3 offset:2048
    v_mfma_f32_16x16x32_bf16 v[40:43], a[4:7], v[96:99], v[40:43]
    ds_read_b128 a[0:3], v7 offset:18432
    v_exp_f32 v52, v52
    ds_read_b64_tr_b16 a[68:69], v3 offset:4096
    v_mfma_f32_16x16x32_bf16 v[44:47], a[4:7], v[100:103], v[44:47]
    v_exp_f32 v53, v53
    ds_read_b64_tr_b16 a[70:71], v3 offset:6144
    s_waitcnt lgkmcnt(6)
    v_mfma_f32_16x16x32_bf16 v[40:43], a[8:11], v[104:107], v[40:43]
    ds_read_b128 a[4:7], v8 offset:18432
    v_cvt_pk_bf16_f32 v27, v50, v51
    ds_read_b64_tr_b16 a[72:73], v3 offset:8192
    v_mfma_f32_16x16x32_bf16 v[44:47], a[8:11], v[108:111], v[44:47]
    v_exp_f32 v54, v54
    ds_read_b64_tr_b16 a[74:75], v3 offset:10240
    ds_read_b64_tr_b16 a[76:77], v3 offset:12288
    v_mfma_f32_16x16x32_bf16 v[40:43], a[12:15], v[112:115], v[40:43]
    ds_read_b128 a[8:11], v9 offset:18432
    v_exp_f32 v55, v55
    ds_read_b64_tr_b16 a[78:79], v3 offset:14336
    v_mfma_f32_16x16x32_bf16 v[44:47], a[12:15], v[116:119], v[44:47]
    v_cvt_pk_bf16_f32 v30, v52, v53
    s_nop 0
    s_waitcnt lgkmcnt(8)
    v_mfma_f32_16x16x32_bf16 v[40:43], a[16:19], v[120:123], v[40:43]
    ds_read_b128 a[12:15], v10 offset:18432
    buffer_load_dwordx4 v21, s[12:15], s30 offen offset:2048 nt lds
    v_cvt_pk_bf16_f32 v31, v54, v55
    v_mfma_f32_16x16x32_bf16 v[44:47], a[16:19], v[124:127], v[44:47]
    v_mfma_f32_16x16x32_bf16 v[48:51], a[0:3], v[64:67], v[56:59]
    ds_read_b128 a[16:19], v7 offset:18688
    v_mfma_f32_16x16x32_bf16 v[52:55], a[0:3], v[68:71], v[60:63]
    s_waitcnt lgkmcnt(3)
    v_mfma_f32_16x16x32_bf16 v[48:51], a[4:7], v[72:75], v[48:51]
    ds_read_b128 a[0:3], v8 offset:18688
    v_mfma_f32_16x16x32_bf16 v[52:55], a[4:7], v[76:79], v[52:55]
    v_mfma_f32_16x16x32_bf16 v[48:51], a[8:11], v[80:83], v[48:51]
    ds_read_b128 a[4:7], v9 offset:18688
    v_mfma_f32_16x16x32_bf16 v[52:55], a[8:11], v[84:87], v[52:55]
    buffer_load_dwordx4 v22, s[12:15], s30 offen offset:3072 nt lds
    s_waitcnt lgkmcnt(2)
    v_mfma_f32_16x16x32_bf16 v[48:51], a[12:15], v[88:91], v[48:51]
    ds_read_b128 a[8:11], v10 offset:18688
    v_max3_f32 v0, v40, v41, v42
    v_mfma_f32_16x16x32_bf16 v[52:55], a[12:15], v[92:95], v[52:55]
    v_max3_f32 v1, v43, v44, v45
    v_max3_f32 v0, v0, v46, v47
    v_mfma_f32_16x16x32_bf16 v[48:51], a[16:19], v[96:99], v[48:51]
    v_mfma_f32_16x16x32_bf16 v[52:55], a[16:19], v[100:103], v[52:55]
    s_waitcnt lgkmcnt(1)
    v_mfma_f32_16x16x32_bf16 v[48:51], a[0:3], v[104:107], v[48:51]
    v_mfma_f32_16x16x32_bf16 v[52:55], a[0:3], v[108:111], v[52:55]
    v_mfma_f32_16x16x32_bf16 v[48:51], a[4:7], v[112:115], v[48:51]
    v_mfma_f32_16x16x32_bf16 v[52:55], a[4:7], v[116:119], v[52:55]
    s_waitcnt lgkmcnt(0)
    v_mfma_f32_16x16x32_bf16 v[48:51], a[8:11], v[120:123], v[48:51]
    v_mfma_f32_16x16x32_bf16 v[52:55], a[8:11], v[124:127], v[52:55]
    s_barrier
    ds_read_b64_tr_b16 a[12:13], v11 offset:49152
    ds_read_b64_tr_b16 a[14:15], v11 offset:51200
    ds_read_b64_tr_b16 a[16:17], v12 offset:49152
    ds_read_b64_tr_b16 a[18:19], v12 offset:51200
    ds_read_b64_tr_b16 a[0:1], v13 offset:49152
    ds_read_b64_tr_b16 a[2:3], v13 offset:51200
    s_waitcnt lgkmcnt(4)
    v_mfma_f32_16x16x32_bf16 v[128:131], a[12:15], v[24:27], v[128:131]
    ds_read_b64_tr_b16 a[4:5], v14 offset:49152
    s_add_u32 m0, s29, 16384
    v_mfma_f32_16x16x32_bf16 v[132:135], a[12:15], v[28:31], v[132:135]
    ds_read_b64_tr_b16 a[6:7], v14 offset:51200
    s_waitcnt lgkmcnt(4)
    v_mfma_f32_16x16x32_bf16 v[136:139], a[16:19], v[24:27], v[136:139]
    ds_read_b64_tr_b16 a[8:9], v15 offset:49152
    s_mov_b32 s30, 180224
    v_mfma_f32_16x16x32_bf16 v[140:143], a[16:19], v[28:31], v[140:143]
    ds_read_b64_tr_b16 a[10:11], v15 offset:51200
    buffer_load_dwordx4 v19, s[8:11], s30 offen offset:0 nt lds
    v_max3_f32 v1, v1, v48, v49
    v_mfma_f32_16x16x32_bf16 a[20:23], a[28:31], v[24:27], a[20:23]
    ds_read_b64_tr_b16 a[12:13], v16 offset:49152
    buffer_load_dwordx4 v20, s[8:11], s30 offen offset:1024 nt lds
    v_max3_f32 v0, v0, v50, v51
    v_mfma_f32_16x16x32_bf16 a[24:27], a[28:31], v[28:31], a[24:27]
    ds_read_b64_tr_b16 a[14:15], v16 offset:51200
    v_max3_f32 v1, v1, v52, v53
    s_waitcnt lgkmcnt(4)
    v_mfma_f32_16x16x32_bf16 v[144:147], a[0:3], v[24:27], v[144:147]
    ds_read_b64_tr_b16 a[16:17], v17 offset:49152
    v_max3_f32 v0, v0, v54, v55
    v_max_f32 v0, v0, v1
    v_mfma_f32_16x16x32_bf16 v[148:151], a[0:3], v[28:31], v[148:151]
    ds_read_b64_tr_b16 a[18:19], v17 offset:51200
    v_cmp_lt_f32 vcc, s31, v0
    s_cbranch_vccnz L_up_6
L_upb_6:
    v_mfma_f32_16x16x32_bf16 v[152:155], a[4:7], v[24:27], v[152:155]
    ds_read_b64_tr_b16 a[0:1], v18 offset:49152
    buffer_load_dwordx4 v19, s[8:11], s30 offen offset:2048 nt lds
    v_mfma_f32_16x16x32_bf16 v[156:159], a[4:7], v[28:31], v[156:159]
    ds_read_b64_tr_b16 a[2:3], v18 offset:51200
    s_waitcnt lgkmcnt(4)
    v_mfma_f32_16x16x32_bf16 v[160:163], a[8:11], v[24:27], v[160:163]
    ds_read_b64_tr_b16 a[4:5], v11 offset:49408
    v_exp_f32 v40, v40
    v_mfma_f32_16x16x32_bf16 v[164:167], a[8:11], v[28:31], v[164:167]
    ds_read_b64_tr_b16 a[6:7], v11 offset:51456
    v_exp_f32 v41, v41
    v_mfma_f32_16x16x32_bf16 v[168:171], a[12:15], v[24:27], v[168:171]
    ds_read_b64_tr_b16 a[8:9], v12 offset:49408
    s_add_u32 m0, s29, 32768
    v_mfma_f32_16x16x32_bf16 v[172:175], a[12:15], v[28:31], v[172:175]
    ds_read_b64_tr_b16 a[10:11], v12 offset:51456
    s_waitcnt lgkmcnt(4)
    v_mfma_f32_16x16x32_bf16 v[176:179], a[16:19], v[24:27], v[176:179]
    ds_read_b64_tr_b16 a[12:13], v13 offset:49408
    s_add_u32 s30, s77, 114688
    v_mfma_f32_16x16x32_bf16 v[180:183], a[16:19], v[28:31], v[180:183]
    ds_read_b64_tr_b16 a[14:15], v13 offset:51456
    buffer_load_dwordx4 v23, s[20:23], s30 offen offset:0  lds
    v_mfma_f32_16x16x32_bf16 v[184:187], a[0:3], v[24:27], v[184:187]
    ds_read_b64_tr_b16 a[16:17], v14 offset:49408
    s_add_u32 s30, s77, 120832
    v_mfma_f32_16x16x32_bf16 v[188:191], a[0:3], v[28:31], v[188:191]
    ds_read_b64_tr_b16 a[18:19], v14 offset:51456
    s_waitcnt lgkmcnt(4)
    v_mfma_f32_16x16x32_bf16 v[192:195], a[4:7], v[24:27], v[192:195]
    ds_read_b64_tr_b16 a[0:1], v15 offset:49408
    buffer_load_dwordx4 v23, s[20:23], s30 offen offset:1024  lds
    v_mfma_f32_16x16x32_bf16 v[196:199], a[4:7], v[28:31], v[196:199]
    ds_read_b64_tr_b16 a[2:3], v15 offset:51456
    v_exp_f32 v42, v42
    v_mfma_f32_16x16x32_bf16 v[200:203], a[8:11], v[24:27], v[200:203]
    ds_read_b64_tr_b16 a[4:5], v16 offset:49408
    s_add_u32 s30, s77, 126976
    v_mfma_f32_16x16x32_bf16 v[204:207], a[8:11], v[28:31], v[204:207]
    ds_read_b64_tr_b16 a[6:7], v16 offset:51456
    s_waitcnt lgkmcnt(4)
    v_mfma_f32_16x16x32_bf16 v[208:211], a[12:15], v[24:27], v[208:211]
    ds_read_b64_tr_b16 a[8:9], v17 offset:49408
    buffer_load_dwordx4 v23, s[20:23], s30 offen offset:2048  lds
    v_mfma_f32_16x16x32_bf16 v[212:215], a[12:15], v[28:31], v[212:215]
    ds_read_b64_tr_b16 a[10:11], v17 offset:51456
    v_exp_f32 v43, v43
    v_mfma_f32_16x16x32_bf16 v[216:219], a[16:19], v[24:27], v[216:219]
    ds_read_b64_tr_b16 a[12:13], v18 offset:49408
    s_add_u32 s30, s77, 133120
    v_cvt_pk_bf16_f32 v32, v40, v41
    v_mfma_f32_16x16x32_bf16 v[220:223], a[16:19], v[28:31], v[220:223]
    ds_read_b64_tr_b16 a[14:15], v18 offset:51456
    s_waitcnt lgkmcnt(4)
    v_mfma_f32_16x16x32_bf16 v[224:227], a[0:3], v[24:27], v[224:227]
    buffer_load_dwordx4 v23, s[20:23], s30 offen offset:3072  lds
    v_exp_f32 v44, v44
    v_mfma_f32_16x16x32_bf16 v[228:231], a[0:3], v[28:31], v[228:231]
    v_exp_f32 v45, v45
    v_cvt_pk_bf16_f32 v33, v42, v43
    v_mfma_f32_16x16x32_bf16 v[232:235], a[4:7], v[24:27], v[232:235]
    v_exp_f32 v46, v46
    v_mfma_f32_16x16x32_bf16 v[236:239], a[4:7], v[28:31], v[236:239]
    v_exp_f32 v47, v47
    s_waitcnt lgkmcnt(0)
    v_mfma_f32_16x16x32_bf16 v[240:243], a[8:11], v[24:27], v[240:243]
    v_cvt_pk_bf16_f32 v36, v44, v45
    s_nop 0
    v_cvt_pk_bf16_f32 v37, v46, v47
    v_mfma_f32_16x16x32_bf16 v[244:247], a[8:11], v[28:31], v[244:247]
    v_mfma_f32_16x16x32_bf16 v[248:251], a[12:15], v[24:27], v[248:251]
    v_mfma_f32_16x16x32_bf16 v[252:255], a[12:15], v[28:31], v[252:255]
    s_cbranch_vccnz L_rs_6
L_rsb_6:
    s_barrier
    ds_read_b128 a[16:19], v7 offset:32768
    ds_read_b128 a[0:3], v8 offset:32768
    ds_read_b128 a[4:7], v9 offset:32768
    ds_read_b128 a[8:11], v10 offset:32768
    s_waitcnt lgkmcnt(3)
    v_mfma_f32_16x16x32_bf16 v[40:43], a[16:19], v[64:67], v[56:59]
    ds_read_b128 a[12:15], v7 offset:33024
    s_add_u32 m0, s29, 16384
    v_mfma_f32_16x16x32_bf16 v[44:47], a[16:19], v[68:71], v[60:63]
    s_mov_b32 s30, 180224
    s_waitcnt lgkmcnt(2)
    v_mfma_f32_16x16x32_bf16 v[40:43], a[0:3], v[72:75], v[40:43]
    ds_read_b128 a[16:19], v8 offset:33024
    buffer_load_dwordx4 v20, s[8:11], s30 offen offset:3072 nt lds
    v_mfma_f32_16x16x32_bf16 v[44:47], a[0:3], v[76:79], v[44:47]
    v_exp_f32 v48, v48
    v_mfma_f32_16x16x32_bf16 v[40:43], a[4:7], v[80:83], v[40:43]
    ds_read_b128 a[0:3], v9 offset:33024
    v_exp_f32 v49, v49
    v_mfma_f32_16x16x32_bf16 v[44:47], a[4:7], v[84:87], v[44:47]
    v_exp_f32 v50, v50
    s_waitcnt lgkmcnt(2)
    v_mfma_f32_16x16x32_bf16 v[40:43], a[8:11], v[88:91], v[40:43]
    ds_read_b128 a[4:7], v10 offset:33024
    v_exp_f32 v51, v51
    v_mfma_f32_16x16x32_bf16 v[44:47], a[8:11], v[92:95], v[44:47]
    s_add_u32 m0, s29, 81920
    s_mov_b32 s30, 163840
    v_cvt_pk_bf16_f32 v34, v48, v49
    v_mfma_f32_16x16x32_bf16 v[40:43], a[12:15], v[96:99], v[40:43]
    ds_read_b128 a[8:11], v7 offset:34816
    buffer_load_dwordx4 v21, s[12:15], s30 offen offset:0 nt lds
    v_mfma_f32_16x16x32_bf16 v[44:47], a[12:15], v[100:103], v[44:47]
    v_exp_f32 v52, v52
    s_waitcnt lgkmcnt(2)
    v_mfma_f32_16x16x32_bf16 v[40:43], a[16:19], v[104:107], v[40:43]
    ds_read_b128 a[12:15], v8 offset:34816
    v_exp_f32 v53, v53
    v_mfma_f32_16x16x32_bf16 v[44:47], a[16:19], v[108:111], v[44:47]
    v_cvt_pk_bf16_f32 v35, v50, v51
    v_exp_f32 v54, v54
    v_mfma_f32_16x16x32_bf16 v[40:43], a[0:3], v[112:115], v[40:43]
    ds_read_b128 a[16:19], v9 offset:34816
    v_exp_f32 v55, v55
    v_mfma_f32_16x16x32_bf16 v[44:47], a[0:3], v[116:119], v[44:47]
    v_cvt_pk_bf16_f32 v38, v52, v53
    s_nop 0
    s_waitcnt lgkmcnt(2)
    v_mfma_f32_16x16x32_bf16 v[40:43], a[4:7], v[120:123], v[40:43]
    ds_read_b128 a[0:3], v10 offset:34816
    buffer_load_dwordx4 v22, s[12:15], s30 offen offset:1024 nt lds
    v_cvt_pk_bf16_f32 v39, v54, v55
    v_mfma_f32_16x16x32_bf16 v[44:47], a[4:7], v[124:127], v[44:47]
    v_mfma_f32_16x16x32_bf16 v[48:51], a[8:11], v[64:67], v[56:59]
    ds_read_b128 a[4:7], v7 offset:35072
    v_mfma_f32_16x16x32_bf16 v[52:55], a[8:11], v[68:71], v[60:63]
    s_waitcnt lgkmcnt(2)
    v_mfma_f32_16x16x32_bf16 v[48:51], a[12:15], v[72:75], v[48:51]
    ds_read_b128 a[8:11], v8 offset:35072
    v_mfma_f32_16x16x32_bf16 v[52:55], a[12:15], v[76:79], v[52:55]
    v_mfma_f32_16x16x32_bf16 v[48:51], a[16:19], v[80:83], v[48:51]
    ds_read_b128 a[12:15], v9 offset:35072
    v_mfma_f32_16x16x32_bf16 v[52:55], a[16:19], v[84:87], v[52:55]
    buffer_load_dwordx4 v21, s[12:15], s30 offen offset:2048 nt lds
    s_waitcnt lgkmcnt(2)
    v_mfma_f32_16x16x32_bf16 v[48:51], a[0:3], v[88:91], v[48:51]
    ds_read_b128 a[16:19], v10 offset:35072
    v_max3_f32 v0, v40, v41, v42
    v_mfma_f32_16x16x32_bf16 v[52:55], a[0:3], v[92:95], v[52:55]
    v_max3_f32 v1, v43, v44, v45
    v_max3_f32 v0, v0, v46, v47
    v_mfma_f32_16x16x32_bf16 v[48:51], a[4:7], v[96:99], v[48:51]
    v_mfma_f32_16x16x32_bf16 v[52:55], a[4:7], v[100:103], v[52:55]
    s_waitcnt lgkmcnt(1)
    v_mfma_f32_16x16x32_bf16 v[48:51], a[8:11], v[104:107], v[48:51]
    v_mfma_f32_16x16x32_bf16 v[52:55], a[8:11], v[108:111], v[52:55]
    v_mfma_f32_16x16x32_bf16 v[48:51], a[12:15], v[112:115], v[48:51]
    v_mfma_f32_16x16x32_bf16 v[52:55], a[12:15], v[116:119], v[52:55]
    s_waitcnt lgkmcnt(0)
    v_mfma_f32_16x16x32_bf16 v[48:51], a[16:19], v[120:123], v[48:51]
    v_mfma_f32_16x16x32_bf16 v[52:55], a[16:19], v[124:127], v[52:55]
    s_barrier
    v_add_u32 v11, 0x18000, v11
    v_add_u32 v12, 0x18000, v12
    v_add_u32 v13, 0x18000, v13
    v_add_u32 v14, 0x18000, v14
    v_add_u32 v15, 0x18000, v15
    v_add_u32 v16, 0x18000, v16
    v_add_u32 v17, 0x18000, v17
    v_add_u32 v18, 0x18000, v18
    ds_read_b64_tr_b16 a[0:1], v11 offset:32768
    ds_read_b64_tr_b16 a[2:3], v11 offset:34816
    ds_read_b64_tr_b16 a[4:5], v12 offset:32768
    ds_read_b64_tr_b16 a[6:7], v12 offset:34816
    ds_read_b64_tr_b16 a[8:9], v13 offset:32768
    ds_read_b64_tr_b16 a[10:11], v13 offset:34816
    s_waitcnt lgkmcnt(4)
    v_mfma_f32_16x16x32_bf16 v[128:131], a[0:3], v[32:35], v[128:131]
    ds_read_b64_tr_b16 a[12:13], v14 offset:32768
    buffer_load_dwordx4 v22, s[12:15], s30 offen offset:3072 nt lds
    v_mfma_f32_16x16x32_bf16 v[132:135], a[0:3], v[36:39], v[132:135]
    ds_read_b64_tr_b16 a[14:15], v14 offset:34816
    s_waitcnt lgkmcnt(4)
    v_mfma_f32_16x16x32_bf16 v[136:139], a[4:7], v[32:35], v[136:139]
    ds_read_b64_tr_b16 a[16:17], v15 offset:32768
    v_mfma_f32_16x16x32_bf16 v[140:143], a[4:7], v[36:39], v[140:143]
    ds_read_b64_tr_b16 a[18:19], v15 offset:34816
    v_max3_f32 v1, v1, v48, v49
    v_max3_f32 v0, v0, v50, v51
    v_mfma_f32_16x16x32_bf16 a[20:23], a[28:31], v[32:35], a[20:23]
    ds_read_b64_tr_b16 a[0:1], v16 offset:32768
    v_max3_f32 v1, v1, v52, v53
    v_max3_f32 v0, v0, v54, v55
    v_mfma_f32_16x16x32_bf16 a[24:27], a[28:31], v[36:39], a[24:27]
    ds_read_b64_tr_b16 a[2:3], v16 offset:34816
    v_max_f32 v0, v0, v1
    s_waitcnt lgkmcnt(4)
    v_mfma_f32_16x16x32_bf16 v[144:147], a[8:11], v[32:35], v[144:147]
    ds_read_b64_tr_b16 a[4:5], v17 offset:32768
    v_cmp_lt_f32 vcc, s31, v0
    s_cbranch_vccnz L_up_7
L_upb_7:
    v_mfma_f32_16x16x32_bf16 v[148:151], a[8:11], v[36:39], v[148:151]
    ds_read_b64_tr_b16 a[6:7], v17 offset:34816
    v_exp_f32 v40, v40
    v_mfma_f32_16x16x32_bf16 v[152:155], a[12:15], v[32:35], v[152:155]
    ds_read_b64_tr_b16 a[8:9], v18 offset:32768
    s_add_u32 m0, s29, 49152
    v_mfma_f32_16x16x32_bf16 v[156:159], a[12:15], v[36:39], v[156:159]
    ds_read_b64_tr_b16 a[10:11], v18 offset:34816
    s_waitcnt lgkmcnt(4)
    v_mfma_f32_16x16x32_bf16 v[160:163], a[16:19], v[32:35], v[160:163]
    ds_read_b64_tr_b16 a[12:13], v11 offset:33024
    s_mov_b32 s30, 196608
    v_mfma_f32_16x16x32_bf16 v[164:167], a[16:19], v[36:39], v[164:167]
    ds_read_b64_tr_b16 a[14:15], v11 offset:35072
    buffer_load_dwordx4 v19, s[8:11], s30 offen offset:0 nt lds
    v_mfma_f32_16x16x32_bf16 v[168:171], a[0:3], v[32:35], v[168:171]
    ds_read_b64_tr_b16 a[16:17], v12 offset:33024
    v_exp_f32 v41, v41
    v_mfma_f32_16x16x32_bf16 v[172:175], a[0:3], v[36:39], v[172:175]
    ds_read_b64_tr_b16 a[18:19], v12 offset:35072
    s_waitcnt lgkmcnt(4)
    v_mfma_f32_16x16x32_bf16 v[176:179], a[4:7], v[32:35], v[176:179]
    ds_read_b64_tr_b16 a[0:1], v13 offset:33024
    v_exp_f32 v42, v42
    v_mfma_f32_16x16x32_bf16 v[180:183], a[4:7], v[36:39], v[180:183]
    ds_read_b64_tr_b16 a[2:3], v13 offset:35072
    v_exp_f32 v43, v43
    v_mfma_f32_16x16x32_bf16 v[184:187], a[8:11], v[32:35], v[184:187]
    ds_read_b64_tr_b16 a[4:5], v14 offset:33024
    buffer_load_dwordx4 v20, s[8:11], s30 offen offset:1024 nt lds
    v_cvt_pk_bf16_f32 v24, v40, v41
    v_mfma_f32_16x16x32_bf16 v[188:191], a[8:11], v[36:39], v[188:191]
    ds_read_b64_tr_b16 a[6:7], v14 offset:35072
    s_waitcnt lgkmcnt(4)
    v_mfma_f32_16x16x32_bf16 v[192:195], a[12:15], v[32:35], v[192:195]
    ds_read_b64_tr_b16 a[8:9], v15 offset:33024
    v_exp_f32 v44, v44
    v_mfma_f32_16x16x32_bf16 v[196:199], a[12:15], v[36:39], v[196:199]
    ds_read_b64_tr_b16 a[10:11], v15 offset:35072
    v_exp_f32 v45, v45
    v_mfma_f32_16x16x32_bf16 v[200:203], a[16:19], v[32:35], v[200:203]
    ds_read_b64_tr_b16 a[12:13], v16 offset:33024
    v_cvt_pk_bf16_f32 v25, v42, v43
    v_mfma_f32_16x16x32_bf16 v[204:207], a[16:19], v[36:39], v[204:207]
    ds_read_b64_tr_b16 a[14:15], v16 offset:35072
    s_waitcnt lgkmcnt(4)
    v_mfma_f32_16x16x32_bf16 v[208:211], a[0:3], v[32:35], v[208:211]
    ds_read_b64_tr_b16 a[16:17], v17 offset:33024
    v_exp_f32 v46, v46
    v_mfma_f32_16x16x32_bf16 v[212:215], a[0:3], v[36:39], v[212:215]
    ds_read_b64_tr_b16 a[18:19], v17 offset:35072
    v_exp_f32 v47, v47
    v_mfma_f32_16x16x32_bf16 v[216:219], a[4:7], v[32:35], v[216:219]
    ds_read_b64_tr_b16 a[0:1], v18 offset:33024
    buffer_load_dwordx4 v19, s[8:11], s30 offen offset:2048 nt lds
    v_cvt_pk_bf16_f32 v28, v44, v45
    v_mfma_f32_16x16x32_bf16 v[220:223], a[4:7], v[36:39], v[220:223]
    ds_read_b64_tr_b16 a[2:3], v18 offset:35072
    s_nop 0
    s_waitcnt lgkmcnt(4)
    v_mfma_f32_16x16x32_bf16 v[224:227], a[8:11], v[32:35], v[224:227]
    v_cvt_pk_bf16_f32 v29, v46, v47
    v_mfma_f32_16x16x32_bf16 v[228:231], a[8:11], v[36:39], v[228:231]
    v_mfma_f32_16x16x32_bf16 v[232:235], a[12:15], v[32:35], v[232:235]
    v_mfma_f32_16x16x32_bf16 v[236:239], a[12:15], v[36:39], v[236:239]
    s_waitcnt lgkmcnt(0)
    v_mfma_f32_16x16x32_bf16 v[240:243], a[16:19], v[32:35], v[240:243]
    v_mfma_f32_16x16x32_bf16 v[244:247], a[16:19], v[36:39], v[244:247]
    v_mfma_f32_16x16x32_bf16 v[248:251], a[0:3], v[32:35], v[248:251]
    v_mfma_f32_16x16x32_bf16 v[252:255], a[0:3], v[36:39], v[252:255]
    s_cbranch_vccnz L_rs_7
L_rsb_7:
    s_waitcnt vmcnt(8)
    s_barrier
    ds_read_b128 a[4:7], v7 offset:49152
    ds_read_b128 a[8:11], v8 offset:49152
    ds_read_b128 a[12:15], v9 offset:49152
    ds_read_b128 a[16:19], v10 offset:49152
    s_waitcnt lgkmcnt(3)
    v_mfma_f32_16x16x32_bf16 v[40:43], a[4:7], v[64:67], v[56:59]
    ds_read_b128 a[0:3], v7 offset:49408
    buffer_load_dwordx4 v20, s[8:11], s30 offen offset:3072 nt lds
    v_mfma_f32_16x16x32_bf16 v[44:47], a[4:7], v[68:71], v[60:63]
    v_exp_f32 v48, v48
    s_waitcnt lgkmcnt(2)
    v_mfma_f32_16x16x32_bf16 v[40:43], a[8:11], v[72:75], v[40:43]
    ds_read_b128 a[4:7], v8 offset:49408
    v_exp_f32 v49, v49
    v_mfma_f32_16x16x32_bf16 v[44:47], a[8:11], v[76:79], v[44:47]
    v_exp_f32 v50, v50
    v_mfma_f32_16x16x32_bf16 v[40:43], a[12:15], v[80:83], v[40:43]
    ds_read_b128 a[8:11], v9 offset:49408
    v_exp_f32 v51, v51
    v_mfma_f32_16x16x32_bf16 v[44:47], a[12:15], v[84:87], v[44:47]
    v_cvt_pk_bf16_f32 v26, v48, v49
    s_waitcnt lgkmcnt(2)
    v_mfma_f32_16x16x32_bf16 v[40:43], a[16:19], v[88:91], v[40:43]
    ds_read_b128 a[12:15], v10 offset:49408
    v_exp_f32 v52, v52
    v_add_u32 v3, 32768, v2
    v_mfma_f32_16x16x32_bf16 v[44:47], a[16:19], v[92:95], v[44:47]
    v_exp_f32 v53, v53
    v_cvt_pk_bf16_f32 v27, v50, v51
    ds_read_b64_tr_b16 a[80:81], v3 offset:0
    v_mfma_f32_16x16x32_bf16 v[40:43], a[0:3], v[96:99], v[40:43]
    ds_read_b128 a[16:19], v7 offset:51200
    v_exp_f32 v54, v54
    ds_read_b64_tr_b16 a[82:83], v3 offset:2048
    v_mfma_f32_16x16x32_bf16 v[44:47], a[0:3], v[100:103], v[44:47]
    v_exp_f32 v55, v55
    ds_read_b64_tr_b16 a[84:85], v3 offset:4096
    s_waitcnt lgkmcnt(5)
    v_mfma_f32_16x16x32_bf16 v[40:43], a[4:7], v[104:107], v[40:43]
    ds_read_b128 a[0:3], v8 offset:51200
    s_add_u32 m0, s29, 98304
    v_cvt_pk_bf16_f32 v30, v52, v53
    ds_read_b64_tr_b16 a[86:87], v3 offset:6144
    v_mfma_f32_16x16x32_bf16 v[44:47], a[4:7], v[108:111], v[44:47]
    s_mov_b32 s30, 180224
    buffer_load_dwordx4 v21, s[12:15], s30 offen offset:0 nt lds
    s_nop 0
    ds_read_b64_tr_b16 a[88:89], v3 offset:8192
    v_mfma_f32_16x16x32_bf16 v[40:43], a[8:11], v[112:115], v[40:43]
    ds_read_b128 a[4:7], v9 offset:51200
    v_cvt_pk_bf16_f32 v31, v54, v55
    ds_read_b64_tr_b16 a[90:91], v3 offset:10240
    v_mfma_f32_16x16x32_bf16 v[44:47], a[8:11], v[116:119], v[44:47]
    ds_read_b64_tr_b16 a[92:93], v3 offset:12288
    ds_read_b64_tr_b16 a[94:95], v3 offset:14336
    s_waitcnt lgkmcnt(9)
    v_mfma_f32_16x16x32_bf16 v[40:43], a[12:15], v[120:123], v[40:43]
    ds_read_b128 a[8:11], v10 offset:51200
    v_mfma_f32_16x16x32_bf16 v[44:47], a[12:15], v[124:127], v[44:47]
    v_mfma_f32_16x16x32_bf16 v[48:51], a[16:19], v[64:67], v[56:59]
    ds_read_b128 a[12:15], v7 offset:51456
    v_mfma_f32_16x16x32_bf16 v[52:55], a[16:19], v[68:71], v[60:63]
    s_waitcnt lgkmcnt(5)
    v_mfma_f32_16x16x32_bf16 v[48:51], a[0:3], v[72:75], v[48:51]
    ds_read_b128 a[16:19], v8 offset:51456
    v_mfma_f32_16x16x32_bf16 v[52:55], a[0:3], v[76:79], v[52:55]
    v_mfma_f32_16x16x32_bf16 v[48:51], a[4:7], v[80:83], v[48:51]
    ds_read_b128 a[0:3], v9 offset:51456
    buffer_load_dwordx4 v22, s[12:15], s30 offen offset:1024 nt lds
    v_mfma_f32_16x16x32_bf16 v[52:55], a[4:7], v[84:87], v[52:55]
    s_waitcnt lgkmcnt(2)
    v_mfma_f32_16x16x32_bf16 v[48:51], a[8:11], v[88:91], v[48:51]
    ds_read_b128 a[4:7], v10 offset:51456
    v_max3_f32 v0, v40, v41, v42
    v_mfma_f32_16x16x32_bf16 v[52:55], a[8:11], v[92:95], v[52:55]
    v_max3_f32 v1, v43, v44, v45
    v_max3_f32 v0, v0, v46, v47
    v_mfma_f32_16x16x32_bf16 v[48:51], a[12:15], v[96:99], v[48:51]
    v_mfma_f32_16x16x32_bf16 v[52:55], a[12:15], v[100:103], v[52:55]
    s_waitcnt lgkmcnt(1)
    v_mfma_f32_16x16x32_bf16 v[48:51], a[16:19], v[104:107], v[48:51]
    v_mfma_f32_16x16x32_bf16 v[52:55], a[16:19], v[108:111], v[52:55]
    v_mfma_f32_16x16x32_bf16 v[48:51], a[0:3], v[112:115], v[48:51]
    v_mfma_f32_16x16x32_bf16 v[52:55], a[0:3], v[116:119], v[52:55]
    s_waitcnt lgkmcnt(0)
    v_mfma_f32_16x16x32_bf16 v[48:51], a[4:7], v[120:123], v[48:51]
    v_mfma_f32_16x16x32_bf16 v[52:55], a[4:7], v[124:127], v[52:55]
    s_barrier
    ds_read_b64_tr_b16 a[8:9], v11 offset:49152
    ds_read_b64_tr_b16 a[10:11], v11 offset:51200
    ds_read_b64_tr_b16 a[12:13], v12 offset:49152
    ds_read_b64_tr_b16 a[14:15], v12 offset:51200
    ds_read_b64_tr_b16 a[16:17], v13 offset:49152
    ds_read_b64_tr_b16 a[18:19], v13 offset:51200
    s_waitcnt lgkmcnt(4)
    v_mfma_f32_16x16x32_bf16 v[128:131], a[8:11], v[24:27], v[128:131]
    ds_read_b64_tr_b16 a[0:1], v14 offset:49152
    buffer_load_dwordx4 v21, s[12:15], s30 offen offset:2048 nt lds
    v_mfma_f32_16x16x32_bf16 v[132:135], a[8:11], v[28:31], v[132:135]
    ds_read_b64_tr_b16 a[2:3], v14 offset:51200
    s_waitcnt lgkmcnt(4)
    v_mfma_f32_16x16x32_bf16 v[136:139], a[12:15], v[24:27], v[136:139]
    ds_read_b64_tr_b16 a[4:5], v15 offset:49152
    v_mfma_f32_16x16x32_bf16 v[140:143], a[12:15], v[28:31], v[140:143]
    ds_read_b64_tr_b16 a[6:7], v15 offset:51200
    v_max3_f32 v1, v1, v48, v49
    v_max3_f32 v0, v0, v50, v51
    v_mfma_f32_16x16x32_bf16 a[20:23], a[28:31], v[24:27], a[20:23]
    ds_read_b64_tr_b16 a[8:9], v16 offset:49152
    buffer_load_dwordx4 v22, s[12:15], s30 offen offset:3072 nt lds
    v_max3_f32 v1, v1, v52, v53
    v_mfma_f32_16x16x32_bf16 a[24:27], a[28:31], v[28:31], a[24:27]
    ds_read_b64_tr_b16 a[10:11], v16 offset:51200
    v_max3_f32 v0, v0, v54, v55
    s_waitcnt lgkmcnt(4)
    v_mfma_f32_16x16x32_bf16 v[144:147], a[16:19], v[24:27], v[144:147]
    ds_read_b64_tr_b16 a[12:13], v17 offset:49152
    v_max_f32 v0, v0, v1
    v_cmp_lt_f32 vcc, s31, v0
    v_mfma_f32_16x16x32_bf16 v[148:151], a[16:19], v[28:31], v[148:151]
    ds_read_b64_tr_b16 a[14:15], v17 offset:51200
    s_cbranch_vccnz L_up_8
L_upb_8:
    v_mfma_f32_16x16x32_bf16 v[152:155], a[0:3], v[24:27], v[152:155]
    ds_read_b64_tr_b16 a[16:17], v18 offset:49152
    s_add_u32 m0, s29, 32768
    v_mfma_f32_16x16x32_bf16 v[156:159], a[0:3], v[28:31], v[156:159]
    ds_read_b64_tr_b16 a[18:19], v18 offset:51200
    s_waitcnt lgkmcnt(4)
    v_mfma_f32_16x16x32_bf16 v[160:163], a[4:7], v[24:27], v[160:163]
    ds_read_b64_tr_b16 a[0:1], v11 offset:49408
    s_mov_b32 s30, 212992
    v_mfma_f32_16x16x32_bf16 v[164:167], a[4:7], v[28:31], v[164:167]
    ds_read_b64_tr_b16 a[2:3], v11 offset:51456
    buffer_load_dwordx4 v19, s[8:11], s30 offen offset:0 nt lds
    v_mfma_f32_16x16x32_bf16 v[168:171], a[8:11], v[24:27], v[168:171]
    ds_read_b64_tr_b16 a[4:5], v12 offset:49408
    buffer_load_dwordx4 v20, s[8:11], s30 offen offset:1024 nt lds
    v_mfma_f32_16x16x32_bf16 v[172:175], a[8:11], v[28:31], v[172:175]
    ds_read_b64_tr_b16 a[6:7], v12 offset:51456
    s_waitcnt lgkmcnt(4)
    v_mfma_f32_16x16x32_bf16 v[176:179], a[12:15], v[24:27], v[176:179]
    ds_read_b64_tr_b16 a[8:9], v13 offset:49408
    v_exp_f32 v40, v40
    v_mfma_f32_16x16x32_bf16 v[180:183], a[12:15], v[28:31], v[180:183]
    ds_read_b64_tr_b16 a[10:11], v13 offset:51456
    v_exp_f32 v41, v41
    v_mfma_f32_16x16x32_bf16 v[184:187], a[16:19], v[24:27], v[184:187]
    ds_read_b64_tr_b16 a[12:13], v14 offset:49408
    s_add_u32 m0, s29, 131072
    v_mfma_f32_16x16x32_bf16 v[188:191], a[16:19], v[28:31], v[188:191]
    ds_read_b64_tr_b16 a[14:15], v14 offset:51456
    s_waitcnt lgkmcnt(4)
    v_mfma_f32_16x16x32_bf16 v[192:195], a[0:3], v[24:27], v[192:195]
    ds_read_b64_tr_b16 a[16:17], v15 offset:49408
    s_add_u32 s30, s78, 0
    v_mfma_f32_16x16x32_bf16 v[196:199], a[0:3], v[28:31], v[196:199]
    ds_read_b64_tr_b16 a[18:19], v15 offset:51456
    buffer_load_dwordx4 v23, s[20:23], s30 offen offset:0  lds
    v_mfma_f32_16x16x32_bf16 v[200:203], a[4:7], v[24:27], v[200:203]
    ds_read_b64_tr_b16 a[0:1], v16 offset:49408
    s_add_u32 s30, s78, 6144
    v_mfma_f32_16x16x32_bf16 v[204:207], a[4:7], v[28:31], v[204:207]
    ds_read_b64_tr_b16 a[2:3], v16 offset:51456
    s_waitcnt lgkmcnt(4)
    v_mfma_f32_16x16x32_bf16 v[208:211], a[8:11], v[24:27], v[208:211]
    ds_read_b64_tr_b16 a[4:5], v17 offset:49408
    buffer_load_dwordx4 v23, s[20:23], s30 offen offset:1024  lds
    v_mfma_f32_16x16x32_bf16 v[212:215], a[8:11], v[28:31], v[212:215]
    ds_read_b64_tr_b16 a[6:7], v17 offset:51456
    v_exp_f32 v42, v42
    v_mfma_f32_16x16x32_bf16 v[216:219], a[12:15], v[24:27], v[216:219]
    ds_read_b64_tr_b16 a[8:9], v18 offset:49408
    s_add_u32 s30, s78, 12288
    v_mfma_f32_16x16x32_bf16 v[220:223], a[12:15], v[28:31], v[220:223]
    ds_read_b64_tr_b16 a[10:11], v18 offset:51456
    s_waitcnt lgkmcnt(4)
    v_mfma_f32_16x16x32_bf16 v[224:227], a[16:19], v[24:27], v[224:227]
    buffer_load_dwordx4 v23, s[20:23], s30 offen offset:2048  lds
    v_exp_f32 v43, v43
    v_mfma_f32_16x16x32_bf16 v[228:231], a[16:19], v[28:31], v[228:231]
    v_cvt_pk_bf16_f32 v32, v40, v41
    v_exp_f32 v44, v44
    v_mfma_f32_16x16x32_bf16 v[232:235], a[0:3], v[24:27], v[232:235]
    s_add_u32 s30, s78, 18432
    buffer_load_dwordx4 v23, s[20:23], s30 offen offset:3072  lds
    v_mfma_f32_16x16x32_bf16 v[236:239], a[0:3], v[28:31], v[236:239]
    v_exp_f32 v45, v45
    s_waitcnt lgkmcnt(0)
    v_mfma_f32_16x16x32_bf16 v[240:243], a[4:7], v[24:27], v[240:243]
    v_cvt_pk_bf16_f32 v33, v42, v43
    v_exp_f32 v46, v46
    v_mfma_f32_16x16x32_bf16 v[244:247], a[4:7], v[28:31], v[244:247]
    v_exp_f32 v47, v47
    v_cvt_pk_bf16_f32 v36, v44, v45
    v_mfma_f32_16x16x32_bf16 v[248:251], a[8:11], v[24:27], v[248:251]
    s_nop 0
    v_cvt_pk_bf16_f32 v37, v46, v47
    v_mfma_f32_16x16x32_bf16 v[252:255], a[8:11], v[28:31], v[252:255]
    s_cbranch_vccnz L_rs_8
L_rsb_8:
    s_barrier
    v_add_u32 v7, 0xffff0000, v7
    v_add_u32 v8, 0xffff0000, v8
    v_add_u32 v9, 0xffff0000, v9
    v_add_u32 v10, 0xffff0000, v10
    ds_read_b128 a[12:15], v7 offset:0
    ds_read_b128 a[16:19], v8 offset:0
    ds_read_b128 a[0:3], v9 offset:0
    ds_read_b128 a[4:7], v10 offset:0
    s_waitcnt lgkmcnt(3)
    v_mfma_f32_16x16x32_bf16 v[40:43], a[12:15], v[64:67], v[56:59]
    ds_read_b128 a[8:11], v7 offset:256
    s_add_u32 m0, s29, 32768
    v_mfma_f32_16x16x32_bf16 v[44:47], a[12:15], v[68:71], v[60:63]
    s_mov_b32 s30, 212992
    s_waitcnt lgkmcnt(2)
    v_mfma_f32_16x16x32_bf16 v[40:43], a[16:19], v[72:75], v[40:43]
    ds_read_b128 a[12:15], v8 offset:256
    buffer_load_dwordx4 v19, s[8:11], s30 offen offset:2048 nt lds
    v_mfma_f32_16x16x32_bf16 v[44:47], a[16:19], v[76:79], v[44:47]
    v_exp_f32 v48, v48
    v_mfma_f32_16x16x32_bf16 v[40:43], a[0:3], v[80:83], v[40:43]
    ds_read_b128 a[16:19], v9 offset:256
    v_exp_f32 v49, v49
    v_mfma_f32_16x16x32_bf16 v[44:47], a[0:3], v[84:87], v[44:47]
    v_exp_f32 v50, v50
    s_waitcnt lgkmcnt(2)
    v_mfma_f32_16x16x32_bf16 v[40:43], a[4:7], v[88:91], v[40:43]
    ds_read_b128 a[0:3], v10 offset:256
    v_exp_f32 v51, v51
    v_mfma_f32_16x16x32_bf16 v[44:47], a[4:7], v[92:95], v[44:47]
    v_cvt_pk_bf16_f32 v34, v48, v49
    v_exp_f32 v52, v52
    v_mfma_f32_16x16x32_bf16 v[40:43], a[8:11], v[96:99], v[40:43]
    ds_read_b128 a[4:7], v7 offset:2048
    v_exp_f32 v53, v53
    v_mfma_f32_16x16x32_bf16 v[44:47], a[8:11], v[100:103], v[44:47]
    v_cvt_pk_bf16_f32 v35, v50, v51
    s_waitcnt lgkmcnt(2)
    v_mfma_f32_16x16x32_bf16 v[40:43], a[12:15], v[104:107], v[40:43]
    ds_read_b128 a[8:11], v8 offset:2048
    buffer_load_dwordx4 v20, s[8:11], s30 offen offset:3072 nt lds
    v_mfma_f32_16x16x32_bf16 v[44:47], a[12:15], v[108:111], v[44:47]
    v_exp_f32 v54, v54
    v_mfma_f32_16x16x32_bf16 v[40:43], a[16:19], v[112:115], v[40:43]
    ds_read_b128 a[12:15], v9 offset:2048
    v_exp_f32 v55, v55
    v_mfma_f32_16x16x32_bf16 v[44:47], a[16:19], v[116:119], v[44:47]
    v_cvt_pk_bf16_f32 v38, v52, v53
    s_nop 0
    s_waitcnt lgkmcnt(2)
    v_mfma_f32_16x16x32_bf16 v[40:43], a[0:3], v[120:123], v[40:43]
    ds_read_b128 a[16:19], v10 offset:2048
    v_cvt_pk_bf16_f32 v39, v54, v55
    v_mfma_f32_16x16x32_bf16 v[44:47], a[0:3], v[124:127], v[44:47]
    v_mfma_f32_16x16x32_bf16 v[48:51], a[4:7], v[64:67], v[56:59]
    ds_read_b128 a[0:3], v7 offset:2304
    v_mfma_f32_16x16x32_bf16 v[52:55], a[4:7], v[68:71], v[60:63]
    s_waitcnt lgkmcnt(2)
    v_mfma_f32_16x16x32_bf16 v[48:51], a[8:11], v[72:75], v[48:51]
    ds_read_b128 a[4:7], v8 offset:2304
    v_mfma_f32_16x16x32_bf16 v[52:55], a[8:11], v[76:79], v[52:55]
    v_mfma_f32_16x16x32_bf16 v[48:51], a[12:15], v[80:83], v[48:51]
    ds_read_b128 a[8:11], v9 offset:2304
    s_add_u32 m0, s29, 114688
    v_mfma_f32_16x16x32_bf16 v[52:55], a[12:15], v[84:87], v[52:55]
    s_mov_b32 s30, 196608
    s_waitcnt lgkmcnt(2)
    v_mfma_f32_16x16x32_bf16 v[48:51], a[16:19], v[88:91], v[48:51]
    ds_read_b128 a[12:15], v10 offset:2304
    buffer_load_dwordx4 v21, s[12:15], s30 offen offset:0 nt lds
    v_mfma_f32_16x16x32_bf16 v[52:55], a[16:19], v[92:95], v[52:55]
    v_max3_f32 v0, v40, v41, v42
    v_max3_f32 v1, v43, v44, v45
    v_mfma_f32_16x16x32_bf16 v[48:51], a[0:3], v[96:99], v[48:51]
    v_max3_f32 v0, v0, v46, v47
    v_mfma_f32_16x16x32_bf16 v[52:55], a[0:3], v[100:103], v[52:55]
    s_waitcnt lgkmcnt(1)
    v_mfma_f32_16x16x32_bf16 v[48:51], a[4:7], v[104:107], v[48:51]
    v_mfma_f32_16x16x32_bf16 v[52:55], a[4:7], v[108:111], v[52:55]
    v_mfma_f32_16x16x32_bf16 v[48:51], a[8:11], v[112:115], v[48:51]
    v_mfma_f32_16x16x32_bf16 v[52:55], a[8:11], v[116:119], v[52:55]
    s_waitcnt lgkmcnt(0)
    v_mfma_f32_16x16x32_bf16 v[48:51], a[12:15], v[120:123], v[48:51]
    v_mfma_f32_16x16x32_bf16 v[52:55], a[12:15], v[124:127], v[52:55]
    s_barrier
    v_add_u32 v11, 0xffff8000, v11
    v_add_u32 v12, 0xffff8000, v12
    v_add_u32 v13, 0xffff8000, v13
    v_add_u32 v14, 0xffff8000, v14
    v_add_u32 v15, 0xffff8000, v15
    v_add_u32 v16, 0xffff8000, v16
    v_add_u32 v17, 0xffff8000, v17
    v_add_u32 v18, 0xffff8000, v18
    ds_read_b64_tr_b16 a[16:17], v11 offset:0
    ds_read_b64_tr_b16 a[18:19], v11 offset:2048
    ds_read_b64_tr_b16 a[0:1], v12 offset:0
    ds_read_b64_tr_b16 a[2:3], v12 offset:2048
    ds_read_b64_tr_b16 a[4:5], v13 offset:0
    ds_read_b64_tr_b16 a[6:7], v13 offset:2048
    s_waitcnt lgkmcnt(4)
    v_mfma_f32_16x16x32_bf16 v[128:131], a[16:19], v[32:35], v[128:131]
    ds_read_b64_tr_b16 a[8:9], v14 offset:0
    buffer_load_dwordx4 v22, s[12:15], s30 offen offset:1024 nt lds
    v_mfma_f32_16x16x32_bf16 v[132:135], a[16:19], v[36:39], v[132:135]
    ds_read_b64_tr_b16 a[10:11], v14 offset:2048
    s_waitcnt lgkmcnt(4)
    v_mfma_f32_16x16x32_bf16 v[136:139], a[0:3], v[32:35], v[136:139]
    ds_read_b64_tr_b16 a[12:13], v15 offset:0
    v_mfma_f32_16x16x32_bf16 v[140:143], a[0:3], v[36:39], v[140:143]
    ds_read_b64_tr_b16 a[14:15], v15 offset:2048
    v_max3_f32 v1, v1, v48, v49
    v_max3_f32 v0, v0, v50, v51
    v_mfma_f32_16x16x32_bf16 a[20:23], a[28:31], v[32:35], a[20:23]
    ds_read_b64_tr_b16 a[16:17], v16 offset:0
    v_max3_f32 v1, v1, v52, v53
    v_max3_f32 v0, v0, v54, v55
    v_mfma_f32_16x16x32_bf16 a[24:27], a[28:31], v[36:39], a[24:27]
    ds_read_b64_tr_b16 a[18:19], v16 offset:2048
    v_max_f32 v0, v0, v1
    s_waitcnt lgkmcnt(4)
    v_mfma_f32_16x16x32_bf16 v[144:147], a[4:7], v[32:35], v[144:147]
    ds_read_b64_tr_b16 a[0:1], v17 offset:0
    v_cmp_lt_f32 vcc, s31, v0
    s_cbranch_vccnz L_up_9
L_upb_9:
    v_mfma_f32_16x16x32_bf16 v[148:151], a[4:7], v[36:39], v[148:151]
    ds_read_b64_tr_b16 a[2:3], v17 offset:2048
    v_exp_f32 v40, v40
    v_mfma_f32_16x16x32_bf16 v[152:155], a[8:11], v[32:35], v[152:155]
    ds_read_b64_tr_b16 a[4:5], v18 offset:0
    buffer_load_dwordx4 v21, s[12:15], s30 offen offset:2048 nt lds
    v_mfma_f32_16x16x32_bf16 v[156:159], a[8:11], v[36:39], v[156:159]
    ds_read_b64_tr_b16 a[6:7], v18 offset:2048
    s_waitcnt lgkmcnt(4)
    v_mfma_f32_16x16x32_bf16 v[160:163], a[12:15], v[32:35], v[160:163]
    ds_read_b64_tr_b16 a[8:9], v11 offset:256
    v_exp_f32 v41, v41
    v_mfma_f32_16x16x32_bf16 v[164:167], a[12:15], v[36:39], v[164:167]
    ds_read_b64_tr_b16 a[10:11], v11 offset:2304
    v_exp_f32 v42, v42
    v_mfma_f32_16x16x32_bf16 v[168:171], a[16:19], v[32:35], v[168:171]
    ds_read_b64_tr_b16 a[12:13], v12 offset:256
    v_exp_f32 v43, v43
    v_mfma_f32_16x16x32_bf16 v[172:175], a[16:19], v[36:39], v[172:175]
    ds_read_b64_tr_b16 a[14:15], v12 offset:2304
    v_cvt_pk_bf16_f32 v24, v40, v41
    s_waitcnt lgkmcnt(4)
    v_mfma_f32_16x16x32_bf16 v[176:179], a[0:3], v[32:35], v[176:179]
    ds_read_b64_tr_b16 a[16:17], v13 offset:256
    v_exp_f32 v44, v44
    v_mfma_f32_16x16x32_bf16 v[180:183], a[0:3], v[36:39], v[180:183]
    ds_read_b64_tr_b16 a[18:19], v13 offset:2304
    v_exp_f32 v45, v45
    v_mfma_f32_16x16x32_bf16 v[184:187], a[4:7], v[32:35], v[184:187]
    ds_read_b64_tr_b16 a[0:1], v14 offset:256
    buffer_load_dwordx4 v22, s[12:15], s30 offen offset:3072 nt lds
    v_cvt_pk_bf16_f32 v25, v42, v43
    v_mfma_f32_16x16x32_bf16 v[188:191], a[4:7], v[36:39], v[188:191]
    ds_read_b64_tr_b16 a[2:3], v14 offset:2304
    s_waitcnt lgkmcnt(4)
    v_mfma_f32_16x16x32_bf16 v[192:195], a[8:11], v[32:35], v[192:195]
    ds_read_b64_tr_b16 a[4:5], v15 offset:256
    v_exp_f32 v46, v46
    v_mfma_f32_16x16x32_bf16 v[196:199], a[8:11], v[36:39], v[196:199]
    ds_read_b64_tr_b16 a[6:7], v15 offset:2304
    v_exp_f32 v47, v47
    v_mfma_f32_16x16x32_bf16 v[200:203], a[12:15], v[32:35], v[200:203]
    ds_read_b64_tr_b16 a[8:9], v16 offset:256
    v_cvt_pk_bf16_f32 v28, v44, v45
    s_nop 0
    v_mfma_f32_16x16x32_bf16 v[204:207], a[12:15], v[36:39], v[204:207]
    ds_read_b64_tr_b16 a[10:11], v16 offset:2304
    v_cvt_pk_bf16_f32 v29, v46, v47
    s_waitcnt lgkmcnt(4)
    v_mfma_f32_16x16x32_bf16 v[208:211], a[16:19], v[32:35], v[208:211]
    ds_read_b64_tr_b16 a[12:13], v17 offset:256
    v_mfma_f32_16x16x32_bf16 v[212:215], a[16:19], v[36:39], v[212:215]
    ds_read_b64_tr_b16 a[14:15], v17 offset:2304
    v_mfma_f32_16x16x32_bf16 v[216:219], a[0:3], v[32:35], v[216:219]
    ds_read_b64_tr_b16 a[16:17], v18 offset:256
    s_add_u32 m0, s29, 0
    v_mfma_f32_16x16x32_bf16 v[220:223], a[0:3], v[36:39], v[220:223]
    ds_read_b64_tr_b16 a[18:19], v18 offset:2304
    s_waitcnt lgkmcnt(4)
    v_mfma_f32_16x16x32_bf16 v[224:227], a[4:7], v[32:35], v[224:227]
    s_mov_b32 s30, 229376
    buffer_load_dwordx4 v19, s[8:11], s30 offen offset:0 nt lds
    v_mfma_f32_16x16x32_bf16 v[228:231], a[4:7], v[36:39], v[228:231]
    v_mfma_f32_16x16x32_bf16 v[232:235], a[8:11], v[32:35], v[232:235]
    v_mfma_f32_16x16x32_bf16 v[236:239], a[8:11], v[36:39], v[236:239]
    s_waitcnt lgkmcnt(0)
    v_mfma_f32_16x16x32_bf16 v[240:243], a[12:15], v[32:35], v[240:243]
    v_mfma_f32_16x16x32_bf16 v[244:247], a[12:15], v[36:39], v[244:247]
    v_mfma_f32_16x16x32_bf16 v[248:251], a[16:19], v[32:35], v[248:251]
    v_mfma_f32_16x16x32_bf16 v[252:255], a[16:19], v[36:39], v[252:255]
    s_cbranch_vccnz L_rs_9
L_rsb_9:
    s_waitcnt vmcnt(7)
    s_barrier
    ds_read_b128 a[0:3], v7 offset:16384
    ds_read_b128 a[4:7], v8 offset:16384
    ds_read_b128 a[8:11], v9 offset:16384
    ds_read_b128 a[12:15], v10 offset:16384
    s_waitcnt lgkmcnt(3)
    v_mfma_f32_16x16x32_bf16 v[40:43], a[0:3], v[64:67], v[56:59]
    ds_read_b128 a[16:19], v7 offset:16640
    buffer_load_dwordx4 v20, s[8:11], s30 offen offset:1024 nt lds
    v_mfma_f32_16x16x32_bf16 v[44:47], a[0:3], v[68:71], v[60:63]
    v_exp_f32 v48, v48
    s_waitcnt lgkmcnt(2)
    v_mfma_f32_16x16x32_bf16 v[40:43], a[4:7], v[72:75], v[40:43]
    ds_read_b128 a[0:3], v8 offset:16640
    v_exp_f32 v49, v49
    v_mfma_f32_16x16x32_bf16 v[44:47], a[4:7], v[76:79], v[44:47]
    v_exp_f32 v50, v50
    v_mfma_f32_16x16x32_bf16 v[40:43], a[8:11], v[80:83], v[40:43]
    ds_read_b128 a[4:7], v9 offset:16640
    v_exp_f32 v51, v51
    v_mfma_f32_16x16x32_bf16 v[44:47], a[8:11], v[84:87], v[44:47]
    v_cvt_pk_bf16_f32 v26, v48, v49
    s_waitcnt lgkmcnt(2)
    v_mfma_f32_16x16x32_bf16 v[40:43], a[12:15], v[88:91], v[40:43]
    ds_read_b128 a[8:11], v10 offset:16640
    v_exp_f32 v52, v52
    v_add_u32 v3, 131072, v2
    v_mfma_f32_16x16x32_bf16 v[44:47], a[12:15], v[92:95], v[44:47]
    buffer_load_dwordx4 v19, s[8:11], s30 offen offset:2048 nt lds
    v_exp_f32 v53, v53
    ds_read_b64_tr_b16 a[96:97], v3 offset:0
    v_mfma_f32_16x16x32_bf16 v[40:43], a[16:19], v[96:99], v[40:43]
    ds_read_b128 a[12:15], v7 offset:18432
    v_cvt_pk_bf16_f32 v27, v50, v51
    ds_read_b64_tr_b16 a[98:99], v3 offset:2048
    v_mfma_f32_16x16x32_bf16 v[44:47], a[16:19], v[100:103], v[44:47]
    v_exp_f32 v54, v54
    ds_read_b64_tr_b16 a[100:101], v3 offset:4096
    s_waitcnt lgkmcnt(5)
    v_mfma_f32_16x16x32_bf16 v[40:43], a[0:3], v[104:107], v[40:43]
    ds_read_b128 a[16:19], v8 offset:18432
    v_exp_f32 v55, v55
    ds_read_b64_tr_b16 a[102:103], v3 offset:6144
    v_mfma_f32_16x16x32_bf16 v[44:47], a[0:3], v[108:111], v[44:47]
    v_cvt_pk_bf16_f32 v30, v52, v53
    s_nop 0
    v_cvt_pk_bf16_f32 v31, v54, v55
    ds_read_b64_tr_b16 a[104:105], v3 offset:8192
    v_mfma_f32_16x16x32_bf16 v[40:43], a[4:7], v[112:115], v[40:43]
    ds_read_b128 a[0:3], v9 offset:18432
    ds_read_b64_tr_b16 a[106:107], v3 offset:10240
    v_mfma_f32_16x16x32_bf16 v[44:47], a[4:7], v[116:119], v[44:47]
    ds_read_b64_tr_b16 a[108:109], v3 offset:12288
    ds_read_b64_tr_b16 a[110:111], v3 offset:14336
    s_waitcnt lgkmcnt(9)
    v_mfma_f32_16x16x32_bf16 v[40:43], a[8:11], v[120:123], v[40:43]
    ds_read_b128 a[4:7], v10 offset:18432
    buffer_load_dwordx4 v20, s[8:11], s30 offen offset:3072 nt lds
    v_mfma_f32_16x16x32_bf16 v[44:47], a[8:11], v[124:127], v[44:47]
    v_mfma_f32_16x16x32_bf16 v[48:51], a[12:15], v[64:67], v[56:59]
    ds_read_b128 a[8:11], v7 offset:18688
    v_mfma_f32_16x16x32_bf16 v[52:55], a[12:15], v[68:71], v[60:63]
    s_waitcnt lgkmcnt(5)
    v_mfma_f32_16x16x32_bf16 v[48:51], a[16:19], v[72:75], v[48:51]
    ds_read_b128 a[12:15], v8 offset:18688
    v_mfma_f32_16x16x32_bf16 v[52:55], a[16:19], v[76:79], v[52:55]
    v_mfma_f32_16x16x32_bf16 v[48:51], a[0:3], v[80:83], v[48:51]
    ds_read_b128 a[16:19], v9 offset:18688
    v_mfma_f32_16x16x32_bf16 v[52:55], a[0:3], v[84:87], v[52:55]
    s_add_u32 m0, s29, 65536
    s_waitcnt lgkmcnt(2)
    v_mfma_f32_16x16x32_bf16 v[48:51], a[4:7], v[88:91], v[48:51]
    ds_read_b128 a[0:3], v10 offset:18688
    s_mov_b32 s30, 212992
    v_mfma_f32_16x16x32_bf16 v[52:55], a[4:7], v[92:95], v[52:55]
    buffer_load_dwordx4 v21, s[12:15], s30 offen offset:0 nt lds
    v_max3_f32 v0, v40, v41, v42
    v_mfma_f32_16x16x32_bf16 v[48:51], a[8:11], v[96:99], v[48:51]
    v_max3_f32 v1, v43, v44, v45
    v_max3_f32 v0, v0, v46, v47
    v_mfma_f32_16x16x32_bf16 v[52:55], a[8:11], v[100:103], v[52:55]
    s_waitcnt lgkmcnt(1)
    v_mfma_f32_16x16x32_bf16 v[48:51], a[12:15], v[104:107], v[48:51]
    v_mfma_f32_16x16x32_bf16 v[52:55], a[12:15], v[108:111], v[52:55]
    v_mfma_f32_16x16x32_bf16 v[48:51], a[16:19], v[112:115], v[48:51]
    v_mfma_f32_16x16x32_bf16 v[52:55], a[16:19], v[116:119], v[52:55]
    s_waitcnt lgkmcnt(0)
    v_mfma_f32_16x16x32_bf16 v[48:51], a[0:3], v[120:123], v[48:51]
    v_mfma_f32_16x16x32_bf16 v[52:55], a[0:3], v[124:127], v[52:55]
    s_barrier
    ds_read_b64_tr_b16 a[4:5], v11 offset:16384
    ds_read_b64_tr_b16 a[6:7], v11 offset:18432
    ds_read_b64_tr_b16 a[8:9], v12 offset:16384
    ds_read_b64_tr_b16 a[10:11], v12 offset:18432
    ds_read_b64_tr_b16 a[12:13], v13 offset:16384
    ds_read_b64_tr_b16 a[14:15], v13 offset:18432
    s_waitcnt lgkmcnt(4)
    v_mfma_f32_16x16x32_bf16 v[128:131], a[4:7], v[24:27], v[128:131]
    ds_read_b64_tr_b16 a[16:17], v14 offset:16384
    buffer_load_dwordx4 v22, s[12:15], s30 offen offset:1024 nt lds
    v_mfma_f32_16x16x32_bf16 v[132:135], a[4:7], v[28:31], v[132:135]
    ds_read_b64_tr_b16 a[18:19], v14 offset:18432
    s_waitcnt lgkmcnt(4)
    v_mfma_f32_16x16x32_bf16 v[136:139], a[8:11], v[24:27], v[136:139]
    ds_read_b64_tr_b16 a[0:1], v15 offset:16384
    v_mfma_f32_16x16x32_bf16 v[140:143], a[8:11], v[28:31], v[140:143]
    ds_read_b64_tr_b16 a[2:3], v15 offset:18432
    v_max3_f32 v1, v1, v48, v49
    v_max3_f32 v0, v0, v50, v51
    v_mfma_f32_16x16x32_bf16 a[20:23], a[28:31], v[24:27], a[20:23]
    ds_read_b64_tr_b16 a[4:5], v16 offset:16384
    buffer_load_dwordx4 v21, s[12:15], s30 offen offset:2048 nt lds
    v_max3_f32 v1, v1, v52, v53
    v_mfma_f32_16x16x32_bf16 a[24:27], a[28:31], v[28:31], a[24:27]
    ds_read_b64_tr_b16 a[6:7], v16 offset:18432
    v_max3_f32 v0, v0, v54, v55
    s_waitcnt lgkmcnt(4)
    v_mfma_f32_16x16x32_bf16 v[144:147], a[12:15], v[24:27], v[144:147]
    ds_read_b64_tr_b16 a[8:9], v17 offset:16384
    v_max_f32 v0, v0, v1
    v_cmp_lt_f32 vcc, s31, v0
    v_mfma_f32_16x16x32_bf16 v[148:151], a[12:15], v[28:31], v[148:151]
    ds_read_b64_tr_b16 a[10:11], v17 offset:18432
    s_cbranch_vccnz L_up_10
L_upb_10:
    v_mfma_f32_16x16x32_bf16 v[152:155], a[16:19], v[24:27], v[152:155]
    ds_read_b64_tr_b16 a[12:13], v18 offset:16384
    buffer_load_dwordx4 v22, s[12:15], s30 offen offset:3072 nt lds
    v_mfma_f32_16x16x32_bf16 v[156:159], a[16:19], v[28:31], v[156:159]
    ds_read_b64_tr_b16 a[14:15], v18 offset:18432
    s_waitcnt lgkmcnt(4)
    v_mfma_f32_16x16x32_bf16 v[160:163], a[0:3], v[24:27], v[160:163]
    ds_read_b64_tr_b16 a[16:17], v11 offset:16640
    v_exp_f32 v40, v40
    v_mfma_f32_16x16x32_bf16 v[164:167], a[0:3], v[28:31], v[164:167]
    ds_read_b64_tr_b16 a[18:19], v11 offset:18688
    v_exp_f32 v41, v41
    v_mfma_f32_16x16x32_bf16 v[168:171], a[4:7], v[24:27], v[168:171]
    ds_read_b64_tr_b16 a[0:1], v12 offset:16640
    s_add_u32 m0, s29, 147456
    v_mfma_f32_16x16x32_bf16 v[172:175], a[4:7], v[28:31], v[172:175]
    ds_read_b64_tr_b16 a[2:3], v12 offset:18688
    s_waitcnt lgkmcnt(4)
    v_mfma_f32_16x16x32_bf16 v[176:179], a[8:11], v[24:27], v[176:179]
    ds_read_b64_tr_b16 a[4:5], v13 offset:16640
    s_add_u32 s30, s78, 114688
    v_mfma_f32_16x16x32_bf16 v[180:183], a[8:11], v[28:31], v[180:183]
    ds_read_b64_tr_b16 a[6:7], v13 offset:18688
    buffer_load_dwordx4 v23, s[20:23], s30 offen offset:0  lds
    v_mfma_f32_16x16x32_bf16 v[184:187], a[12:15], v[24:27], v[184:187]
    ds_read_b64_tr_b16 a[8:9], v14 offset:16640
    s_add_u32 s30, s78, 120832
    v_mfma_f32_16x16x32_bf16 v[188:191], a[12:15], v[28:31], v[188:191]
    ds_read_b64_tr_b16 a[10:11], v14 offset:18688
    s_waitcnt lgkmcnt(4)
    v_mfma_f32_16x16x32_bf16 v[192:195], a[16:19], v[24:27], v[192:195]
    ds_read_b64_tr_b16 a[12:13], v15 offset:16640
    buffer_load_dwordx4 v23, s[20:23], s30 offen offset:1024  lds
    v_mfma_f32_16x16x32_bf16 v[196:199], a[16:19], v[28:31], v[196:199]
    ds_read_b64_tr_b16 a[14:15], v15 offset:18688
    v_exp_f32 v42, v42
    v_mfma_f32_16x16x32_bf16 v[200:203], a[0:3], v[24:27], v[200:203]
    ds_read_b64_tr_b16 a[16:17], v16 offset:16640
    s_add_u32 s30, s78, 126976
    v_mfma_f32_16x16x32_bf16 v[204:207], a[0:3], v[28:31], v[204:207]
    ds_read_b64_tr_b16 a[18:19], v16 offset:18688
    s_waitcnt lgkmcnt(4)
    v_mfma_f32_16x16x32_bf16 v[208:211], a[4:7], v[24:27], v[208:211]
    ds_read_b64_tr_b16 a[0:1], v17 offset:16640
    buffer_load_dwordx4 v23, s[20:23], s30 offen offset:2048  lds
    v_mfma_f32_16x16x32_bf16 v[212:215], a[4:7], v[28:31], v[212:215]
    ds_read_b64_tr_b16 a[2:3], v17 offset:18688
    v_exp_f32 v43, v43
    v_mfma_f32_16x16x32_bf16 v[216:219], a[8:11], v[24:27], v[216:219]
    ds_read_b64_tr_b16 a[4:5], v18 offset:16640
    s_add_u32 s30, s78, 133120
    v_cvt_pk_bf16_f32 v32, v40, v41
    v_mfma_f32_16x16x32_bf16 v[220:223], a[8:11], v[28:31], v[220:223]
    ds_read_b64_tr_b16 a[6:7], v18 offset:18688
    s_waitcnt lgkmcnt(4)
    v_mfma_f32_16x16x32_bf16 v[224:227], a[12:15], v[24:27], v[224:227]
    buffer_load_dwordx4 v23, s[20:23], s30 offen offset:3072  lds
    v_exp_f32 v44, v44
    v_mfma_f32_16x16x32_bf16 v[228:231], a[12:15], v[28:31], v[228:231]
    v_exp_f32 v45, v45
    v_cvt_pk_bf16_f32 v33, v42, v43
    v_mfma_f32_16x16x32_bf16 v[232:235], a[16:19], v[24:27], v[232:235]
    v_exp_f32 v46, v46
    v_mfma_f32_16x16x32_bf16 v[236:239], a[16:19], v[28:31], v[236:239]
    v_exp_f32 v47, v47
    s_waitcnt lgkmcnt(0)
    v_mfma_f32_16x16x32_bf16 v[240:243], a[0:3], v[24:27], v[240:243]
    v_cvt_pk_bf16_f32 v36, v44, v45
    s_nop 0
    v_cvt_pk_bf16_f32 v37, v46, v47
    v_mfma_f32_16x16x32_bf16 v[244:247], a[0:3], v[28:31], v[244:247]
    v_mfma_f32_16x16x32_bf16 v[248:251], a[4:7], v[24:27], v[248:251]
    v_mfma_f32_16x16x32_bf16 v[252:255], a[4:7], v[28:31], v[252:255]
    s_cbranch_vccnz L_rs_10
L_rsb_10:
    s_barrier
    ds_read_b128 a[8:11], v7 offset:49152
    ds_read_b128 a[12:15], v8 offset:49152
    ds_read_b128 a[16:19], v9 offset:49152
    ds_read_b128 a[0:3], v10 offset:49152
    s_waitcnt lgkmcnt(3)
    v_mfma_f32_16x16x32_bf16 v[40:43], a[8:11], v[64:67], v[56:59]
    ds_read_b128 a[4:7], v7 offset:49408
    s_add_u32 m0, s29, 16384
    v_mfma_f32_16x16x32_bf16 v[44:47], a[8:11], v[68:71], v[60:63]
    s_mov_b32 s30, 245760
    s_waitcnt lgkmcnt(2)
    v_mfma_f32_16x16x32_bf16 v[40:43], a[12:15], v[72:75], v[40:43]
    ds_read_b128 a[8:11], v8 offset:49408
    buffer_load_dwordx4 v19, s[8:11], s30 offen offset:0 nt lds
    v_mfma_f32_16x16x32_bf16 v[44:47], a[12:15], v[76:79], v[44:47]
    v_exp_f32 v48, v48
    v_mfma_f32_16x16x32_bf16 v[40:43], a[16:19], v[80:83], v[40:43]
    ds_read_b128 a[12:15], v9 offset:49408
    v_exp_f32 v49, v49
    v_mfma_f32_16x16x32_bf16 v[44:47], a[16:19], v[84:87], v[44:47]
    v_exp_f32 v50, v50
    s_waitcnt lgkmcnt(2)
    v_mfma_f32_16x16x32_bf16 v[40:43], a[0:3], v[88:91], v[40:43]
    ds_read_b128 a[16:19], v10 offset:49408
    v_exp_f32 v51, v51
    v_mfma_f32_16x16x32_bf16 v[44:47], a[0:3], v[92:95], v[44:47]
    buffer_load_dwordx4 v20, s[8:11], s30 offen offset:1024 nt lds
    v_cvt_pk_bf16_f32 v34, v48, v49
    v_mfma_f32_16x16x32_bf16 v[40:43], a[4:7], v[96:99], v[40:43]
    ds_read_b128 a[0:3], v7 offset:51200
    v_exp_f32 v52, v52
    v_mfma_f32_16x16x32_bf16 v[44:47], a[4:7], v[100:103], v[44:47]
    v_exp_f32 v53, v53
    s_waitcnt lgkmcnt(2)
    v_mfma_f32_16x16x32_bf16 v[40:43], a[8:11], v[104:107], v[40:43]
    ds_read_b128 a[4:7], v8 offset:51200
    v_cvt_pk_bf16_f32 v35, v50, v51
    v_mfma_f32_16x16x32_bf16 v[44:47], a[8:11], v[108:111], v[44:47]
    v_exp_f32 v54, v54
    v_mfma_f32_16x16x32_bf16 v[40:43], a[12:15], v[112:115], v[40:43]
    ds_read_b128 a[8:11], v9 offset:51200
    v_exp_f32 v55, v55
    v_mfma_f32_16x16x32_bf16 v[44:47], a[12:15], v[116:119], v[44:47]
    v_cvt_pk_bf16_f32 v38, v52, v53
    s_nop 0
    s_waitcnt lgkmcnt(2)
    v_mfma_f32_16x16x32_bf16 v[40:43], a[16:19], v[120:123], v[40:43]
    ds_read_b128 a[12:15], v10 offset:51200
    buffer_load_dwordx4 v19, s[8:11], s30 offen offset:2048 nt lds
    v_cvt_pk_bf16_f32 v39, v54, v55
    v_mfma_f32_16x16x32_bf16 v[44:47], a[16:19], v[124:127], v[44:47]
    v_mfma_f32_16x16x32_bf16 v[48:51], a[0:3], v[64:67], v[56:59]
    ds_read_b128 a[16:19], v7 offset:51456
    v_mfma_f32_16x16x32_bf16 v[52:55], a[0:3], v[68:71], v[60:63]
    s_waitcnt lgkmcnt(2)
    v_mfma_f32_16x16x32_bf16 v[48:51], a[4:7], v[72:75], v[48:51]
    ds_read_b128 a[0:3], v8 offset:51456
    v_mfma_f32_16x16x32_bf16 v[52:55], a[4:7], v[76:79], v[52:55]
    v_mfma_f32_16x16x32_bf16 v[48:51], a[8:11], v[80:83], v[48:51]
    ds_read_b128 a[4:7], v9 offset:51456
    v_mfma_f32_16x16x32_bf16 v[52:55], a[8:11], v[84:87], v[52:55]
    buffer_load_dwordx4 v20, s[8:11], s30 offen offset:3072 nt lds
    s_waitcnt lgkmcnt(2)
    v_mfma_f32_16x16x32_bf16 v[48:51], a[12:15], v[88:91], v[48:51]
    ds_read_b128 a[8:11], v10 offset:51456
    v_max3_f32 v0, v40, v41, v42
    v_mfma_f32_16x16x32_bf16 v[52:55], a[12:15], v[92:95], v[52:55]
    v_max3_f32 v1, v43, v44, v45
    v_max3_f32 v0, v0, v46, v47
    v_mfma_f32_16x16x32_bf16 v[48:51], a[16:19], v[96:99], v[48:51]
    v_mfma_f32_16x16x32_bf16 v[52:55], a[16:19], v[100:103], v[52:55]
    s_waitcnt lgkmcnt(1)
    v_mfma_f32_16x16x32_bf16 v[48:51], a[0:3], v[104:107], v[48:51]
    v_mfma_f32_16x16x32_bf16 v[52:55], a[0:3], v[108:111], v[52:55]
    v_mfma_f32_16x16x32_bf16 v[48:51], a[4:7], v[112:115], v[48:51]
    v_mfma_f32_16x16x32_bf16 v[52:55], a[4:7], v[116:119], v[52:55]
    s_waitcnt lgkmcnt(0)
    v_mfma_f32_16x16x32_bf16 v[48:51], a[8:11], v[120:123], v[48:51]
    v_mfma_f32_16x16x32_bf16 v[52:55], a[8:11], v[124:127], v[52:55]
    s_barrier
    ds_read_b64_tr_b16 a[12:13], v11 offset:32768
    ds_read_b64_tr_b16 a[14:15], v11 offset:34816
    ds_read_b64_tr_b16 a[16:17], v12 offset:32768
    ds_read_b64_tr_b16 a[18:19], v12 offset:34816
    ds_read_b64_tr_b16 a[0:1], v13 offset:32768
    ds_read_b64_tr_b16 a[2:3], v13 offset:34816
    s_waitcnt lgkmcnt(4)
    v_mfma_f32_16x16x32_bf16 v[128:131], a[12:15], v[32:35], v[128:131]
    ds_read_b64_tr_b16 a[4:5], v14 offset:32768
    s_add_u32 m0, s29, 81920
    v_mfma_f32_16x16x32_bf16 v[132:135], a[12:15], v[36:39], v[132:135]
    ds_read_b64_tr_b16 a[6:7], v14 offset:34816
    s_waitcnt lgkmcnt(4)
    v_mfma_f32_16x16x32_bf16 v[136:139], a[16:19], v[32:35], v[136:139]
    ds_read_b64_tr_b16 a[8:9], v15 offset:32768
    s_mov_b32 s30, 229376
    v_mfma_f32_16x16x32_bf16 v[140:143], a[16:19], v[36:39], v[140:143]
    ds_read_b64_tr_b16 a[10:11], v15 offset:34816
    buffer_load_dwordx4 v21, s[12:15], s30 offen offset:0 nt lds
    v_max3_f32 v1, v1, v48, v49
    v_mfma_f32_16x16x32_bf16 a[20:23], a[28:31], v[32:35], a[20:23]
    ds_read_b64_tr_b16 a[12:13], v16 offset:32768
    v_max3_f32 v0, v0, v50, v51
    v_max3_f32 v1, v1, v52, v53
    v_mfma_f32_16x16x32_bf16 a[24:27], a[28:31], v[36:39], a[24:27]
    ds_read_b64_tr_b16 a[14:15], v16 offset:34816
    v_max3_f32 v0, v0, v54, v55
    s_waitcnt lgkmcnt(4)
    v_mfma_f32_16x16x32_bf16 v[144:147], a[0:3], v[32:35], v[144:147]
    ds_read_b64_tr_b16 a[16:17], v17 offset:32768
    v_max_f32 v0, v0, v1
    v_cmp_lt_f32 vcc, s31, v0
    v_mfma_f32_16x16x32_bf16 v[148:151], a[0:3], v[36:39], v[148:151]
    ds_read_b64_tr_b16 a[18:19], v17 offset:34816
    s_cbranch_vccnz L_up_11
L_upb_11:
    v_mfma_f32_16x16x32_bf16 v[152:155], a[4:7], v[32:35], v[152:155]
    ds_read_b64_tr_b16 a[0:1], v18 offset:32768
    buffer_load_dwordx4 v22, s[12:15], s30 offen offset:1024 nt lds
    v_mfma_f32_16x16x32_bf16 v[156:159], a[4:7], v[36:39], v[156:159]
    ds_read_b64_tr_b16 a[2:3], v18 offset:34816
    s_waitcnt lgkmcnt(4)
    v_mfma_f32_16x16x32_bf16 v[160:163], a[8:11], v[32:35], v[160:163]
    ds_read_b64_tr_b16 a[4:5], v11 offset:33024
    v_exp_f32 v40, v40
    v_mfma_f32_16x16x32_bf16 v[164:167], a[8:11], v[36:39], v[164:167]
    ds_read_b64_tr_b16 a[6:7], v11 offset:35072
    v_exp_f32 v41, v41
    v_mfma_f32_16x16x32_bf16 v[168:171], a[12:15], v[32:35], v[168:171]
    ds_read_b64_tr_b16 a[8:9], v12 offset:33024
    v_exp_f32 v42, v42
    v_mfma_f32_16x16x32_bf16 v[172:175], a[12:15], v[36:39], v[172:175]
    ds_read_b64_tr_b16 a[10:11], v12 offset:35072
    s_waitcnt lgkmcnt(4)
    v_mfma_f32_16x16x32_bf16 v[176:179], a[16:19], v[32:35], v[176:179]
    ds_read_b64_tr_b16 a[12:13], v13 offset:33024
    v_exp_f32 v43, v43
    v_mfma_f32_16x16x32_bf16 v[180:183], a[16:19], v[36:39], v[180:183]
    ds_read_b64_tr_b16 a[14:15], v13 offset:35072
    v_cvt_pk_bf16_f32 v24, v40, v41
    v_mfma_f32_16x16x32_bf16 v[184:187], a[0:3], v[32:35], v[184:187]
    ds_read_b64_tr_b16 a[16:17], v14 offset:33024
    buffer_load_dwordx4 v21, s[12:15], s30 offen offset:2048 nt lds
    v_mfma_f32_16x16x32_bf16 v[188:191], a[0:3], v[36:39], v[188:191]
    ds_read_b64_tr_b16 a[18:19], v14 offset:35072
    s_waitcnt lgkmcnt(4)
    v_mfma_f32_16x16x32_bf16 v[192:195], a[4:7], v[32:35], v[192:195]
    ds_read_b64_tr_b16 a[0:1], v15 offset:33024
    v_exp_f32 v44, v44
    v_mfma_f32_16x16x32_bf16 v[196:199], a[4:7], v[36:39], v[196:199]
    ds_read_b64_tr_b16 a[2:3], v15 offset:35072
    v_exp_f32 v45, v45
    v_mfma_f32_16x16x32_bf16 v[200:203], a[8:11], v[32:35], v[200:203]
    ds_read_b64_tr_b16 a[4:5], v16 offset:33024
    v_cvt_pk_bf16_f32 v25, v42, v43
    v_mfma_f32_16x16x32_bf16 v[204:207], a[8:11], v[36:39], v[204:207]
    ds_read_b64_tr_b16 a[6:7], v16 offset:35072
    s_waitcnt lgkmcnt(4)
    v_mfma_f32_16x16x32_bf16 v[208:211], a[12:15], v[32:35], v[208:211]
    ds_read_b64_tr_b16 a[8:9], v17 offset:33024
    v_exp_f32 v46, v46
    v_mfma_f32_16x16x32_bf16 v[212:215], a[12:15], v[36:39], v[212:215]
    ds_read_b64_tr_b16 a[10:11], v17 offset:35072
    v_exp_f32 v47, v47
    v_mfma_f32_16x16x32_bf16 v[216:219], a[16:19], v[32:35], v[216:219]
    ds_read_b64_tr_b16 a[12:13], v18 offset:33024
    buffer_load_dwordx4 v22, s[12:15], s30 offen offset:3072 nt lds
    v_cvt_pk_bf16_f32 v28, v44, v45
    v_mfma_f32_16x16x32_bf16 v[220:223], a[16:19], v[36:39], v[220:223]
    ds_read_b64_tr_b16 a[14:15], v18 offset:35072
    s_nop 0
    s_waitcnt lgkmcnt(4)
    v_mfma_f32_16x16x32_bf16 v[224:227], a[0:3], v[32:35], v[224:227]
    v_cvt_pk_bf16_f32 v29, v46, v47
    v_mfma_f32_16x16x32_bf16 v[228:231], a[0:3], v[36:39], v[228:231]
    v_mfma_f32_16x16x32_bf16 v[232:235], a[4:7], v[32:35], v[232:235]
    v_mfma_f32_16x16x32_bf16 v[236:239], a[4:7], v[36:39], v[236:239]
    s_waitcnt lgkmcnt(0)
    v_mfma_f32_16x16x32_bf16 v[240:243], a[8:11], v[32:35], v[240:243]
    v_mfma_f32_16x16x32_bf16 v[244:247], a[8:11], v[36:39], v[244:247]
    v_mfma_f32_16x16x32_bf16 v[248:251], a[12:15], v[32:35], v[248:251]
    v_mfma_f32_16x16x32_bf16 v[252:255], a[12:15], v[36:39], v[252:255]
    s_cbranch_vccnz L_rs_11
L_rsb_11:
    s_waitcnt vmcnt(8)
    s_barrier
    ds_read_b128 a[16:19], v7 offset:32768
    ds_read_b128 a[0:3], v8 offset:32768
    ds_read_b128 a[4:7], v9 offset:32768
    ds_read_b128 a[8:11], v10 offset:32768
    s_waitcnt lgkmcnt(3)
    v_mfma_f32_16x16x32_bf16 v[40:43], a[16:19], v[64:67], v[56:59]
    ds_read_b128 a[12:15], v7 offset:33024
    s_add_u32 m0, s29, 49152
    v_mfma_f32_16x16x32_bf16 v[44:47], a[16:19], v[68:71], v[60:63]
    s_mov_b32 s30, 262144
    s_waitcnt lgkmcnt(2)
    v_mfma_f32_16x16x32_bf16 v[40:43], a[0:3], v[72:75], v[40:43]
    ds_read_b128 a[16:19], v8 offset:33024
    buffer_load_dwordx4 v19, s[8:11], s30 offen offset:0 nt lds
    v_mfma_f32_16x16x32_bf16 v[44:47], a[0:3], v[76:79], v[44:47]
    v_exp_f32 v48, v48
    v_mfma_f32_16x16x32_bf16 v[40:43], a[4:7], v[80:83], v[40:43]
    ds_read_b128 a[0:3], v9 offset:33024
    v_exp_f32 v49, v49
    v_mfma_f32_16x16x32_bf16 v[44:47], a[4:7], v[84:87], v[44:47]
    v_exp_f32 v50, v50
    s_waitcnt lgkmcnt(2)
    v_mfma_f32_16x16x32_bf16 v[40:43], a[8:11], v[88:91], v[40:43]
    ds_read_b128 a[4:7], v10 offset:33024
    v_exp_f32 v51, v51
    v_mfma_f32_16x16x32_bf16 v[44:47], a[8:11], v[92:95], v[44:47]
    buffer_load_dwordx4 v20, s[8:11], s30 offen offset:1024 nt lds
    v_cvt_pk_bf16_f32 v26, v48, v49
    v_add_u32 v3, 147456, v2
    v_mfma_f32_16x16x32_bf16 v[40:43], a[12:15], v[96:99], v[40:43]
    ds_read_b128 a[8:11], v7 offset:34816
    v_exp_f32 v52, v52
    v_mfma_f32_16x16x32_bf16 v[44:47], a[12:15], v[100:103], v[44:47]
    v_exp_f32 v53, v53
    s_waitcnt lgkmcnt(2)
    v_mfma_f32_16x16x32_bf16 v[40:43], a[16:19], v[104:107], v[40:43]
    ds_read_b128 a[12:15], v8 offset:34816
    v_cvt_pk_bf16_f32 v27, v50, v51
    v_mfma_f32_16x16x32_bf16 v[44:47], a[16:19], v[108:111], v[44:47]
    v_exp_f32 v54, v54
    ds_read_b64_tr_b16 a[112:113], v3 offset:0
    v_mfma_f32_16x16x32_bf16 v[40:43], a[0:3], v[112:115], v[40:43]
    ds_read_b128 a[16:19], v9 offset:34816
    v_exp_f32 v55, v55
    v_mfma_f32_16x16x32_bf16 v[44:47], a[0:3], v[116:119], v[44:47]
    v_cvt_pk_bf16_f32 v30, v52, v53
    s_nop 0
    s_waitcnt lgkmcnt(3)
    v_mfma_f32_16x16x32_bf16 v[40:43], a[4:7], v[120:123], v[40:43]
    ds_read_b128 a[0:3], v10 offset:34816
    buffer_load_dwordx4 v19, s[8:11], s30 offen offset:2048 nt lds
    v_cvt_pk_bf16_f32 v31, v54, v55
    v_mfma_f32_16x16x32_bf16 v[44:47], a[4:7], v[124:127], v[44:47]
    ds_read_b64_tr_b16 a[114:115], v3 offset:2048
    v_mfma_f32_16x16x32_bf16 v[48:51], a[8:11], v[64:67], v[56:59]
    ds_read_b128 a[4:7], v7 offset:35072
    v_mfma_f32_16x16x32_bf16 v[52:55], a[8:11], v[68:71], v[60:63]
    ds_read_b64_tr_b16 a[116:117], v3 offset:4096
    s_waitcnt lgkmcnt(4)
    v_mfma_f32_16x16x32_bf16 v[48:51], a[12:15], v[72:75], v[48:51]
    ds_read_b128 a[8:11], v8 offset:35072
    v_mfma_f32_16x16x32_bf16 v[52:55], a[12:15], v[76:79], v[52:55]
    ds_read_b64_tr_b16 a[118:119], v3 offset:6144
    v_mfma_f32_16x16x32_bf16 v[48:51], a[16:19], v[80:83], v[48:51]
    ds_read_b128 a[12:15], v9 offset:35072
    v_mfma_f32_16x16x32_bf16 v[52:55], a[16:19], v[84:87], v[52:55]
    ds_read_b64_tr_b16 a[120:121], v3 offset:8192
    s_waitcnt lgkmcnt(5)
    v_mfma_f32_16x16x32_bf16 v[48:51], a[0:3], v[88:91], v[48:51]
    ds_read_b128 a[16:19], v10 offset:35072
    v_max3_f32 v0, v40, v41, v42
    v_mfma_f32_16x16x32_bf16 v[52:55], a[0:3], v[92:95], v[52:55]
    ds_read_b64_tr_b16 a[122:123], v3 offset:10240
    v_max3_f32 v1, v43, v44, v45
    v_mfma_f32_16x16x32_bf16 v[48:51], a[4:7], v[96:99], v[48:51]
    s_barrier
    ds_read_b64_tr_b16 a[0:1], v11 offset:49152
    v_mfma_f32_16x16x32_bf16 v[52:55], a[4:7], v[100:103], v[52:55]
    ds_read_b64_tr_b16 a[2:3], v11 offset:51200
    s_waitcnt lgkmcnt(5)
    v_mfma_f32_16x16x32_bf16 v[48:51], a[8:11], v[104:107], v[48:51]
    ds_read_b64_tr_b16 a[4:5], v12 offset:49152
    buffer_load_dwordx4 v20, s[8:11], s30 offen offset:3072 nt lds
    v_mfma_f32_16x16x32_bf16 v[52:55], a[8:11], v[108:111], v[52:55]
    ds_read_b64_tr_b16 a[6:7], v12 offset:51200
    v_max3_f32 v0, v0, v46, v47
    v_mfma_f32_16x16x32_bf16 v[48:51], a[12:15], v[112:115], v[48:51]
    s_add_u32 m0, s29, 98304
    s_mov_b32 s30, 245760
    ds_read_b64_tr_b16 a[124:125], v3 offset:12288
    v_mfma_f32_16x16x32_bf16 v[52:55], a[12:15], v[116:119], v[52:55]
    buffer_load_dwordx4 v21, s[12:15], s30 offen offset:0 nt lds
    ds_read_b64_tr_b16 a[126:127], v3 offset:14336
    s_waitcnt lgkmcnt(4)
    v_mfma_f32_16x16x32_bf16 v[48:51], a[16:19], v[120:123], v[48:51]
    ds_read_b64_tr_b16 a[8:9], v13 offset:49152
    v_mfma_f32_16x16x32_bf16 v[52:55], a[16:19], v[124:127], v[52:55]
    ds_read_b64_tr_b16 a[10:11], v13 offset:51200
    v_mfma_f32_16x16x32_bf16 v[128:131], a[0:3], v[24:27], v[128:131]
    ds_read_b64_tr_b16 a[12:13], v14 offset:49152
    buffer_load_dwordx4 v22, s[12:15], s30 offen offset:1024 nt lds
    v_mfma_f32_16x16x32_bf16 v[132:135], a[0:3], v[28:31], v[132:135]
    ds_read_b64_tr_b16 a[14:15], v14 offset:51200
    s_waitcnt lgkmcnt(6)
    v_mfma_f32_16x16x32_bf16 v[136:139], a[4:7], v[24:27], v[136:139]
    ds_read_b64_tr_b16 a[16:17], v15 offset:49152
    v_mfma_f32_16x16x32_bf16 v[140:143], a[4:7], v[28:31], v[140:143]
    ds_read_b64_tr_b16 a[18:19], v15 offset:51200
    v_max3_f32 v1, v1, v48, v49
    v_max3_f32 v0, v0, v50, v51
    v_max3_f32 v1, v1, v52, v53
    v_mfma_f32_16x16x32_bf16 a[20:23], a[28:31], v[24:27], a[20:23]
    ds_read_b64_tr_b16 a[0:1], v16 offset:49152
    buffer_load_dwordx4 v21, s[12:15], s30 offen offset:2048 nt lds
    v_max3_f32 v0, v0, v54, v55
    v_max_f32 v0, v0, v1
    v_mfma_f32_16x16x32_bf16 a[24:27], a[28:31], v[28:31], a[24:27]
    ds_read_b64_tr_b16 a[2:3], v16 offset:51200
    v_cmp_lt_f32 vcc, s31, v0
    s_cbranch_vccnz L_up_12
L_upb_12:
    s_waitcnt lgkmcnt(4)
    v_mfma_f32_16x16x32_bf16 v[144:147], a[8:11], v[24:27], v[144:147]
    ds_read_b64_tr_b16 a[4:5], v17 offset:49152
    v_exp_f32 v40, v40
    v_mfma_f32_16x16x32_bf16 v[148:151], a[8:11], v[28:31], v[148:151]
    ds_read_b64_tr_b16 a[6:7], v17 offset:51200
    v_exp_f32 v41, v41
    v_mfma_f32_16x16x32_bf16 v[152:155], a[12:15], v[24:27], v[152:155]
    ds_read_b64_tr_b16 a[8:9], v18 offset:49152
    s_add_u32 m0, s29, 131072
    v_exp_f32 v42, v42
    v_mfma_f32_16x16x32_bf16 v[156:159], a[12:15], v[28:31], v[156:159]
    ds_read_b64_tr_b16 a[10:11], v18 offset:51200
    v_exp_f32 v43, v43
    s_waitcnt lgkmcnt(4)
    v_mfma_f32_16x16x32_bf16 v[160:163], a[16:19], v[24:27], v[160:163]
    ds_read_b64_tr_b16 a[12:13], v11 offset:49408
    s_add_u32 s30, s79, 0
    v_cvt_pk_bf16_f32 v32, v40, v41
    v_mfma_f32_16x16x32_bf16 v[164:167], a[16:19], v[28:31], v[164:167]
    ds_read_b64_tr_b16 a[14:15], v11 offset:51456
    buffer_load_dwordx4 v23, s[20:23], s30 offen offset:0  lds
    v_exp_f32 v44, v44
    v_mfma_f32_16x16x32_bf16 v[168:171], a[0:3], v[24:27], v[168:171]
    ds_read_b64_tr_b16 a[16:17], v12 offset:49408
    s_add_u32 s30, s79, 6144
    v_exp_f32 v45, v45
    v_mfma_f32_16x16x32_bf16 v[172:175], a[0:3], v[28:31], v[172:175]
    ds_read_b64_tr_b16 a[18:19], v12 offset:51456
    v_cvt_pk_bf16_f32 v33, v42, v43
    s_waitcnt lgkmcnt(4)
    v_mfma_f32_16x16x32_bf16 v[176:179], a[4:7], v[24:27], v[176:179]
    ds_read_b64_tr_b16 a[0:1], v13 offset:49408
    buffer_load_dwordx4 v23, s[20:23], s30 offen offset:1024  lds
    v_exp_f32 v46, v46
    v_mfma_f32_16x16x32_bf16 v[180:183], a[4:7], v[28:31], v[180:183]
    ds_read_b64_tr_b16 a[2:3], v13 offset:51456
    v_exp_f32 v47, v47
    v_cvt_pk_bf16_f32 v36, v44, v45
    v_mfma_f32_16x16x32_bf16 v[184:187], a[8:11], v[24:27], v[184:187]
    ds_read_b64_tr_b16 a[4:5], v14 offset:49408
    s_add_u32 s30, s79, 12288
    s_nop 0
    v_cvt_pk_bf16_f32 v37, v46, v47
    v_mfma_f32_16x16x32_bf16 v[188:191], a[8:11], v[28:31], v[188:191]
    ds_read_b64_tr_b16 a[6:7], v14 offset:51456
    s_waitcnt lgkmcnt(4)
    v_mfma_f32_16x16x32_bf16 v[192:195], a[12:15], v[24:27], v[192:195]
    ds_read_b64_tr_b16 a[8:9], v15 offset:49408
    buffer_load_dwordx4 v23, s[20:23], s30 offen offset:2048  lds
    v_mfma_f32_16x16x32_bf16 v[196:199], a[12:15], v[28:31], v[196:199]
    ds_read_b64_tr_b16 a[10:11], v15 offset:51456
    v_mfma_f32_16x16x32_bf16 v[200:203], a[16:19], v[24:27], v[200:203]
    ds_read_b64_tr_b16 a[12:13], v16 offset:49408
    s_add_u32 s30, s79, 18432
    v_mfma_f32_16x16x32_bf16 v[204:207], a[16:19], v[28:31], v[204:207]
    ds_read_b64_tr_b16 a[14:15], v16 offset:51456
    s_waitcnt lgkmcnt(4)
    v_mfma_f32_16x16x32_bf16 v[208:211], a[0:3], v[24:27], v[208:211]
    ds_read_b64_tr_b16 a[16:17], v17 offset:49408
    buffer_load_dwordx4 v23, s[20:23], s30 offen offset:3072  lds
    v_mfma_f32_16x16x32_bf16 v[212:215], a[0:3], v[28:31], v[212:215]
    ds_read_b64_tr_b16 a[18:19], v17 offset:51456
    v_mfma_f32_16x16x32_bf16 v[216:219], a[4:7], v[24:27], v[216:219]
    ds_read_b64_tr_b16 a[0:1], v18 offset:49408
    v_mfma_f32_16x16x32_bf16 v[220:223], a[4:7], v[28:31], v[220:223]
    ds_read_b64_tr_b16 a[2:3], v18 offset:51456
    s_waitcnt lgkmcnt(4)
    v_mfma_f32_16x16x32_bf16 v[224:227], a[8:11], v[24:27], v[224:227]
    s_barrier
    ds_read_b128 a[4:7], v7 offset:0
    v_mfma_f32_16x16x32_bf16 v[228:231], a[8:11], v[28:31], v[228:231]
    s_add_u32 m0, s29, 98304
    s_mov_b32 s30, 245760
    v_mfma_f32_16x16x32_bf16 v[232:235], a[12:15], v[24:27], v[232:235]
    ds_read_b128 a[8:11], v8 offset:0
    buffer_load_dwordx4 v22, s[12:15], s30 offen offset:3072 nt lds
    v_mfma_f32_16x16x32_bf16 v[236:239], a[12:15], v[28:31], v[236:239]
    s_waitcnt lgkmcnt(2)
    v_mfma_f32_16x16x32_bf16 v[240:243], a[16:19], v[24:27], v[240:243]
    ds_read_b128 a[12:15], v9 offset:0
    v_mfma_f32_16x16x32_bf16 v[244:247], a[16:19], v[28:31], v[244:247]
    v_mfma_f32_16x16x32_bf16 v[248:251], a[0:3], v[24:27], v[248:251]
    ds_read_b128 a[16:19], v10 offset:0
    v_mfma_f32_16x16x32_bf16 v[252:255], a[0:3], v[28:31], v[252:255]
    s_add_u32 m0, s29, 32768
    s_cbranch_vccnz L_rs_12
L_rsb_12:
    s_waitcnt lgkmcnt(2)
    v_mfma_f32_16x16x32_bf16 v[40:43], a[4:7], v[64:67], v[56:59]
    ds_read_b128 a[0:3], v7 offset:256
    s_mov_b32 s30, 278528
    v_mfma_f32_16x16x32_bf16 v[44:47], a[4:7], v[68:71], v[60:63]
    buffer_load_dwordx4 v19, s[8:11], s30 offen offset:0 nt lds
    v_exp_f32 v48, v48
    v_mfma_f32_16x16x32_bf16 v[40:43], a[8:11], v[72:75], v[40:43]
    ds_read_b128 a[4:7], v8 offset:256
    v_exp_f32 v49, v49
    v_mfma_f32_16x16x32_bf16 v[44:47], a[8:11], v[76:79], v[44:47]
    v_exp_f32 v50, v50
    s_waitcnt lgkmcnt(2)
    v_mfma_f32_16x16x32_bf16 v[40:43], a[12:15], v[80:83], v[40:43]
    ds_read_b128 a[8:11], v9 offset:256
    v_exp_f32 v51, v51
    v_mfma_f32_16x16x32_bf16 v[44:47], a[12:15], v[84:87], v[44:47]
    v_cvt_pk_bf16_f32 v34, v48, v49
    v_exp_f32 v52, v52
    v_mfma_f32_16x16x32_bf16 v[40:43], a[16:19], v[88:91], v[40:43]
    ds_read_b128 a[12:15], v10 offset:256
    buffer_load_dwordx4 v20, s[8:11], s30 offen offset:1024 nt lds
    v_mfma_f32_16x16x32_bf16 v[44:47], a[16:19], v[92:95], v[44:47]
    v_exp_f32 v53, v53
    s_waitcnt lgkmcnt(2)
    v_mfma_f32_16x16x32_bf16 v[40:43], a[0:3], v[96:99], v[40:43]
    ds_read_b128 a[16:19], v7 offset:2048
    v_cvt_pk_bf16_f32 v35, v50, v51
    v_mfma_f32_16x16x32_bf16 v[44:47], a[0:3], v[100:103], v[44:47]
    v_exp_f32 v54, v54
    v_mfma_f32_16x16x32_bf16 v[40:43], a[4:7], v[104:107], v[40:43]
    ds_read_b128 a[0:3], v8 offset:2048
    v_exp_f32 v55, v55
    v_mfma_f32_16x16x32_bf16 v[44:47], a[4:7], v[108:111], v[44:47]
    v_cvt_pk_bf16_f32 v38, v52, v53
    s_nop 0
    s_waitcnt lgkmcnt(2)
    v_mfma_f32_16x16x32_bf16 v[40:43], a[8:11], v[112:115], v[40:43]
    ds_read_b128 a[4:7], v9 offset:2048
    v_cvt_pk_bf16_f32 v39, v54, v55
    v_mfma_f32_16x16x32_bf16 v[44:47], a[8:11], v[116:119], v[44:47]
    buffer_load_dwordx4 v19, s[8:11], s30 offen offset:2048 nt lds
    v_mfma_f32_16x16x32_bf16 v[40:43], a[12:15], v[120:123], v[40:43]
    ds_read_b128 a[8:11], v10 offset:2048
    v_mfma_f32_16x16x32_bf16 v[44:47], a[12:15], v[124:127], v[44:47]
    s_waitcnt lgkmcnt(2)
    v_mfma_f32_16x16x32_bf16 v[48:51], a[16:19], v[64:67], v[56:59]
    ds_read_b128 a[12:15], v7 offset:2304
    v_mfma_f32_16x16x32_bf16 v[52:55], a[16:19], v[68:71], v[60:63]
    v_mfma_f32_16x16x32_bf16 v[48:51], a[0:3], v[72:75], v[48:51]
    ds_read_b128 a[16:19], v8 offset:2304
    v_mfma_f32_16x16x32_bf16 v[52:55], a[0:3], v[76:79], v[52:55]
    s_waitcnt lgkmcnt(2)
    v_mfma_f32_16x16x32_bf16 v[48:51], a[4:7], v[80:83], v[48:51]
    ds_read_b128 a[0:3], v9 offset:2304
    v_mfma_f32_16x16x32_bf16 v[52:55], a[4:7], v[84:87], v[52:55]
    v_mfma_f32_16x16x32_bf16 v[48:51], a[8:11], v[88:91], v[48:51]
    ds_read_b128 a[4:7], v10 offset:2304
    v_max3_f32 v0, v40, v41, v42
    v_mfma_f32_16x16x32_bf16 v[52:55], a[8:11], v[92:95], v[52:55]
    v_max3_f32 v1, v43, v44, v45
    s_waitcnt lgkmcnt(2)
    v_mfma_f32_16x16x32_bf16 v[48:51], a[12:15], v[96:99], v[48:51]
    s_barrier
    ds_read_b64_tr_b16 a[8:9], v11 offset:0
    v_mfma_f32_16x16x32_bf16 v[52:55], a[12:15], v[100:103], v[52:55]
    ds_read_b64_tr_b16 a[10:11], v11 offset:2048
    buffer_load_dwordx4 v20, s[8:11], s30 offen offset:3072 nt lds
    v_mfma_f32_16x16x32_bf16 v[48:51], a[16:19], v[104:107], v[48:51]
    ds_read_b64_tr_b16 a[12:13], v12 offset:0
    v_max3_f32 v0, v0, v46, v47
    v_mfma_f32_16x16x32_bf16 v[52:55], a[16:19], v[108:111], v[52:55]
    ds_read_b64_tr_b16 a[14:15], v12 offset:2048
    s_waitcnt lgkmcnt(4)
    v_mfma_f32_16x16x32_bf16 v[48:51], a[0:3], v[112:115], v[48:51]
    v_mfma_f32_16x16x32_bf16 v[52:55], a[0:3], v[116:119], v[52:55]
    v_mfma_f32_16x16x32_bf16 v[48:51], a[4:7], v[120:123], v[48:51]
    ds_read_b64_tr_b16 a[16:17], v13 offset:0
    v_mfma_f32_16x16x32_bf16 v[52:55], a[4:7], v[124:127], v[52:55]
    ds_read_b64_tr_b16 a[18:19], v13 offset:2048
    s_waitcnt lgkmcnt(2)
    v_mfma_f32_16x16x32_bf16 v[128:131], a[8:11], v[32:35], v[128:131]
    ds_read_b64_tr_b16 a[0:1], v14 offset:0
    v_mfma_f32_16x16x32_bf16 v[132:135], a[8:11], v[36:39], v[132:135]
    ds_read_b64_tr_b16 a[2:3], v14 offset:2048
    v_mfma_f32_16x16x32_bf16 v[136:139], a[12:15], v[32:35], v[136:139]
    ds_read_b64_tr_b16 a[4:5], v15 offset:0
    s_add_u32 m0, s29, 114688
    v_mfma_f32_16x16x32_bf16 v[140:143], a[12:15], v[36:39], v[140:143]
    ds_read_b64_tr_b16 a[6:7], v15 offset:2048
    s_mov_b32 s30, 262144
    v_max3_f32 v1, v1, v48, v49
    v_mfma_f32_16x16x32_bf16 a[20:23], a[28:31], v[32:35], a[20:23]
    ds_read_b64_tr_b16 a[8:9], v16 offset:0
    buffer_load_dwordx4 v21, s[12:15], s30 offen offset:0 nt lds
    v_max3_f32 v0, v0, v50, v51
    v_mfma_f32_16x16x32_bf16 a[24:27], a[28:31], v[36:39], a[24:27]
    ds_read_b64_tr_b16 a[10:11], v16 offset:2048
    v_max3_f32 v1, v1, v52, v53
    s_waitcnt lgkmcnt(4)
    v_mfma_f32_16x16x32_bf16 v[144:147], a[16:19], v[32:35], v[144:147]
    ds_read_b64_tr_b16 a[12:13], v17 offset:0
    v_max3_f32 v0, v0, v54, v55
    v_max_f32 v0, v0, v1
    v_mfma_f32_16x16x32_bf16 v[148:151], a[16:19], v[36:39], v[148:151]
    ds_read_b64_tr_b16 a[14:15], v17 offset:2048
    v_cmp_lt_f32 vcc, s31, v0
    s_cbranch_vccnz L_up_13
L_upb_13:
    v_mfma_f32_16x16x32_bf16 v[152:155], a[0:3], v[32:35], v[152:155]
    ds_read_b64_tr_b16 a[16:17], v18 offset:0
    v_exp_f32 v40, v40
    v_mfma_f32_16x16x32_bf16 v[156:159], a[0:3], v[36:39], v[156:159]
    ds_read_b64_tr_b16 a[18:19], v18 offset:2048
    s_waitcnt lgkmcnt(4)
    v_mfma_f32_16x16x32_bf16 v[160:163], a[4:7], v[32:35], v[160:163]
    ds_read_b64_tr_b16 a[0:1], v11 offset:256
    v_exp_f32 v41, v41
    v_mfma_f32_16x16x32_bf16 v[164:167], a[4:7], v[36:39], v[164:167]
    ds_read_b64_tr_b16 a[2:3], v11 offset:2304
    v_exp_f32 v42, v42
    v_mfma_f32_16x16x32_bf16 v[168:171], a[8:11], v[32:35], v[168:171]
    ds_read_b64_tr_b16 a[4:5], v12 offset:256
    buffer_load_dwordx4 v22, s[12:15], s30 offen offset:1024 nt lds
    v_mfma_f32_16x16x32_bf16 v[172:175], a[8:11], v[36:39], v[172:175]
    ds_read_b64_tr_b16 a[6:7], v12 offset:2304
    s_waitcnt lgkmcnt(4)
    v_mfma_f32_16x16x32_bf16 v[176:179], a[12:15], v[32:35], v[176:179]
    ds_read_b64_tr_b16 a[8:9], v13 offset:256
    v_exp_f32 v43, v43
    v_mfma_f32_16x16x32_bf16 v[180:183], a[12:15], v[36:39], v[180:183]
    ds_read_b64_tr_b16 a[10:11], v13 offset:2304
    v_cvt_pk_bf16_f32 v24, v40, v41
    v_mfma_f32_16x16x32_bf16 v[184:187], a[16:19], v[32:35], v[184:187]
    ds_read_b64_tr_b16 a[12:13], v14 offset:256
    v_exp_f32 v44, v44
    v_mfma_f32_16x16x32_bf16 v[188:191], a[16:19], v[36:39], v[188:191]
    ds_read_b64_tr_b16 a[14:15], v14 offset:2304
    s_waitcnt lgkmcnt(4)
    v_mfma_f32_16x16x32_bf16 v[192:195], a[0:3], v[32:35], v[192:195]
    ds_read_b64_tr_b16 a[16:17], v15 offset:256
    v_exp_f32 v45, v45
    v_mfma_f32_16x16x32_bf16 v[196:199], a[0:3], v[36:39], v[196:199]
    ds_read_b64_tr_b16 a[18:19], v15 offset:2304
    v_cvt_pk_bf16_f32 v25, v42, v43
    v_mfma_f32_16x16x32_bf16 v[200:203], a[4:7], v[32:35], v[200:203]
    ds_read_b64_tr_b16 a[0:1], v16 offset:256
    v_exp_f32 v46, v46
    v_mfma_f32_16x16x32_bf16 v[204:207], a[4:7], v[36:39], v[204:207]
    ds_read_b64_tr_b16 a[2:3], v16 offset:2304
    s_waitcnt lgkmcnt(4)
    v_mfma_f32_16x16x32_bf16 v[208:211], a[8:11], v[32:35], v[208:211]
    ds_read_b64_tr_b16 a[4:5], v17 offset:256
    v_exp_f32 v47, v47
    v_mfma_f32_16x16x32_bf16 v[212:215], a[8:11], v[36:39], v[212:215]
    ds_read_b64_tr_b16 a[6:7], v17 offset:2304
    v_cvt_pk_bf16_f32 v28, v44, v45
    s_nop 0
    v_mfma_f32_16x16x32_bf16 v[216:219], a[12:15], v[32:35], v[216:219]
    ds_read_b64_tr_b16 a[8:9], v18 offset:256
    v_cvt_pk_bf16_f32 v29, v46, v47
    v_mfma_f32_16x16x32_bf16 v[220:223], a[12:15], v[36:39], v[220:223]
    ds_read_b64_tr_b16 a[10:11], v18 offset:2304
    s_waitcnt lgkmcnt(4)
    v_mfma_f32_16x16x32_bf16 v[224:227], a[16:19], v[32:35], v[224:227]
    s_waitcnt vmcnt(7)
    s_barrier
    ds_read_b128 a[12:15], v7 offset:16384
    v_mfma_f32_16x16x32_bf16 v[228:231], a[16:19], v[36:39], v[228:231]
    buffer_load_dwordx4 v21, s[12:15], s30 offen offset:2048 nt lds
    v_mfma_f32_16x16x32_bf16 v[232:235], a[0:3], v[32:35], v[232:235]
    ds_read_b128 a[16:19], v8 offset:16384
    v_mfma_f32_16x16x32_bf16 v[236:239], a[0:3], v[36:39], v[236:239]
    s_waitcnt lgkmcnt(2)
    v_mfma_f32_16x16x32_bf16 v[240:243], a[4:7], v[32:35], v[240:243]
    ds_read_b128 a[0:3], v9 offset:16384
    v_mfma_f32_16x16x32_bf16 v[244:247], a[4:7], v[36:39], v[244:247]
    v_mfma_f32_16x16x32_bf16 v[248:251], a[8:11], v[32:35], v[248:251]
    ds_read_b128 a[4:7], v10 offset:16384
    v_mfma_f32_16x16x32_bf16 v[252:255], a[8:11], v[36:39], v[252:255]
    buffer_load_dwordx4 v22, s[12:15], s30 offen offset:3072 nt lds
    s_cbranch_vccnz L_rs_13
L_rsb_13:
    s_waitcnt lgkmcnt(2)
    v_mfma_f32_16x16x32_bf16 v[40:43], a[12:15], v[64:67], v[56:59]
    ds_read_b128 a[8:11], v7 offset:16640
    v_exp_f32 v48, v48
    v_mfma_f32_16x16x32_bf16 v[44:47], a[12:15], v[68:71], v[60:63]
    v_exp_f32 v49, v49
    v_mfma_f32_16x16x32_bf16 v[40:43], a[16:19], v[72:75], v[40:43]
    ds_read_b128 a[12:15], v8 offset:16640
    v_exp_f32 v50, v50
    v_mfma_f32_16x16x32_bf16 v[44:47], a[16:19], v[76:79], v[44:47]
    v_exp_f32 v51, v51
    s_waitcnt lgkmcnt(2)
    v_mfma_f32_16x16x32_bf16 v[40:43], a[0:3], v[80:83], v[40:43]
    ds_read_b128 a[16:19], v9 offset:16640
    v_cvt_pk_bf16_f32 v26, v48, v49
    v_mfma_f32_16x16x32_bf16 v[44:47], a[0:3], v[84:87], v[44:47]
    v_exp_f32 v52, v52
    v_mfma_f32_16x16x32_bf16 v[40:43], a[4:7], v[88:91], v[40:43]
    ds_read_b128 a[0:3], v10 offset:16640
    s_add_u32 m0, s29, 0
    v_add_u32 v3, 131072, v2
    v_mfma_f32_16x16x32_bf16 v[44:47], a[4:7], v[92:95], v[44:47]
    s_mov_b32 s30, 294912
    ds_read_b64_tr_b16 a[128:129], v3 offset:0
    s_waitcnt lgkmcnt(3)
    v_mfma_f32_16x16x32_bf16 v[40:43], a[8:11], v[96:99], v[40:43]
    ds_read_b128 a[4:7], v7 offset:18432
    buffer_load_dwordx4 v19, s[8:11], s30 offen offset:0 nt lds
    v_mfma_f32_16x16x32_bf16 v[44:47], a[8:11], v[100:103], v[44:47]
    v_exp_f32 v53, v53
    v_cvt_pk_bf16_f32 v27, v50, v51
    v_mfma_f32_16x16x32_bf16 v[40:43], a[12:15], v[104:107], v[40:43]
    ds_read_b128 a[8:11], v8 offset:18432
    v_exp_f32 v54, v54
    v_mfma_f32_16x16x32_bf16 v[44:47], a[12:15], v[108:111], v[44:47]
    v_exp_f32 v55, v55
    s_waitcnt lgkmcnt(3)
    v_mfma_f32_16x16x32_bf16 v[40:43], a[16:19], v[112:115], v[40:43]
    ds_read_b128 a[12:15], v9 offset:18432
    v_cvt_pk_bf16_f32 v30, v52, v53
    s_nop 0
    v_mfma_f32_16x16x32_bf16 v[44:47], a[16:19], v[116:119], v[44:47]
    buffer_load_dwordx4 v20, s[8:11], s30 offen offset:1024 nt lds
    v_cvt_pk_bf16_f32 v31, v54, v55
    ds_read_b64_tr_b16 a[130:131], v3 offset:2048
    v_mfma_f32_16x16x32_bf16 v[40:43], a[0:3], v[120:123], v[40:43]
    ds_read_b128 a[16:19], v10 offset:18432
    v_mfma_f32_16x16x32_bf16 v[44:47], a[0:3], v[124:127], v[44:47]
    ds_read_b64_tr_b16 a[132:133], v3 offset:4096
    s_waitcnt lgkmcnt(4)
    v_mfma_f32_16x16x32_bf16 v[48:51], a[4:7], v[64:67], v[56:59]
    ds_read_b128 a[0:3], v7 offset:18688
    v_mfma_f32_16x16x32_bf16 v[52:55], a[4:7], v[68:71], v[60:63]
    ds_read_b64_tr_b16 a[134:135], v3 offset:6144
    v_mfma_f32_16x16x32_bf16 v[48:51], a[8:11], v[72:75], v[48:51]
    ds_read_b128 a[4:7], v8 offset:18688
    v_mfma_f32_16x16x32_bf16 v[52:55], a[8:11], v[76:79], v[52:55]
    ds_read_b64_tr_b16 a[136:137], v3 offset:8192
    s_waitcnt lgkmcnt(5)
    v_mfma_f32_16x16x32_bf16 v[48:51], a[12:15], v[80:83], v[48:51]
    ds_read_b128 a[8:11], v9 offset:18688
    v_mfma_f32_16x16x32_bf16 v[52:55], a[12:15], v[84:87], v[52:55]
    ds_read_b64_tr_b16 a[138:139], v3 offset:10240
    v_mfma_f32_16x16x32_bf16 v[48:51], a[16:19], v[88:91], v[48:51]
    ds_read_b128 a[12:15], v10 offset:18688
    v_max3_f32 v0, v40, v41, v42
    v_mfma_f32_16x16x32_bf16 v[52:55], a[16:19], v[92:95], v[52:55]
    ds_read_b64_tr_b16 a[140:141], v3 offset:12288
    s_waitcnt lgkmcnt(5)
    v_mfma_f32_16x16x32_bf16 v[48:51], a[0:3], v[96:99], v[48:51]
    s_barrier
    ds_read_b64_tr_b16 a[16:17], v11 offset:16384
    v_mfma_f32_16x16x32_bf16 v[52:55], a[0:3], v[100:103], v[52:55]
    ds_read_b64_tr_b16 a[18:19], v11 offset:18432
    buffer_load_dwordx4 v19, s[8:11], s30 offen offset:2048 nt lds
    v_mfma_f32_16x16x32_bf16 v[48:51], a[4:7], v[104:107], v[48:51]
    ds_read_b64_tr_b16 a[0:1], v12 offset:16384
    v_max3_f32 v1, v43, v44, v45
    v_mfma_f32_16x16x32_bf16 v[52:55], a[4:7], v[108:111], v[52:55]
    ds_read_b64_tr_b16 a[2:3], v12 offset:18432
    s_waitcnt lgkmcnt(5)
    v_mfma_f32_16x16x32_bf16 v[48:51], a[8:11], v[112:115], v[48:51]
    buffer_load_dwordx4 v20, s[8:11], s30 offen offset:3072 nt lds
    ds_read_b64_tr_b16 a[142:143], v3 offset:14336
    v_mfma_f32_16x16x32_bf16 v[52:55], a[8:11], v[116:119], v[52:55]
    v_max3_f32 v0, v0, v46, v47
    v_mfma_f32_16x16x32_bf16 v[48:51], a[12:15], v[120:123], v[48:51]
    ds_read_b64_tr_b16 a[4:5], v13 offset:16384
    v_mfma_f32_16x16x32_bf16 v[52:55], a[12:15], v[124:127], v[52:55]
    ds_read_b64_tr_b16 a[6:7], v13 offset:18432
    s_waitcnt lgkmcnt(3)
    v_mfma_f32_16x16x32_bf16 v[128:131], a[16:19], v[24:27], v[128:131]
    ds_read_b64_tr_b16 a[8:9], v14 offset:16384
    s_add_u32 m0, s29, 65536
    v_mfma_f32_16x16x32_bf16 v[132:135], a[16:19], v[28:31], v[132:135]
    ds_read_b64_tr_b16 a[10:11], v14 offset:18432
    s_mov_b32 s30, 278528
    v_mfma_f32_16x16x32_bf16 v[136:139], a[0:3], v[24:27], v[136:139]
    ds_read_b64_tr_b16 a[12:13], v15 offset:16384
    buffer_load_dwordx4 v21, s[12:15], s30 offen offset:0 nt lds
    v_mfma_f32_16x16x32_bf16 v[140:143], a[0:3], v[28:31], v[140:143]
    ds_read_b64_tr_b16 a[14:15], v15 offset:18432
    v_max3_f32 v1, v1, v48, v49
    v_max3_f32 v0, v0, v50, v51
    v_max3_f32 v1, v1, v52, v53
    v_mfma_f32_16x16x32_bf16 a[20:23], a[28:31], v[24:27], a[20:23]
    ds_read_b64_tr_b16 a[16:17], v16 offset:16384
    buffer_load_dwordx4 v22, s[12:15], s30 offen offset:1024 nt lds
    v_max3_f32 v0, v0, v54, v55
    v_max_f32 v0, v0, v1
    v_mfma_f32_16x16x32_bf16 a[24:27], a[28:31], v[28:31], a[24:27]
    ds_read_b64_tr_b16 a[18:19], v16 offset:18432
    v_cmp_lt_f32 vcc, s31, v0
    s_cbranch_vccnz L_up_14
L_upb_14:
    s_waitcnt lgkmcnt(4)
    v_mfma_f32_16x16x32_bf16 v[144:147], a[4:7], v[24:27], v[144:147]
    ds_read_b64_tr_b16 a[0:1], v17 offset:16384
    v_exp_f32 v40, v40
    v_mfma_f32_16x16x32_bf16 v[148:151], a[4:7], v[28:31], v[148:151]
    ds_read_b64_tr_b16 a[2:3], v17 offset:18432
    v_exp_f32 v41, v41
    v_mfma_f32_16x16x32_bf16 v[152:155], a[8:11], v[24:27], v[152:155]
    ds_read_b64_tr_b16 a[4:5], v18 offset:16384
    s_add_u32 m0, s29, 147456
    v_exp_f32 v42, v42
    v_mfma_f32_16x16x32_bf16 v[156:159], a[8:11], v[28:31], v[156:159]
    ds_read_b64_tr_b16 a[6:7], v18 offset:18432
    v_exp_f32 v43, v43
    s_waitcnt lgkmcnt(4)
    v_mfma_f32_16x16x32_bf16 v[160:163], a[12:15], v[24:27], v[160:163]
    ds_read_b64_tr_b16 a[8:9], v11 offset:16640
    s_add_u32 s30, s79, 114688
    v_cvt_pk_bf16_f32 v32, v40, v41
    v_mfma_f32_16x16x32_bf16 v[164:167], a[12:15], v[28:31], v[164:167]
    ds_read_b64_tr_b16 a[10:11], v11 offset:18688
    buffer_load_dwordx4 v23, s[20:23], s30 offen offset:0  lds
    v_exp_f32 v44, v44
    v_mfma_f32_16x16x32_bf16 v[168:171], a[16:19], v[24:27], v[168:171]
    ds_read_b64_tr_b16 a[12:13], v12 offset:16640
    s_add_u32 s30, s79, 120832
    v_exp_f32 v45, v45
    v_mfma_f32_16x16x32_bf16 v[172:175], a[16:19], v[28:31], v[172:175]
    ds_read_b64_tr_b16 a[14:15], v12 offset:18688
    v_cvt_pk_bf16_f32 v33, v42, v43
    s_waitcnt lgkmcnt(4)
    v_mfma_f32_16x16x32_bf16 v[176:179], a[0:3], v[24:27], v[176:179]
    ds_read_b64_tr_b16 a[16:17], v13 offset:16640
    buffer_load_dwordx4 v23, s[20:23], s30 offen offset:1024  lds
    v_exp_f32 v46, v46
    v_mfma_f32_16x16x32_bf16 v[180:183], a[0:3], v[28:31], v[180:183]
    ds_read_b64_tr_b16 a[18:19], v13 offset:18688
    v_exp_f32 v47, v47
    v_cvt_pk_bf16_f32 v36, v44, v45
    v_mfma_f32_16x16x32_bf16 v[184:187], a[4:7], v[24:27], v[184:187]
    ds_read_b64_tr_b16 a[0:1], v14 offset:16640
    s_add_u32 s30, s79, 126976
    s_nop 0
    v_cvt_pk_bf16_f32 v37, v46, v47
    v_mfma_f32_16x16x32_bf16 v[188:191], a[4:7], v[28:31], v[188:191]
    ds_read_b64_tr_b16 a[2:3], v14 offset:18688
    s_waitcnt lgkmcnt(4)
    v_mfma_f32_16x16x32_bf16 v[192:195], a[8:11], v[24:27], v[192:195]
    ds_read_b64_tr_b16 a[4:5], v15 offset:16640
    buffer_load_dwordx4 v23, s[20:23], s30 offen offset:2048  lds
    v_mfma_f32_16x16x32_bf16 v[196:199], a[8:11], v[28:31], v[196:199]
    ds_read_b64_tr_b16 a[6:7], v15 offset:18688
    v_mfma_f32_16x16x32_bf16 v[200:203], a[12:15], v[24:27], v[200:203]
    ds_read_b64_tr_b16 a[8:9], v16 offset:16640
    s_add_u32 s30, s79, 133120
    v_mfma_f32_16x16x32_bf16 v[204:207], a[12:15], v[28:31], v[204:207]
    ds_read_b64_tr_b16 a[10:11], v16 offset:18688
    s_waitcnt lgkmcnt(4)
    v_mfma_f32_16x16x32_bf16 v[208:211], a[16:19], v[24:27], v[208:211]
    ds_read_b64_tr_b16 a[12:13], v17 offset:16640
    buffer_load_dwordx4 v23, s[20:23], s30 offen offset:3072  lds
    v_mfma_f32_16x16x32_bf16 v[212:215], a[16:19], v[28:31], v[212:215]
    ds_read_b64_tr_b16 a[14:15], v17 offset:18688
    v_mfma_f32_16x16x32_bf16 v[216:219], a[0:3], v[24:27], v[216:219]
    ds_read_b64_tr_b16 a[16:17], v18 offset:16640
    v_mfma_f32_16x16x32_bf16 v[220:223], a[0:3], v[28:31], v[220:223]
    ds_read_b64_tr_b16 a[18:19], v18 offset:18688
    s_waitcnt lgkmcnt(4)
    v_mfma_f32_16x16x32_bf16 v[224:227], a[4:7], v[24:27], v[224:227]
    s_barrier
    ds_read_b128 a[0:3], v7 offset:49152
    v_mfma_f32_16x16x32_bf16 v[228:231], a[4:7], v[28:31], v[228:231]
    s_add_u32 m0, s29, 65536
    s_mov_b32 s30, 278528
    v_mfma_f32_16x16x32_bf16 v[232:235], a[8:11], v[24:27], v[232:235]
    ds_read_b128 a[4:7], v8 offset:49152
    buffer_load_dwordx4 v21, s[12:15], s30 offen offset:2048 nt lds
    v_mfma_f32_16x16x32_bf16 v[236:239], a[8:11], v[28:31], v[236:239]
    s_waitcnt lgkmcnt(2)
    v_mfma_f32_16x16x32_bf16 v[240:243], a[12:15], v[24:27], v[240:243]
    ds_read_b128 a[8:11], v9 offset:49152
    v_mfma_f32_16x16x32_bf16 v[244:247], a[12:15], v[28:31], v[244:247]
    v_mfma_f32_16x16x32_bf16 v[248:251], a[16:19], v[24:27], v[248:251]
    ds_read_b128 a[12:15], v10 offset:49152
    v_mfma_f32_16x16x32_bf16 v[252:255], a[16:19], v[28:31], v[252:255]
    s_cbranch_vccnz L_rs_14
L_rsb_14:
    s_waitcnt lgkmcnt(2)
    v_mfma_f32_16x16x32_bf16 v[40:43], a[0:3], v[64:67], v[56:59]
    ds_read_b128 a[16:19], v7 offset:49408
    v_exp_f32 v48, v48
    v_mfma_f32_16x16x32_bf16 v[44:47], a[0:3], v[68:71], v[60:63]
    v_exp_f32 v49, v49
    v_mfma_f32_16x16x32_bf16 v[40:43], a[4:7], v[72:75], v[40:43]
    ds_read_b128 a[0:3], v8 offset:49408
    buffer_load_dwordx4 v22, s[12:15], s30 offen offset:3072 nt lds
    v_mfma_f32_16x16x32_bf16 v[44:47], a[4:7], v[76:79], v[44:47]
    v_exp_f32 v50, v50
    s_waitcnt lgkmcnt(2)
    v_mfma_f32_16x16x32_bf16 v[40:43], a[8:11], v[80:83], v[40:43]
    ds_read_b128 a[4:7], v9 offset:49408
    v_exp_f32 v51, v51
    v_mfma_f32_16x16x32_bf16 v[44:47], a[8:11], v[84:87], v[44:47]
    v_cvt_pk_bf16_f32 v34, v48, v49
    v_exp_f32 v52, v52
    v_mfma_f32_16x16x32_bf16 v[40:43], a[12:15], v[88:91], v[40:43]
    ds_read_b128 a[8:11], v10 offset:49408
    v_exp_f32 v53, v53
    v_mfma_f32_16x16x32_bf16 v[44:47], a[12:15], v[92:95], v[44:47]
    v_cvt_pk_bf16_f32 v35, v50, v51
    s_waitcnt lgkmcnt(2)
    v_mfma_f32_16x16x32_bf16 v[40:43], a[16:19], v[96:99], v[40:43]
    ds_read_b128 a[12:15], v7 offset:51200
    v_exp_f32 v54, v54
    v_mfma_f32_16x16x32_bf16 v[44:47], a[16:19], v[100:103], v[44:47]
    v_exp_f32 v55, v55
    v_cvt_pk_bf16_f32 v38, v52, v53
    v_mfma_f32_16x16x32_bf16 v[40:43], a[0:3], v[104:107], v[40:43]
    ds_read_b128 a[16:19], v8 offset:51200
    s_nop 0
    v_cvt_pk_bf16_f32 v39, v54, v55
    v_mfma_f32_16x16x32_bf16 v[44:47], a[0:3], v[108:111], v[44:47]
    s_waitcnt lgkmcnt(2)
    v_mfma_f32_16x16x32_bf16 v[40:43], a[4:7], v[112:115], v[40:43]
    ds_read_b128 a[0:3], v9 offset:51200
    s_add_u32 m0, s29, 16384
    v_mfma_f32_16x16x32_bf16 v[44:47], a[4:7], v[116:119], v[44:47]
    s_mov_b32 s30, 311296
    buffer_load_dwordx4 v19, s[8:11], s30 offen offset:0 nt lds
    v_mfma_f32_16x16x32_bf16 v[40:43], a[8:11], v[120:123], v[40:43]
    ds_read_b128 a[4:7], v10 offset:51200
    v_mfma_f32_16x16x32_bf16 v[44:47], a[8:11], v[124:127], v[44:47]
    s_waitcnt lgkmcnt(2)
    v_mfma_f32_16x16x32_bf16 v[48:51], a[12:15], v[64:67], v[56:59]
    ds_read_b128 a[8:11], v7 offset:51456
    v_mfma_f32_16x16x32_bf16 v[52:55], a[12:15], v[68:71], v[60:63]
    v_mfma_f32_16x16x32_bf16 v[48:51], a[16:19], v[72:75], v[48:51]
    ds_read_b128 a[12:15], v8 offset:51456
    v_mfma_f32_16x16x32_bf16 v[52:55], a[16:19], v[76:79], v[52:55]
    s_waitcnt lgkmcnt(2)
    v_mfma_f32_16x16x32_bf16 v[48:51], a[0:3], v[80:83], v[48:51]
    ds_read_b128 a[16:19], v9 offset:51456
    v_mfma_f32_16x16x32_bf16 v[52:55], a[0:3], v[84:87], v[52:55]
    v_mfma_f32_16x16x32_bf16 v[48:51], a[4:7], v[88:91], v[48:51]
    ds_read_b128 a[0:3], v10 offset:51456
    v_max3_f32 v0, v40, v41, v42
    v_mfma_f32_16x16x32_bf16 v[52:55], a[4:7], v[92:95], v[52:55]
    v_max3_f32 v1, v43, v44, v45
    s_waitcnt lgkmcnt(2)
    v_mfma_f32_16x16x32_bf16 v[48:51], a[8:11], v[96:99], v[48:51]
    s_waitcnt vmcnt(21)
    s_barrier
    ds_read_b64_tr_b16 a[4:5], v11 offset:32768
    v_mfma_f32_16x16x32_bf16 v[52:55], a[8:11], v[100:103], v[52:55]
    ds_read_b64_tr_b16 a[6:7], v11 offset:34816
    buffer_load_dwordx4 v20, s[8:11], s30 offen offset:1024 nt lds
    v_mfma_f32_16x16x32_bf16 v[48:51], a[12:15], v[104:107], v[48:51]
    ds_read_b64_tr_b16 a[8:9], v12 offset:32768
    v_max3_f32 v0, v0, v46, v47
    v_mfma_f32_16x16x32_bf16 v[52:55], a[12:15], v[108:111], v[52:55]
    ds_read_b64_tr_b16 a[10:11], v12 offset:34816
    s_waitcnt lgkmcnt(4)
    v_mfma_f32_16x16x32_bf16 v[48:51], a[16:19], v[112:115], v[48:51]
    v_mfma_f32_16x16x32_bf16 v[52:55], a[16:19], v[116:119], v[52:55]
    v_mfma_f32_16x16x32_bf16 v[48:51], a[0:3], v[120:123], v[48:51]
    ds_read_b64_tr_b16 a[12:13], v13 offset:32768
    v_mfma_f32_16x16x32_bf16 v[52:55], a[0:3], v[124:127], v[52:55]
    ds_read_b64_tr_b16 a[14:15], v13 offset:34816
    s_waitcnt lgkmcnt(2)
    v_mfma_f32_16x16x32_bf16 v[128:131], a[4:7], v[32:35], v[128:131]
    ds_read_b64_tr_b16 a[16:17], v14 offset:32768
    buffer_load_dwordx4 v19, s[8:11], s30 offen offset:2048 nt lds
    v_mfma_f32_16x16x32_bf16 v[132:135], a[4:7], v[36:39], v[132:135]
    ds_read_b64_tr_b16 a[18:19], v14 offset:34816
    v_mfma_f32_16x16x32_bf16 v[136:139], a[8:11], v[32:35], v[136:139]
    ds_read_b64_tr_b16 a[0:1], v15 offset:32768
    v_mfma_f32_16x16x32_bf16 v[140:143], a[8:11], v[36:39], v[140:143]
    ds_read_b64_tr_b16 a[2:3], v15 offset:34816
    v_max3_f32 v1, v1, v48, v49
    v_max3_f32 v0, v0, v50, v51
    v_mfma_f32_16x16x32_bf16 a[20:23], a[28:31], v[32:35], a[20:23]
    ds_read_b64_tr_b16 a[4:5], v16 offset:32768
    v_max3_f32 v1, v1, v52, v53
    v_max3_f32 v0, v0, v54, v55
    v_mfma_f32_16x16x32_bf16 a[24:27], a[28:31], v[36:39], a[24:27]
    ds_read_b64_tr_b16 a[6:7], v16 offset:34816
    v_max_f32 v0, v0, v1
    s_waitcnt lgkmcnt(4)
    v_mfma_f32_16x16x32_bf16 v[144:147], a[12:15], v[32:35], v[144:147]
    ds_read_b64_tr_b16 a[8:9], v17 offset:32768
    v_cmp_lt_f32 vcc, s31, v0
    s_cbranch_vccnz L_up_15
L_upb_15:
    v_mfma_f32_16x16x32_bf16 v[148:151], a[12:15], v[36:39], v[148:151]
    ds_read_b64_tr_b16 a[10:11], v17 offset:34816
    v_exp_f32 v40, v40
    v_mfma_f32_16x16x32_bf16 v[152:155], a[16:19], v[32:35], v[152:155]
    ds_read_b64_tr_b16 a[12:13], v18 offset:32768
    buffer_load_dwordx4 v20, s[8:11], s30 offen offset:3072 nt lds
    v_mfma_f32_16x16x32_bf16 v[156:159], a[16:19], v[36:39], v[156:159]
    ds_read_b64_tr_b16 a[14:15], v18 offset:34816
    s_waitcnt lgkmcnt(4)
    v_mfma_f32_16x16x32_bf16 v[160:163], a[0:3], v[32:35], v[160:163]
    ds_read_b64_tr_b16 a[16:17], v11 offset:33024
    v_exp_f32 v41, v41
    v_mfma_f32_16x16x32_bf16 v[164:167], a[0:3], v[36:39], v[164:167]
    ds_read_b64_tr_b16 a[18:19], v11 offset:35072
    v_exp_f32 v42, v42
    v_mfma_f32_16x16x32_bf16 v[168:171], a[4:7], v[32:35], v[168:171]
    ds_read_b64_tr_b16 a[0:1], v12 offset:33024
    v_exp_f32 v43, v43
    v_mfma_f32_16x16x32_bf16 v[172:175], a[4:7], v[36:39], v[172:175]
    ds_read_b64_tr_b16 a[2:3], v12 offset:35072
    v_cvt_pk_bf16_f32 v24, v40, v41
    s_waitcnt lgkmcnt(4)
    v_mfma_f32_16x16x32_bf16 v[176:179], a[8:11], v[32:35], v[176:179]
    ds_read_b64_tr_b16 a[4:5], v13 offset:33024
    v_exp_f32 v44, v44
    v_mfma_f32_16x16x32_bf16 v[180:183], a[8:11], v[36:39], v[180:183]
    ds_read_b64_tr_b16 a[6:7], v13 offset:35072
    v_exp_f32 v45, v45
    v_mfma_f32_16x16x32_bf16 v[184:187], a[12:15], v[32:35], v[184:187]
    ds_read_b64_tr_b16 a[8:9], v14 offset:33024
    s_add_u32 m0, s29, 81920
    v_cvt_pk_bf16_f32 v25, v42, v43
    v_mfma_f32_16x16x32_bf16 v[188:191], a[12:15], v[36:39], v[188:191]
    ds_read_b64_tr_b16 a[10:11], v14 offset:35072
    s_waitcnt lgkmcnt(4)
    v_mfma_f32_16x16x32_bf16 v[192:195], a[16:19], v[32:35], v[192:195]
    ds_read_b64_tr_b16 a[12:13], v15 offset:33024
    s_mov_b32 s30, 294912
    v_mfma_f32_16x16x32_bf16 v[196:199], a[16:19], v[36:39], v[196:199]
    ds_read_b64_tr_b16 a[14:15], v15 offset:35072
    buffer_load_dwordx4 v21, s[12:15], s30 offen offset:0 nt lds
    v_mfma_f32_16x16x32_bf16 v[200:203], a[0:3], v[32:35], v[200:203]
    ds_read_b64_tr_b16 a[16:17], v16 offset:33024
    v_exp_f32 v46, v46
    v_mfma_f32_16x16x32_bf16 v[204:207], a[0:3], v[36:39], v[204:207]
    ds_read_b64_tr_b16 a[18:19], v16 offset:35072
    s_waitcnt lgkmcnt(4)
    v_mfma_f32_16x16x32_bf16 v[208:211], a[4:7], v[32:35], v[208:211]
    ds_read_b64_tr_b16 a[0:1], v17 offset:33024
    v_exp_f32 v47, v47
    v_mfma_f32_16x16x32_bf16 v[212:215], a[4:7], v[36:39], v[212:215]
    ds_read_b64_tr_b16 a[2:3], v17 offset:35072
    v_cvt_pk_bf16_f32 v28, v44, v45
    s_nop 0
    v_mfma_f32_16x16x32_bf16 v[216:219], a[8:11], v[32:35], v[216:219]
    ds_read_b64_tr_b16 a[4:5], v18 offset:33024
    v_cvt_pk_bf16_f32 v29, v46, v47
    v_mfma_f32_16x16x32_bf16 v[220:223], a[8:11], v[36:39], v[220:223]
    ds_read_b64_tr_b16 a[6:7], v18 offset:35072
    s_waitcnt lgkmcnt(4)
    v_mfma_f32_16x16x32_bf16 v[224:227], a[12:15], v[32:35], v[224:227]
    s_waitcnt vmcnt(7)
    s_barrier
    ds_read_b128 a[8:11], v7 offset:32768
    v_mfma_f32_16x16x32_bf16 v[228:231], a[12:15], v[36:39], v[228:231]
    buffer_load_dwordx4 v22, s[12:15], s30 offen offset:1024 nt lds
    v_mfma_f32_16x16x32_bf16 v[232:235], a[16:19], v[32:35], v[232:235]
    ds_read_b128 a[12:15], v8 offset:32768
    v_mfma_f32_16x16x32_bf16 v[236:239], a[16:19], v[36:39], v[236:239]
    s_waitcnt lgkmcnt(2)
    v_mfma_f32_16x16x32_bf16 v[240:243], a[0:3], v[32:35], v[240:243]
    ds_read_b128 a[16:19], v9 offset:32768
    v_mfma_f32_16x16x32_bf16 v[244:247], a[0:3], v[36:39], v[244:247]
    v_mfma_f32_16x16x32_bf16 v[248:251], a[4:7], v[32:35], v[248:251]
    ds_read_b128 a[0:3], v10 offset:32768
    v_mfma_f32_16x16x32_bf16 v[252:255], a[4:7], v[36:39], v[252:255]
    s_cbranch_vccnz L_rs_15
L_rsb_15:
    s_waitcnt lgkmcnt(2)
    v_mfma_f32_16x16x32_bf16 v[40:43], a[8:11], v[64:67], v[56:59]
    ds_read_b128 a[4:7], v7 offset:33024
    v_exp_f32 v48, v48
    v_mfma_f32_16x16x32_bf16 v[44:47], a[8:11], v[68:71], v[60:63]
    v_exp_f32 v49, v49
    v_mfma_f32_16x16x32_bf16 v[40:43], a[12:15], v[72:75], v[40:43]
    ds_read_b128 a[8:11], v8 offset:33024
    buffer_load_dwordx4 v21, s[12:15], s30 offen offset:2048 nt lds
    v_mfma_f32_16x16x32_bf16 v[44:47], a[12:15], v[76:79], v[44:47]
    v_exp_f32 v50, v50
    s_waitcnt lgkmcnt(2)
    v_mfma_f32_16x16x32_bf16 v[40:43], a[16:19], v[80:83], v[40:43]
    ds_read_b128 a[12:15], v9 offset:33024
    v_exp_f32 v51, v51
    v_mfma_f32_16x16x32_bf16 v[44:47], a[16:19], v[84:87], v[44:47]
    v_cvt_pk_bf16_f32 v26, v48, v49
    v_exp_f32 v52, v52
    v_mfma_f32_16x16x32_bf16 v[40:43], a[0:3], v[88:91], v[40:43]
    ds_read_b128 a[16:19], v10 offset:33024
    v_exp_f32 v53, v53
    v_mfma_f32_16x16x32_bf16 v[44:47], a[0:3], v[92:95], v[44:47]
    v_cvt_pk_bf16_f32 v27, v50, v51
    s_waitcnt lgkmcnt(2)
    v_mfma_f32_16x16x32_bf16 v[40:43], a[4:7], v[96:99], v[40:43]
    ds_read_b128 a[0:3], v7 offset:34816
    v_exp_f32 v54, v54
    v_mfma_f32_16x16x32_bf16 v[44:47], a[4:7], v[100:103], v[44:47]
    v_exp_f32 v55, v55
    v_cvt_pk_bf16_f32 v30, v52, v53
    v_mfma_f32_16x16x32_bf16 v[40:43], a[8:11], v[104:107], v[40:43]
    ds_read_b128 a[4:7], v8 offset:34816
    s_nop 0
    v_cvt_pk_bf16_f32 v31, v54, v55
    v_mfma_f32_16x16x32_bf16 v[44:47], a[8:11], v[108:111], v[44:47]
    v_add_u32 v3, 147456, v2
    s_waitcnt lgkmcnt(2)
    v_mfma_f32_16x16x32_bf16 v[40:43], a[12:15], v[112:115], v[40:43]
    ds_read_b128 a[8:11], v9 offset:34816
    buffer_load_dwordx4 v22, s[12:15], s30 offen offset:3072 nt lds
    v_mfma_f32_16x16x32_bf16 v[44:47], a[12:15], v[116:119], v[44:47]
    ds_read_b64_tr_b16 a[144:145], v3 offset:0
    v_mfma_f32_16x16x32_bf16 v[40:43], a[16:19], v[120:123], v[40:43]
    ds_read_b128 a[12:15], v10 offset:34816
    v_mfma_f32_16x16x32_bf16 v[44:47], a[16:19], v[124:127], v[44:47]
    ds_read_b64_tr_b16 a[146:147], v3 offset:2048
    s_waitcnt lgkmcnt(4)
    v_mfma_f32_16x16x32_bf16 v[48:51], a[0:3], v[64:67], v[56:59]
    ds_read_b128 a[16:19], v7 offset:35072
    v_mfma_f32_16x16x32_bf16 v[52:55], a[0:3], v[68:71], v[60:63]
    ds_read_b64_tr_b16 a[148:149], v3 offset:4096
    v_mfma_f32_16x16x32_bf16 v[48:51], a[4:7], v[72:75], v[48:51]
    ds_read_b128 a[0:3], v8 offset:35072
    v_mfma_f32_16x16x32_bf16 v[52:55], a[4:7], v[76:79], v[52:55]
    ds_read_b64_tr_b16 a[150:151], v3 offset:6144
    s_waitcnt lgkmcnt(5)
    v_mfma_f32_16x16x32_bf16 v[48:51], a[8:11], v[80:83], v[48:51]
    ds_read_b128 a[4:7], v9 offset:35072
    v_mfma_f32_16x16x32_bf16 v[52:55], a[8:11], v[84:87], v[52:55]
    ds_read_b64_tr_b16 a[152:153], v3 offset:8192
    v_mfma_f32_16x16x32_bf16 v[48:51], a[12:15], v[88:91], v[48:51]
    ds_read_b128 a[8:11], v10 offset:35072
    v_max3_f32 v0, v40, v41, v42
    v_max3_f32 v1, v43, v44, v45
    v_mfma_f32_16x16x32_bf16 v[52:55], a[12:15], v[92:95], v[52:55]
    ds_read_b64_tr_b16 a[154:155], v3 offset:10240
    v_max3_f32 v0, v0, v46, v47
    s_waitcnt lgkmcnt(5)
    v_mfma_f32_16x16x32_bf16 v[48:51], a[16:19], v[96:99], v[48:51]
    s_barrier
    ds_read_b64_tr_b16 a[12:13], v11 offset:49152
    v_mfma_f32_16x16x32_bf16 v[52:55], a[16:19], v[100:103], v[52:55]
    ds_read_b64_tr_b16 a[14:15], v11 offset:51200
    s_add_u32 m0, s29, 49152
    v_mfma_f32_16x16x32_bf16 v[48:51], a[0:3], v[104:107], v[48:51]
    ds_read_b64_tr_b16 a[16:17], v12 offset:49152
    s_mov_b32 s30, 327680
    v_mfma_f32_16x16x32_bf16 v[52:55], a[0:3], v[108:111], v[52:55]
    ds_read_b64_tr_b16 a[18:19], v12 offset:51200
    s_waitcnt lgkmcnt(5)
    v_mfma_f32_16x16x32_bf16 v[48:51], a[4:7], v[112:115], v[48:51]
    buffer_load_dwordx4 v19, s[8:11], s30 offen offset:0 nt lds
    ds_read_b64_tr_b16 a[156:157], v3 offset:12288
    v_mfma_f32_16x16x32_bf16 v[52:55], a[4:7], v[116:119], v[52:55]
    buffer_load_dwordx4 v20, s[8:11], s30 offen offset:1024 nt lds
    ds_read_b64_tr_b16 a[158:159], v3 offset:14336
    v_mfma_f32_16x16x32_bf16 v[48:51], a[8:11], v[120:123], v[48:51]
    ds_read_b64_tr_b16 a[0:1], v13 offset:49152
    v_mfma_f32_16x16x32_bf16 v[52:55], a[8:11], v[124:127], v[52:55]
    ds_read_b64_tr_b16 a[2:3], v13 offset:51200
    s_waitcnt lgkmcnt(4)
    v_mfma_f32_16x16x32_bf16 v[128:131], a[12:15], v[24:27], v[128:131]
    ds_read_b64_tr_b16 a[4:5], v14 offset:49152
    buffer_load_dwordx4 v19, s[8:11], s30 offen offset:2048 nt lds
    v_mfma_f32_16x16x32_bf16 v[132:135], a[12:15], v[28:31], v[132:135]
    ds_read_b64_tr_b16 a[6:7], v14 offset:51200
    v_mfma_f32_16x16x32_bf16 v[136:139], a[16:19], v[24:27], v[136:139]
    ds_read_b64_tr_b16 a[8:9], v15 offset:49152
    v_mfma_f32_16x16x32_bf16 v[140:143], a[16:19], v[28:31], v[140:143]
    ds_read_b64_tr_b16 a[10:11], v15 offset:51200
    v_max3_f32 v1, v1, v48, v49
    v_max3_f32 v0, v0, v50, v51
    v_max3_f32 v1, v1, v52, v53
    v_mfma_f32_16x16x32_bf16 a[20:23], a[28:31], v[24:27], a[20:23]
    ds_read_b64_tr_b16 a[12:13], v16 offset:49152
    buffer_load_dwordx4 v20, s[8:11], s30 offen offset:3072 nt lds
    v_max3_f32 v0, v0, v54, v55
    v_max_f32 v0, v0, v1
    v_mfma_f32_16x16x32_bf16 a[24:27], a[28:31], v[28:31], a[24:27]
    ds_read_b64_tr_b16 a[14:15], v16 offset:51200
    v_cmp_lt_f32 vcc, s31, v0
    s_cbranch_vccnz L_up_16
L_upb_16:
    s_waitcnt lgkmcnt(4)
    v_mfma_f32_16x16x32_bf16 v[144:147], a[0:3], v[24:27], v[144:147]
    ds_read_b64_tr_b16 a[16:17], v17 offset:49152
    v_exp_f32 v40, v40
    v_mfma_f32_16x16x32_bf16 v[148:151], a[0:3], v[28:31], v[148:151]
    ds_read_b64_tr_b16 a[18:19], v17 offset:51200
    v_exp_f32 v41, v41
    v_mfma_f32_16x16x32_bf16 v[152:155], a[4:7], v[24:27], v[152:155]
    ds_read_b64_tr_b16 a[0:1], v18 offset:49152
    s_add_u32 m0, s29, 131072
    v_exp_f32 v42, v42
    v_mfma_f32_16x16x32_bf16 v[156:159], a[4:7], v[28:31], v[156:159]
    ds_read_b64_tr_b16 a[2:3], v18 offset:51200
    v_exp_f32 v43, v43
    s_waitcnt lgkmcnt(4)
    v_mfma_f32_16x16x32_bf16 v[160:163], a[8:11], v[24:27], v[160:163]
    ds_read_b64_tr_b16 a[4:5], v11 offset:49408
    s_add_u32 s30, s80, 0
    v_cvt_pk_bf16_f32 v32, v40, v41
    v_mfma_f32_16x16x32_bf16 v[164:167], a[8:11], v[28:31], v[164:167]
    ds_read_b64_tr_b16 a[6:7], v11 offset:51456
    buffer_load_dwordx4 v23, s[20:23], s30 offen offset:0  lds
    v_exp_f32 v44, v44
    v_mfma_f32_16x16x32_bf16 v[168:171], a[12:15], v[24:27], v[168:171]
    ds_read_b64_tr_b16 a[8:9], v12 offset:49408
    s_add_u32 s30, s80, 6144
    v_exp_f32 v45, v45
    v_mfma_f32_16x16x32_bf16 v[172:175], a[12:15], v[28:31], v[172:175]
    ds_read_b64_tr_b16 a[10:11], v12 offset:51456
    v_cvt_pk_bf16_f32 v33, v42, v43
    s_waitcnt lgkmcnt(4)
    v_mfma_f32_16x16x32_bf16 v[176:179], a[16:19], v[24:27], v[176:179]
    ds_read_b64_tr_b16 a[12:13], v13 offset:49408
    buffer_load_dwordx4 v23, s[20:23], s30 offen offset:1024  lds
    v_exp_f32 v46, v46
    v_mfma_f32_16x16x32_bf16 v[180:183], a[16:19], v[28:31], v[180:183]
    ds_read_b64_tr_b16 a[14:15], v13 offset:51456
    v_exp_f32 v47, v47
    v_cvt_pk_bf16_f32 v36, v44, v45
    v_mfma_f32_16x16x32_bf16 v[184:187], a[0:3], v[24:27], v[184:187]
    ds_read_b64_tr_b16 a[16:17], v14 offset:49408
    s_add_u32 s30, s80, 12288
    s_nop 0
    v_cvt_pk_bf16_f32 v37, v46, v47
    v_mfma_f32_16x16x32_bf16 v[188:191], a[0:3], v[28:31], v[188:191]
    ds_read_b64_tr_b16 a[18:19], v14 offset:51456
    s_waitcnt lgkmcnt(4)
    v_mfma_f32_16x16x32_bf16 v[192:195], a[4:7], v[24:27], v[192:195]
    ds_read_b64_tr_b16 a[0:1], v15 offset:49408
    buffer_load_dwordx4 v23, s[20:23], s30 offen offset:2048  lds
    v_mfma_f32_16x16x32_bf16 v[196:199], a[4:7], v[28:31], v[196:199]
    ds_read_b64_tr_b16 a[2:3], v15 offset:51456
    v_mfma_f32_16x16x32_bf16 v[200:203], a[8:11], v[24:27], v[200:203]
    ds_read_b64_tr_b16 a[4:5], v16 offset:49408
    s_add_u32 s30, s80, 18432
    v_mfma_f32_16x16x32_bf16 v[204:207], a[8:11], v[28:31], v[204:207]
    ds_read_b64_tr_b16 a[6:7], v16 offset:51456
    s_waitcnt lgkmcnt(4)
    v_mfma_f32_16x16x32_bf16 v[208:211], a[12:15], v[24:27], v[208:211]
    ds_read_b64_tr_b16 a[8:9], v17 offset:49408
    buffer_load_dwordx4 v23, s[20:23], s30 offen offset:3072  lds
    v_mfma_f32_16x16x32_bf16 v[212:215], a[12:15], v[28:31], v[212:215]
    ds_read_b64_tr_b16 a[10:11], v17 offset:51456
    v_mfma_f32_16x16x32_bf16 v[216:219], a[16:19], v[24:27], v[216:219]
    ds_read_b64_tr_b16 a[12:13], v18 offset:49408
    v_mfma_f32_16x16x32_bf16 v[220:223], a[16:19], v[28:31], v[220:223]
    ds_read_b64_tr_b16 a[14:15], v18 offset:51456
    s_waitcnt lgkmcnt(4)
    v_mfma_f32_16x16x32_bf16 v[224:227], a[0:3], v[24:27], v[224:227]
    s_barrier
    ds_read_b128 a[16:19], v7 offset:0
    v_mfma_f32_16x16x32_bf16 v[228:231], a[0:3], v[28:31], v[228:231]
    s_add_u32 m0, s29, 98304
    s_mov_b32 s30, 311296
    v_mfma_f32_16x16x32_bf16 v[232:235], a[4:7], v[24:27], v[232:235]
    ds_read_b128 a[0:3], v8 offset:0
    buffer_load_dwordx4 v21, s[12:15], s30 offen offset:0 nt lds
    v_mfma_f32_16x16x32_bf16 v[236:239], a[4:7], v[28:31], v[236:239]
    s_waitcnt lgkmcnt(2)
    v_mfma_f32_16x16x32_bf16 v[240:243], a[8:11], v[24:27], v[240:243]
    ds_read_b128 a[4:7], v9 offset:0
    v_mfma_f32_16x16x32_bf16 v[244:247], a[8:11], v[28:31], v[244:247]
    v_mfma_f32_16x16x32_bf16 v[248:251], a[12:15], v[24:27], v[248:251]
    ds_read_b128 a[8:11], v10 offset:0
    v_mfma_f32_16x16x32_bf16 v[252:255], a[12:15], v[28:31], v[252:255]
    buffer_load_dwordx4 v22, s[12:15], s30 offen offset:1024 nt lds
    s_cbranch_vccnz L_rs_16
L_rsb_16:
    s_waitcnt lgkmcnt(2)
    v_mfma_f32_16x16x32_bf16 v[40:43], a[16:19], v[64:67], v[56:59]
    ds_read_b128 a[12:15], v7 offset:256
    v_exp_f32 v48, v48
    v_mfma_f32_16x16x32_bf16 v[44:47], a[16:19], v[68:71], v[60:63]
    v_exp_f32 v49, v49
    v_mfma_f32_16x16x32_bf16 v[40:43], a[0:3], v[72:75], v[40:43]
    ds_read_b128 a[16:19], v8 offset:256
    v_exp_f32 v50, v50
    v_mfma_f32_16x16x32_bf16 v[44:47], a[0:3], v[76:79], v[44:47]
    v_exp_f32 v51, v51
    s_waitcnt lgkmcnt(2)
    v_mfma_f32_16x16x32_bf16 v[40:43], a[4:7], v[80:83], v[40:43]
    ds_read_b128 a[0:3], v9 offset:256
    v_cvt_pk_bf16_f32 v34, v48, v49
    v_mfma_f32_16x16x32_bf16 v[44:47], a[4:7], v[84:87], v[44:47]
    v_exp_f32 v52, v52
    v_mfma_f32_16x16x32_bf16 v[40:43], a[8:11], v[88:91], v[40:43]
    ds_read_b128 a[4:7], v10 offset:256
    buffer_load_dwordx4 v21, s[12:15], s30 offen offset:2048 nt lds
    v_mfma_f32_16x16x32_bf16 v[44:47], a[8:11], v[92:95], v[44:47]
    v_exp_f32 v53, v53
    s_waitcnt lgkmcnt(2)
    v_mfma_f32_16x16x32_bf16 v[40:43], a[12:15], v[96:99], v[40:43]
    ds_read_b128 a[8:11], v7 offset:2048
    v_cvt_pk_bf16_f32 v35, v50, v51
    v_mfma_f32_16x16x32_bf16 v[44:47], a[12:15], v[100:103], v[44:47]
    v_exp_f32 v54, v54
    v_mfma_f32_16x16x32_bf16 v[40:43], a[16:19], v[104:107], v[40:43]
    ds_read_b128 a[12:15], v8 offset:2048
    v_exp_f32 v55, v55
    v_mfma_f32_16x16x32_bf16 v[44:47], a[16:19], v[108:111], v[44:47]
    v_cvt_pk_bf16_f32 v38, v52, v53
    s_nop 0
    s_waitcnt lgkmcnt(2)
    v_mfma_f32_16x16x32_bf16 v[40:43], a[0:3], v[112:115], v[40:43]
    ds_read_b128 a[16:19], v9 offset:2048
    v_cvt_pk_bf16_f32 v39, v54, v55
    v_mfma_f32_16x16x32_bf16 v[44:47], a[0:3], v[116:119], v[44:47]
    buffer_load_dwordx4 v22, s[12:15], s30 offen offset:3072 nt lds
    v_mfma_f32_16x16x32_bf16 v[40:43], a[4:7], v[120:123], v[40:43]
    ds_read_b128 a[0:3], v10 offset:2048
    v_mfma_f32_16x16x32_bf16 v[44:47], a[4:7], v[124:127], v[44:47]
    s_waitcnt lgkmcnt(2)
    v_mfma_f32_16x16x32_bf16 v[48:51], a[8:11], v[64:67], v[56:59]
    ds_read_b128 a[4:7], v7 offset:2304
    v_mfma_f32_16x16x32_bf16 v[52:55], a[8:11], v[68:71], v[60:63]
    v_mfma_f32_16x16x32_bf16 v[48:51], a[12:15], v[72:75], v[48:51]
    ds_read_b128 a[8:11], v8 offset:2304
    v_mfma_f32_16x16x32_bf16 v[52:55], a[12:15], v[76:79], v[52:55]
    s_waitcnt lgkmcnt(2)
    v_mfma_f32_16x16x32_bf16 v[48:51], a[16:19], v[80:83], v[48:51]
    ds_read_b128 a[12:15], v9 offset:2304
    v_mfma_f32_16x16x32_bf16 v[52:55], a[16:19], v[84:87], v[52:55]
    v_mfma_f32_16x16x32_bf16 v[48:51], a[0:3], v[88:91], v[48:51]
    ds_read_b128 a[16:19], v10 offset:2304
    v_max3_f32 v0, v40, v41, v42
    v_mfma_f32_16x16x32_bf16 v[52:55], a[0:3], v[92:95], v[52:55]
    v_max3_f32 v1, v43, v44, v45
    s_waitcnt lgkmcnt(2)
    v_mfma_f32_16x16x32_bf16 v[48:51], a[4:7], v[96:99], v[48:51]
    s_waitcnt vmcnt(20)
    s_barrier
    ds_read_b64_tr_b16 a[0:1], v11 offset:0
    v_mfma_f32_16x16x32_bf16 v[52:55], a[4:7], v[100:103], v[52:55]
    ds_read_b64_tr_b16 a[2:3], v11 offset:2048
    s_add_u32 m0, s29, 32768
    v_mfma_f32_16x16x32_bf16 v[48:51], a[8:11], v[104:107], v[48:51]
    ds_read_b64_tr_b16 a[4:5], v12 offset:0
    s_mov_b32 s30, 344064
    v_mfma_f32_16x16x32_bf16 v[52:55], a[8:11], v[108:111], v[52:55]
    ds_read_b64_tr_b16 a[6:7], v12 offset:2048
    s_waitcnt lgkmcnt(4)
    v_mfma_f32_16x16x32_bf16 v[48:51], a[12:15], v[112:115], v[48:51]
    buffer_load_dwordx4 v19, s[8:11], s30 offen offset:0 nt lds
    v_max3_f32 v0, v0, v46, v47
    v_mfma_f32_16x16x32_bf16 v[52:55], a[12:15], v[116:119], v[52:55]
    v_mfma_f32_16x16x32_bf16 v[48:51], a[16:19], v[120:123], v[48:51]
    ds_read_b64_tr_b16 a[8:9], v13 offset:0
    v_mfma_f32_16x16x32_bf16 v[52:55], a[16:19], v[124:127], v[52:55]
    ds_read_b64_tr_b16 a[10:11], v13 offset:2048
    s_waitcnt lgkmcnt(2)
    v_mfma_f32_16x16x32_bf16 v[128:131], a[0:3], v[32:35], v[128:131]
    ds_read_b64_tr_b16 a[12:13], v14 offset:0
    v_mfma_f32_16x16x32_bf16 v[132:135], a[0:3], v[36:39], v[132:135]
    ds_read_b64_tr_b16 a[14:15], v14 offset:2048
    v_mfma_f32_16x16x32_bf16 v[136:139], a[4:7], v[32:35], v[136:139]
    ds_read_b64_tr_b16 a[16:17], v15 offset:0
    buffer_load_dwordx4 v20, s[8:11], s30 offen offset:1024 nt lds
    v_mfma_f32_16x16x32_bf16 v[140:143], a[4:7], v[36:39], v[140:143]
    ds_read_b64_tr_b16 a[18:19], v15 offset:2048
    v_max3_f32 v1, v1, v48, v49
    v_max3_f32 v0, v0, v50, v51
    v_mfma_f32_16x16x32_bf16 a[20:23], a[28:31], v[32:35], a[20:23]
    ds_read_b64_tr_b16 a[0:1], v16 offset:0
    v_max3_f32 v1, v1, v52, v53
    v_max3_f32 v0, v0, v54, v55
    v_mfma_f32_16x16x32_bf16 a[24:27], a[28:31], v[36:39], a[24:27]
    ds_read_b64_tr_b16 a[2:3], v16 offset:2048
    v_max_f32 v0, v0, v1
    s_waitcnt lgkmcnt(4)
    v_mfma_f32_16x16x32_bf16 v[144:147], a[8:11], v[32:35], v[144:147]
    ds_read_b64_tr_b16 a[4:5], v17 offset:0
    v_cmp_lt_f32 vcc, s31, v0
    s_cbranch_vccnz L_up_17
L_upb_17:
    v_mfma_f32_16x16x32_bf16 v[148:151], a[8:11], v[36:39], v[148:151]
    ds_read_b64_tr_b16 a[6:7], v17 offset:2048
    v_exp_f32 v40, v40
    v_mfma_f32_16x16x32_bf16 v[152:155], a[12:15], v[32:35], v[152:155]
    ds_read_b64_tr_b16 a[8:9], v18 offset:0
    v_exp_f32 v41, v41
    v_mfma_f32_16x16x32_bf16 v[156:159], a[12:15], v[36:39], v[156:159]
    ds_read_b64_tr_b16 a[10:11], v18 offset:2048
    s_waitcnt lgkmcnt(4)
    v_mfma_f32_16x16x32_bf16 v[160:163], a[16:19], v[32:35], v[160:163]
    ds_read_b64_tr_b16 a[12:13], v11 offset:256
    v_exp_f32 v42, v42
    v_mfma_f32_16x16x32_bf16 v[164:167], a[16:19], v[36:39], v[164:167]
    ds_read_b64_tr_b16 a[14:15], v11 offset:2304
    v_exp_f32 v43, v43
    v_mfma_f32_16x16x32_bf16 v[168:171], a[0:3], v[32:35], v[168:171]
    ds_read_b64_tr_b16 a[16:17], v12 offset:256
    buffer_load_dwordx4 v19, s[8:11], s30 offen offset:2048 nt lds
    v_cvt_pk_bf16_f32 v24, v40, v41
    v_mfma_f32_16x16x32_bf16 v[172:175], a[0:3], v[36:39], v[172:175]
    ds_read_b64_tr_b16 a[18:19], v12 offset:2304
    s_waitcnt lgkmcnt(4)
    v_mfma_f32_16x16x32_bf16 v[176:179], a[4:7], v[32:35], v[176:179]
    ds_read_b64_tr_b16 a[0:1], v13 offset:256
    v_exp_f32 v44, v44
    v_mfma_f32_16x16x32_bf16 v[180:183], a[4:7], v[36:39], v[180:183]
    ds_read_b64_tr_b16 a[2:3], v13 offset:2304
    v_exp_f32 v45, v45
    v_mfma_f32_16x16x32_bf16 v[184:187], a[8:11], v[32:35], v[184:187]
    ds_read_b64_tr_b16 a[4:5], v14 offset:256
    v_cvt_pk_bf16_f32 v25, v42, v43
    v_mfma_f32_16x16x32_bf16 v[188:191], a[8:11], v[36:39], v[188:191]
    ds_read_b64_tr_b16 a[6:7], v14 offset:2304
    s_waitcnt lgkmcnt(4)
    v_mfma_f32_16x16x32_bf16 v[192:195], a[12:15], v[32:35], v[192:195]
    ds_read_b64_tr_b16 a[8:9], v15 offset:256
    v_exp_f32 v46, v46
    v_mfma_f32_16x16x32_bf16 v[196:199], a[12:15], v[36:39], v[196:199]
    ds_read_b64_tr_b16 a[10:11], v15 offset:2304
    v_exp_f32 v47, v47
    v_mfma_f32_16x16x32_bf16 v[200:203], a[16:19], v[32:35], v[200:203]
    ds_read_b64_tr_b16 a[12:13], v16 offset:256
    v_cvt_pk_bf16_f32 v28, v44, v45
    s_nop 0
    v_mfma_f32_16x16x32_bf16 v[204:207], a[16:19], v[36:39], v[204:207]
    ds_read_b64_tr_b16 a[14:15], v16 offset:2304
    v_cvt_pk_bf16_f32 v29, v46, v47
    s_waitcnt lgkmcnt(4)
    v_mfma_f32_16x16x32_bf16 v[208:211], a[0:3], v[32:35], v[208:211]
    ds_read_b64_tr_b16 a[16:17], v17 offset:256
    v_mfma_f32_16x16x32_bf16 v[212:215], a[0:3], v[36:39], v[212:215]
    ds_read_b64_tr_b16 a[18:19], v17 offset:2304
    v_mfma_f32_16x16x32_bf16 v[216:219], a[4:7], v[32:35], v[216:219]
    ds_read_b64_tr_b16 a[0:1], v18 offset:256
    v_mfma_f32_16x16x32_bf16 v[220:223], a[4:7], v[36:39], v[220:223]
    ds_read_b64_tr_b16 a[2:3], v18 offset:2304
    s_waitcnt lgkmcnt(4)
    v_mfma_f32_16x16x32_bf16 v[224:227], a[8:11], v[32:35], v[224:227]
    s_waitcnt vmcnt(7)
    s_barrier
    ds_read_b128 a[4:7], v7 offset:16384
    v_mfma_f32_16x16x32_bf16 v[228:231], a[8:11], v[36:39], v[228:231]
    buffer_load_dwordx4 v20, s[8:11], s30 offen offset:3072 nt lds
    v_mfma_f32_16x16x32_bf16 v[232:235], a[12:15], v[32:35], v[232:235]
    ds_read_b128 a[8:11], v8 offset:16384
    v_mfma_f32_16x16x32_bf16 v[236:239], a[12:15], v[36:39], v[236:239]
    s_waitcnt lgkmcnt(2)
    v_mfma_f32_16x16x32_bf16 v[240:243], a[16:19], v[32:35], v[240:243]
    ds_read_b128 a[12:15], v9 offset:16384
    v_mfma_f32_16x16x32_bf16 v[244:247], a[16:19], v[36:39], v[244:247]
    v_mfma_f32_16x16x32_bf16 v[248:251], a[0:3], v[32:35], v[248:251]
    ds_read_b128 a[16:19], v10 offset:16384
    v_mfma_f32_16x16x32_bf16 v[252:255], a[0:3], v[36:39], v[252:255]
    s_add_u32 m0, s29, 114688
    s_cbranch_vccnz L_rs_17
L_rsb_17:
    s_waitcnt lgkmcnt(2)
    v_mfma_f32_16x16x32_bf16 v[40:43], a[4:7], v[64:67], v[56:59]
    ds_read_b128 a[0:3], v7 offset:16640
    s_mov_b32 s30, 327680
    v_mfma_f32_16x16x32_bf16 v[44:47], a[4:7], v[68:71], v[60:63]
    buffer_load_dwordx4 v21, s[12:15], s30 offen offset:0 nt lds
    v_exp_f32 v48, v48
    v_mfma_f32_16x16x32_bf16 v[40:43], a[8:11], v[72:75], v[40:43]
    ds_read_b128 a[4:7], v8 offset:16640
    v_exp_f32 v49, v49
    v_mfma_f32_16x16x32_bf16 v[44:47], a[8:11], v[76:79], v[44:47]
    v_exp_f32 v50, v50
    s_waitcnt lgkmcnt(2)
    v_mfma_f32_16x16x32_bf16 v[40:43], a[12:15], v[80:83], v[40:43]
    ds_read_b128 a[8:11], v9 offset:16640
    v_exp_f32 v51, v51
    v_mfma_f32_16x16x32_bf16 v[44:47], a[12:15], v[84:87], v[44:47]
    v_cvt_pk_bf16_f32 v26, v48, v49
    v_exp_f32 v52, v52
    v_mfma_f32_16x16x32_bf16 v[40:43], a[16:19], v[88:91], v[40:43]
    ds_read_b128 a[12:15], v10 offset:16640
    buffer_load_dwordx4 v22, s[12:15], s30 offen offset:1024 nt lds
    v_add_u32 v3, 131072, v2
    v_mfma_f32_16x16x32_bf16 v[44:47], a[16:19], v[92:95], v[44:47]
    v_exp_f32 v53, v53
    s_waitcnt lgkmcnt(2)
    v_mfma_f32_16x16x32_bf16 v[40:43], a[0:3], v[96:99], v[40:43]
    ds_read_b128 a[16:19], v7 offset:18432
    v_cvt_pk_bf16_f32 v27, v50, v51
    v_mfma_f32_16x16x32_bf16 v[44:47], a[0:3], v[100:103], v[44:47]
    v_exp_f32 v54, v54
    ds_read_b64_tr_b16 a[160:161], v3 offset:0
    v_mfma_f32_16x16x32_bf16 v[40:43], a[4:7], v[104:107], v[40:43]
    ds_read_b128 a[0:3], v8 offset:18432
    v_exp_f32 v55, v55
    v_mfma_f32_16x16x32_bf16 v[44:47], a[4:7], v[108:111], v[44:47]
    v_cvt_pk_bf16_f32 v30, v52, v53
    s_nop 0
    s_waitcnt lgkmcnt(3)
    v_mfma_f32_16x16x32_bf16 v[40:43], a[8:11], v[112:115], v[40:43]
    ds_read_b128 a[4:7], v9 offset:18432
    v_cvt_pk_bf16_f32 v31, v54, v55
    v_mfma_f32_16x16x32_bf16 v[44:47], a[8:11], v[116:119], v[44:47]
    buffer_load_dwordx4 v21, s[12:15], s30 offen offset:2048 nt lds
    ds_read_b64_tr_b16 a[162:163], v3 offset:2048
    v_mfma_f32_16x16x32_bf16 v[40:43], a[12:15], v[120:123], v[40:43]
    ds_read_b128 a[8:11], v10 offset:18432
    v_mfma_f32_16x16x32_bf16 v[44:47], a[12:15], v[124:127], v[44:47]
    ds_read_b64_tr_b16 a[164:165], v3 offset:4096
    s_waitcnt lgkmcnt(4)
    v_mfma_f32_16x16x32_bf16 v[48:51], a[16:19], v[64:67], v[56:59]
    ds_read_b128 a[12:15], v7 offset:18688
    v_mfma_f32_16x16x32_bf16 v[52:55], a[16:19], v[68:71], v[60:63]
    ds_read_b64_tr_b16 a[166:167], v3 offset:6144
    v_mfma_f32_16x16x32_bf16 v[48:51], a[0:3], v[72:75], v[48:51]
    ds_read_b128 a[16:19], v8 offset:18688
    v_mfma_f32_16x16x32_bf16 v[52:55], a[0:3], v[76:79], v[52:55]
    ds_read_b64_tr_b16 a[168:169], v3 offset:8192
    s_waitcnt lgkmcnt(5)
    v_mfma_f32_16x16x32_bf16 v[48:51], a[4:7], v[80:83], v[48:51]
    ds_read_b128 a[0:3], v9 offset:18688
    v_mfma_f32_16x16x32_bf16 v[52:55], a[4:7], v[84:87], v[52:55]
    ds_read_b64_tr_b16 a[170:171], v3 offset:10240
    v_mfma_f32_16x16x32_bf16 v[48:51], a[8:11], v[88:91], v[48:51]
    ds_read_b128 a[4:7], v10 offset:18688
    v_max3_f32 v0, v40, v41, v42
    v_mfma_f32_16x16x32_bf16 v[52:55], a[8:11], v[92:95], v[52:55]
    ds_read_b64_tr_b16 a[172:173], v3 offset:12288
    s_waitcnt lgkmcnt(5)
    v_mfma_f32_16x16x32_bf16 v[48:51], a[12:15], v[96:99], v[48:51]
    s_barrier
    ds_read_b64_tr_b16 a[8:9], v11 offset:16384
    v_mfma_f32_16x16x32_bf16 v[52:55], a[12:15], v[100:103], v[52:55]
    ds_read_b64_tr_b16 a[10:11], v11 offset:18432
    buffer_load_dwordx4 v22, s[12:15], s30 offen offset:3072 nt lds
    v_mfma_f32_16x16x32_bf16 v[48:51], a[16:19], v[104:107], v[48:51]
    ds_read_b64_tr_b16 a[12:13], v12 offset:16384
    v_max3_f32 v1, v43, v44, v45
    v_mfma_f32_16x16x32_bf16 v[52:55], a[16:19], v[108:111], v[52:55]
    ds_read_b64_tr_b16 a[14:15], v12 offset:18432
    s_waitcnt lgkmcnt(5)
    v_mfma_f32_16x16x32_bf16 v[48:51], a[0:3], v[112:115], v[48:51]
    s_add_u32 m0, s29, 0
    s_mov_b32 s30, 360448
    ds_read_b64_tr_b16 a[174:175], v3 offset:14336
    v_mfma_f32_16x16x32_bf16 v[52:55], a[0:3], v[116:119], v[52:55]
    buffer_load_dwordx4 v19, s[8:11], s30 offen offset:0 nt lds
    v_max3_f32 v0, v0, v46, v47
    v_mfma_f32_16x16x32_bf16 v[48:51], a[4:7], v[120:123], v[48:51]
    ds_read_b64_tr_b16 a[16:17], v13 offset:16384
    v_mfma_f32_16x16x32_bf16 v[52:55], a[4:7], v[124:127], v[52:55]
    ds_read_b64_tr_b16 a[18:19], v13 offset:18432
    s_waitcnt lgkmcnt(3)
    v_mfma_f32_16x16x32_bf16 v[128:131], a[8:11], v[24:27], v[128:131]
    ds_read_b64_tr_b16 a[0:1], v14 offset:16384
    buffer_load_dwordx4 v20, s[8:11], s30 offen offset:1024 nt lds
    v_mfma_f32_16x16x32_bf16 v[132:135], a[8:11], v[28:31], v[132:135]
    ds_read_b64_tr_b16 a[2:3], v14 offset:18432
    v_mfma_f32_16x16x32_bf16 v[136:139], a[12:15], v[24:27], v[136:139]
    ds_read_b64_tr_b16 a[4:5], v15 offset:16384
    v_mfma_f32_16x16x32_bf16 v[140:143], a[12:15], v[28:31], v[140:143]
    ds_read_b64_tr_b16 a[6:7], v15 offset:18432
    v_max3_f32 v1, v1, v48, v49
    v_max3_f32 v0, v0, v50, v51
    v_max3_f32 v1, v1, v52, v53
    v_mfma_f32_16x16x32_bf16 a[20:23], a[28:31], v[24:27], a[20:23]
    ds_read_b64_tr_b16 a[8:9], v16 offset:16384
    buffer_load_dwordx4 v19, s[8:11], s30 offen offset:2048 nt lds
    v_max3_f32 v0, v0, v54, v55
    v_max_f32 v0, v0, v1
    v_mfma_f32_16x16x32_bf16 a[24:27], a[28:31], v[28:31], a[24:27]
    ds_read_b64_tr_b16 a[10:11], v16 offset:18432
    v_cmp_lt_f32 vcc, s31, v0
    s_cbranch_vccnz L_up_18
L_upb_18:
    s_waitcnt lgkmcnt(4)
    v_mfma_f32_16x16x32_bf16 v[144:147], a[16:19], v[24:27], v[144:147]
    ds_read_b64_tr_b16 a[12:13], v17 offset:16384
    v_exp_f32 v40, v40
    v_mfma_f32_16x16x32_bf16 v[148:151], a[16:19], v[28:31], v[148:151]
    ds_read_b64_tr_b16 a[14:15], v17 offset:18432
    v_exp_f32 v41, v41
    v_mfma_f32_16x16x32_bf16 v[152:155], a[0:3], v[24:27], v[152:155]
    ds_read_b64_tr_b16 a[16:17], v18 offset:16384
    s_add_u32 m0, s29, 147456
    v_exp_f32 v42, v42
    v_mfma_f32_16x16x32_bf16 v[156:159], a[0:3], v[28:31], v[156:159]
    ds_read_b64_tr_b16 a[18:19], v18 offset:18432
    v_exp_f32 v43, v43
    s_waitcnt lgkmcnt(4)
    v_mfma_f32_16x16x32_bf16 v[160:163], a[4:7], v[24:27], v[160:163]
    ds_read_b64_tr_b16 a[0:1], v11 offset:16640
    s_add_u32 s30, s80, 114688
    v_cvt_pk_bf16_f32 v32, v40, v41
    v_mfma_f32_16x16x32_bf16 v[164:167], a[4:7], v[28:31], v[164:167]
    ds_read_b64_tr_b16 a[2:3], v11 offset:18688
    buffer_load_dwordx4 v23, s[20:23], s30 offen offset:0  lds
    v_exp_f32 v44, v44
    v_mfma_f32_16x16x32_bf16 v[168:171], a[8:11], v[24:27], v[168:171]
    ds_read_b64_tr_b16 a[4:5], v12 offset:16640
    s_add_u32 s30, s80, 120832
    v_exp_f32 v45, v45
    v_mfma_f32_16x16x32_bf16 v[172:175], a[8:11], v[28:31], v[172:175]
    ds_read_b64_tr_b16 a[6:7], v12 offset:18688
    v_cvt_pk_bf16_f32 v33, v42, v43
    s_waitcnt lgkmcnt(4)
    v_mfma_f32_16x16x32_bf16 v[176:179], a[12:15], v[24:27], v[176:179]
    ds_read_b64_tr_b16 a[8:9], v13 offset:16640
    buffer_load_dwordx4 v23, s[20:23], s30 offen offset:1024  lds
    v_exp_f32 v46, v46
    v_mfma_f32_16x16x32_bf16 v[180:183], a[12:15], v[28:31], v[180:183]
    ds_read_b64_tr_b16 a[10:11], v13 offset:18688
    v_exp_f32 v47, v47
    v_cvt_pk_bf16_f32 v36, v44, v45
    v_mfma_f32_16x16x32_bf16 v[184:187], a[16:19], v[24:27], v[184:187]
    ds_read_b64_tr_b16 a[12:13], v14 offset:16640
    s_add_u32 s30, s80, 126976
    s_nop 0
    v_cvt_pk_bf16_f32 v37, v46, v47
    v_mfma_f32_16x16x32_bf16 v[188:191], a[16:19], v[28:31], v[188:191]
    ds_read_b64_tr_b16 a[14:15], v14 offset:18688
    s_waitcnt lgkmcnt(4)
    v_mfma_f32_16x16x32_bf16 v[192:195], a[0:3], v[24:27], v[192:195]
    ds_read_b64_tr_b16 a[16:17], v15 offset:16640
    buffer_load_dwordx4 v23, s[20:23], s30 offen offset:2048  lds
    v_mfma_f32_16x16x32_bf16 v[196:199], a[0:3], v[28:31], v[196:199]
    ds_read_b64_tr_b16 a[18:19], v15 offset:18688
    v_mfma_f32_16x16x32_bf16 v[200:203], a[4:7], v[24:27], v[200:203]
    ds_read_b64_tr_b16 a[0:1], v16 offset:16640
    s_add_u32 s30, s80, 133120
    v_mfma_f32_16x16x32_bf16 v[204:207], a[4:7], v[28:31], v[204:207]
    ds_read_b64_tr_b16 a[2:3], v16 offset:18688
    s_waitcnt lgkmcnt(4)
    v_mfma_f32_16x16x32_bf16 v[208:211], a[8:11], v[24:27], v[208:211]
    ds_read_b64_tr_b16 a[4:5], v17 offset:16640
    buffer_load_dwordx4 v23, s[20:23], s30 offen offset:3072  lds
    v_mfma_f32_16x16x32_bf16 v[212:215], a[8:11], v[28:31], v[212:215]
    ds_read_b64_tr_b16 a[6:7], v17 offset:18688
    v_mfma_f32_16x16x32_bf16 v[216:219], a[12:15], v[24:27], v[216:219]
    ds_read_b64_tr_b16 a[8:9], v18 offset:16640
    v_mfma_f32_16x16x32_bf16 v[220:223], a[12:15], v[28:31], v[220:223]
    ds_read_b64_tr_b16 a[10:11], v18 offset:18688
    s_waitcnt lgkmcnt(4)
    v_mfma_f32_16x16x32_bf16 v[224:227], a[16:19], v[24:27], v[224:227]
    s_barrier
    ds_read_b128 a[12:15], v7 offset:49152
    v_mfma_f32_16x16x32_bf16 v[228:231], a[16:19], v[28:31], v[228:231]
    s_add_u32 m0, s29, 0
    s_mov_b32 s30, 360448
    v_mfma_f32_16x16x32_bf16 v[232:235], a[0:3], v[24:27], v[232:235]
    ds_read_b128 a[16:19], v8 offset:49152
    buffer_load_dwordx4 v20, s[8:11], s30 offen offset:3072 nt lds
    v_mfma_f32_16x16x32_bf16 v[236:239], a[0:3], v[28:31], v[236:239]
    s_waitcnt lgkmcnt(2)
    v_mfma_f32_16x16x32_bf16 v[240:243], a[4:7], v[24:27], v[240:243]
    ds_read_b128 a[0:3], v9 offset:49152
    v_mfma_f32_16x16x32_bf16 v[244:247], a[4:7], v[28:31], v[244:247]
    v_mfma_f32_16x16x32_bf16 v[248:251], a[8:11], v[24:27], v[248:251]
    ds_read_b128 a[4:7], v10 offset:49152
    v_mfma_f32_16x16x32_bf16 v[252:255], a[8:11], v[28:31], v[252:255]
    s_cbranch_vccnz L_rs_18
L_rsb_18:
    s_waitcnt lgkmcnt(2)
    v_mfma_f32_16x16x32_bf16 v[40:43], a[12:15], v[64:67], v[56:59]
    ds_read_b128 a[8:11], v7 offset:49408
    v_exp_f32 v48, v48
    v_mfma_f32_16x16x32_bf16 v[44:47], a[12:15], v[68:71], v[60:63]
    v_exp_f32 v49, v49
    v_mfma_f32_16x16x32_bf16 v[40:43], a[16:19], v[72:75], v[40:43]
    ds_read_b128 a[12:15], v8 offset:49408
    s_add_u32 m0, s29, 65536
    v_mfma_f32_16x16x32_bf16 v[44:47], a[16:19], v[76:79], v[44:47]
    s_mov_b32 s30, 344064
    s_waitcnt lgkmcnt(2)
    v_mfma_f32_16x16x32_bf16 v[40:43], a[0:3], v[80:83], v[40:43]
    ds_read_b128 a[16:19], v9 offset:49408
    buffer_load_dwordx4 v21, s[12:15], s30 offen offset:0 nt lds
    v_mfma_f32_16x16x32_bf16 v[44:47], a[0:3], v[84:87], v[44:47]
    v_exp_f32 v50, v50
    v_mfma_f32_16x16x32_bf16 v[40:43], a[4:7], v[88:91], v[40:43]
    ds_read_b128 a[0:3], v10 offset:49408
    v_exp_f32 v51, v51
    v_mfma_f32_16x16x32_bf16 v[44:47], a[4:7], v[92:95], v[44:47]
    v_cvt_pk_bf16_f32 v34, v48, v49
    s_waitcnt lgkmcnt(2)
    v_mfma_f32_16x16x32_bf16 v[40:43], a[8:11], v[96:99], v[40:43]
    ds_read_b128 a[4:7], v7 offset:51200
    v_exp_f32 v52, v52
    v_mfma_f32_16x16x32_bf16 v[44:47], a[8:11], v[100:103], v[44:47]
    v_exp_f32 v53, v53
    v_cvt_pk_bf16_f32 v35, v50, v51
    v_mfma_f32_16x16x32_bf16 v[40:43], a[12:15], v[104:107], v[40:43]
    ds_read_b128 a[8:11], v8 offset:51200
    v_exp_f32 v54, v54
    v_mfma_f32_16x16x32_bf16 v[44:47], a[12:15], v[108:111], v[44:47]
    v_exp_f32 v55, v55
    s_waitcnt lgkmcnt(2)
    v_mfma_f32_16x16x32_bf16 v[40:43], a[16:19], v[112:115], v[40:43]
    ds_read_b128 a[12:15], v9 offset:51200
    buffer_load_dwordx4 v22, s[12:15], s30 offen offset:1024 nt lds
    v_cvt_pk_bf16_f32 v38, v52, v53
    v_mfma_f32_16x16x32_bf16 v[44:47], a[16:19], v[116:119], v[44:47]
    s_nop 0
    v_cvt_pk_bf16_f32 v39, v54, v55
    v_mfma_f32_16x16x32_bf16 v[40:43], a[0:3], v[120:123], v[40:43]
    ds_read_b128 a[16:19], v10 offset:51200
    v_mfma_f32_16x16x32_bf16 v[44:47], a[0:3], v[124:127], v[44:47]
    s_waitcnt lgkmcnt(2)
    v_mfma_f32_16x16x32_bf16 v[48:51], a[4:7], v[64:67], v[56:59]
    ds_read_b128 a[0:3], v7 offset:51456
    v_mfma_f32_16x16x32_bf16 v[52:55], a[4:7], v[68:71], v[60:63]
    v_mfma_f32_16x16x32_bf16 v[48:51], a[8:11], v[72:75], v[48:51]
    ds_read_b128 a[4:7], v8 offset:51456
    v_mfma_f32_16x16x32_bf16 v[52:55], a[8:11], v[76:79], v[52:55]
    s_waitcnt lgkmcnt(2)
    v_mfma_f32_16x16x32_bf16 v[48:51], a[12:15], v[80:83], v[48:51]
    ds_read_b128 a[8:11], v9 offset:51456
    v_mfma_f32_16x16x32_bf16 v[52:55], a[12:15], v[84:87], v[52:55]
    v_mfma_f32_16x16x32_bf16 v[48:51], a[16:19], v[88:91], v[48:51]
    ds_read_b128 a[12:15], v10 offset:51456
    v_max3_f32 v0, v40, v41, v42
    v_mfma_f32_16x16x32_bf16 v[52:55], a[16:19], v[92:95], v[52:55]
    v_max3_f32 v1, v43, v44, v45
    s_waitcnt lgkmcnt(2)
    v_mfma_f32_16x16x32_bf16 v[48:51], a[0:3], v[96:99], v[48:51]
    s_waitcnt vmcnt(18)
    s_barrier
    ds_read_b64_tr_b16 a[16:17], v11 offset:32768
    v_mfma_f32_16x16x32_bf16 v[52:55], a[0:3], v[100:103], v[52:55]
    ds_read_b64_tr_b16 a[18:19], v11 offset:34816
    buffer_load_dwordx4 v21, s[12:15], s30 offen offset:2048 nt lds
    v_mfma_f32_16x16x32_bf16 v[48:51], a[4:7], v[104:107], v[48:51]
    ds_read_b64_tr_b16 a[0:1], v12 offset:32768
    v_max3_f32 v0, v0, v46, v47
    v_mfma_f32_16x16x32_bf16 v[52:55], a[4:7], v[108:111], v[52:55]
    ds_read_b64_tr_b16 a[2:3], v12 offset:34816
    s_waitcnt lgkmcnt(4)
    v_mfma_f32_16x16x32_bf16 v[48:51], a[8:11], v[112:115], v[48:51]
    v_mfma_f32_16x16x32_bf16 v[52:55], a[8:11], v[116:119], v[52:55]
    v_mfma_f32_16x16x32_bf16 v[48:51], a[12:15], v[120:123], v[48:51]
    ds_read_b64_tr_b16 a[4:5], v13 offset:32768
    v_mfma_f32_16x16x32_bf16 v[52:55], a[12:15], v[124:127], v[52:55]
    ds_read_b64_tr_b16 a[6:7], v13 offset:34816
    s_waitcnt lgkmcnt(2)
    v_mfma_f32_16x16x32_bf16 v[128:131], a[16:19], v[32:35], v[128:131]
    ds_read_b64_tr_b16 a[8:9], v14 offset:32768
    buffer_load_dwordx4 v22, s[12:15], s30 offen offset:3072 nt lds
    v_mfma_f32_16x16x32_bf16 v[132:135], a[16:19], v[36:39], v[132:135]
    ds_read_b64_tr_b16 a[10:11], v14 offset:34816
    v_mfma_f32_16x16x32_bf16 v[136:139], a[0:3], v[32:35], v[136:139]
    ds_read_b64_tr_b16 a[12:13], v15 offset:32768
    v_mfma_f32_16x16x32_bf16 v[140:143], a[0:3], v[36:39], v[140:143]
    ds_read_b64_tr_b16 a[14:15], v15 offset:34816
    v_max3_f32 v1, v1, v48, v49
    v_max3_f32 v0, v0, v50, v51
    v_mfma_f32_16x16x32_bf16 a[20:23], a[28:31], v[32:35], a[20:23]
    ds_read_b64_tr_b16 a[16:17], v16 offset:32768
    v_max3_f32 v1, v1, v52, v53
    v_max3_f32 v0, v0, v54, v55
    v_mfma_f32_16x16x32_bf16 a[24:27], a[28:31], v[36:39], a[24:27]
    ds_read_b64_tr_b16 a[18:19], v16 offset:34816
    v_max_f32 v0, v0, v1
    s_waitcnt lgkmcnt(4)
    v_mfma_f32_16x16x32_bf16 v[144:147], a[4:7], v[32:35], v[144:147]
    ds_read_b64_tr_b16 a[0:1], v17 offset:32768
    v_cmp_lt_f32 vcc, s31, v0
    s_cbranch_vccnz L_up_19
L_upb_19:
    v_mfma_f32_16x16x32_bf16 v[148:151], a[4:7], v[36:39], v[148:151]
    ds_read_b64_tr_b16 a[2:3], v17 offset:34816
    v_exp_f32 v40, v40
    v_mfma_f32_16x16x32_bf16 v[152:155], a[8:11], v[32:35], v[152:155]
    ds_read_b64_tr_b16 a[4:5], v18 offset:32768
    s_add_u32 m0, s29, 16384
    v_mfma_f32_16x16x32_bf16 v[156:159], a[8:11], v[36:39], v[156:159]
    ds_read_b64_tr_b16 a[6:7], v18 offset:34816
    s_waitcnt lgkmcnt(4)
    v_mfma_f32_16x16x32_bf16 v[160:163], a[12:15], v[32:35], v[160:163]
    ds_read_b64_tr_b16 a[8:9], v11 offset:33024
    s_mov_b32 s30, 376832
    v_mfma_f32_16x16x32_bf16 v[164:167], a[12:15], v[36:39], v[164:167]
    ds_read_b64_tr_b16 a[10:11], v11 offset:35072
    buffer_load_dwordx4 v19, s[8:11], s30 offen offset:0 nt lds
    v_mfma_f32_16x16x32_bf16 v[168:171], a[16:19], v[32:35], v[168:171]
    ds_read_b64_tr_b16 a[12:13], v12 offset:33024
    v_exp_f32 v41, v41
    v_mfma_f32_16x16x32_bf16 v[172:175], a[16:19], v[36:39], v[172:175]
    ds_read_b64_tr_b16 a[14:15], v12 offset:35072
    s_waitcnt lgkmcnt(4)
    v_mfma_f32_16x16x32_bf16 v[176:179], a[0:3], v[32:35], v[176:179]
    ds_read_b64_tr_b16 a[16:17], v13 offset:33024
    v_exp_f32 v42, v42
    v_mfma_f32_16x16x32_bf16 v[180:183], a[0:3], v[36:39], v[180:183]
    ds_read_b64_tr_b16 a[18:19], v13 offset:35072
    v_exp_f32 v43, v43
    v_mfma_f32_16x16x32_bf16 v[184:187], a[4:7], v[32:35], v[184:187]
    ds_read_b64_tr_b16 a[0:1], v14 offset:33024
    buffer_load_dwordx4 v20, s[8:11], s30 offen offset:1024 nt lds
    v_cvt_pk_bf16_f32 v24, v40, v41
    v_mfma_f32_16x16x32_bf16 v[188:191], a[4:7], v[36:39], v[188:191]
    ds_read_b64_tr_b16 a[2:3], v14 offset:35072
    s_waitcnt lgkmcnt(4)
    v_mfma_f32_16x16x32_bf16 v[192:195], a[8:11], v[32:35], v[192:195]
    ds_read_b64_tr_b16 a[4:5], v15 offset:33024
    v_exp_f32 v44, v44
    v_mfma_f32_16x16x32_bf16 v[196:199], a[8:11], v[36:39], v[196:199]
    ds_read_b64_tr_b16 a[6:7], v15 offset:35072
    v_exp_f32 v45, v45
    v_mfma_f32_16x16x32_bf16 v[200:203], a[12:15], v[32:35], v[200:203]
    ds_read_b64_tr_b16 a[8:9], v16 offset:33024
    v_cvt_pk_bf16_f32 v25, v42, v43
    v_mfma_f32_16x16x32_bf16 v[204:207], a[12:15], v[36:39], v[204:207]
    ds_read_b64_tr_b16 a[10:11], v16 offset:35072
    s_waitcnt lgkmcnt(4)
    v_mfma_f32_16x16x32_bf16 v[208:211], a[16:19], v[32:35], v[208:211]
    ds_read_b64_tr_b16 a[12:13], v17 offset:33024
    v_exp_f32 v46, v46
    v_mfma_f32_16x16x32_bf16 v[212:215], a[16:19], v[36:39], v[212:215]
    ds_read_b64_tr_b16 a[14:15], v17 offset:35072
    v_exp_f32 v47, v47
    v_mfma_f32_16x16x32_bf16 v[216:219], a[0:3], v[32:35], v[216:219]
    ds_read_b64_tr_b16 a[16:17], v18 offset:33024
    v_cvt_pk_bf16_f32 v28, v44, v45
    s_nop 0
    v_mfma_f32_16x16x32_bf16 v[220:223], a[0:3], v[36:39], v[220:223]
    ds_read_b64_tr_b16 a[18:19], v18 offset:35072
    v_cvt_pk_bf16_f32 v29, v46, v47
    s_waitcnt lgkmcnt(4)
    v_mfma_f32_16x16x32_bf16 v[224:227], a[4:7], v[32:35], v[224:227]
    s_waitcnt vmcnt(7)
    s_barrier
    ds_read_b128 a[0:3], v7 offset:32768
    v_mfma_f32_16x16x32_bf16 v[228:231], a[4:7], v[36:39], v[228:231]
    buffer_load_dwordx4 v19, s[8:11], s30 offen offset:2048 nt lds
    v_mfma_f32_16x16x32_bf16 v[232:235], a[8:11], v[32:35], v[232:235]
    ds_read_b128 a[4:7], v8 offset:32768
    v_mfma_f32_16x16x32_bf16 v[236:239], a[8:11], v[36:39], v[236:239]
    s_waitcnt lgkmcnt(2)
    v_mfma_f32_16x16x32_bf16 v[240:243], a[12:15], v[32:35], v[240:243]
    ds_read_b128 a[8:11], v9 offset:32768
    v_mfma_f32_16x16x32_bf16 v[244:247], a[12:15], v[36:39], v[244:247]
    v_mfma_f32_16x16x32_bf16 v[248:251], a[16:19], v[32:35], v[248:251]
    ds_read_b128 a[12:15], v10 offset:32768
    v_mfma_f32_16x16x32_bf16 v[252:255], a[16:19], v[36:39], v[252:255]
    buffer_load_dwordx4 v20, s[8:11], s30 offen offset:3072 nt lds
    s_cbranch_vccnz L_rs_19
L_rsb_19:
    s_waitcnt lgkmcnt(2)
    v_mfma_f32_16x16x32_bf16 v[40:43], a[0:3], v[64:67], v[56:59]
    ds_read_b128 a[16:19], v7 offset:33024
    v_exp_f32 v48, v48
    v_mfma_f32_16x16x32_bf16 v[44:47], a[0:3], v[68:71], v[60:63]
    v_exp_f32 v49, v49
    v_mfma_f32_16x16x32_bf16 v[40:43], a[4:7], v[72:75], v[40:43]
    ds_read_b128 a[0:3], v8 offset:33024
    v_exp_f32 v50, v50
    v_mfma_f32_16x16x32_bf16 v[44:47], a[4:7], v[76:79], v[44:47]
    v_exp_f32 v51, v51
    s_waitcnt lgkmcnt(2)
    v_mfma_f32_16x16x32_bf16 v[40:43], a[8:11], v[80:83], v[40:43]
    ds_read_b128 a[4:7], v9 offset:33024
    v_cvt_pk_bf16_f32 v26, v48, v49
    v_mfma_f32_16x16x32_bf16 v[44:47], a[8:11], v[84:87], v[44:47]
    v_exp_f32 v52, v52
    v_mfma_f32_16x16x32_bf16 v[40:43], a[12:15], v[88:91], v[40:43]
    ds_read_b128 a[8:11], v10 offset:33024
    s_add_u32 m0, s29, 81920
    v_add_u32 v3, 147456, v2
    v_mfma_f32_16x16x32_bf16 v[44:47], a[12:15], v[92:95], v[44:47]
    s_mov_b32 s30, 360448
    ds_read_b64_tr_b16 a[176:177], v3 offset:0
    s_waitcnt lgkmcnt(3)
    v_mfma_f32_16x16x32_bf16 v[40:43], a[16:19], v[96:99], v[40:43]
    ds_read_b128 a[12:15], v7 offset:34816
    buffer_load_dwordx4 v21, s[12:15], s30 offen offset:0 nt lds
    v_mfma_f32_16x16x32_bf16 v[44:47], a[16:19], v[100:103], v[44:47]
    v_exp_f32 v53, v53
    v_cvt_pk_bf16_f32 v27, v50, v51
    v_mfma_f32_16x16x32_bf16 v[40:43], a[0:3], v[104:107], v[40:43]
    ds_read_b128 a[16:19], v8 offset:34816
    v_exp_f32 v54, v54
    v_mfma_f32_16x16x32_bf16 v[44:47], a[0:3], v[108:111], v[44:47]
    v_exp_f32 v55, v55
    s_waitcnt lgkmcnt(3)
    v_mfma_f32_16x16x32_bf16 v[40:43], a[4:7], v[112:115], v[40:43]
    ds_read_b128 a[0:3], v9 offset:34816
    v_cvt_pk_bf16_f32 v30, v52, v53
    s_nop 0
    v_mfma_f32_16x16x32_bf16 v[44:47], a[4:7], v[116:119], v[44:47]
    buffer_load_dwordx4 v22, s[12:15], s30 offen offset:1024 nt lds
    v_cvt_pk_bf16_f32 v31, v54, v55
    ds_read_b64_tr_b16 a[178:179], v3 offset:2048
    v_mfma_f32_16x16x32_bf16 v[40:43], a[8:11], v[120:123], v[40:43]
    ds_read_b128 a[4:7], v10 offset:34816
    v_mfma_f32_16x16x32_bf16 v[44:47], a[8:11], v[124:127], v[44:47]
    ds_read_b64_tr_b16 a[180:181], v3 offset:4096
    s_waitcnt lgkmcnt(4)
    v_mfma_f32_16x16x32_bf16 v[48:51], a[12:15], v[64:67], v[56:59]
    ds_read_b128 a[8:11], v7 offset:35072
    v_mfma_f32_16x16x32_bf16 v[52:55], a[12:15], v[68:71], v[60:63]
    ds_read_b64_tr_b16 a[182:183], v3 offset:6144
    v_mfma_f32_16x16x32_bf16 v[48:51], a[16:19], v[72:75], v[48:51]
    ds_read_b128 a[12:15], v8 offset:35072
    v_mfma_f32_16x16x32_bf16 v[52:55], a[16:19], v[76:79], v[52:55]
    ds_read_b64_tr_b16 a[184:185], v3 offset:8192
    s_waitcnt lgkmcnt(5)
    v_mfma_f32_16x16x32_bf16 v[48:51], a[0:3], v[80:83], v[48:51]
    ds_read_b128 a[16:19], v9 offset:35072
    v_mfma_f32_16x16x32_bf16 v[52:55], a[0:3], v[84:87], v[52:55]
    ds_read_b64_tr_b16 a[186:187], v3 offset:10240
    v_mfma_f32_16x16x32_bf16 v[48:51], a[4:7], v[88:91], v[48:51]
    ds_read_b128 a[0:3], v10 offset:35072
    v_max3_f32 v0, v40, v41, v42
    v_mfma_f32_16x16x32_bf16 v[52:55], a[4:7], v[92:95], v[52:55]
    ds_read_b64_tr_b16 a[188:189], v3 offset:12288
    s_waitcnt lgkmcnt(5)
    v_mfma_f32_16x16x32_bf16 v[48:51], a[8:11], v[96:99], v[48:51]
    s_barrier
    ds_read_b64_tr_b16 a[4:5], v11 offset:49152
    v_mfma_f32_16x16x32_bf16 v[52:55], a[8:11], v[100:103], v[52:55]
    ds_read_b64_tr_b16 a[6:7], v11 offset:51200
    buffer_load_dwordx4 v21, s[12:15], s30 offen offset:2048 nt lds
    v_mfma_f32_16x16x32_bf16 v[48:51], a[12:15], v[104:107], v[48:51]
    ds_read_b64_tr_b16 a[8:9], v12 offset:49152
    v_max3_f32 v1, v43, v44, v45
    v_mfma_f32_16x16x32_bf16 v[52:55], a[12:15], v[108:111], v[52:55]
    ds_read_b64_tr_b16 a[10:11], v12 offset:51200
    s_waitcnt lgkmcnt(5)
    v_mfma_f32_16x16x32_bf16 v[48:51], a[16:19], v[112:115], v[48:51]
    buffer_load_dwordx4 v22, s[12:15], s30 offen offset:3072 nt lds
    ds_read_b64_tr_b16 a[190:191], v3 offset:14336
    v_mfma_f32_16x16x32_bf16 v[52:55], a[16:19], v[116:119], v[52:55]
    v_max3_f32 v0, v0, v46, v47
    v_mfma_f32_16x16x32_bf16 v[48:51], a[0:3], v[120:123], v[48:51]
    ds_read_b64_tr_b16 a[12:13], v13 offset:49152
    v_mfma_f32_16x16x32_bf16 v[52:55], a[0:3], v[124:127], v[52:55]
    ds_read_b64_tr_b16 a[14:15], v13 offset:51200
    s_waitcnt lgkmcnt(3)
    v_mfma_f32_16x16x32_bf16 v[128:131], a[4:7], v[24:27], v[128:131]
    ds_read_b64_tr_b16 a[16:17], v14 offset:49152
    s_add_u32 m0, s29, 49152
    v_mfma_f32_16x16x32_bf16 v[132:135], a[4:7], v[28:31], v[132:135]
    ds_read_b64_tr_b16 a[18:19], v14 offset:51200
    s_mov_b32 s30, 393216
    v_mfma_f32_16x16x32_bf16 v[136:139], a[8:11], v[24:27], v[136:139]
    ds_read_b64_tr_b16 a[0:1], v15 offset:49152
    buffer_load_dwordx4 v19, s[8:11], s30 offen offset:0 nt lds
    v_mfma_f32_16x16x32_bf16 v[140:143], a[8:11], v[28:31], v[140:143]
    ds_read_b64_tr_b16 a[2:3], v15 offset:51200
    v_max3_f32 v1, v1, v48, v49
    v_max3_f32 v0, v0, v50, v51
    v_mfma_f32_16x16x32_bf16 a[20:23], a[28:31], v[24:27], a[20:23]
    ds_read_b64_tr_b16 a[4:5], v16 offset:49152
    s_add_u32 m0, s29, 131072
    v_max3_f32 v1, v1, v52, v53
    v_mfma_f32_16x16x32_bf16 a[24:27], a[28:31], v[28:31], a[24:27]
    ds_read_b64_tr_b16 a[6:7], v16 offset:51200
    v_max3_f32 v0, v0, v54, v55
    s_waitcnt lgkmcnt(4)
    v_mfma_f32_16x16x32_bf16 v[144:147], a[12:15], v[24:27], v[144:147]
    ds_read_b64_tr_b16 a[8:9], v17 offset:49152
    s_add_u32 s30, s81, 0
    v_max_f32 v0, v0, v1
    v_mfma_f32_16x16x32_bf16 v[148:151], a[12:15], v[28:31], v[148:151]
    ds_read_b64_tr_b16 a[10:11], v17 offset:51200
    buffer_load_dwordx4 v23, s[20:23], s30 offen offset:0  lds
    v_cmp_lt_f32 vcc, s31, v0
    v_mfma_f32_16x16x32_bf16 v[152:155], a[16:19], v[24:27], v[152:155]
    ds_read_b64_tr_b16 a[12:13], v18 offset:49152
    s_add_u32 s30, s81, 6144
    s_cbranch_vccnz L_up_20
L_upb_20:
    v_mfma_f32_16x16x32_bf16 v[156:159], a[16:19], v[28:31], v[156:159]
    ds_read_b64_tr_b16 a[14:15], v18 offset:51200
    s_waitcnt lgkmcnt(4)
    v_mfma_f32_16x16x32_bf16 v[160:163], a[0:3], v[24:27], v[160:163]
    ds_read_b64_tr_b16 a[16:17], v11 offset:49408
    buffer_load_dwordx4 v23, s[20:23], s30 offen offset:1024  lds
    v_mfma_f32_16x16x32_bf16 v[164:167], a[0:3], v[28:31], v[164:167]
    ds_read_b64_tr_b16 a[18:19], v11 offset:51456
    v_exp_f32 v40, v40
    v_mfma_f32_16x16x32_bf16 v[168:171], a[4:7], v[24:27], v[168:171]
    ds_read_b64_tr_b16 a[0:1], v12 offset:49408
    s_add_u32 s30, s81, 12288
    v_mfma_f32_16x16x32_bf16 v[172:175], a[4:7], v[28:31], v[172:175]
    ds_read_b64_tr_b16 a[2:3], v12 offset:51456
    s_waitcnt lgkmcnt(4)
    v_mfma_f32_16x16x32_bf16 v[176:179], a[8:11], v[24:27], v[176:179]
    ds_read_b64_tr_b16 a[4:5], v13 offset:49408
    buffer_load_dwordx4 v23, s[20:23], s30 offen offset:2048  lds
    v_mfma_f32_16x16x32_bf16 v[180:183], a[8:11], v[28:31], v[180:183]
    ds_read_b64_tr_b16 a[6:7], v13 offset:51456
    v_exp_f32 v41, v41
    v_mfma_f32_16x16x32_bf16 v[184:187], a[12:15], v[24:27], v[184:187]
    ds_read_b64_tr_b16 a[8:9], v14 offset:49408
    s_add_u32 s30, s81, 18432
    v_mfma_f32_16x16x32_bf16 v[188:191], a[12:15], v[28:31], v[188:191]
    ds_read_b64_tr_b16 a[10:11], v14 offset:51456
    s_waitcnt lgkmcnt(4)
    v_mfma_f32_16x16x32_bf16 v[192:195], a[16:19], v[24:27], v[192:195]
    ds_read_b64_tr_b16 a[12:13], v15 offset:49408
    buffer_load_dwordx4 v23, s[20:23], s30 offen offset:3072  lds
    v_mfma_f32_16x16x32_bf16 v[196:199], a[16:19], v[28:31], v[196:199]
    ds_read_b64_tr_b16 a[14:15], v15 offset:51456
    v_exp_f32 v42, v42
    v_mfma_f32_16x16x32_bf16 v[200:203], a[0:3], v[24:27], v[200:203]
    ds_read_b64_tr_b16 a[16:17], v16 offset:49408
    v_exp_f32 v43, v43
    v_mfma_f32_16x16x32_bf16 v[204:207], a[0:3], v[28:31], v[204:207]
    ds_read_b64_tr_b16 a[18:19], v16 offset:51456
    v_cvt_pk_bf16_f32 v32, v40, v41
    s_waitcnt lgkmcnt(4)
    v_mfma_f32_16x16x32_bf16 v[208:211], a[4:7], v[24:27], v[208:211]
    ds_read_b64_tr_b16 a[0:1], v17 offset:49408
    v_exp_f32 v44, v44
    v_mfma_f32_16x16x32_bf16 v[212:215], a[4:7], v[28:31], v[212:215]
    ds_read_b64_tr_b16 a[2:3], v17 offset:51456
    v_exp_f32 v45, v45
    v_mfma_f32_16x16x32_bf16 v[216:219], a[8:11], v[24:27], v[216:219]
    ds_read_b64_tr_b16 a[4:5], v18 offset:49408
    v_cvt_pk_bf16_f32 v33, v42, v43
    v_mfma_f32_16x16x32_bf16 v[220:223], a[8:11], v[28:31], v[220:223]
    ds_read_b64_tr_b16 a[6:7], v18 offset:51456
    s_waitcnt lgkmcnt(4)
    v_mfma_f32_16x16x32_bf16 v[224:227], a[12:15], v[24:27], v[224:227]
    s_waitcnt vmcnt(17)
    s_barrier
    ds_read_b128 a[8:11], v7 offset:0
    v_mfma_f32_16x16x32_bf16 v[228:231], a[12:15], v[28:31], v[228:231]
    s_add_u32 m0, s29, 49152
    s_mov_b32 s30, 393216
    v_mfma_f32_16x16x32_bf16 v[232:235], a[16:19], v[24:27], v[232:235]
    ds_read_b128 a[12:15], v8 offset:0
    buffer_load_dwordx4 v20, s[8:11], s30 offen offset:1024 nt lds
    v_mfma_f32_16x16x32_bf16 v[236:239], a[16:19], v[28:31], v[236:239]
    v_exp_f32 v46, v46
    s_waitcnt lgkmcnt(2)
    v_mfma_f32_16x16x32_bf16 v[240:243], a[0:3], v[24:27], v[240:243]
    ds_read_b128 a[16:19], v9 offset:0
    v_exp_f32 v47, v47
    v_mfma_f32_16x16x32_bf16 v[244:247], a[0:3], v[28:31], v[244:247]
    v_cvt_pk_bf16_f32 v36, v44, v45
    s_nop 0
    v_cvt_pk_bf16_f32 v37, v46, v47
    v_mfma_f32_16x16x32_bf16 v[248:251], a[4:7], v[24:27], v[248:251]
    ds_read_b128 a[0:3], v10 offset:0
    v_mfma_f32_16x16x32_bf16 v[252:255], a[4:7], v[28:31], v[252:255]
    buffer_load_dwordx4 v19, s[8:11], s30 offen offset:2048 nt lds
    s_cbranch_vccnz L_rs_20
L_rsb_20:
    s_waitcnt lgkmcnt(2)
    v_mfma_f32_16x16x32_bf16 v[40:43], a[8:11], v[64:67], v[56:59]
    ds_read_b128 a[4:7], v7 offset:256
    v_exp_f32 v48, v48
    v_mfma_f32_16x16x32_bf16 v[44:47], a[8:11], v[68:71], v[60:63]
    v_exp_f32 v49, v49
    v_mfma_f32_16x16x32_bf16 v[40:43], a[12:15], v[72:75], v[40:43]
    ds_read_b128 a[8:11], v8 offset:256
    v_exp_f32 v50, v50
    v_mfma_f32_16x16x32_bf16 v[44:47], a[12:15], v[76:79], v[44:47]
    v_exp_f32 v51, v51
    s_waitcnt lgkmcnt(2)
    v_mfma_f32_16x16x32_bf16 v[40:43], a[16:19], v[80:83], v[40:43]
    ds_read_b128 a[12:15], v9 offset:256
    v_cvt_pk_bf16_f32 v34, v48, v49
    v_mfma_f32_16x16x32_bf16 v[44:47], a[16:19], v[84:87], v[44:47]
    v_exp_f32 v52, v52
    v_mfma_f32_16x16x32_bf16 v[40:43], a[0:3], v[88:91], v[40:43]
    ds_read_b128 a[16:19], v10 offset:256
    buffer_load_dwordx4 v20, s[8:11], s30 offen offset:3072 nt lds
    v_mfma_f32_16x16x32_bf16 v[44:47], a[0:3], v[92:95], v[44:47]
    v_exp_f32 v53, v53
    s_waitcnt lgkmcnt(2)
    v_mfma_f32_16x16x32_bf16 v[40:43], a[4:7], v[96:99], v[40:43]
    ds_read_b128 a[0:3], v7 offset:2048
    v_cvt_pk_bf16_f32 v35, v50, v51
    v_mfma_f32_16x16x32_bf16 v[44:47], a[4:7], v[100:103], v[44:47]
    v_exp_f32 v54, v54
    v_mfma_f32_16x16x32_bf16 v[40:43], a[8:11], v[104:107], v[40:43]
    ds_read_b128 a[4:7], v8 offset:2048
    v_exp_f32 v55, v55
    v_mfma_f32_16x16x32_bf16 v[44:47], a[8:11], v[108:111], v[44:47]
    v_cvt_pk_bf16_f32 v38, v52, v53
    s_nop 0
    s_waitcnt lgkmcnt(2)
    v_mfma_f32_16x16x32_bf16 v[40:43], a[12:15], v[112:115], v[40:43]
    ds_read_b128 a[8:11], v9 offset:2048
    v_cvt_pk_bf16_f32 v39, v54, v55
    v_mfma_f32_16x16x32_bf16 v[44:47], a[12:15], v[116:119], v[44:47]
    s_add_u32 m0, s29, 98304
    s_mov_b32 s30, 376832
    v_mfma_f32_16x16x32_bf16 v[40:43], a[16:19], v[120:123], v[40:43]
    ds_read_b128 a[12:15], v10 offset:2048
    buffer_load_dwordx4 v21, s[12:15], s30 offen offset:0 nt lds
    v_mfma_f32_16x16x32_bf16 v[44:47], a[16:19], v[124:127], v[44:47]
    s_waitcnt lgkmcnt(2)
    v_mfma_f32_16x16x32_bf16 v[48:51], a[0:3], v[64:67], v[56:59]
    ds_read_b128 a[16:19], v7 offset:2304
    v_mfma_f32_16x16x32_bf16 v[52:55], a[0:3], v[68:71], v[60:63]
    s_mov_b64 exec, 0
    s_branch L_pg0
L_pgb0:
    s_mov_b64 exec, -1
    v_mfma_f32_16x16x32_bf16 v[48:51], a[4:7], v[72:75], v[48:51]
    ds_read_b128 a[0:3], v8 offset:2304
    v_mfma_f32_16x16x32_bf16 v[52:55], a[4:7], v[76:79], v[52:55]
    s_waitcnt lgkmcnt(2)
    v_mfma_f32_16x16x32_bf16 v[48:51], a[8:11], v[80:83], v[48:51]
    ds_read_b128 a[4:7], v9 offset:2304
    v_mfma_f32_16x16x32_bf16 v[52:55], a[8:11], v[84:87], v[52:55]
    v_mfma_f32_16x16x32_bf16 v[48:51], a[12:15], v[88:91], v[48:51]
    ds_read_b128 a[8:11], v10 offset:2304
    v_max3_f32 v0, v40, v41, v42
    v_mfma_f32_16x16x32_bf16 v[52:55], a[12:15], v[92:95], v[52:55]
    v_max3_f32 v1, v43, v44, v45
    s_waitcnt lgkmcnt(2)
    v_mfma_f32_16x16x32_bf16 v[48:51], a[16:19], v[96:99], v[48:51]
    s_waitcnt vmcnt(17)
    s_barrier
    ds_read_b64_tr_b16 a[12:13], v11 offset:0
    v_mfma_f32_16x16x32_bf16 v[52:55], a[16:19], v[100:103], v[52:55]
    ds_read_b64_tr_b16 a[14:15], v11 offset:2048
    buffer_load_dwordx4 v22, s[12:15], s30 offen offset:1024 nt lds
    v_mfma_f32_16x16x32_bf16 v[48:51], a[0:3], v[104:107], v[48:51]
    ds_read_b64_tr_b16 a[16:17], v12 offset:0
    v_max3_f32 v0, v0, v46, v47
    v_mfma_f32_16x16x32_bf16 v[52:55], a[0:3], v[108:111], v[52:55]
    ds_read_b64_tr_b16 a[18:19], v12 offset:2048
    s_waitcnt lgkmcnt(4)
    v_mfma_f32_16x16x32_bf16 v[48:51], a[4:7], v[112:115], v[48:51]
    v_mfma_f32_16x16x32_bf16 v[52:55], a[4:7], v[116:119], v[52:55]
    v_mfma_f32_16x16x32_bf16 v[48:51], a[8:11], v[120:123], v[48:51]
    ds_read_b64_tr_b16 a[0:1], v13 offset:0
    v_mfma_f32_16x16x32_bf16 v[52:55], a[8:11], v[124:127], v[52:55]
    ds_read_b64_tr_b16 a[2:3], v13 offset:2048
    s_waitcnt lgkmcnt(2)
    v_mfma_f32_16x16x32_bf16 v[128:131], a[12:15], v[32:35], v[128:131]
    ds_read_b64_tr_b16 a[4:5], v14 offset:0
    buffer_load_dwordx4 v21, s[12:15], s30 offen offset:2048 nt lds
    v_mfma_f32_16x16x32_bf16 v[132:135], a[12:15], v[36:39], v[132:135]
    ds_read_b64_tr_b16 a[6:7], v14 offset:2048
    v_mfma_f32_16x16x32_bf16 v[136:139], a[16:19], v[32:35], v[136:139]
    ds_read_b64_tr_b16 a[8:9], v15 offset:0
    v_mfma_f32_16x16x32_bf16 v[140:143], a[16:19], v[36:39], v[140:143]
    ds_read_b64_tr_b16 a[10:11], v15 offset:2048
    v_max3_f32 v1, v1, v48, v49
    v_max3_f32 v0, v0, v50, v51
    v_mfma_f32_16x16x32_bf16 a[20:23], a[28:31], v[32:35], a[20:23]
    ds_read_b64_tr_b16 a[12:13], v16 offset:0
    v_max3_f32 v1, v1, v52, v53
    v_max3_f32 v0, v0, v54, v55
    v_mfma_f32_16x16x32_bf16 a[24:27], a[28:31], v[36:39], a[24:27]
    ds_read_b64_tr_b16 a[14:15], v16 offset:2048
    v_max_f32 v0, v0, v1
    s_waitcnt lgkmcnt(4)
    v_mfma_f32_16x16x32_bf16 v[144:147], a[0:3], v[32:35], v[144:147]
    ds_read_b64_tr_b16 a[16:17], v17 offset:0
    v_cmp_lt_f32 vcc, s31, v0
    s_cbranch_vccnz L_up_21
L_upb_21:
    v_mfma_f32_16x16x32_bf16 v[148:151], a[0:3], v[36:39], v[148:151]
    ds_read_b64_tr_b16 a[18:19], v17 offset:2048
    v_exp_f32 v40, v40
    v_mfma_f32_16x16x32_bf16 v[152:155], a[4:7], v[32:35], v[152:155]
    ds_read_b64_tr_b16 a[0:1], v18 offset:0
    buffer_load_dwordx4 v22, s[12:15], s30 offen offset:3072 nt lds
    v_mfma_f32_16x16x32_bf16 v[156:159], a[4:7], v[36:39], v[156:159]
    ds_read_b64_tr_b16 a[2:3], v18 offset:2048
    s_waitcnt lgkmcnt(4)
    v_mfma_f32_16x16x32_bf16 v[160:163], a[8:11], v[32:35], v[160:163]
    ds_read_b64_tr_b16 a[4:5], v11 offset:256
    v_exp_f32 v41, v41
    v_mfma_f32_16x16x32_bf16 v[164:167], a[8:11], v[36:39], v[164:167]
    ds_read_b64_tr_b16 a[6:7], v11 offset:2304
    v_exp_f32 v42, v42
    v_mfma_f32_16x16x32_bf16 v[168:171], a[12:15], v[32:35], v[168:171]
    ds_read_b64_tr_b16 a[8:9], v12 offset:256
    v_exp_f32 v43, v43
    v_mfma_f32_16x16x32_bf16 v[172:175], a[12:15], v[36:39], v[172:175]
    ds_read_b64_tr_b16 a[10:11], v12 offset:2304
    v_cvt_pk_bf16_f32 v24, v40, v41
    s_waitcnt lgkmcnt(4)
    v_mfma_f32_16x16x32_bf16 v[176:179], a[16:19], v[32:35], v[176:179]
    ds_read_b64_tr_b16 a[12:13], v13 offset:256
    v_exp_f32 v44, v44
    v_mfma_f32_16x16x32_bf16 v[180:183], a[16:19], v[36:39], v[180:183]
    ds_read_b64_tr_b16 a[14:15], v13 offset:2304
    v_exp_f32 v45, v45
    v_mfma_f32_16x16x32_bf16 v[184:187], a[0:3], v[32:35], v[184:187]
    ds_read_b64_tr_b16 a[16:17], v14 offset:256
    s_add_u32 m0, s29, 32768
    v_cvt_pk_bf16_f32 v25, v42, v43
    v_mfma_f32_16x16x32_bf16 v[188:191], a[0:3], v[36:39], v[188:191]
    ds_read_b64_tr_b16 a[18:19], v14 offset:2304
    s_waitcnt lgkmcnt(4)
    v_mfma_f32_16x16x32_bf16 v[192:195], a[4:7], v[32:35], v[192:195]
    ds_read_b64_tr_b16 a[0:1], v15 offset:256
    s_mov_b32 s30, 409600
    v_mfma_f32_16x16x32_bf16 v[196:199], a[4:7], v[36:39], v[196:199]
    ds_read_b64_tr_b16 a[2:3], v15 offset:2304
    buffer_load_dwordx4 v19, s[8:11], s30 offen offset:0 nt lds
    v_mfma_f32_16x16x32_bf16 v[200:203], a[8:11], v[32:35], v[200:203]
    ds_read_b64_tr_b16 a[4:5], v16 offset:256
    v_exp_f32 v46, v46
    v_mfma_f32_16x16x32_bf16 v[204:207], a[8:11], v[36:39], v[204:207]
    ds_read_b64_tr_b16 a[6:7], v16 offset:2304
    s_waitcnt lgkmcnt(4)
    v_mfma_f32_16x16x32_bf16 v[208:211], a[12:15], v[32:35], v[208:211]
    ds_read_b64_tr_b16 a[8:9], v17 offset:256
    v_exp_f32 v47, v47
    v_mfma_f32_16x16x32_bf16 v[212:215], a[12:15], v[36:39], v[212:215]
    ds_read_b64_tr_b16 a[10:11], v17 offset:2304
    v_cvt_pk_bf16_f32 v28, v44, v45
    s_nop 0
    v_mfma_f32_16x16x32_bf16 v[216:219], a[16:19], v[32:35], v[216:219]
    ds_read_b64_tr_b16 a[12:13], v18 offset:256
    v_cvt_pk_bf16_f32 v29, v46, v47
    v_mfma_f32_16x16x32_bf16 v[220:223], a[16:19], v[36:39], v[220:223]
    ds_read_b64_tr_b16 a[14:15], v18 offset:2304
    s_waitcnt lgkmcnt(4)
    v_mfma_f32_16x16x32_bf16 v[224:227], a[0:3], v[32:35], v[224:227]
    s_waitcnt vmcnt(8)
    s_barrier
    ds_read_b128 a[16:19], v7 offset:16384
    v_mfma_f32_16x16x32_bf16 v[228:231], a[0:3], v[36:39], v[228:231]
    buffer_load_dwordx4 v20, s[8:11], s30 offen offset:1024 nt lds
    v_mfma_f32_16x16x32_bf16 v[232:235], a[4:7], v[32:35], v[232:235]
    ds_read_b128 a[0:3], v8 offset:16384
    v_mfma_f32_16x16x32_bf16 v[236:239], a[4:7], v[36:39], v[236:239]
    s_waitcnt lgkmcnt(2)
    v_mfma_f32_16x16x32_bf16 v[240:243], a[8:11], v[32:35], v[240:243]
    ds_read_b128 a[4:7], v9 offset:16384
    v_mfma_f32_16x16x32_bf16 v[244:247], a[8:11], v[36:39], v[244:247]
    v_mfma_f32_16x16x32_bf16 v[248:251], a[12:15], v[32:35], v[248:251]
    ds_read_b128 a[8:11], v10 offset:16384
    v_mfma_f32_16x16x32_bf16 v[252:255], a[12:15], v[36:39], v[252:255]
    s_cbranch_vccnz L_rs_21
L_rsb_21:
    s_waitcnt lgkmcnt(2)
    v_mfma_f32_16x16x32_bf16 v[40:43], a[16:19], v[64:67], v[56:59]
    ds_read_b128 a[12:15], v7 offset:16640
    v_exp_f32 v48, v48
    v_mfma_f32_16x16x32_bf16 v[44:47], a[16:19], v[68:71], v[60:63]
    v_exp_f32 v49, v49
    v_mfma_f32_16x16x32_bf16 v[40:43], a[0:3], v[72:75], v[40:43]
    ds_read_b128 a[16:19], v8 offset:16640
    buffer_load_dwordx4 v19, s[8:11], s30 offen offset:2048 nt lds
    v_mfma_f32_16x16x32_bf16 v[44:47], a[0:3], v[76:79], v[44:47]
    v_exp_f32 v50, v50
    s_waitcnt lgkmcnt(2)
    v_mfma_f32_16x16x32_bf16 v[40:43], a[4:7], v[80:83], v[40:43]
    ds_read_b128 a[0:3], v9 offset:16640
    v_exp_f32 v51, v51
    v_mfma_f32_16x16x32_bf16 v[44:47], a[4:7], v[84:87], v[44:47]
    v_cvt_pk_bf16_f32 v26, v48, v49
    v_exp_f32 v52, v52
    v_mfma_f32_16x16x32_bf16 v[40:43], a[8:11], v[88:91], v[40:43]
    ds_read_b128 a[4:7], v10 offset:16640
    v_exp_f32 v53, v53
    v_mfma_f32_16x16x32_bf16 v[44:47], a[8:11], v[92:95], v[44:47]
    v_cvt_pk_bf16_f32 v27, v50, v51
    s_waitcnt lgkmcnt(2)
    v_mfma_f32_16x16x32_bf16 v[40:43], a[12:15], v[96:99], v[40:43]
    ds_read_b128 a[8:11], v7 offset:18432
    v_exp_f32 v54, v54
    v_mfma_f32_16x16x32_bf16 v[44:47], a[12:15], v[100:103], v[44:47]
    v_exp_f32 v55, v55
    v_cvt_pk_bf16_f32 v30, v52, v53
    v_mfma_f32_16x16x32_bf16 v[40:43], a[16:19], v[104:107], v[40:43]
    ds_read_b128 a[12:15], v8 offset:18432
    s_nop 0
    v_cvt_pk_bf16_f32 v31, v54, v55
    v_mfma_f32_16x16x32_bf16 v[44:47], a[16:19], v[108:111], v[44:47]
    v_add_u32 v3, 131072, v2
    s_waitcnt lgkmcnt(2)
    v_mfma_f32_16x16x32_bf16 v[40:43], a[0:3], v[112:115], v[40:43]
    ds_read_b128 a[16:19], v9 offset:18432
    buffer_load_dwordx4 v20, s[8:11], s30 offen offset:3072 nt lds
    v_mfma_f32_16x16x32_bf16 v[44:47], a[0:3], v[116:119], v[44:47]
    ds_read_b64_tr_b16 a[192:193], v3 offset:0
    v_mfma_f32_16x16x32_bf16 v[40:43], a[4:7], v[120:123], v[40:43]
    ds_read_b128 a[0:3], v10 offset:18432
    v_mfma_f32_16x16x32_bf16 v[44:47], a[4:7], v[124:127], v[44:47]
    ds_read_b64_tr_b16 a[194:195], v3 offset:2048
    s_waitcnt lgkmcnt(4)
    v_mfma_f32_16x16x32_bf16 v[48:51], a[8:11], v[64:67], v[56:59]
    ds_read_b128 a[4:7], v7 offset:18688
    v_mfma_f32_16x16x32_bf16 v[52:55], a[8:11], v[68:71], v[60:63]
    ds_read_b64_tr_b16 a[196:197], v3 offset:4096
    s_mov_b64 exec, 0
    s_branch L_pg1
L_pgb1:
    s_mov_b64 exec, -1
    v_mfma_f32_16x16x32_bf16 v[48:51], a[12:15], v[72:75], v[48:51]
    ds_read_b128 a[8:11], v8 offset:18688
    v_mfma_f32_16x16x32_bf16 v[52:55], a[12:15], v[76:79], v[52:55]
    ds_read_b64_tr_b16 a[198:199], v3 offset:6144
    s_waitcnt lgkmcnt(5)
    v_mfma_f32_16x16x32_bf16 v[48:51], a[16:19], v[80:83], v[48:51]
    ds_read_b128 a[12:15], v9 offset:18688
    v_mfma_f32_16x16x32_bf16 v[52:55], a[16:19], v[84:87], v[52:55]
    ds_read_b64_tr_b16 a[200:201], v3 offset:8192
    v_mfma_f32_16x16x32_bf16 v[48:51], a[0:3], v[88:91], v[48:51]
    ds_read_b128 a[16:19], v10 offset:18688
    v_max3_f32 v0, v40, v41, v42
    v_max3_f32 v1, v43, v44, v45
    v_mfma_f32_16x16x32_bf16 v[52:55], a[0:3], v[92:95], v[52:55]
    ds_read_b64_tr_b16 a[202:203], v3 offset:10240
    v_max3_f32 v0, v0, v46, v47
    s_waitcnt lgkmcnt(5)
    v_mfma_f32_16x16x32_bf16 v[48:51], a[4:7], v[96:99], v[48:51]
    s_barrier
    ds_read_b64_tr_b16 a[0:1], v11 offset:16384
    v_mfma_f32_16x16x32_bf16 v[52:55], a[4:7], v[100:103], v[52:55]
    ds_read_b64_tr_b16 a[2:3], v11 offset:18432
    s_add_u32 m0, s29, 65536
    v_mfma_f32_16x16x32_bf16 v[48:51], a[8:11], v[104:107], v[48:51]
    ds_read_b64_tr_b16 a[4:5], v12 offset:16384
    s_mov_b32 s30, 393216
    v_mfma_f32_16x16x32_bf16 v[52:55], a[8:11], v[108:111], v[52:55]
    ds_read_b64_tr_b16 a[6:7], v12 offset:18432
    s_waitcnt lgkmcnt(5)
    v_mfma_f32_16x16x32_bf16 v[48:51], a[12:15], v[112:115], v[48:51]
    buffer_load_dwordx4 v21, s[12:15], s30 offen offset:0 nt lds
    ds_read_b64_tr_b16 a[204:205], v3 offset:12288
    v_mfma_f32_16x16x32_bf16 v[52:55], a[12:15], v[116:119], v[52:55]
    buffer_load_dwordx4 v22, s[12:15], s30 offen offset:1024 nt lds
    ds_read_b64_tr_b16 a[206:207], v3 offset:14336
    v_mfma_f32_16x16x32_bf16 v[48:51], a[16:19], v[120:123], v[48:51]
    ds_read_b64_tr_b16 a[8:9], v13 offset:16384
    v_mfma_f32_16x16x32_bf16 v[52:55], a[16:19], v[124:127], v[52:55]
    ds_read_b64_tr_b16 a[10:11], v13 offset:18432
    s_waitcnt lgkmcnt(4)
    v_mfma_f32_16x16x32_bf16 v[128:131], a[0:3], v[24:27], v[128:131]
    ds_read_b64_tr_b16 a[12:13], v14 offset:16384
    buffer_load_dwordx4 v21, s[12:15], s30 offen offset:2048 nt lds
    v_mfma_f32_16x16x32_bf16 v[132:135], a[0:3], v[28:31], v[132:135]
    ds_read_b64_tr_b16 a[14:15], v14 offset:18432
    v_mfma_f32_16x16x32_bf16 v[136:139], a[4:7], v[24:27], v[136:139]
    ds_read_b64_tr_b16 a[16:17], v15 offset:16384
    v_mfma_f32_16x16x32_bf16 v[140:143], a[4:7], v[28:31], v[140:143]
    ds_read_b64_tr_b16 a[18:19], v15 offset:18432
    v_max3_f32 v1, v1, v48, v49
    v_max3_f32 v0, v0, v50, v51
    v_max3_f32 v1, v1, v52, v53
    v_mfma_f32_16x16x32_bf16 a[20:23], a[28:31], v[24:27], a[20:23]
    ds_read_b64_tr_b16 a[0:1], v16 offset:16384
    buffer_load_dwordx4 v22, s[12:15], s30 offen offset:3072 nt lds
    v_max3_f32 v0, v0, v54, v55
    v_max_f32 v0, v0, v1
    v_mfma_f32_16x16x32_bf16 a[24:27], a[28:31], v[28:31], a[24:27]
    ds_read_b64_tr_b16 a[2:3], v16 offset:18432
    v_cmp_lt_f32 vcc, s31, v0
    s_cbranch_vccnz L_up_22
L_upb_22:
    s_waitcnt lgkmcnt(4)
    v_mfma_f32_16x16x32_bf16 v[144:147], a[8:11], v[24:27], v[144:147]
    ds_read_b64_tr_b16 a[4:5], v17 offset:16384
    v_exp_f32 v40, v40
    v_mfma_f32_16x16x32_bf16 v[148:151], a[8:11], v[28:31], v[148:151]
    ds_read_b64_tr_b16 a[6:7], v17 offset:18432
    v_exp_f32 v41, v41
    v_mfma_f32_16x16x32_bf16 v[152:155], a[12:15], v[24:27], v[152:155]
    ds_read_b64_tr_b16 a[8:9], v18 offset:16384
    s_add_u32 m0, s29, 147456
    v_exp_f32 v42, v42
    v_mfma_f32_16x16x32_bf16 v[156:159], a[12:15], v[28:31], v[156:159]
    ds_read_b64_tr_b16 a[10:11], v18 offset:18432
    v_exp_f32 v43, v43
    s_waitcnt lgkmcnt(4)
    v_mfma_f32_16x16x32_bf16 v[160:163], a[16:19], v[24:27], v[160:163]
    ds_read_b64_tr_b16 a[12:13], v11 offset:16640
    s_add_u32 s30, s81, 114688
    v_cvt_pk_bf16_f32 v32, v40, v41
    v_mfma_f32_16x16x32_bf16 v[164:167], a[16:19], v[28:31], v[164:167]
    ds_read_b64_tr_b16 a[14:15], v11 offset:18688
    buffer_load_dwordx4 v23, s[20:23], s30 offen offset:0  lds
    v_exp_f32 v44, v44
    v_mfma_f32_16x16x32_bf16 v[168:171], a[0:3], v[24:27], v[168:171]
    ds_read_b64_tr_b16 a[16:17], v12 offset:16640
    s_add_u32 s30, s81, 120832
    v_exp_f32 v45, v45
    v_mfma_f32_16x16x32_bf16 v[172:175], a[0:3], v[28:31], v[172:175]
    ds_read_b64_tr_b16 a[18:19], v12 offset:18688
    v_cvt_pk_bf16_f32 v33, v42, v43
    s_waitcnt lgkmcnt(4)
    v_mfma_f32_16x16x32_bf16 v[176:179], a[4:7], v[24:27], v[176:179]
    ds_read_b64_tr_b16 a[0:1], v13 offset:16640
    buffer_load_dwordx4 v23, s[20:23], s30 offen offset:1024  lds
    v_exp_f32 v46, v46
    v_mfma_f32_16x16x32_bf16 v[180:183], a[4:7], v[28:31], v[180:183]
    ds_read_b64_tr_b16 a[2:3], v13 offset:18688
    v_exp_f32 v47, v47
    v_cvt_pk_bf16_f32 v36, v44, v45
    v_mfma_f32_16x16x32_bf16 v[184:187], a[8:11], v[24:27], v[184:187]
    ds_read_b64_tr_b16 a[4:5], v14 offset:16640
    s_add_u32 s30, s81, 126976
    s_nop 0
    v_cvt_pk_bf16_f32 v37, v46, v47
    v_mfma_f32_16x16x32_bf16 v[188:191], a[8:11], v[28:31], v[188:191]
    ds_read_b64_tr_b16 a[6:7], v14 offset:18688
    s_waitcnt lgkmcnt(4)
    v_mfma_f32_16x16x32_bf16 v[192:195], a[12:15], v[24:27], v[192:195]
    ds_read_b64_tr_b16 a[8:9], v15 offset:16640
    buffer_load_dwordx4 v23, s[20:23], s30 offen offset:2048  lds
    v_mfma_f32_16x16x32_bf16 v[196:199], a[12:15], v[28:31], v[196:199]
    ds_read_b64_tr_b16 a[10:11], v15 offset:18688
    v_mfma_f32_16x16x32_bf16 v[200:203], a[16:19], v[24:27], v[200:203]
    ds_read_b64_tr_b16 a[12:13], v16 offset:16640
    s_add_u32 s30, s81, 133120
    v_mfma_f32_16x16x32_bf16 v[204:207], a[16:19], v[28:31], v[204:207]
    ds_read_b64_tr_b16 a[14:15], v16 offset:18688
    s_waitcnt lgkmcnt(4)
    v_mfma_f32_16x16x32_bf16 v[208:211], a[0:3], v[24:27], v[208:211]
    ds_read_b64_tr_b16 a[16:17], v17 offset:16640
    buffer_load_dwordx4 v23, s[20:23], s30 offen offset:3072  lds
    v_mfma_f32_16x16x32_bf16 v[212:215], a[0:3], v[28:31], v[212:215]
    ds_read_b64_tr_b16 a[18:19], v17 offset:18688
    v_mfma_f32_16x16x32_bf16 v[216:219], a[4:7], v[24:27], v[216:219]
    ds_read_b64_tr_b16 a[0:1], v18 offset:16640
    v_mfma_f32_16x16x32_bf16 v[220:223], a[4:7], v[28:31], v[220:223]
    ds_read_b64_tr_b16 a[2:3], v18 offset:18688
    s_waitcnt lgkmcnt(4)
    v_mfma_f32_16x16x32_bf16 v[224:227], a[8:11], v[24:27], v[224:227]
    s_waitcnt vmcnt(16)
    s_barrier
    ds_read_b128 a[4:7], v7 offset:49152
    v_mfma_f32_16x16x32_bf16 v[228:231], a[8:11], v[28:31], v[228:231]
    s_add_u32 m0, s29, 0
    s_mov_b32 s30, 425984
    v_mfma_f32_16x16x32_bf16 v[232:235], a[12:15], v[24:27], v[232:235]
    ds_read_b128 a[8:11], v8 offset:49152
    buffer_load_dwordx4 v19, s[8:11], s30 offen offset:0 nt lds
    v_mfma_f32_16x16x32_bf16 v[236:239], a[12:15], v[28:31], v[236:239]
    s_waitcnt lgkmcnt(2)
    v_mfma_f32_16x16x32_bf16 v[240:243], a[16:19], v[24:27], v[240:243]
    ds_read_b128 a[12:15], v9 offset:49152
    v_mfma_f32_16x16x32_bf16 v[244:247], a[16:19], v[28:31], v[244:247]
    v_mfma_f32_16x16x32_bf16 v[248:251], a[0:3], v[24:27], v[248:251]
    ds_read_b128 a[16:19], v10 offset:49152
    v_mfma_f32_16x16x32_bf16 v[252:255], a[0:3], v[28:31], v[252:255]
    s_cbranch_vccnz L_rs_22
L_rsb_22:
    s_waitcnt lgkmcnt(2)
    v_mfma_f32_16x16x32_bf16 v[40:43], a[4:7], v[64:67], v[56:59]
    ds_read_b128 a[0:3], v7 offset:49408
    v_exp_f32 v48, v48
    v_mfma_f32_16x16x32_bf16 v[44:47], a[4:7], v[68:71], v[60:63]
    v_exp_f32 v49, v49
    v_mfma_f32_16x16x32_bf16 v[40:43], a[8:11], v[72:75], v[40:43]
    ds_read_b128 a[4:7], v8 offset:49408
    buffer_load_dwordx4 v20, s[8:11], s30 offen offset:1024 nt lds
    v_mfma_f32_16x16x32_bf16 v[44:47], a[8:11], v[76:79], v[44:47]
    v_exp_f32 v50, v50
    s_waitcnt lgkmcnt(2)
    v_mfma_f32_16x16x32_bf16 v[40:43], a[12:15], v[80:83], v[40:43]
    ds_read_b128 a[8:11], v9 offset:49408
    v_exp_f32 v51, v51
    v_mfma_f32_16x16x32_bf16 v[44:47], a[12:15], v[84:87], v[44:47]
    v_cvt_pk_bf16_f32 v34, v48, v49
    v_exp_f32 v52, v52
    v_mfma_f32_16x16x32_bf16 v[40:43], a[16:19], v[88:91], v[40:43]
    ds_read_b128 a[12:15], v10 offset:49408
    v_exp_f32 v53, v53
    v_mfma_f32_16x16x32_bf16 v[44:47], a[16:19], v[92:95], v[44:47]
    v_cvt_pk_bf16_f32 v35, v50, v51
    s_waitcnt lgkmcnt(2)
    v_mfma_f32_16x16x32_bf16 v[40:43], a[0:3], v[96:99], v[40:43]
    ds_read_b128 a[16:19], v7 offset:51200
    v_exp_f32 v54, v54
    v_mfma_f32_16x16x32_bf16 v[44:47], a[0:3], v[100:103], v[44:47]
    v_exp_f32 v55, v55
    v_cvt_pk_bf16_f32 v38, v52, v53
    v_mfma_f32_16x16x32_bf16 v[40:43], a[4:7], v[104:107], v[40:43]
    ds_read_b128 a[0:3], v8 offset:51200
    s_nop 0
    v_cvt_pk_bf16_f32 v39, v54, v55
    v_mfma_f32_16x16x32_bf16 v[44:47], a[4:7], v[108:111], v[44:47]
    s_waitcnt lgkmcnt(2)
    v_mfma_f32_16x16x32_bf16 v[40:43], a[8:11], v[112:115], v[40:43]
    ds_read_b128 a[4:7], v9 offset:51200
    buffer_load_dwordx4 v19, s[8:11], s30 offen offset:2048 nt lds
    v_mfma_f32_16x16x32_bf16 v[44:47], a[8:11], v[116:119], v[44:47]
    v_mfma_f32_16x16x32_bf16 v[40:43], a[12:15], v[120:123], v[40:43]
    ds_read_b128 a[8:11], v10 offset:51200
    v_mfma_f32_16x16x32_bf16 v[44:47], a[12:15], v[124:127], v[44:47]
    s_waitcnt lgkmcnt(2)
    v_mfma_f32_16x16x32_bf16 v[48:51], a[16:19], v[64:67], v[56:59]
    ds_read_b128 a[12:15], v7 offset:51456
    v_mfma_f32_16x16x32_bf16 v[52:55], a[16:19], v[68:71], v[60:63]
    s_mov_b64 exec, 0
    s_branch L_pg2
L_pgb2:
    s_mov_b64 exec, -1
    v_mfma_f32_16x16x32_bf16 v[48:51], a[0:3], v[72:75], v[48:51]
    ds_read_b128 a[16:19], v8 offset:51456
    v_mfma_f32_16x16x32_bf16 v[52:55], a[0:3], v[76:79], v[52:55]
    s_waitcnt lgkmcnt(2)
    v_mfma_f32_16x16x32_bf16 v[48:51], a[4:7], v[80:83], v[48:51]
    ds_read_b128 a[0:3], v9 offset:51456
    v_mfma_f32_16x16x32_bf16 v[52:55], a[4:7], v[84:87], v[52:55]
    v_mfma_f32_16x16x32_bf16 v[48:51], a[8:11], v[88:91], v[48:51]
    ds_read_b128 a[4:7], v10 offset:51456
    v_max3_f32 v0, v40, v41, v42
    v_mfma_f32_16x16x32_bf16 v[52:55], a[8:11], v[92:95], v[52:55]
    v_max3_f32 v1, v43, v44, v45
    s_waitcnt lgkmcnt(2)
    v_mfma_f32_16x16x32_bf16 v[48:51], a[12:15], v[96:99], v[48:51]
    s_waitcnt vmcnt(15)
    s_barrier
    ds_read_b64_tr_b16 a[8:9], v11 offset:32768
    v_mfma_f32_16x16x32_bf16 v[52:55], a[12:15], v[100:103], v[52:55]
    ds_read_b64_tr_b16 a[10:11], v11 offset:34816
    buffer_load_dwordx4 v20, s[8:11], s30 offen offset:3072 nt lds
    v_mfma_f32_16x16x32_bf16 v[48:51], a[16:19], v[104:107], v[48:51]
    ds_read_b64_tr_b16 a[12:13], v12 offset:32768
    v_max3_f32 v0, v0, v46, v47
    v_mfma_f32_16x16x32_bf16 v[52:55], a[16:19], v[108:111], v[52:55]
    ds_read_b64_tr_b16 a[14:15], v12 offset:34816
    s_waitcnt lgkmcnt(4)
    v_mfma_f32_16x16x32_bf16 v[48:51], a[0:3], v[112:115], v[48:51]
    v_mfma_f32_16x16x32_bf16 v[52:55], a[0:3], v[116:119], v[52:55]
    v_mfma_f32_16x16x32_bf16 v[48:51], a[4:7], v[120:123], v[48:51]
    ds_read_b64_tr_b16 a[16:17], v13 offset:32768
    v_mfma_f32_16x16x32_bf16 v[52:55], a[4:7], v[124:127], v[52:55]
    ds_read_b64_tr_b16 a[18:19], v13 offset:34816
    s_waitcnt lgkmcnt(2)
    v_mfma_f32_16x16x32_bf16 v[128:131], a[8:11], v[32:35], v[128:131]
    ds_read_b64_tr_b16 a[0:1], v14 offset:32768
    s_add_u32 m0, s29, 81920
    v_mfma_f32_16x16x32_bf16 v[132:135], a[8:11], v[36:39], v[132:135]
    ds_read_b64_tr_b16 a[2:3], v14 offset:34816
    s_mov_b32 s30, 409600
    v_mfma_f32_16x16x32_bf16 v[136:139], a[12:15], v[32:35], v[136:139]
    ds_read_b64_tr_b16 a[4:5], v15 offset:32768
    buffer_load_dwordx4 v21, s[12:15], s30 offen offset:0 nt lds
    v_mfma_f32_16x16x32_bf16 v[140:143], a[12:15], v[36:39], v[140:143]
    ds_read_b64_tr_b16 a[6:7], v15 offset:34816
    v_max3_f32 v1, v1, v48, v49
    v_max3_f32 v0, v0, v50, v51
    v_mfma_f32_16x16x32_bf16 a[20:23], a[28:31], v[32:35], a[20:23]
    ds_read_b64_tr_b16 a[8:9], v16 offset:32768
    v_max3_f32 v1, v1, v52, v53
    v_max3_f32 v0, v0, v54, v55
    v_mfma_f32_16x16x32_bf16 a[24:27], a[28:31], v[36:39], a[24:27]
    ds_read_b64_tr_b16 a[10:11], v16 offset:34816
    v_max_f32 v0, v0, v1
    s_waitcnt lgkmcnt(4)
    v_mfma_f32_16x16x32_bf16 v[144:147], a[16:19], v[32:35], v[144:147]
    ds_read_b64_tr_b16 a[12:13], v17 offset:32768
    v_cmp_lt_f32 vcc, s31, v0
    s_cbranch_vccnz L_up_23
L_upb_23:
    v_mfma_f32_16x16x32_bf16 v[148:151], a[16:19], v[36:39], v[148:151]
    ds_read_b64_tr_b16 a[14:15], v17 offset:34816
    v_exp_f32 v40, v40
    v_mfma_f32_16x16x32_bf16 v[152:155], a[0:3], v[32:35], v[152:155]
    ds_read_b64_tr_b16 a[16:17], v18 offset:32768
    buffer_load_dwordx4 v22, s[12:15], s30 offen offset:1024 nt lds
    v_mfma_f32_16x16x32_bf16 v[156:159], a[0:3], v[36:39], v[156:159]
    ds_read_b64_tr_b16 a[18:19], v18 offset:34816
    s_waitcnt lgkmcnt(4)
    v_mfma_f32_16x16x32_bf16 v[160:163], a[4:7], v[32:35], v[160:163]
    ds_read_b64_tr_b16 a[0:1], v11 offset:33024
    v_exp_f32 v41, v41
    v_mfma_f32_16x16x32_bf16 v[164:167], a[4:7], v[36:39], v[164:167]
    ds_read_b64_tr_b16 a[2:3], v11 offset:35072
    v_exp_f32 v42, v42
    v_mfma_f32_16x16x32_bf16 v[168:171], a[8:11], v[32:35], v[168:171]
    ds_read_b64_tr_b16 a[4:5], v12 offset:33024
    v_exp_f32 v43, v43
    v_mfma_f32_16x16x32_bf16 v[172:175], a[8:11], v[36:39], v[172:175]
    ds_read_b64_tr_b16 a[6:7], v12 offset:35072
    v_cvt_pk_bf16_f32 v24, v40, v41
    s_waitcnt lgkmcnt(4)
    v_mfma_f32_16x16x32_bf16 v[176:179], a[12:15], v[32:35], v[176:179]
    ds_read_b64_tr_b16 a[8:9], v13 offset:33024
    v_exp_f32 v44, v44
    v_mfma_f32_16x16x32_bf16 v[180:183], a[12:15], v[36:39], v[180:183]
    ds_read_b64_tr_b16 a[10:11], v13 offset:35072
    v_exp_f32 v45, v45
    v_mfma_f32_16x16x32_bf16 v[184:187], a[16:19], v[32:35], v[184:187]
    ds_read_b64_tr_b16 a[12:13], v14 offset:33024
    buffer_load_dwordx4 v21, s[12:15], s30 offen offset:2048 nt lds
    v_cvt_pk_bf16_f32 v25, v42, v43
    v_mfma_f32_16x16x32_bf16 v[188:191], a[16:19], v[36:39], v[188:191]
    ds_read_b64_tr_b16 a[14:15], v14 offset:35072
    s_waitcnt lgkmcnt(4)
    v_mfma_f32_16x16x32_bf16 v[192:195], a[0:3], v[32:35], v[192:195]
    ds_read_b64_tr_b16 a[16:17], v15 offset:33024
    v_exp_f32 v46, v46
    v_mfma_f32_16x16x32_bf16 v[196:199], a[0:3], v[36:39], v[196:199]
    ds_read_b64_tr_b16 a[18:19], v15 offset:35072
    v_exp_f32 v47, v47
    v_mfma_f32_16x16x32_bf16 v[200:203], a[4:7], v[32:35], v[200:203]
    ds_read_b64_tr_b16 a[0:1], v16 offset:33024
    v_cvt_pk_bf16_f32 v28, v44, v45
    s_nop 0
    v_mfma_f32_16x16x32_bf16 v[204:207], a[4:7], v[36:39], v[204:207]
    ds_read_b64_tr_b16 a[2:3], v16 offset:35072
    v_cvt_pk_bf16_f32 v29, v46, v47
    s_waitcnt lgkmcnt(4)
    v_mfma_f32_16x16x32_bf16 v[208:211], a[8:11], v[32:35], v[208:211]
    ds_read_b64_tr_b16 a[4:5], v17 offset:33024
    v_mfma_f32_16x16x32_bf16 v[212:215], a[8:11], v[36:39], v[212:215]
    ds_read_b64_tr_b16 a[6:7], v17 offset:35072
    v_mfma_f32_16x16x32_bf16 v[216:219], a[12:15], v[32:35], v[216:219]
    ds_read_b64_tr_b16 a[8:9], v18 offset:33024
    v_mfma_f32_16x16x32_bf16 v[220:223], a[12:15], v[36:39], v[220:223]
    ds_read_b64_tr_b16 a[10:11], v18 offset:35072
    s_waitcnt lgkmcnt(4)
    v_mfma_f32_16x16x32_bf16 v[224:227], a[16:19], v[32:35], v[224:227]
    s_waitcnt vmcnt(7)
    s_barrier
    ds_read_b128 a[12:15], v7 offset:32768
    v_mfma_f32_16x16x32_bf16 v[228:231], a[16:19], v[36:39], v[228:231]
    buffer_load_dwordx4 v22, s[12:15], s30 offen offset:3072 nt lds
    v_mfma_f32_16x16x32_bf16 v[232:235], a[0:3], v[32:35], v[232:235]
    ds_read_b128 a[16:19], v8 offset:32768
    v_mfma_f32_16x16x32_bf16 v[236:239], a[0:3], v[36:39], v[236:239]
    s_waitcnt lgkmcnt(2)
    v_mfma_f32_16x16x32_bf16 v[240:243], a[4:7], v[32:35], v[240:243]
    ds_read_b128 a[0:3], v9 offset:32768
    v_mfma_f32_16x16x32_bf16 v[244:247], a[4:7], v[36:39], v[244:247]
    v_mfma_f32_16x16x32_bf16 v[248:251], a[8:11], v[32:35], v[248:251]
    ds_read_b128 a[4:7], v10 offset:32768
    v_mfma_f32_16x16x32_bf16 v[252:255], a[8:11], v[36:39], v[252:255]
    s_add_u32 m0, s29, 16384
    s_cbranch_vccnz L_rs_23
L_rsb_23:
    s_waitcnt lgkmcnt(2)
    v_mfma_f32_16x16x32_bf16 v[40:43], a[12:15], v[64:67], v[56:59]
    ds_read_b128 a[8:11], v7 offset:33024
    s_mov_b32 s30, 442368
    v_mfma_f32_16x16x32_bf16 v[44:47], a[12:15], v[68:71], v[60:63]
    buffer_load_dwordx4 v19, s[8:11], s30 offen offset:0 nt lds
    v_exp_f32 v48, v48
    v_mfma_f32_16x16x32_bf16 v[40:43], a[16:19], v[72:75], v[40:43]
    ds_read_b128 a[12:15], v8 offset:33024
    v_exp_f32 v49, v49
    v_mfma_f32_16x16x32_bf16 v[44:47], a[16:19], v[76:79], v[44:47]
    v_exp_f32 v50, v50
    s_waitcnt lgkmcnt(2)
    v_mfma_f32_16x16x32_bf16 v[40:43], a[0:3], v[80:83], v[40:43]
    ds_read_b128 a[16:19], v9 offset:33024
    v_exp_f32 v51, v51
    v_mfma_f32_16x16x32_bf16 v[44:47], a[0:3], v[84:87], v[44:47]
    v_cvt_pk_bf16_f32 v26, v48, v49
    v_exp_f32 v52, v52
    v_mfma_f32_16x16x32_bf16 v[40:43], a[4:7], v[88:91], v[40:43]
    ds_read_b128 a[0:3], v10 offset:33024
    buffer_load_dwordx4 v20, s[8:11], s30 offen offset:1024 nt lds
    v_add_u32 v3, 147456, v2
    v_mfma_f32_16x16x32_bf16 v[44:47], a[4:7], v[92:95], v[44:47]
    v_exp_f32 v53, v53
    s_waitcnt lgkmcnt(2)
    v_mfma_f32_16x16x32_bf16 v[40:43], a[8:11], v[96:99], v[40:43]
    ds_read_b128 a[4:7], v7 offset:34816
    v_cvt_pk_bf16_f32 v27, v50, v51
    v_mfma_f32_16x16x32_bf16 v[44:47], a[8:11], v[100:103], v[44:47]
    v_exp_f32 v54, v54
    ds_read_b64_tr_b16 a[208:209], v3 offset:0
    v_mfma_f32_16x16x32_bf16 v[40:43], a[12:15], v[104:107], v[40:43]
    ds_read_b128 a[8:11], v8 offset:34816
    v_exp_f32 v55, v55
    v_mfma_f32_16x16x32_bf16 v[44:47], a[12:15], v[108:111], v[44:47]
    v_cvt_pk_bf16_f32 v30, v52, v53
    s_nop 0
    s_waitcnt lgkmcnt(3)
    v_mfma_f32_16x16x32_bf16 v[40:43], a[16:19], v[112:115], v[40:43]
    ds_read_b128 a[12:15], v9 offset:34816
    v_cvt_pk_bf16_f32 v31, v54, v55
    v_mfma_f32_16x16x32_bf16 v[44:47], a[16:19], v[116:119], v[44:47]
    buffer_load_dwordx4 v19, s[8:11], s30 offen offset:2048 nt lds
    ds_read_b64_tr_b16 a[210:211], v3 offset:2048
    v_mfma_f32_16x16x32_bf16 v[40:43], a[0:3], v[120:123], v[40:43]
    ds_read_b128 a[16:19], v10 offset:34816
    v_mfma_f32_16x16x32_bf16 v[44:47], a[0:3], v[124:127], v[44:47]
    ds_read_b64_tr_b16 a[212:213], v3 offset:4096
    s_waitcnt lgkmcnt(4)
    v_mfma_f32_16x16x32_bf16 v[48:51], a[4:7], v[64:67], v[56:59]
    ds_read_b128 a[0:3], v7 offset:35072
    v_mfma_f32_16x16x32_bf16 v[52:55], a[4:7], v[68:71], v[60:63]
    ds_read_b64_tr_b16 a[214:215], v3 offset:6144
    v_mfma_f32_16x16x32_bf16 v[48:51], a[8:11], v[72:75], v[48:51]
    ds_read_b128 a[4:7], v8 offset:35072
    v_mfma_f32_16x16x32_bf16 v[52:55], a[8:11], v[76:79], v[52:55]
    ds_read_b64_tr_b16 a[216:217], v3 offset:8192
    s_waitcnt lgkmcnt(5)
    v_mfma_f32_16x16x32_bf16 v[48:51], a[12:15], v[80:83], v[48:51]
    ds_read_b128 a[8:11], v9 offset:35072
    v_mfma_f32_16x16x32_bf16 v[52:55], a[12:15], v[84:87], v[52:55]
    ds_read_b64_tr_b16 a[218:219], v3 offset:10240
    v_mfma_f32_16x16x32_bf16 v[48:51], a[16:19], v[88:91], v[48:51]
    ds_read_b128 a[12:15], v10 offset:35072
    v_max3_f32 v0, v40, v41, v42
    v_mfma_f32_16x16x32_bf16 v[52:55], a[16:19], v[92:95], v[52:55]
    ds_read_b64_tr_b16 a[220:221], v3 offset:12288
    s_waitcnt lgkmcnt(5)
    v_mfma_f32_16x16x32_bf16 v[48:51], a[0:3], v[96:99], v[48:51]
    s_barrier
    ds_read_b64_tr_b16 a[16:17], v11 offset:0
    v_mfma_f32_16x16x32_bf16 v[52:55], a[0:3], v[100:103], v[52:55]
    ds_read_b64_tr_b16 a[18:19], v11 offset:2048
    buffer_load_dwordx4 v20, s[8:11], s30 offen offset:3072 nt lds
    v_mfma_f32_16x16x32_bf16 v[48:51], a[4:7], v[104:107], v[48:51]
    ds_read_b64_tr_b16 a[0:1], v12 offset:0
    v_max3_f32 v1, v43, v44, v45
    v_mfma_f32_16x16x32_bf16 v[52:55], a[4:7], v[108:111], v[52:55]
    ds_read_b64_tr_b16 a[2:3], v12 offset:2048
    s_waitcnt lgkmcnt(5)
    v_mfma_f32_16x16x32_bf16 v[48:51], a[8:11], v[112:115], v[48:51]
    s_add_u32 m0, s29, 98304
    s_mov_b32 s30, 425984
    ds_read_b64_tr_b16 a[222:223], v3 offset:14336
    v_mfma_f32_16x16x32_bf16 v[52:55], a[8:11], v[116:119], v[52:55]
    buffer_load_dwordx4 v21, s[12:15], s30 offen offset:0 nt lds
    v_max3_f32 v0, v0, v46, v47
    v_mfma_f32_16x16x32_bf16 v[48:51], a[12:15], v[120:123], v[48:51]
    ds_read_b64_tr_b16 a[4:5], v13 offset:0
    v_mfma_f32_16x16x32_bf16 v[52:55], a[12:15], v[124:127], v[52:55]
    ds_read_b64_tr_b16 a[6:7], v13 offset:2048
    s_waitcnt lgkmcnt(3)
    v_mfma_f32_16x16x32_bf16 v[128:131], a[16:19], v[24:27], v[128:131]
    ds_read_b64_tr_b16 a[8:9], v14 offset:0
    buffer_load_dwordx4 v22, s[12:15], s30 offen offset:1024 nt lds
    v_mfma_f32_16x16x32_bf16 v[132:135], a[16:19], v[28:31], v[132:135]
    ds_read_b64_tr_b16 a[10:11], v14 offset:2048
    v_mfma_f32_16x16x32_bf16 v[136:139], a[0:3], v[24:27], v[136:139]
    ds_read_b64_tr_b16 a[12:13], v15 offset:0
    v_mfma_f32_16x16x32_bf16 v[140:143], a[0:3], v[28:31], v[140:143]
    ds_read_b64_tr_b16 a[14:15], v15 offset:2048
    v_max3_f32 v1, v1, v48, v49
    v_max3_f32 v0, v0, v50, v51
    v_mfma_f32_16x16x32_bf16 a[20:23], a[28:31], v[24:27], a[20:23]
    ds_read_b64_tr_b16 a[16:17], v16 offset:0
    s_add_u32 m0, s29, 131072
    v_max3_f32 v1, v1, v52, v53
    v_mfma_f32_16x16x32_bf16 a[24:27], a[28:31], v[28:31], a[24:27]
    ds_read_b64_tr_b16 a[18:19], v16 offset:2048
    v_max3_f32 v0, v0, v54, v55
    s_waitcnt lgkmcnt(4)
    v_mfma_f32_16x16x32_bf16 v[144:147], a[4:7], v[24:27], v[144:147]
    ds_read_b64_tr_b16 a[0:1], v17 offset:0
    s_add_u32 s30, s82, 0
    v_max_f32 v0, v0, v1
    v_mfma_f32_16x16x32_bf16 v[148:151], a[4:7], v[28:31], v[148:151]
    ds_read_b64_tr_b16 a[2:3], v17 offset:2048
    buffer_load_dwordx4 v23, s[20:23], s30 offen offset:0  lds
    v_cmp_lt_f32 vcc, s31, v0
    v_mfma_f32_16x16x32_bf16 v[152:155], a[8:11], v[24:27], v[152:155]
    ds_read_b64_tr_b16 a[4:5], v18 offset:0
    s_add_u32 s30, s82, 6144
    s_cbranch_vccnz L_up_24
L_upb_24:
    v_mfma_f32_16x16x32_bf16 v[156:159], a[8:11], v[28:31], v[156:159]
    ds_read_b64_tr_b16 a[6:7], v18 offset:2048
    s_waitcnt lgkmcnt(4)
    v_mfma_f32_16x16x32_bf16 v[160:163], a[12:15], v[24:27], v[160:163]
    ds_read_b64_tr_b16 a[8:9], v11 offset:256
    buffer_load_dwordx4 v23, s[20:23], s30 offen offset:1024  lds
    v_mfma_f32_16x16x32_bf16 v[164:167], a[12:15], v[28:31], v[164:167]
    ds_read_b64_tr_b16 a[10:11], v11 offset:2304
    v_exp_f32 v40, v40
    v_mfma_f32_16x16x32_bf16 v[168:171], a[16:19], v[24:27], v[168:171]
    ds_read_b64_tr_b16 a[12:13], v12 offset:256
    s_add_u32 s30, s82, 12288
    v_mfma_f32_16x16x32_bf16 v[172:175], a[16:19], v[28:31], v[172:175]
    ds_read_b64_tr_b16 a[14:15], v12 offset:2304
    s_waitcnt lgkmcnt(4)
    v_mfma_f32_16x16x32_bf16 v[176:179], a[0:3], v[24:27], v[176:179]
    ds_read_b64_tr_b16 a[16:17], v13 offset:256
    buffer_load_dwordx4 v23, s[20:23], s30 offen offset:2048  lds
    v_mfma_f32_16x16x32_bf16 v[180:183], a[0:3], v[28:31], v[180:183]
    ds_read_b64_tr_b16 a[18:19], v13 offset:2304
    v_exp_f32 v41, v41
    v_mfma_f32_16x16x32_bf16 v[184:187], a[4:7], v[24:27], v[184:187]
    ds_read_b64_tr_b16 a[0:1], v14 offset:256
    s_add_u32 s30, s82, 18432
    v_mfma_f32_16x16x32_bf16 v[188:191], a[4:7], v[28:31], v[188:191]
    ds_read_b64_tr_b16 a[2:3], v14 offset:2304
    s_waitcnt lgkmcnt(4)
    v_mfma_f32_16x16x32_bf16 v[192:195], a[8:11], v[24:27], v[192:195]
    ds_read_b64_tr_b16 a[4:5], v15 offset:256
    buffer_load_dwordx4 v23, s[20:23], s30 offen offset:3072  lds
    v_mfma_f32_16x16x32_bf16 v[196:199], a[8:11], v[28:31], v[196:199]
    ds_read_b64_tr_b16 a[6:7], v15 offset:2304
    v_exp_f32 v42, v42
    v_mfma_f32_16x16x32_bf16 v[200:203], a[12:15], v[24:27], v[200:203]
    ds_read_b64_tr_b16 a[8:9], v16 offset:256
    v_exp_f32 v43, v43
    v_mfma_f32_16x16x32_bf16 v[204:207], a[12:15], v[28:31], v[204:207]
    ds_read_b64_tr_b16 a[10:11], v16 offset:2304
    v_cvt_pk_bf16_f32 v32, v40, v41
    s_waitcnt lgkmcnt(4)
    v_mfma_f32_16x16x32_bf16 v[208:211], a[16:19], v[24:27], v[208:211]
    ds_read_b64_tr_b16 a[12:13], v17 offset:256
    v_exp_f32 v44, v44
    v_mfma_f32_16x16x32_bf16 v[212:215], a[16:19], v[28:31], v[212:215]
    ds_read_b64_tr_b16 a[14:15], v17 offset:2304
    v_exp_f32 v45, v45
    v_mfma_f32_16x16x32_bf16 v[216:219], a[0:3], v[24:27], v[216:219]
    ds_read_b64_tr_b16 a[16:17], v18 offset:256
    v_cvt_pk_bf16_f32 v33, v42, v43
    v_mfma_f32_16x16x32_bf16 v[220:223], a[0:3], v[28:31], v[220:223]
    ds_read_b64_tr_b16 a[18:19], v18 offset:2304
    s_waitcnt lgkmcnt(4)
    v_mfma_f32_16x16x32_bf16 v[224:227], a[4:7], v[24:27], v[224:227]
    s_waitcnt vmcnt(14)
    s_barrier
    ds_read_b128 a[0:3], v7 offset:0
    v_mfma_f32_16x16x32_bf16 v[228:231], a[4:7], v[28:31], v[228:231]
    s_add_u32 m0, s29, 98304
    s_mov_b32 s30, 425984
    v_mfma_f32_16x16x32_bf16 v[232:235], a[8:11], v[24:27], v[232:235]
    ds_read_b128 a[4:7], v8 offset:0
    buffer_load_dwordx4 v21, s[12:15], s30 offen offset:2048 nt lds
    v_mfma_f32_16x16x32_bf16 v[236:239], a[8:11], v[28:31], v[236:239]
    v_exp_f32 v46, v46
    s_waitcnt lgkmcnt(2)
    v_mfma_f32_16x16x32_bf16 v[240:243], a[12:15], v[24:27], v[240:243]
    ds_read_b128 a[8:11], v9 offset:0
    v_exp_f32 v47, v47
    v_mfma_f32_16x16x32_bf16 v[244:247], a[12:15], v[28:31], v[244:247]
    v_cvt_pk_bf16_f32 v36, v44, v45
    s_nop 0
    v_cvt_pk_bf16_f32 v37, v46, v47
    v_mfma_f32_16x16x32_bf16 v[248:251], a[16:19], v[24:27], v[248:251]
    ds_read_b128 a[12:15], v10 offset:0
    v_mfma_f32_16x16x32_bf16 v[252:255], a[16:19], v[28:31], v[252:255]
    buffer_load_dwordx4 v22, s[12:15], s30 offen offset:3072 nt lds
    s_cbranch_vccnz L_rs_24
L_rsb_24:
    s_waitcnt lgkmcnt(2)
    v_mfma_f32_16x16x32_bf16 v[40:43], a[0:3], v[64:67], v[56:59]
    ds_read_b128 a[16:19], v7 offset:256
    v_exp_f32 v48, v48
    v_mfma_f32_16x16x32_bf16 v[44:47], a[0:3], v[68:71], v[60:63]
    v_exp_f32 v49, v49
    v_mfma_f32_16x16x32_bf16 v[40:43], a[4:7], v[72:75], v[40:43]
    ds_read_b128 a[0:3], v8 offset:256
    v_exp_f32 v50, v50
    v_mfma_f32_16x16x32_bf16 v[44:47], a[4:7], v[76:79], v[44:47]
    v_exp_f32 v51, v51
    s_waitcnt lgkmcnt(2)
    v_mfma_f32_16x16x32_bf16 v[40:43], a[8:11], v[80:83], v[40:43]
    ds_read_b128 a[4:7], v9 offset:256
    v_cvt_pk_bf16_f32 v34, v48, v49
    v_mfma_f32_16x16x32_bf16 v[44:47], a[8:11], v[84:87], v[44:47]
    v_exp_f32 v52, v52
    v_mfma_f32_16x16x32_bf16 v[40:43], a[12:15], v[88:91], v[40:43]
    ds_read_b128 a[8:11], v10 offset:256
    s_add_u32 m0, s29, 32768
    v_mfma_f32_16x16x32_bf16 v[44:47], a[12:15], v[92:95], v[44:47]
    s_mov_b32 s30, 458752
    s_waitcnt lgkmcnt(2)
    v_mfma_f32_16x16x32_bf16 v[40:43], a[16:19], v[96:99], v[40:43]
    ds_read_b128 a[12:15], v7 offset:2048
    buffer_load_dwordx4 v19, s[8:11], s30 offen offset:0 nt lds
    v_mfma_f32_16x16x32_bf16 v[44:47], a[16:19], v[100:103], v[44:47]
    v_exp_f32 v53, v53
    v_cvt_pk_bf16_f32 v35, v50, v51
    v_mfma_f32_16x16x32_bf16 v[40:43], a[0:3], v[104:107], v[40:43]
    ds_read_b128 a[16:19], v8 offset:2048
    v_exp_f32 v54, v54
    v_mfma_f32_16x16x32_bf16 v[44:47], a[0:3], v[108:111], v[44:47]
    v_exp_f32 v55, v55
    s_waitcnt lgkmcnt(2)
    v_mfma_f32_16x16x32_bf16 v[40:43], a[4:7], v[112:115], v[40:43]
    ds_read_b128 a[0:3], v9 offset:2048
    v_cvt_pk_bf16_f32 v38, v52, v53
    s_nop 0
    v_mfma_f32_16x16x32_bf16 v[44:47], a[4:7], v[116:119], v[44:47]
    buffer_load_dwordx4 v20, s[8:11], s30 offen offset:1024 nt lds
    v_cvt_pk_bf16_f32 v39, v54, v55
    v_mfma_f32_16x16x32_bf16 v[40:43], a[8:11], v[120:123], v[40:43]
    ds_read_b128 a[4:7], v10 offset:2048
    v_mfma_f32_16x16x32_bf16 v[44:47], a[8:11], v[124:127], v[44:47]
    s_waitcnt lgkmcnt(2)
    v_mfma_f32_16x16x32_bf16 v[48:51], a[12:15], v[64:67], v[56:59]
    ds_read_b128 a[8:11], v7 offset:2304
    v_mfma_f32_16x16x32_bf16 v[52:55], a[12:15], v[68:71], v[60:63]
    v_mfma_f32_16x16x32_bf16 v[48:51], a[16:19], v[72:75], v[48:51]
    ds_read_b128 a[12:15], v8 offset:2304
    v_mfma_f32_16x16x32_bf16 v[52:55], a[16:19], v[76:79], v[52:55]
    s_waitcnt lgkmcnt(2)
    v_mfma_f32_16x16x32_bf16 v[48:51], a[0:3], v[80:83], v[48:51]
    ds_read_b128 a[16:19], v9 offset:2304
    v_mfma_f32_16x16x32_bf16 v[52:55], a[0:3], v[84:87], v[52:55]
    v_mfma_f32_16x16x32_bf16 v[48:51], a[4:7], v[88:91], v[48:51]
    ds_read_b128 a[0:3], v10 offset:2304
    v_max3_f32 v0, v40, v41, v42
    v_mfma_f32_16x16x32_bf16 v[52:55], a[4:7], v[92:95], v[52:55]
    v_max3_f32 v1, v43, v44, v45
    s_waitcnt lgkmcnt(2)
    v_mfma_f32_16x16x32_bf16 v[48:51], a[8:11], v[96:99], v[48:51]
    s_waitcnt vmcnt(14)
    s_barrier
    ds_read_b64_tr_b16 a[4:5], v11 offset:16384
    v_mfma_f32_16x16x32_bf16 v[52:55], a[8:11], v[100:103], v[52:55]
    ds_read_b64_tr_b16 a[6:7], v11 offset:18432
    buffer_load_dwordx4 v19, s[8:11], s30 offen offset:2048 nt lds
    v_mfma_f32_16x16x32_bf16 v[48:51], a[12:15], v[104:107], v[48:51]
    ds_read_b64_tr_b16 a[8:9], v12 offset:16384
    v_max3_f32 v0, v0, v46, v47
    v_mfma_f32_16x16x32_bf16 v[52:55], a[12:15], v[108:111], v[52:55]
    ds_read_b64_tr_b16 a[10:11], v12 offset:18432
    s_waitcnt lgkmcnt(4)
    v_mfma_f32_16x16x32_bf16 v[48:51], a[16:19], v[112:115], v[48:51]
    v_mfma_f32_16x16x32_bf16 v[52:55], a[16:19], v[116:119], v[52:55]
    v_mfma_f32_16x16x32_bf16 v[48:51], a[0:3], v[120:123], v[48:51]
    ds_read_b64_tr_b16 a[12:13], v13 offset:16384
    v_mfma_f32_16x16x32_bf16 v[52:55], a[0:3], v[124:127], v[52:55]
    ds_read_b64_tr_b16 a[14:15], v13 offset:18432
    s_waitcnt lgkmcnt(2)
    v_mfma_f32_16x16x32_bf16 v[128:131], a[4:7], v[32:35], v[128:131]
    ds_read_b64_tr_b16 a[16:17], v14 offset:16384
    buffer_load_dwordx4 v20, s[8:11], s30 offen offset:3072 nt lds
    v_mfma_f32_16x16x32_bf16 v[132:135], a[4:7], v[36:39], v[132:135]
    ds_read_b64_tr_b16 a[18:19], v14 offset:18432
    v_mfma_f32_16x16x32_bf16 v[136:139], a[8:11], v[32:35], v[136:139]
    ds_read_b64_tr_b16 a[0:1], v15 offset:16384
    v_mfma_f32_16x16x32_bf16 v[140:143], a[8:11], v[36:39], v[140:143]
    ds_read_b64_tr_b16 a[2:3], v15 offset:18432
    v_max3_f32 v1, v1, v48, v49
    v_max3_f32 v0, v0, v50, v51
    v_mfma_f32_16x16x32_bf16 a[20:23], a[28:31], v[32:35], a[20:23]
    ds_read_b64_tr_b16 a[4:5], v16 offset:16384
    v_max3_f32 v1, v1, v52, v53
    v_max3_f32 v0, v0, v54, v55
    v_mfma_f32_16x16x32_bf16 a[24:27], a[28:31], v[36:39], a[24:27]
    ds_read_b64_tr_b16 a[6:7], v16 offset:18432
    v_max_f32 v0, v0, v1
    s_waitcnt lgkmcnt(4)
    v_mfma_f32_16x16x32_bf16 v[144:147], a[12:15], v[32:35], v[144:147]
    ds_read_b64_tr_b16 a[8:9], v17 offset:16384
    v_cmp_lt_f32 vcc, s31, v0
    s_cbranch_vccnz L_up_25
L_upb_25:
    v_mfma_f32_16x16x32_bf16 v[148:151], a[12:15], v[36:39], v[148:151]
    ds_read_b64_tr_b16 a[10:11], v17 offset:18432
    v_exp_f32 v40, v40
    v_mfma_f32_16x16x32_bf16 v[152:155], a[16:19], v[32:35], v[152:155]
    ds_read_b64_tr_b16 a[12:13], v18 offset:16384
    s_add_u32 m0, s29, 65536
    v_mfma_f32_16x16x32_bf16 v[156:159], a[16:19], v[36:39], v[156:159]
    ds_read_b64_tr_b16 a[14:15], v18 offset:18432
    s_waitcnt lgkmcnt(4)
    v_mfma_f32_16x16x32_bf16 v[160:163], a[0:3], v[32:35], v[160:163]
    ds_read_b64_tr_b16 a[16:17], v11 offset:16640
    s_mov_b32 s30, 442368
    v_mfma_f32_16x16x32_bf16 v[164:167], a[0:3], v[36:39], v[164:167]
    ds_read_b64_tr_b16 a[18:19], v11 offset:18688
    buffer_load_dwordx4 v21, s[12:15], s30 offen offset:0 nt lds
    v_mfma_f32_16x16x32_bf16 v[168:171], a[4:7], v[32:35], v[168:171]
    ds_read_b64_tr_b16 a[0:1], v12 offset:16640
    v_exp_f32 v41, v41
    v_mfma_f32_16x16x32_bf16 v[172:175], a[4:7], v[36:39], v[172:175]
    ds_read_b64_tr_b16 a[2:3], v12 offset:18688
    s_waitcnt lgkmcnt(4)
    v_mfma_f32_16x16x32_bf16 v[176:179], a[8:11], v[32:35], v[176:179]
    ds_read_b64_tr_b16 a[4:5], v13 offset:16640
    v_exp_f32 v42, v42
    v_mfma_f32_16x16x32_bf16 v[180:183], a[8:11], v[36:39], v[180:183]
    ds_read_b64_tr_b16 a[6:7], v13 offset:18688
    v_exp_f32 v43, v43
    v_mfma_f32_16x16x32_bf16 v[184:187], a[12:15], v[32:35], v[184:187]
    ds_read_b64_tr_b16 a[8:9], v14 offset:16640
    buffer_load_dwordx4 v22, s[12:15], s30 offen offset:1024 nt lds
    v_cvt_pk_bf16_f32 v24, v40, v41
    v_mfma_f32_16x16x32_bf16 v[188:191], a[12:15], v[36:39], v[188:191]
    ds_read_b64_tr_b16 a[10:11], v14 offset:18688
    s_waitcnt lgkmcnt(4)
    v_mfma_f32_16x16x32_bf16 v[192:195], a[16:19], v[32:35], v[192:195]
    ds_read_b64_tr_b16 a[12:13], v15 offset:16640
    v_exp_f32 v44, v44
    v_mfma_f32_16x16x32_bf16 v[196:199], a[16:19], v[36:39], v[196:199]
    ds_read_b64_tr_b16 a[14:15], v15 offset:18688
    v_exp_f32 v45, v45
    v_mfma_f32_16x16x32_bf16 v[200:203], a[0:3], v[32:35], v[200:203]
    ds_read_b64_tr_b16 a[16:17], v16 offset:16640
    v_cvt_pk_bf16_f32 v25, v42, v43
    v_mfma_f32_16x16x32_bf16 v[204:207], a[0:3], v[36:39], v[204:207]
    ds_read_b64_tr_b16 a[18:19], v16 offset:18688
    s_waitcnt lgkmcnt(4)
    v_mfma_f32_16x16x32_bf16 v[208:211], a[4:7], v[32:35], v[208:211]
    ds_read_b64_tr_b16 a[0:1], v17 offset:16640
    v_exp_f32 v46, v46
    v_mfma_f32_16x16x32_bf16 v[212:215], a[4:7], v[36:39], v[212:215]
    ds_read_b64_tr_b16 a[2:3], v17 offset:18688
    v_exp_f32 v47, v47
    v_mfma_f32_16x16x32_bf16 v[216:219], a[8:11], v[32:35], v[216:219]
    ds_read_b64_tr_b16 a[4:5], v18 offset:16640
    v_cvt_pk_bf16_f32 v28, v44, v45
    s_nop 0
    v_mfma_f32_16x16x32_bf16 v[220:223], a[8:11], v[36:39], v[220:223]
    ds_read_b64_tr_b16 a[6:7], v18 offset:18688
    v_cvt_pk_bf16_f32 v29, v46, v47
    s_waitcnt lgkmcnt(4)
    v_mfma_f32_16x16x32_bf16 v[224:227], a[12:15], v[32:35], v[224:227]
    s_waitcnt vmcnt(8)
    s_barrier
    ds_read_b128 a[8:11], v7 offset:16384
    v_mfma_f32_16x16x32_bf16 v[228:231], a[12:15], v[36:39], v[228:231]
    buffer_load_dwordx4 v21, s[12:15], s30 offen offset:2048 nt lds
    v_mfma_f32_16x16x32_bf16 v[232:235], a[16:19], v[32:35], v[232:235]
    ds_read_b128 a[12:15], v8 offset:16384
    v_mfma_f32_16x16x32_bf16 v[236:239], a[16:19], v[36:39], v[236:239]
    s_waitcnt lgkmcnt(2)
    v_mfma_f32_16x16x32_bf16 v[240:243], a[0:3], v[32:35], v[240:243]
    ds_read_b128 a[16:19], v9 offset:16384
    v_mfma_f32_16x16x32_bf16 v[244:247], a[0:3], v[36:39], v[244:247]
    v_mfma_f32_16x16x32_bf16 v[248:251], a[4:7], v[32:35], v[248:251]
    ds_read_b128 a[0:3], v10 offset:16384
    v_mfma_f32_16x16x32_bf16 v[252:255], a[4:7], v[36:39], v[252:255]
    s_cbranch_vccnz L_rs_25
L_rsb_25:
    s_waitcnt lgkmcnt(2)
    v_mfma_f32_16x16x32_bf16 v[40:43], a[8:11], v[64:67], v[56:59]
    ds_read_b128 a[4:7], v7 offset:16640
    v_exp_f32 v48, v48
    v_mfma_f32_16x16x32_bf16 v[44:47], a[8:11], v[68:71], v[60:63]
    v_exp_f32 v49, v49
    v_mfma_f32_16x16x32_bf16 v[40:43], a[12:15], v[72:75], v[40:43]
    ds_read_b128 a[8:11], v8 offset:16640
    buffer_load_dwordx4 v22, s[12:15], s30 offen offset:3072 nt lds
    v_mfma_f32_16x16x32_bf16 v[44:47], a[12:15], v[76:79], v[44:47]
    v_exp_f32 v50, v50
    s_waitcnt lgkmcnt(2)
    v_mfma_f32_16x16x32_bf16 v[40:43], a[16:19], v[80:83], v[40:43]
    ds_read_b128 a[12:15], v9 offset:16640
    v_exp_f32 v51, v51
    v_mfma_f32_16x16x32_bf16 v[44:47], a[16:19], v[84:87], v[44:47]
    v_cvt_pk_bf16_f32 v26, v48, v49
    v_exp_f32 v52, v52
    v_mfma_f32_16x16x32_bf16 v[40:43], a[0:3], v[88:91], v[40:43]
    ds_read_b128 a[16:19], v10 offset:16640
    v_exp_f32 v53, v53
    v_mfma_f32_16x16x32_bf16 v[44:47], a[0:3], v[92:95], v[44:47]
    v_cvt_pk_bf16_f32 v27, v50, v51
    v_add_u32 v3, 131072, v2
    s_waitcnt lgkmcnt(2)
    v_mfma_f32_16x16x32_bf16 v[40:43], a[4:7], v[96:99], v[40:43]
    ds_read_b128 a[0:3], v7 offset:18432
    v_exp_f32 v54, v54
    v_mfma_f32_16x16x32_bf16 v[44:47], a[4:7], v[100:103], v[44:47]
    v_exp_f32 v55, v55
    v_cvt_pk_bf16_f32 v30, v52, v53
    v_mfma_f32_16x16x32_bf16 v[40:43], a[8:11], v[104:107], v[40:43]
    ds_read_b128 a[4:7], v8 offset:18432
    s_nop 0
    v_cvt_pk_bf16_f32 v31, v54, v55
    v_mfma_f32_16x16x32_bf16 v[44:47], a[8:11], v[108:111], v[44:47]
    ds_read_b64_tr_b16 a[224:225], v3 offset:0
    s_waitcnt lgkmcnt(3)
    v_mfma_f32_16x16x32_bf16 v[40:43], a[12:15], v[112:115], v[40:43]
    ds_read_b128 a[8:11], v9 offset:18432
    s_add_u32 m0, s29, 0
    v_mfma_f32_16x16x32_bf16 v[44:47], a[12:15], v[116:119], v[44:47]
    s_mov_b32 s30, 475136
    buffer_load_dwordx4 v19, s[8:11], s30 offen offset:0 nt lds
    ds_read_b64_tr_b16 a[226:227], v3 offset:2048
    v_mfma_f32_16x16x32_bf16 v[40:43], a[16:19], v[120:123], v[40:43]
    ds_read_b128 a[12:15], v10 offset:18432
    v_mfma_f32_16x16x32_bf16 v[44:47], a[16:19], v[124:127], v[44:47]
    ds_read_b64_tr_b16 a[228:229], v3 offset:4096
    s_waitcnt lgkmcnt(5)
    v_mfma_f32_16x16x32_bf16 v[48:51], a[0:3], v[64:67], v[56:59]
    ds_read_b128 a[16:19], v7 offset:18688
    v_mfma_f32_16x16x32_bf16 v[52:55], a[0:3], v[68:71], v[60:63]
    ds_read_b64_tr_b16 a[230:231], v3 offset:6144
    v_mfma_f32_16x16x32_bf16 v[48:51], a[4:7], v[72:75], v[48:51]
    ds_read_b128 a[0:3], v8 offset:18688
    v_mfma_f32_16x16x32_bf16 v[52:55], a[4:7], v[76:79], v[52:55]
    ds_read_b64_tr_b16 a[232:233], v3 offset:8192
    s_waitcnt lgkmcnt(5)
    v_mfma_f32_16x16x32_bf16 v[48:51], a[8:11], v[80:83], v[48:51]
    ds_read_b128 a[4:7], v9 offset:18688
    v_mfma_f32_16x16x32_bf16 v[52:55], a[8:11], v[84:87], v[52:55]
    ds_read_b64_tr_b16 a[234:235], v3 offset:10240
    v_mfma_f32_16x16x32_bf16 v[48:51], a[12:15], v[88:91], v[48:51]
    ds_read_b128 a[8:11], v10 offset:18688
    v_max3_f32 v0, v40, v41, v42
    v_mfma_f32_16x16x32_bf16 v[52:55], a[12:15], v[92:95], v[52:55]
    ds_read_b64_tr_b16 a[236:237], v3 offset:12288
    s_waitcnt lgkmcnt(5)
    v_mfma_f32_16x16x32_bf16 v[48:51], a[16:19], v[96:99], v[48:51]
    s_waitcnt vmcnt(9)
    s_barrier
    ds_read_b64_tr_b16 a[12:13], v11 offset:32768
    v_mfma_f32_16x16x32_bf16 v[52:55], a[16:19], v[100:103], v[52:55]
    ds_read_b64_tr_b16 a[14:15], v11 offset:34816
    buffer_load_dwordx4 v20, s[8:11], s30 offen offset:1024 nt lds
    v_mfma_f32_16x16x32_bf16 v[48:51], a[0:3], v[104:107], v[48:51]
    ds_read_b64_tr_b16 a[16:17], v12 offset:32768
    v_max3_f32 v1, v43, v44, v45
    v_mfma_f32_16x16x32_bf16 v[52:55], a[0:3], v[108:111], v[52:55]
    ds_read_b64_tr_b16 a[18:19], v12 offset:34816
    s_waitcnt lgkmcnt(5)
    v_mfma_f32_16x16x32_bf16 v[48:51], a[4:7], v[112:115], v[48:51]
    buffer_load_dwordx4 v19, s[8:11], s30 offen offset:2048 nt lds
    ds_read_b64_tr_b16 a[238:239], v3 offset:14336
    v_mfma_f32_16x16x32_bf16 v[52:55], a[4:7], v[116:119], v[52:55]
    v_max3_f32 v0, v0, v46, v47
    v_mfma_f32_16x16x32_bf16 v[48:51], a[8:11], v[120:123], v[48:51]
    ds_read_b64_tr_b16 a[0:1], v13 offset:32768
    v_mfma_f32_16x16x32_bf16 v[52:55], a[8:11], v[124:127], v[52:55]
    ds_read_b64_tr_b16 a[2:3], v13 offset:34816
    s_waitcnt lgkmcnt(3)
    v_mfma_f32_16x16x32_bf16 v[128:131], a[12:15], v[24:27], v[128:131]
    ds_read_b64_tr_b16 a[4:5], v14 offset:32768
    buffer_load_dwordx4 v20, s[8:11], s30 offen offset:3072 nt lds
    v_mfma_f32_16x16x32_bf16 v[132:135], a[12:15], v[28:31], v[132:135]
    ds_read_b64_tr_b16 a[6:7], v14 offset:34816
    v_mfma_f32_16x16x32_bf16 v[136:139], a[16:19], v[24:27], v[136:139]
    ds_read_b64_tr_b16 a[8:9], v15 offset:32768
    v_mfma_f32_16x16x32_bf16 v[140:143], a[16:19], v[28:31], v[140:143]
    ds_read_b64_tr_b16 a[10:11], v15 offset:34816
    v_max3_f32 v1, v1, v48, v49
    v_max3_f32 v0, v0, v50, v51
    v_max3_f32 v1, v1, v52, v53
    v_mfma_f32_16x16x32_bf16 a[20:23], a[28:31], v[24:27], a[20:23]
    ds_read_b64_tr_b16 a[12:13], v16 offset:32768
    s_add_u32 m0, s29, 81920
    v_max3_f32 v0, v0, v54, v55
    v_max_f32 v0, v0, v1
    v_mfma_f32_16x16x32_bf16 a[24:27], a[28:31], v[28:31], a[24:27]
    ds_read_b64_tr_b16 a[14:15], v16 offset:34816
    v_cmp_lt_f32 vcc, s31, v0
    s_cbranch_vccnz L_up_26
L_upb_26:
    s_waitcnt lgkmcnt(4)
    v_mfma_f32_16x16x32_bf16 v[144:147], a[0:3], v[24:27], v[144:147]
    ds_read_b64_tr_b16 a[16:17], v17 offset:32768
    s_mov_b32 s30, 458752
    v_exp_f32 v40, v40
    v_mfma_f32_16x16x32_bf16 v[148:151], a[0:3], v[28:31], v[148:151]
    ds_read_b64_tr_b16 a[18:19], v17 offset:34816
    buffer_load_dwordx4 v21, s[12:15], s30 offen offset:0 nt lds
    v_exp_f32 v41, v41
    v_mfma_f32_16x16x32_bf16 v[152:155], a[4:7], v[24:27], v[152:155]
    ds_read_b64_tr_b16 a[0:1], v18 offset:32768
    s_add_u32 m0, s29, 147456
    v_exp_f32 v42, v42
    v_mfma_f32_16x16x32_bf16 v[156:159], a[4:7], v[28:31], v[156:159]
    ds_read_b64_tr_b16 a[2:3], v18 offset:34816
    v_exp_f32 v43, v43
    s_waitcnt lgkmcnt(4)
    v_mfma_f32_16x16x32_bf16 v[160:163], a[8:11], v[24:27], v[160:163]
    ds_read_b64_tr_b16 a[4:5], v11 offset:33024
    s_add_u32 s30, s82, 114688
    v_cvt_pk_bf16_f32 v32, v40, v41
    v_mfma_f32_16x16x32_bf16 v[164:167], a[8:11], v[28:31], v[164:167]
    ds_read_b64_tr_b16 a[6:7], v11 offset:35072
    buffer_load_dwordx4 v23, s[20:23], s30 offen offset:0  lds
    v_exp_f32 v44, v44
    v_mfma_f32_16x16x32_bf16 v[168:171], a[12:15], v[24:27], v[168:171]
    ds_read_b64_tr_b16 a[8:9], v12 offset:33024
    s_add_u32 s30, s82, 120832
    v_exp_f32 v45, v45
    v_mfma_f32_16x16x32_bf16 v[172:175], a[12:15], v[28:31], v[172:175]
    ds_read_b64_tr_b16 a[10:11], v12 offset:35072
    v_cvt_pk_bf16_f32 v33, v42, v43
    s_waitcnt lgkmcnt(4)
    v_mfma_f32_16x16x32_bf16 v[176:179], a[16:19], v[24:27], v[176:179]
    ds_read_b64_tr_b16 a[12:13], v13 offset:33024
    buffer_load_dwordx4 v23, s[20:23], s30 offen offset:1024  lds
    v_exp_f32 v46, v46
    v_mfma_f32_16x16x32_bf16 v[180:183], a[16:19], v[28:31], v[180:183]
    ds_read_b64_tr_b16 a[14:15], v13 offset:35072
    v_exp_f32 v47, v47
    v_cvt_pk_bf16_f32 v36, v44, v45
    v_mfma_f32_16x16x32_bf16 v[184:187], a[0:3], v[24:27], v[184:187]
    ds_read_b64_tr_b16 a[16:17], v14 offset:33024
    s_add_u32 s30, s82, 126976
    s_nop 0
    v_cvt_pk_bf16_f32 v37, v46, v47
    v_mfma_f32_16x16x32_bf16 v[188:191], a[0:3], v[28:31], v[188:191]
    ds_read_b64_tr_b16 a[18:19], v14 offset:35072
    s_waitcnt lgkmcnt(4)
    v_mfma_f32_16x16x32_bf16 v[192:195], a[4:7], v[24:27], v[192:195]
    ds_read_b64_tr_b16 a[0:1], v15 offset:33024
    buffer_load_dwordx4 v23, s[20:23], s30 offen offset:2048  lds
    v_mfma_f32_16x16x32_bf16 v[196:199], a[4:7], v[28:31], v[196:199]
    ds_read_b64_tr_b16 a[2:3], v15 offset:35072
    v_mfma_f32_16x16x32_bf16 v[200:203], a[8:11], v[24:27], v[200:203]
    ds_read_b64_tr_b16 a[4:5], v16 offset:33024
    s_add_u32 s30, s82, 133120
    v_mfma_f32_16x16x32_bf16 v[204:207], a[8:11], v[28:31], v[204:207]
    ds_read_b64_tr_b16 a[6:7], v16 offset:35072
    s_waitcnt lgkmcnt(4)
    v_mfma_f32_16x16x32_bf16 v[208:211], a[12:15], v[24:27], v[208:211]
    ds_read_b64_tr_b16 a[8:9], v17 offset:33024
    buffer_load_dwordx4 v23, s[20:23], s30 offen offset:3072  lds
    v_mfma_f32_16x16x32_bf16 v[212:215], a[12:15], v[28:31], v[212:215]
    ds_read_b64_tr_b16 a[10:11], v17 offset:35072
    v_mfma_f32_16x16x32_bf16 v[216:219], a[16:19], v[24:27], v[216:219]
    ds_read_b64_tr_b16 a[12:13], v18 offset:33024
    v_mfma_f32_16x16x32_bf16 v[220:223], a[16:19], v[28:31], v[220:223]
    ds_read_b64_tr_b16 a[14:15], v18 offset:35072
    s_waitcnt lgkmcnt(4)
    v_mfma_f32_16x16x32_bf16 v[224:227], a[0:3], v[24:27], v[224:227]
    s_waitcnt vmcnt(13)
    s_barrier
    ds_read_b128 a[16:19], v7 offset:32768
    v_mfma_f32_16x16x32_bf16 v[228:231], a[0:3], v[28:31], v[228:231]
    s_add_u32 m0, s29, 81920
    s_mov_b32 s30, 458752
    v_mfma_f32_16x16x32_bf16 v[232:235], a[4:7], v[24:27], v[232:235]
    ds_read_b128 a[0:3], v8 offset:32768
    buffer_load_dwordx4 v22, s[12:15], s30 offen offset:1024 nt lds
    v_mfma_f32_16x16x32_bf16 v[236:239], a[4:7], v[28:31], v[236:239]
    s_waitcnt lgkmcnt(2)
    v_mfma_f32_16x16x32_bf16 v[240:243], a[8:11], v[24:27], v[240:243]
    ds_read_b128 a[4:7], v9 offset:32768
    v_mfma_f32_16x16x32_bf16 v[244:247], a[8:11], v[28:31], v[244:247]
    v_mfma_f32_16x16x32_bf16 v[248:251], a[12:15], v[24:27], v[248:251]
    ds_read_b128 a[8:11], v10 offset:32768
    v_mfma_f32_16x16x32_bf16 v[252:255], a[12:15], v[28:31], v[252:255]
    buffer_load_dwordx4 v21, s[12:15], s30 offen offset:2048 nt lds
    s_cbranch_vccnz L_rs_26
L_rsb_26:
    s_waitcnt lgkmcnt(2)
    v_mfma_f32_16x16x32_bf16 v[40:43], a[16:19], v[64:67], v[56:59]
    ds_read_b128 a[12:15], v7 offset:33024
    v_exp_f32 v48, v48
    v_mfma_f32_16x16x32_bf16 v[44:47], a[16:19], v[68:71], v[60:63]
    v_exp_f32 v49, v49
    v_mfma_f32_16x16x32_bf16 v[40:43], a[0:3], v[72:75], v[40:43]
    ds_read_b128 a[16:19], v8 offset:33024
    v_exp_f32 v50, v50
    v_mfma_f32_16x16x32_bf16 v[44:47], a[0:3], v[76:79], v[44:47]
    v_exp_f32 v51, v51
    s_waitcnt lgkmcnt(2)
    v_mfma_f32_16x16x32_bf16 v[40:43], a[4:7], v[80:83], v[40:43]
    ds_read_b128 a[0:3], v9 offset:33024
    v_cvt_pk_bf16_f32 v34, v48, v49
    v_mfma_f32_16x16x32_bf16 v[44:47], a[4:7], v[84:87], v[44:47]
    v_exp_f32 v52, v52
    v_mfma_f32_16x16x32_bf16 v[40:43], a[8:11], v[88:91], v[40:43]
    ds_read_b128 a[4:7], v10 offset:33024
    buffer_load_dwordx4 v22, s[12:15], s30 offen offset:3072 nt lds
    v_mfma_f32_16x16x32_bf16 v[44:47], a[8:11], v[92:95], v[44:47]
    v_exp_f32 v53, v53
    s_waitcnt lgkmcnt(2)
    v_mfma_f32_16x16x32_bf16 v[40:43], a[12:15], v[96:99], v[40:43]
    ds_read_b128 a[8:11], v7 offset:34816
    v_cvt_pk_bf16_f32 v35, v50, v51
    v_mfma_f32_16x16x32_bf16 v[44:47], a[12:15], v[100:103], v[44:47]
    v_exp_f32 v54, v54
    v_mfma_f32_16x16x32_bf16 v[40:43], a[16:19], v[104:107], v[40:43]
    ds_read_b128 a[12:15], v8 offset:34816
    v_exp_f32 v55, v55
    v_mfma_f32_16x16x32_bf16 v[44:47], a[16:19], v[108:111], v[44:47]
    v_cvt_pk_bf16_f32 v38, v52, v53
    s_nop 0
    s_waitcnt lgkmcnt(2)
    v_mfma_f32_16x16x32_bf16 v[40:43], a[0:3], v[112:115], v[40:43]
    ds_read_b128 a[16:19], v9 offset:34816
    v_cvt_pk_bf16_f32 v39, v54, v55
    v_mfma_f32_16x16x32_bf16 v[44:47], a[0:3], v[116:119], v[44:47]
    s_add_u32 m0, s29, 16384
    s_mov_b32 s30, 491520
    v_mfma_f32_16x16x32_bf16 v[40:43], a[4:7], v[120:123], v[40:43]
    ds_read_b128 a[0:3], v10 offset:34816
    buffer_load_dwordx4 v19, s[8:11], s30 offen offset:0 nt lds
    v_mfma_f32_16x16x32_bf16 v[44:47], a[4:7], v[124:127], v[44:47]
    s_waitcnt lgkmcnt(2)
    v_mfma_f32_16x16x32_bf16 v[48:51], a[8:11], v[64:67], v[56:59]
    ds_read_b128 a[4:7], v7 offset:35072
    v_mfma_f32_16x16x32_bf16 v[52:55], a[8:11], v[68:71], v[60:63]
    v_mfma_f32_16x16x32_bf16 v[48:51], a[12:15], v[72:75], v[48:51]
    ds_read_b128 a[8:11], v8 offset:35072
    v_mfma_f32_16x16x32_bf16 v[52:55], a[12:15], v[76:79], v[52:55]
    s_waitcnt lgkmcnt(2)
    v_mfma_f32_16x16x32_bf16 v[48:51], a[16:19], v[80:83], v[48:51]
    ds_read_b128 a[12:15], v9 offset:35072
    v_mfma_f32_16x16x32_bf16 v[52:55], a[16:19], v[84:87], v[52:55]
    v_mfma_f32_16x16x32_bf16 v[48:51], a[0:3], v[88:91], v[48:51]
    ds_read_b128 a[16:19], v10 offset:35072
    v_max3_f32 v0, v40, v41, v42
    v_mfma_f32_16x16x32_bf16 v[52:55], a[0:3], v[92:95], v[52:55]
    v_max3_f32 v1, v43, v44, v45
    s_waitcnt lgkmcnt(2)
    v_mfma_f32_16x16x32_bf16 v[48:51], a[4:7], v[96:99], v[48:51]
    s_waitcnt vmcnt(13)
    s_barrier
    ds_read_b64_tr_b16 a[0:1], v11 offset:0
    v_mfma_f32_16x16x32_bf16 v[52:55], a[4:7], v[100:103], v[52:55]
    ds_read_b64_tr_b16 a[2:3], v11 offset:2048
    buffer_load_dwordx4 v20, s[8:11], s30 offen offset:1024 nt lds
    v_mfma_f32_16x16x32_bf16 v[48:51], a[8:11], v[104:107], v[48:51]
    ds_read_b64_tr_b16 a[4:5], v12 offset:0
    v_max3_f32 v0, v0, v46, v47
    v_mfma_f32_16x16x32_bf16 v[52:55], a[8:11], v[108:111], v[52:55]
    ds_read_b64_tr_b16 a[6:7], v12 offset:2048
    s_waitcnt lgkmcnt(4)
    v_mfma_f32_16x16x32_bf16 v[48:51], a[12:15], v[112:115], v[48:51]
    v_mfma_f32_16x16x32_bf16 v[52:55], a[12:15], v[116:119], v[52:55]
    v_mfma_f32_16x16x32_bf16 v[48:51], a[16:19], v[120:123], v[48:51]
    ds_read_b64_tr_b16 a[8:9], v13 offset:0
    v_mfma_f32_16x16x32_bf16 v[52:55], a[16:19], v[124:127], v[52:55]
    ds_read_b64_tr_b16 a[10:11], v13 offset:2048
    s_waitcnt lgkmcnt(2)
    v_mfma_f32_16x16x32_bf16 v[128:131], a[0:3], v[32:35], v[128:131]
    ds_read_b64_tr_b16 a[12:13], v14 offset:0
    v_mfma_f32_16x16x32_bf16 v[132:135], a[0:3], v[36:39], v[132:135]
    ds_read_b64_tr_b16 a[14:15], v14 offset:2048
    v_mfma_f32_16x16x32_bf16 v[136:139], a[4:7], v[32:35], v[136:139]
    ds_read_b64_tr_b16 a[16:17], v15 offset:0
    buffer_load_dwordx4 v19, s[8:11], s30 offen offset:2048 nt lds
    v_mfma_f32_16x16x32_bf16 v[140:143], a[4:7], v[36:39], v[140:143]
    ds_read_b64_tr_b16 a[18:19], v15 offset:2048
    v_max3_f32 v1, v1, v48, v49
    v_max3_f32 v0, v0, v50, v51
    v_mfma_f32_16x16x32_bf16 a[20:23], a[28:31], v[32:35], a[20:23]
    ds_read_b64_tr_b16 a[0:1], v16 offset:0
    v_max3_f32 v1, v1, v52, v53
    v_max3_f32 v0, v0, v54, v55
    v_mfma_f32_16x16x32_bf16 a[24:27], a[28:31], v[36:39], a[24:27]
    ds_read_b64_tr_b16 a[2:3], v16 offset:2048
    v_max_f32 v0, v0, v1
    s_waitcnt lgkmcnt(4)
    v_mfma_f32_16x16x32_bf16 v[144:147], a[8:11], v[32:35], v[144:147]
    ds_read_b64_tr_b16 a[4:5], v17 offset:0
    v_cmp_lt_f32 vcc, s31, v0
    s_cbranch_vccnz L_up_27
L_upb_27:
    v_mfma_f32_16x16x32_bf16 v[148:151], a[8:11], v[36:39], v[148:151]
    ds_read_b64_tr_b16 a[6:7], v17 offset:2048
    v_exp_f32 v40, v40
    v_mfma_f32_16x16x32_bf16 v[152:155], a[12:15], v[32:35], v[152:155]
    ds_read_b64_tr_b16 a[8:9], v18 offset:0
    v_exp_f32 v41, v41
    v_mfma_f32_16x16x32_bf16 v[156:159], a[12:15], v[36:39], v[156:159]
    ds_read_b64_tr_b16 a[10:11], v18 offset:2048
    s_waitcnt lgkmcnt(4)
    v_mfma_f32_16x16x32_bf16 v[160:163], a[16:19], v[32:35], v[160:163]
    ds_read_b64_tr_b16 a[12:13], v11 offset:256
    v_exp_f32 v42, v42
    v_mfma_f32_16x16x32_bf16 v[164:167], a[16:19], v[36:39], v[164:167]
    ds_read_b64_tr_b16 a[14:15], v11 offset:2304
    v_exp_f32 v43, v43
    v_mfma_f32_16x16x32_bf16 v[168:171], a[0:3], v[32:35], v[168:171]
    ds_read_b64_tr_b16 a[16:17], v12 offset:256
    buffer_load_dwordx4 v20, s[8:11], s30 offen offset:3072 nt lds
    v_cvt_pk_bf16_f32 v24, v40, v41
    v_mfma_f32_16x16x32_bf16 v[172:175], a[0:3], v[36:39], v[172:175]
    ds_read_b64_tr_b16 a[18:19], v12 offset:2304
    s_waitcnt lgkmcnt(4)
    v_mfma_f32_16x16x32_bf16 v[176:179], a[4:7], v[32:35], v[176:179]
    ds_read_b64_tr_b16 a[0:1], v13 offset:256
    v_exp_f32 v44, v44
    v_mfma_f32_16x16x32_bf16 v[180:183], a[4:7], v[36:39], v[180:183]
    ds_read_b64_tr_b16 a[2:3], v13 offset:2304
    v_exp_f32 v45, v45
    v_mfma_f32_16x16x32_bf16 v[184:187], a[8:11], v[32:35], v[184:187]
    ds_read_b64_tr_b16 a[4:5], v14 offset:256
    v_cvt_pk_bf16_f32 v25, v42, v43
    v_mfma_f32_16x16x32_bf16 v[188:191], a[8:11], v[36:39], v[188:191]
    ds_read_b64_tr_b16 a[6:7], v14 offset:2304
    s_waitcnt lgkmcnt(4)
    v_mfma_f32_16x16x32_bf16 v[192:195], a[12:15], v[32:35], v[192:195]
    ds_read_b64_tr_b16 a[8:9], v15 offset:256
    v_exp_f32 v46, v46
    v_mfma_f32_16x16x32_bf16 v[196:199], a[12:15], v[36:39], v[196:199]
    ds_read_b64_tr_b16 a[10:11], v15 offset:2304
    v_exp_f32 v47, v47
    v_mfma_f32_16x16x32_bf16 v[200:203], a[16:19], v[32:35], v[200:203]
    ds_read_b64_tr_b16 a[12:13], v16 offset:256
    v_cvt_pk_bf16_f32 v28, v44, v45
    s_nop 0
    v_mfma_f32_16x16x32_bf16 v[204:207], a[16:19], v[36:39], v[204:207]
    ds_read_b64_tr_b16 a[14:15], v16 offset:2304
    v_cvt_pk_bf16_f32 v29, v46, v47
    s_waitcnt lgkmcnt(4)
    v_mfma_f32_16x16x32_bf16 v[208:211], a[0:3], v[32:35], v[208:211]
    ds_read_b64_tr_b16 a[16:17], v17 offset:256
    v_mfma_f32_16x16x32_bf16 v[212:215], a[0:3], v[36:39], v[212:215]
    ds_read_b64_tr_b16 a[18:19], v17 offset:2304
    v_mfma_f32_16x16x32_bf16 v[216:219], a[4:7], v[32:35], v[216:219]
    ds_read_b64_tr_b16 a[0:1], v18 offset:256
    v_mfma_f32_16x16x32_bf16 v[220:223], a[4:7], v[36:39], v[220:223]
    ds_read_b64_tr_b16 a[2:3], v18 offset:2304
    s_waitcnt lgkmcnt(4)
    v_mfma_f32_16x16x32_bf16 v[224:227], a[8:11], v[32:35], v[224:227]
    s_waitcnt vmcnt(7)
    s_barrier
    ds_read_b128 a[4:7], v7 offset:0
    v_mfma_f32_16x16x32_bf16 v[228:231], a[8:11], v[36:39], v[228:231]
    s_add_u32 m0, s29, 98304
    s_mov_b32 s30, 475136
    v_mfma_f32_16x16x32_bf16 v[232:235], a[12:15], v[32:35], v[232:235]
    ds_read_b128 a[8:11], v8 offset:0
    buffer_load_dwordx4 v21, s[12:15], s30 offen offset:0 nt lds
    v_mfma_f32_16x16x32_bf16 v[236:239], a[12:15], v[36:39], v[236:239]
    s_waitcnt lgkmcnt(2)
    v_mfma_f32_16x16x32_bf16 v[240:243], a[16:19], v[32:35], v[240:243]
    ds_read_b128 a[12:15], v9 offset:0
    v_mfma_f32_16x16x32_bf16 v[244:247], a[16:19], v[36:39], v[244:247]
    v_mfma_f32_16x16x32_bf16 v[248:251], a[0:3], v[32:35], v[248:251]
    ds_read_b128 a[16:19], v10 offset:0
    v_mfma_f32_16x16x32_bf16 v[252:255], a[0:3], v[36:39], v[252:255]
    buffer_load_dwordx4 v22, s[12:15], s30 offen offset:1024 nt lds
    s_cbranch_vccnz L_rs_27
L_rsb_27:
    s_waitcnt lgkmcnt(2)
    v_mfma_f32_16x16x32_bf16 v[40:43], a[4:7], v[64:67], v[56:59]
    ds_read_b128 a[0:3], v7 offset:256
    v_exp_f32 v48, v48
    v_mfma_f32_16x16x32_bf16 v[44:47], a[4:7], v[68:71], v[60:63]
    v_exp_f32 v49, v49
    v_mfma_f32_16x16x32_bf16 v[40:43], a[8:11], v[72:75], v[40:43]
    ds_read_b128 a[4:7], v8 offset:256
    v_exp_f32 v50, v50
    v_mfma_f32_16x16x32_bf16 v[44:47], a[8:11], v[76:79], v[44:47]
    v_exp_f32 v51, v51
    s_waitcnt lgkmcnt(2)
    v_mfma_f32_16x16x32_bf16 v[40:43], a[12:15], v[80:83], v[40:43]
    ds_read_b128 a[8:11], v9 offset:256
    v_cvt_pk_bf16_f32 v26, v48, v49
    v_mfma_f32_16x16x32_bf16 v[44:47], a[12:15], v[84:87], v[44:47]
    v_exp_f32 v52, v52
    v_mfma_f32_16x16x32_bf16 v[40:43], a[16:19], v[88:91], v[40:43]
    ds_read_b128 a[12:15], v10 offset:256
    buffer_load_dwordx4 v21, s[12:15], s30 offen offset:2048 nt lds
    v_add_u32 v3, 147456, v2
    v_mfma_f32_16x16x32_bf16 v[44:47], a[16:19], v[92:95], v[44:47]
    v_exp_f32 v53, v53
    s_waitcnt lgkmcnt(2)
    v_mfma_f32_16x16x32_bf16 v[40:43], a[0:3], v[96:99], v[40:43]
    ds_read_b128 a[16:19], v7 offset:2048
    v_cvt_pk_bf16_f32 v27, v50, v51
    v_mfma_f32_16x16x32_bf16 v[44:47], a[0:3], v[100:103], v[44:47]
    v_exp_f32 v54, v54
    ds_read_b64_tr_b16 a[240:241], v3 offset:0
    v_mfma_f32_16x16x32_bf16 v[40:43], a[4:7], v[104:107], v[40:43]
    ds_read_b128 a[0:3], v8 offset:2048
    v_exp_f32 v55, v55
    v_mfma_f32_16x16x32_bf16 v[44:47], a[4:7], v[108:111], v[44:47]
    v_cvt_pk_bf16_f32 v30, v52, v53
    s_nop 0
    s_waitcnt lgkmcnt(3)
    v_mfma_f32_16x16x32_bf16 v[40:43], a[8:11], v[112:115], v[40:43]
    ds_read_b128 a[4:7], v9 offset:2048
    v_cvt_pk_bf16_f32 v31, v54, v55
    v_mfma_f32_16x16x32_bf16 v[44:47], a[8:11], v[116:119], v[44:47]
    buffer_load_dwordx4 v22, s[12:15], s30 offen offset:3072 nt lds
    ds_read_b64_tr_b16 a[242:243], v3 offset:2048
    v_mfma_f32_16x16x32_bf16 v[40:43], a[12:15], v[120:123], v[40:43]
    ds_read_b128 a[8:11], v10 offset:2048
    v_mfma_f32_16x16x32_bf16 v[44:47], a[12:15], v[124:127], v[44:47]
    ds_read_b64_tr_b16 a[244:245], v3 offset:4096
    s_waitcnt lgkmcnt(4)
    v_mfma_f32_16x16x32_bf16 v[48:51], a[16:19], v[64:67], v[56:59]
    ds_read_b128 a[12:15], v7 offset:2304
    buffer_load_dword v23, off, s[96:99], 0 sc1
    v_mfma_f32_16x16x32_bf16 v[52:55], a[16:19], v[68:71], v[60:63]
    ds_read_b64_tr_b16 a[246:247], v3 offset:6144
    v_mfma_f32_16x16x32_bf16 v[48:51], a[0:3], v[72:75], v[48:51]
    ds_read_b128 a[16:19], v8 offset:2304
    v_mfma_f32_16x16x32_bf16 v[52:55], a[0:3], v[76:79], v[52:55]
    ds_read_b64_tr_b16 a[248:249], v3 offset:8192
    s_waitcnt lgkmcnt(5)
    v_mfma_f32_16x16x32_bf16 v[48:51], a[4:7], v[80:83], v[48:51]
    ds_read_b128 a[0:3], v9 offset:2304
    v_mfma_f32_16x16x32_bf16 v[52:55], a[4:7], v[84:87], v[52:55]
    ds_read_b64_tr_b16 a[250:251], v3 offset:10240
    v_mfma_f32_16x16x32_bf16 v[48:51], a[8:11], v[88:91], v[48:51]
    ds_read_b128 a[4:7], v10 offset:2304
    v_max3_f32 v0, v40, v41, v42
    v_mfma_f32_16x16x32_bf16 v[52:55], a[8:11], v[92:95], v[52:55]
    ds_read_b64_tr_b16 a[252:253], v3 offset:12288
    s_waitcnt lgkmcnt(5)
    v_mfma_f32_16x16x32_bf16 v[48:51], a[12:15], v[96:99], v[48:51]
    s_waitcnt vmcnt(9)
    s_barrier
    ds_read_b64_tr_b16 a[8:9], v11 offset:16384
    v_mfma_f32_16x16x32_bf16 v[52:55], a[12:15], v[100:103], v[52:55]
    ds_read_b64_tr_b16 a[10:11], v11 offset:18432
    s_add_u32 m0, s29, 32768
    v_mfma_f32_16x16x32_bf16 v[48:51], a[16:19], v[104:107], v[48:51]
    ds_read_b64_tr_b16 a[12:13], v12 offset:16384
    s_mov_b32 s30, 507904
    v_mfma_f32_16x16x32_bf16 v[52:55], a[16:19], v[108:111], v[52:55]
    ds_read_b64_tr_b16 a[14:15], v12 offset:18432
    s_waitcnt lgkmcnt(5)
    v_mfma_f32_16x16x32_bf16 v[48:51], a[0:3], v[112:115], v[48:51]
    buffer_load_dwordx4 v19, s[8:11], s30 offen offset:0 nt lds
    ds_read_b64_tr_b16 a[254:255], v3 offset:14336
    v_mfma_f32_16x16x32_bf16 v[52:55], a[0:3], v[116:119], v[52:55]
    v_max3_f32 v1, v43, v44, v45
    v_max3_f32 v0, v0, v46, v47
    v_mfma_f32_16x16x32_bf16 v[48:51], a[4:7], v[120:123], v[48:51]
    ds_read_b64_tr_b16 a[16:17], v13 offset:16384
    v_mfma_f32_16x16x32_bf16 v[52:55], a[4:7], v[124:127], v[52:55]
    ds_read_b64_tr_b16 a[18:19], v13 offset:18432
    s_waitcnt lgkmcnt(3)
    v_mfma_f32_16x16x32_bf16 v[128:131], a[8:11], v[24:27], v[128:131]
    ds_read_b64_tr_b16 a[0:1], v14 offset:16384
    buffer_load_dwordx4 v20, s[8:11], s30 offen offset:1024 nt lds
    v_mfma_f32_16x16x32_bf16 v[132:135], a[8:11], v[28:31], v[132:135]
    ds_read_b64_tr_b16 a[2:3], v14 offset:18432
    v_mfma_f32_16x16x32_bf16 v[136:139], a[12:15], v[24:27], v[136:139]
    ds_read_b64_tr_b16 a[4:5], v15 offset:16384
    v_mfma_f32_16x16x32_bf16 v[140:143], a[12:15], v[28:31], v[140:143]
    ds_read_b64_tr_b16 a[6:7], v15 offset:18432
    v_max3_f32 v1, v1, v48, v49
    v_max3_f32 v0, v0, v50, v51
    v_mfma_f32_16x16x32_bf16 a[20:23], a[28:31], v[24:27], a[20:23]
    ds_read_b64_tr_b16 a[8:9], v16 offset:16384
    v_max3_f32 v1, v1, v52, v53
    v_max3_f32 v0, v0, v54, v55
    v_mfma_f32_16x16x32_bf16 a[24:27], a[28:31], v[28:31], a[24:27]
    ds_read_b64_tr_b16 a[10:11], v16 offset:18432
    v_max_f32 v0, v0, v1
    s_waitcnt lgkmcnt(4)
    v_mfma_f32_16x16x32_bf16 v[144:147], a[16:19], v[24:27], v[144:147]
    ds_read_b64_tr_b16 a[12:13], v17 offset:16384
    v_cmp_lt_f32 vcc, s31, v0
    s_cbranch_vccnz L_up_28
L_upb_28:
    v_mfma_f32_16x16x32_bf16 v[148:151], a[16:19], v[28:31], v[148:151]
    ds_read_b64_tr_b16 a[14:15], v17 offset:18432
    v_exp_f32 v40, v40
    v_mfma_f32_16x16x32_bf16 v[152:155], a[0:3], v[24:27], v[152:155]
    ds_read_b64_tr_b16 a[16:17], v18 offset:16384
    buffer_load_dwordx4 v19, s[8:11], s30 offen offset:2048 nt lds
    v_mfma_f32_16x16x32_bf16 v[156:159], a[0:3], v[28:31], v[156:159]
    ds_read_b64_tr_b16 a[18:19], v18 offset:18432
    s_waitcnt lgkmcnt(4)
    v_mfma_f32_16x16x32_bf16 v[160:163], a[4:7], v[24:27], v[160:163]
    ds_read_b64_tr_b16 a[0:1], v11 offset:16640
    v_exp_f32 v41, v41
    v_mfma_f32_16x16x32_bf16 v[164:167], a[4:7], v[28:31], v[164:167]
    ds_read_b64_tr_b16 a[2:3], v11 offset:18688
    v_exp_f32 v42, v42
    v_mfma_f32_16x16x32_bf16 v[168:171], a[8:11], v[24:27], v[168:171]
    ds_read_b64_tr_b16 a[4:5], v12 offset:16640
    v_exp_f32 v43, v43
    v_mfma_f32_16x16x32_bf16 v[172:175], a[8:11], v[28:31], v[172:175]
    ds_read_b64_tr_b16 a[6:7], v12 offset:18688
    v_cvt_pk_bf16_f32 v32, v40, v41
    s_waitcnt lgkmcnt(4)
    v_mfma_f32_16x16x32_bf16 v[176:179], a[12:15], v[24:27], v[176:179]
    ds_read_b64_tr_b16 a[8:9], v13 offset:16640
    v_exp_f32 v44, v44
    v_mfma_f32_16x16x32_bf16 v[180:183], a[12:15], v[28:31], v[180:183]
    ds_read_b64_tr_b16 a[10:11], v13 offset:18688
    v_exp_f32 v45, v45
    v_mfma_f32_16x16x32_bf16 v[184:187], a[16:19], v[24:27], v[184:187]
    ds_read_b64_tr_b16 a[12:13], v14 offset:16640
    buffer_load_dwordx4 v20, s[8:11], s30 offen offset:3072 nt lds
    v_cvt_pk_bf16_f32 v33, v42, v43
    v_mfma_f32_16x16x32_bf16 v[188:191], a[16:19], v[28:31], v[188:191]
    ds_read_b64_tr_b16 a[14:15], v14 offset:18688
    s_waitcnt lgkmcnt(4)
    v_mfma_f32_16x16x32_bf16 v[192:195], a[0:3], v[24:27], v[192:195]
    ds_read_b64_tr_b16 a[16:17], v15 offset:16640
    v_exp_f32 v46, v46
    v_mfma_f32_16x16x32_bf16 v[196:199], a[0:3], v[28:31], v[196:199]
    ds_read_b64_tr_b16 a[18:19], v15 offset:18688
    v_exp_f32 v47, v47
    v_mfma_f32_16x16x32_bf16 v[200:203], a[4:7], v[24:27], v[200:203]
    ds_read_b64_tr_b16 a[0:1], v16 offset:16640
    v_cvt_pk_bf16_f32 v36, v44, v45
    s_nop 0
    v_mfma_f32_16x16x32_bf16 v[204:207], a[4:7], v[28:31], v[204:207]
    ds_read_b64_tr_b16 a[2:3], v16 offset:18688
    v_cvt_pk_bf16_f32 v37, v46, v47
    s_waitcnt lgkmcnt(4)
    v_mfma_f32_16x16x32_bf16 v[208:211], a[8:11], v[24:27], v[208:211]
    ds_read_b64_tr_b16 a[4:5], v17 offset:16640
    v_mfma_f32_16x16x32_bf16 v[212:215], a[8:11], v[28:31], v[212:215]
    ds_read_b64_tr_b16 a[6:7], v17 offset:18688
    v_mfma_f32_16x16x32_bf16 v[216:219], a[12:15], v[24:27], v[216:219]
    ds_read_b64_tr_b16 a[8:9], v18 offset:16640
    v_mfma_f32_16x16x32_bf16 v[220:223], a[12:15], v[28:31], v[220:223]
    ds_read_b64_tr_b16 a[10:11], v18 offset:18688
    s_waitcnt lgkmcnt(4)
    v_mfma_f32_16x16x32_bf16 v[224:227], a[16:19], v[24:27], v[224:227]
    s_waitcnt vmcnt(9)
    s_barrier
    ds_read_b128 a[12:15], v7 offset:16384
    v_mfma_f32_16x16x32_bf16 v[228:231], a[16:19], v[28:31], v[228:231]
    s_add_u32 m0, s29, 65536
    s_mov_b32 s30, 491520
    v_mfma_f32_16x16x32_bf16 v[232:235], a[0:3], v[24:27], v[232:235]
    ds_read_b128 a[16:19], v8 offset:16384
    buffer_load_dwordx4 v21, s[12:15], s30 offen offset:0 nt lds
    v_mfma_f32_16x16x32_bf16 v[236:239], a[0:3], v[28:31], v[236:239]
    s_waitcnt lgkmcnt(2)
    v_mfma_f32_16x16x32_bf16 v[240:243], a[4:7], v[24:27], v[240:243]
    ds_read_b128 a[0:3], v9 offset:16384
    v_mfma_f32_16x16x32_bf16 v[244:247], a[4:7], v[28:31], v[244:247]
    v_mfma_f32_16x16x32_bf16 v[248:251], a[8:11], v[24:27], v[248:251]
    ds_read_b128 a[4:7], v10 offset:16384
    v_mfma_f32_16x16x32_bf16 v[252:255], a[8:11], v[28:31], v[252:255]
    buffer_load_dwordx4 v22, s[12:15], s30 offen offset:1024 nt lds
    s_cbranch_vccnz L_rs_28
L_rsb_28:
    s_waitcnt lgkmcnt(2)
    v_mfma_f32_16x16x32_bf16 v[40:43], a[12:15], v[64:67], v[56:59]
    ds_read_b128 a[8:11], v7 offset:16640
    v_exp_f32 v48, v48
    v_mfma_f32_16x16x32_bf16 v[44:47], a[12:15], v[68:71], v[60:63]
    v_exp_f32 v49, v49
    v_mfma_f32_16x16x32_bf16 v[40:43], a[16:19], v[72:75], v[40:43]
    ds_read_b128 a[12:15], v8 offset:16640
    v_exp_f32 v50, v50
    v_mfma_f32_16x16x32_bf16 v[44:47], a[16:19], v[76:79], v[44:47]
    v_exp_f32 v51, v51
    s_waitcnt lgkmcnt(2)
    v_mfma_f32_16x16x32_bf16 v[40:43], a[0:3], v[80:83], v[40:43]
    ds_read_b128 a[16:19], v9 offset:16640
    v_cvt_pk_bf16_f32 v34, v48, v49
    v_mfma_f32_16x16x32_bf16 v[44:47], a[0:3], v[84:87], v[44:47]
    v_exp_f32 v52, v52
    v_mfma_f32_16x16x32_bf16 v[40:43], a[4:7], v[88:91], v[40:43]
    ds_read_b128 a[0:3], v10 offset:16640
    buffer_load_dwordx4 v21, s[12:15], s30 offen offset:2048 nt lds
    v_mfma_f32_16x16x32_bf16 v[44:47], a[4:7], v[92:95], v[44:47]
    v_exp_f32 v53, v53
    s_waitcnt lgkmcnt(2)
    v_mfma_f32_16x16x32_bf16 v[40:43], a[8:11], v[96:99], v[40:43]
    ds_read_b128 a[4:7], v7 offset:18432
    v_cvt_pk_bf16_f32 v35, v50, v51
    v_mfma_f32_16x16x32_bf16 v[44:47], a[8:11], v[100:103], v[44:47]
    v_exp_f32 v54, v54
    v_mfma_f32_16x16x32_bf16 v[40:43], a[12:15], v[104:107], v[40:43]
    ds_read_b128 a[8:11], v8 offset:18432
    v_exp_f32 v55, v55
    v_mfma_f32_16x16x32_bf16 v[44:47], a[12:15], v[108:111], v[44:47]
    v_cvt_pk_bf16_f32 v38, v52, v53
    s_nop 0
    s_waitcnt lgkmcnt(2)
    v_mfma_f32_16x16x32_bf16 v[40:43], a[16:19], v[112:115], v[40:43]
    ds_read_b128 a[12:15], v9 offset:18432
    v_cvt_pk_bf16_f32 v39, v54, v55
    v_mfma_f32_16x16x32_bf16 v[44:47], a[16:19], v[116:119], v[44:47]
    buffer_load_dwordx4 v22, s[12:15], s30 offen offset:3072 nt lds
    v_mfma_f32_16x16x32_bf16 v[40:43], a[0:3], v[120:123], v[40:43]
    ds_read_b128 a[16:19], v10 offset:18432
    v_mfma_f32_16x16x32_bf16 v[44:47], a[0:3], v[124:127], v[44:47]
    s_waitcnt lgkmcnt(2)
    v_mfma_f32_16x16x32_bf16 v[48:51], a[4:7], v[64:67], v[56:59]
    ds_read_b128 a[0:3], v7 offset:18688
    v_mfma_f32_16x16x32_bf16 v[52:55], a[4:7], v[68:71], v[60:63]
    v_mfma_f32_16x16x32_bf16 v[48:51], a[8:11], v[72:75], v[48:51]
    ds_read_b128 a[4:7], v8 offset:18688
    v_mfma_f32_16x16x32_bf16 v[52:55], a[8:11], v[76:79], v[52:55]
    s_waitcnt lgkmcnt(2)
    v_mfma_f32_16x16x32_bf16 v[48:51], a[12:15], v[80:83], v[48:51]
    ds_read_b128 a[8:11], v9 offset:18688
    v_mfma_f32_16x16x32_bf16 v[52:55], a[12:15], v[84:87], v[52:55]
    v_mfma_f32_16x16x32_bf16 v[48:51], a[16:19], v[88:91], v[48:51]
    ds_read_b128 a[12:15], v10 offset:18688
    v_max3_f32 v0, v40, v41, v42
    v_mfma_f32_16x16x32_bf16 v[52:55], a[16:19], v[92:95], v[52:55]
    v_max3_f32 v1, v43, v44, v45
    s_waitcnt lgkmcnt(2)
    v_mfma_f32_16x16x32_bf16 v[48:51], a[0:3], v[96:99], v[48:51]
    s_waitcnt vmcnt(8)
    s_barrier
    ds_read_b64_tr_b16 a[16:17], v11 offset:32768
    v_mfma_f32_16x16x32_bf16 v[52:55], a[0:3], v[100:103], v[52:55]
    ds_read_b64_tr_b16 a[18:19], v11 offset:34816
    s_add_u32 m0, s29, 81920
    v_mfma_f32_16x16x32_bf16 v[48:51], a[4:7], v[104:107], v[48:51]
    ds_read_b64_tr_b16 a[0:1], v12 offset:32768
    s_mov_b32 s30, 507904
    v_mfma_f32_16x16x32_bf16 v[52:55], a[4:7], v[108:111], v[52:55]
    ds_read_b64_tr_b16 a[2:3], v12 offset:34816
    s_waitcnt lgkmcnt(4)
    v_mfma_f32_16x16x32_bf16 v[48:51], a[8:11], v[112:115], v[48:51]
    buffer_load_dwordx4 v21, s[12:15], s30 offen offset:0 nt lds
    v_max3_f32 v0, v0, v46, v47
    v_mfma_f32_16x16x32_bf16 v[52:55], a[8:11], v[116:119], v[52:55]
    v_mfma_f32_16x16x32_bf16 v[48:51], a[12:15], v[120:123], v[48:51]
    ds_read_b64_tr_b16 a[4:5], v13 offset:32768
    v_mfma_f32_16x16x32_bf16 v[52:55], a[12:15], v[124:127], v[52:55]
    ds_read_b64_tr_b16 a[6:7], v13 offset:34816
    s_waitcnt lgkmcnt(2)
    v_mfma_f32_16x16x32_bf16 v[128:131], a[16:19], v[32:35], v[128:131]
    ds_read_b64_tr_b16 a[8:9], v14 offset:32768
    buffer_load_dwordx4 v22, s[12:15], s30 offen offset:1024 nt lds
    v_mfma_f32_16x16x32_bf16 v[132:135], a[16:19], v[36:39], v[132:135]
    ds_read_b64_tr_b16 a[10:11], v14 offset:34816
    v_mfma_f32_16x16x32_bf16 v[136:139], a[0:3], v[32:35], v[136:139]
    ds_read_b64_tr_b16 a[12:13], v15 offset:32768
    v_mfma_f32_16x16x32_bf16 v[140:143], a[0:3], v[36:39], v[140:143]
    ds_read_b64_tr_b16 a[14:15], v15 offset:34816
    v_max3_f32 v1, v1, v48, v49
    v_max3_f32 v0, v0, v50, v51
    v_mfma_f32_16x16x32_bf16 a[20:23], a[28:31], v[32:35], a[20:23]
    ds_read_b64_tr_b16 a[16:17], v16 offset:32768
    v_max3_f32 v1, v1, v52, v53
    v_max3_f32 v0, v0, v54, v55
    v_mfma_f32_16x16x32_bf16 a[24:27], a[28:31], v[36:39], a[24:27]
    ds_read_b64_tr_b16 a[18:19], v16 offset:34816
    v_max_f32 v0, v0, v1
    s_waitcnt lgkmcnt(4)
    v_mfma_f32_16x16x32_bf16 v[144:147], a[4:7], v[32:35], v[144:147]
    ds_read_b64_tr_b16 a[0:1], v17 offset:32768
    v_cmp_lt_f32 vcc, s31, v0
    s_cbranch_vccnz L_up_29
L_upb_29:
    v_mfma_f32_16x16x32_bf16 v[148:151], a[4:7], v[36:39], v[148:151]
    ds_read_b64_tr_b16 a[2:3], v17 offset:34816
    v_exp_f32 v40, v40
    v_mfma_f32_16x16x32_bf16 v[152:155], a[8:11], v[32:35], v[152:155]
    ds_read_b64_tr_b16 a[4:5], v18 offset:32768
    buffer_load_dwordx4 v21, s[12:15], s30 offen offset:2048 nt lds
    v_mfma_f32_16x16x32_bf16 v[156:159], a[8:11], v[36:39], v[156:159]
    ds_read_b64_tr_b16 a[6:7], v18 offset:34816
    s_waitcnt lgkmcnt(4)
    v_mfma_f32_16x16x32_bf16 v[160:163], a[12:15], v[32:35], v[160:163]
    ds_read_b64_tr_b16 a[8:9], v11 offset:33024
    v_exp_f32 v41, v41
    v_mfma_f32_16x16x32_bf16 v[164:167], a[12:15], v[36:39], v[164:167]
    ds_read_b64_tr_b16 a[10:11], v11 offset:35072
    v_exp_f32 v42, v42
    v_mfma_f32_16x16x32_bf16 v[168:171], a[16:19], v[32:35], v[168:171]
    ds_read_b64_tr_b16 a[12:13], v12 offset:33024
    v_exp_f32 v43, v43
    v_mfma_f32_16x16x32_bf16 v[172:175], a[16:19], v[36:39], v[172:175]
    ds_read_b64_tr_b16 a[14:15], v12 offset:35072
    v_cvt_pk_bf16_f32 v24, v40, v41
    s_waitcnt lgkmcnt(4)
    v_mfma_f32_16x16x32_bf16 v[176:179], a[0:3], v[32:35], v[176:179]
    ds_read_b64_tr_b16 a[16:17], v13 offset:33024
    v_exp_f32 v44, v44
    v_mfma_f32_16x16x32_bf16 v[180:183], a[0:3], v[36:39], v[180:183]
    ds_read_b64_tr_b16 a[18:19], v13 offset:35072
    v_exp_f32 v45, v45
    v_mfma_f32_16x16x32_bf16 v[184:187], a[4:7], v[32:35], v[184:187]
    ds_read_b64_tr_b16 a[0:1], v14 offset:33024
    buffer_load_dwordx4 v22, s[12:15], s30 offen offset:3072 nt lds
    v_cvt_pk_bf16_f32 v25, v42, v43
    v_mfma_f32_16x16x32_bf16 v[188:191], a[4:7], v[36:39], v[188:191]
    ds_read_b64_tr_b16 a[2:3], v14 offset:35072
    s_waitcnt lgkmcnt(4)
    v_mfma_f32_16x16x32_bf16 v[192:195], a[8:11], v[32:35], v[192:195]
    ds_read_b64_tr_b16 a[4:5], v15 offset:33024
    v_exp_f32 v46, v46
    v_mfma_f32_16x16x32_bf16 v[196:199], a[8:11], v[36:39], v[196:199]
    ds_read_b64_tr_b16 a[6:7], v15 offset:35072
    v_exp_f32 v47, v47
    v_mfma_f32_16x16x32_bf16 v[200:203], a[12:15], v[32:35], v[200:203]
    ds_read_b64_tr_b16 a[8:9], v16 offset:33024
    v_cvt_pk_bf16_f32 v28, v44, v45
    s_nop 0
    v_mfma_f32_16x16x32_bf16 v[204:207], a[12:15], v[36:39], v[204:207]
    ds_read_b64_tr_b16 a[10:11], v16 offset:35072
    v_cvt_pk_bf16_f32 v29, v46, v47
    s_waitcnt lgkmcnt(4)
    v_mfma_f32_16x16x32_bf16 v[208:211], a[16:19], v[32:35], v[208:211]
    ds_read_b64_tr_b16 a[12:13], v17 offset:33024
    v_mfma_f32_16x16x32_bf16 v[212:215], a[16:19], v[36:39], v[212:215]
    ds_read_b64_tr_b16 a[14:15], v17 offset:35072
    v_mfma_f32_16x16x32_bf16 v[216:219], a[0:3], v[32:35], v[216:219]
    ds_read_b64_tr_b16 a[16:17], v18 offset:33024
    v_mfma_f32_16x16x32_bf16 v[220:223], a[0:3], v[36:39], v[220:223]
    ds_read_b64_tr_b16 a[18:19], v18 offset:35072
    s_waitcnt lgkmcnt(4)
    v_mfma_f32_16x16x32_bf16 v[224:227], a[4:7], v[32:35], v[224:227]
    s_waitcnt vmcnt(8)
    s_barrier
    ds_read_b128 a[0:3], v7 offset:32768
    v_mfma_f32_16x16x32_bf16 v[228:231], a[4:7], v[36:39], v[228:231]
    v_mfma_f32_16x16x32_bf16 v[232:235], a[8:11], v[32:35], v[232:235]
    ds_read_b128 a[4:7], v8 offset:32768
    v_mfma_f32_16x16x32_bf16 v[236:239], a[8:11], v[36:39], v[236:239]
    s_waitcnt lgkmcnt(2)
    v_mfma_f32_16x16x32_bf16 v[240:243], a[12:15], v[32:35], v[240:243]
    ds_read_b128 a[8:11], v9 offset:32768
    v_mfma_f32_16x16x32_bf16 v[244:247], a[12:15], v[36:39], v[244:247]
    v_mfma_f32_16x16x32_bf16 v[248:251], a[16:19], v[32:35], v[248:251]
    ds_read_b128 a[12:15], v10 offset:32768
    v_mfma_f32_16x16x32_bf16 v[252:255], a[16:19], v[36:39], v[252:255]
    s_cbranch_vccnz L_rs_29
L_rsb_29:
    s_waitcnt lgkmcnt(2)
    v_mfma_f32_16x16x32_bf16 v[40:43], a[0:3], v[64:67], v[56:59]
    ds_read_b128 a[16:19], v7 offset:33024
    v_exp_f32 v48, v48
    v_mfma_f32_16x16x32_bf16 v[44:47], a[0:3], v[68:71], v[60:63]
    v_exp_f32 v49, v49
    v_mfma_f32_16x16x32_bf16 v[40:43], a[4:7], v[72:75], v[40:43]
    ds_read_b128 a[0:3], v8 offset:33024
    v_exp_f32 v50, v50
    v_mfma_f32_16x16x32_bf16 v[44:47], a[4:7], v[76:79], v[44:47]
    v_exp_f32 v51, v51
    s_waitcnt lgkmcnt(2)
    v_mfma_f32_16x16x32_bf16 v[40:43], a[8:11], v[80:83], v[40:43]
    ds_read_b128 a[4:7], v9 offset:33024
    v_cvt_pk_bf16_f32 v26, v48, v49
    v_mfma_f32_16x16x32_bf16 v[44:47], a[8:11], v[84:87], v[44:47]
    v_exp_f32 v52, v52
    v_mfma_f32_16x16x32_bf16 v[40:43], a[12:15], v[88:91], v[40:43]
    ds_read_b128 a[8:11], v10 offset:33024
    v_exp_f32 v53, v53
    v_mfma_f32_16x16x32_bf16 v[44:47], a[12:15], v[92:95], v[44:47]
    v_cvt_pk_bf16_f32 v27, v50, v51
    s_waitcnt lgkmcnt(2)
    v_mfma_f32_16x16x32_bf16 v[40:43], a[16:19], v[96:99], v[40:43]
    ds_read_b128 a[12:15], v7 offset:34816
    v_exp_f32 v54, v54
    v_mfma_f32_16x16x32_bf16 v[44:47], a[16:19], v[100:103], v[44:47]
    v_exp_f32 v55, v55
    v_cvt_pk_bf16_f32 v30, v52, v53
    v_mfma_f32_16x16x32_bf16 v[40:43], a[0:3], v[104:107], v[40:43]
    ds_read_b128 a[16:19], v8 offset:34816
    s_nop 0
    v_cvt_pk_bf16_f32 v31, v54, v55
    v_mfma_f32_16x16x32_bf16 v[44:47], a[0:3], v[108:111], v[44:47]
    s_waitcnt lgkmcnt(2)
    v_mfma_f32_16x16x32_bf16 v[40:43], a[4:7], v[112:115], v[40:43]
    ds_read_b128 a[0:3], v9 offset:34816
    v_mfma_f32_16x16x32_bf16 v[44:47], a[4:7], v[116:119], v[44:47]
    v_mfma_f32_16x16x32_bf16 v[40:43], a[8:11], v[120:123], v[40:43]
    ds_read_b128 a[4:7], v10 offset:34816
    v_mfma_f32_16x16x32_bf16 v[44:47], a[8:11], v[124:127], v[44:47]
    s_waitcnt lgkmcnt(2)
    v_mfma_f32_16x16x32_bf16 v[48:51], a[12:15], v[64:67], v[56:59]
    ds_read_b128 a[8:11], v7 offset:35072
    v_mfma_f32_16x16x32_bf16 v[52:55], a[12:15], v[68:71], v[60:63]
    v_mfma_f32_16x16x32_bf16 v[48:51], a[16:19], v[72:75], v[48:51]
    ds_read_b128 a[12:15], v8 offset:35072
    v_mfma_f32_16x16x32_bf16 v[52:55], a[16:19], v[76:79], v[52:55]
    s_waitcnt lgkmcnt(2)
    v_mfma_f32_16x16x32_bf16 v[48:51], a[0:3], v[80:83], v[48:51]
    ds_read_b128 a[16:19], v9 offset:35072
    v_mfma_f32_16x16x32_bf16 v[52:55], a[0:3], v[84:87], v[52:55]
    v_mfma_f32_16x16x32_bf16 v[48:51], a[4:7], v[88:91], v[48:51]
    ds_read_b128 a[0:3], v10 offset:35072
    v_max3_f32 v0, v40, v41, v42
    v_mfma_f32_16x16x32_bf16 v[52:55], a[4:7], v[92:95], v[52:55]
    v_max3_f32 v1, v43, v44, v45
    s_waitcnt lgkmcnt(2)
    v_mfma_f32_16x16x32_bf16 v[48:51], a[8:11], v[96:99], v[48:51]
    s_waitcnt vmcnt(4)
    s_barrier
    ds_read_b64_tr_b16 a[4:5], v11 offset:0
    v_mfma_f32_16x16x32_bf16 v[52:55], a[8:11], v[100:103], v[52:55]
    ds_read_b64_tr_b16 a[6:7], v11 offset:2048
    v_max3_f32 v0, v0, v46, v47
    v_mfma_f32_16x16x32_bf16 v[48:51], a[12:15], v[104:107], v[48:51]
    ds_read_b64_tr_b16 a[8:9], v12 offset:0
    v_mfma_f32_16x16x32_bf16 v[52:55], a[12:15], v[108:111], v[52:55]
    ds_read_b64_tr_b16 a[10:11], v12 offset:2048
    s_waitcnt lgkmcnt(4)
    v_mfma_f32_16x16x32_bf16 v[48:51], a[16:19], v[112:115], v[48:51]
    v_mfma_f32_16x16x32_bf16 v[52:55], a[16:19], v[116:119], v[52:55]
    v_mfma_f32_16x16x32_bf16 v[48:51], a[0:3], v[120:123], v[48:51]
    ds_read_b64_tr_b16 a[12:13], v13 offset:0
    v_mfma_f32_16x16x32_bf16 v[52:55], a[0:3], v[124:127], v[52:55]
    ds_read_b64_tr_b16 a[14:15], v13 offset:2048
    s_waitcnt lgkmcnt(2)
    v_mfma_f32_16x16x32_bf16 v[128:131], a[4:7], v[24:27], v[128:131]
    ds_read_b64_tr_b16 a[16:17], v14 offset:0
    v_mbcnt_lo_u32_b32 v21, -1, 0
    v_mbcnt_hi_u32_b32 v21, -1, v21
    v_mfma_f32_16x16x32_bf16 v[132:135], a[4:7], v[28:31], v[132:135]
    ds_read_b64_tr_b16 a[18:19], v14 offset:2048
    s_add_u32 s3, s28, 0
    s_and_b32 s3, s3, 3
    v_mfma_f32_16x16x32_bf16 v[136:139], a[8:11], v[24:27], v[136:139]
    ds_read_b64_tr_b16 a[0:1], v15 offset:0
    s_lshl_b32 s62, s3, 9
    s_add_u32 s62, s62, 98304
    v_mfma_f32_16x16x32_bf16 v[140:143], a[8:11], v[28:31], v[140:143]
    ds_read_b64_tr_b16 a[2:3], v15 offset:2048
    v_max3_f32 v1, v1, v48, v49
    v_max3_f32 v0, v0, v50, v51
    v_max3_f32 v1, v1, v52, v53
    v_mfma_f32_16x16x32_bf16 a[20:23], a[28:31], v[24:27], a[20:23]
    ds_read_b64_tr_b16 a[4:5], v16 offset:0
    v_max3_f32 v0, v0, v54, v55
    v_max_f32 v0, v0, v1
    v_cmp_lt_f32 vcc, s31, v0
    v_mfma_f32_16x16x32_bf16 a[24:27], a[28:31], v[28:31], a[24:27]
    ds_read_b64_tr_b16 a[6:7], v16 offset:2048
    s_cbranch_vccnz L_up_30
L_upb_30:
    s_waitcnt lgkmcnt(4)
    v_mfma_f32_16x16x32_bf16 v[144:147], a[12:15], v[24:27], v[144:147]
    ds_read_b64_tr_b16 a[8:9], v17 offset:0
    v_exp_f32 v40, v40
    v_mfma_f32_16x16x32_bf16 v[148:151], a[12:15], v[28:31], v[148:151]
    ds_read_b64_tr_b16 a[10:11], v17 offset:2048
    v_exp_f32 v41, v41
    v_mfma_f32_16x16x32_bf16 v[152:155], a[16:19], v[24:27], v[152:155]
    ds_read_b64_tr_b16 a[12:13], v18 offset:0
    v_exp_f32 v42, v42
    v_mfma_f32_16x16x32_bf16 v[156:159], a[16:19], v[28:31], v[156:159]
    ds_read_b64_tr_b16 a[14:15], v18 offset:2048
    v_exp_f32 v43, v43
    s_waitcnt lgkmcnt(4)
    v_mfma_f32_16x16x32_bf16 v[160:163], a[0:3], v[24:27], v[160:163]
    ds_read_b64_tr_b16 a[16:17], v11 offset:256
    v_cvt_pk_bf16_f32 v32, v40, v41
    v_exp_f32 v44, v44
    v_mfma_f32_16x16x32_bf16 v[164:167], a[0:3], v[28:31], v[164:167]
    ds_read_b64_tr_b16 a[18:19], v11 offset:2304
    v_exp_f32 v45, v45
    v_cvt_pk_bf16_f32 v33, v42, v43
    v_mfma_f32_16x16x32_bf16 v[168:171], a[4:7], v[24:27], v[168:171]
    ds_read_b64_tr_b16 a[0:1], v12 offset:256
    v_exp_f32 v46, v46
    v_mfma_f32_16x16x32_bf16 v[172:175], a[4:7], v[28:31], v[172:175]
    ds_read_b64_tr_b16 a[2:3], v12 offset:2304
    v_exp_f32 v47, v47
    s_waitcnt lgkmcnt(4)
    v_mfma_f32_16x16x32_bf16 v[176:179], a[8:11], v[24:27], v[176:179]
    ds_read_b64_tr_b16 a[4:5], v13 offset:256
    v_cvt_pk_bf16_f32 v36, v44, v45
    v_exp_f32 v48, v48
    v_mfma_f32_16x16x32_bf16 v[180:183], a[8:11], v[28:31], v[180:183]
    ds_read_b64_tr_b16 a[6:7], v13 offset:2304
    v_exp_f32 v49, v49
    v_cvt_pk_bf16_f32 v37, v46, v47
    v_mfma_f32_16x16x32_bf16 v[184:187], a[12:15], v[24:27], v[184:187]
    ds_read_b64_tr_b16 a[8:9], v14 offset:256
    v_exp_f32 v50, v50
    v_mfma_f32_16x16x32_bf16 v[188:191], a[12:15], v[28:31], v[188:191]
    ds_read_b64_tr_b16 a[10:11], v14 offset:2304
    v_exp_f32 v51, v51
    s_waitcnt lgkmcnt(4)
    v_mfma_f32_16x16x32_bf16 v[192:195], a[16:19], v[24:27], v[192:195]
    ds_read_b64_tr_b16 a[12:13], v15 offset:256
    v_cvt_pk_bf16_f32 v34, v48, v49
    v_exp_f32 v52, v52
    v_mfma_f32_16x16x32_bf16 v[196:199], a[16:19], v[28:31], v[196:199]
    ds_read_b64_tr_b16 a[14:15], v15 offset:2304
    v_exp_f32 v53, v53
    v_cvt_pk_bf16_f32 v35, v50, v51
    v_mfma_f32_16x16x32_bf16 v[200:203], a[0:3], v[24:27], v[200:203]
    ds_read_b64_tr_b16 a[16:17], v16 offset:256
    v_exp_f32 v54, v54
    v_mfma_f32_16x16x32_bf16 v[204:207], a[0:3], v[28:31], v[204:207]
    ds_read_b64_tr_b16 a[18:19], v16 offset:2304
    v_exp_f32 v55, v55
    s_waitcnt lgkmcnt(4)
    v_mfma_f32_16x16x32_bf16 v[208:211], a[4:7], v[24:27], v[208:211]
    ds_read_b64_tr_b16 a[0:1], v17 offset:256
    v_cvt_pk_bf16_f32 v38, v52, v53
    s_nop 0
    v_cvt_pk_bf16_f32 v39, v54, v55
    v_mfma_f32_16x16x32_bf16 v[212:215], a[4:7], v[28:31], v[212:215]
    ds_read_b64_tr_b16 a[2:3], v17 offset:2304
    s_lshl_b32 s3, s3, 14
    s_add_u32 s3, s3, 0
    v_mfma_f32_16x16x32_bf16 v[216:219], a[8:11], v[24:27], v[216:219]
    ds_read_b64_tr_b16 a[4:5], v18 offset:256
    v_lshl_add_u32 v7, v21, 3, s3
    s_add_u32 s3, s28, 1
    v_mfma_f32_16x16x32_bf16 v[220:223], a[8:11], v[28:31], v[220:223]
    ds_read_b64_tr_b16 a[6:7], v18 offset:2304
    s_and_b32 s3, s3, 3
    s_waitcnt lgkmcnt(4)
    v_mfma_f32_16x16x32_bf16 v[224:227], a[12:15], v[24:27], v[224:227]
    s_branch L_pg0
.p2align 12
L_pg0:
    s_cbranch_execz L_pgb0
    s_waitcnt vmcnt(0)
    s_barrier
    ds_read_b64_tr_b16 a[8:9], v11 offset:16384
    v_mfma_f32_16x16x32_bf16 v[228:231], a[12:15], v[28:31], v[228:231]
    ds_read_b64_tr_b16 a[10:11], v11 offset:18432
    s_lshl_b32 s63, s3, 9
    s_add_u32 s63, s63, 98304
    v_mfma_f32_16x16x32_bf16 v[232:235], a[16:19], v[24:27], v[232:235]
    ds_read_b64_tr_b16 a[12:13], v12 offset:16384
    s_lshl_b32 s3, s3, 14
    s_add_u32 s3, s3, 0
    v_mfma_f32_16x16x32_bf16 v[236:239], a[16:19], v[28:31], v[236:239]
    ds_read_b64_tr_b16 a[14:15], v12 offset:18432
    v_lshl_add_u32 v8, v21, 3, s3
    s_waitcnt lgkmcnt(4)
    v_mfma_f32_16x16x32_bf16 v[240:243], a[0:3], v[24:27], v[240:243]
    s_add_u32 s3, s28, 2
    s_and_b32 s3, s3, 3
    s_lshl_b32 s64, s3, 9
    v_mfma_f32_16x16x32_bf16 v[244:247], a[0:3], v[28:31], v[244:247]
    s_add_u32 s64, s64, 98304
    s_lshl_b32 s3, s3, 14
    s_add_u32 s3, s3, 0
    v_mfma_f32_16x16x32_bf16 v[248:251], a[4:7], v[24:27], v[248:251]
    ds_read_b64_tr_b16 a[16:17], v13 offset:16384
    v_lshl_add_u32 v9, v21, 3, s3
    s_add_u32 s3, s28, 3
    v_mfma_f32_16x16x32_bf16 v[252:255], a[4:7], v[28:31], v[252:255]
    ds_read_b64_tr_b16 a[18:19], v13 offset:18432
    s_cbranch_vccnz L_rs_30
L_rsb_30:
    s_waitcnt lgkmcnt(2)
    v_mfma_f32_16x16x32_bf16 v[128:131], a[8:11], v[32:35], v[128:131]
    ds_read_b64_tr_b16 a[0:1], v14 offset:16384
    s_and_b32 s3, s3, 3
    s_lshl_b32 s65, s3, 9
    v_mfma_f32_16x16x32_bf16 v[132:135], a[8:11], v[36:39], v[132:135]
    ds_read_b64_tr_b16 a[2:3], v14 offset:18432
    s_add_u32 s65, s65, 98304
    s_lshl_b32 s3, s3, 14
    v_mfma_f32_16x16x32_bf16 v[136:139], a[12:15], v[32:35], v[136:139]
    ds_read_b64_tr_b16 a[4:5], v15 offset:16384
    s_add_u32 s3, s3, 0
    v_lshl_add_u32 v10, v21, 3, s3
    v_mfma_f32_16x16x32_bf16 v[140:143], a[12:15], v[36:39], v[140:143]
    ds_read_b64_tr_b16 a[6:7], v15 offset:18432
    s_lshl_b32 s3, s34, 8
    v_and_b32 v19, 3, v21
    v_mfma_f32_16x16x32_bf16 a[20:23], a[28:31], v[32:35], a[20:23]
    ds_read_b64_tr_b16 a[8:9], v16 offset:16384
    v_lshlrev_b32 v19, 6, v19
    v_and_b32 v20, 48, v21
    v_mfma_f32_16x16x32_bf16 a[24:27], a[28:31], v[36:39], a[24:27]
    ds_read_b64_tr_b16 a[10:11], v16 offset:18432
    v_add3_u32 v19, v19, v20, s3
    s_waitcnt lgkmcnt(4)
    v_mfma_f32_16x16x32_bf16 v[144:147], a[16:19], v[32:35], v[144:147]
    ds_read_b64_tr_b16 a[12:13], v17 offset:16384
    v_bfe_u32 v20, v21, 2, 2
    v_lshl_add_u32 v19, v20, 12, v19
    v_mfma_f32_16x16x32_bf16 v[148:151], a[16:19], v[36:39], v[148:151]
    ds_read_b64_tr_b16 a[14:15], v17 offset:18432
    v_cvt_pk_bf16_f32 v64, v128, v129
    v_mfma_f32_16x16x32_bf16 v[152:155], a[0:3], v[32:35], v[152:155]
    ds_read_b64_tr_b16 a[16:17], v18 offset:16384
    v_cvt_pk_bf16_f32 v65, v130, v131
    v_mfma_f32_16x16x32_bf16 v[156:159], a[0:3], v[36:39], v[156:159]
    ds_read_b64_tr_b16 a[18:19], v18 offset:18432
    s_waitcnt lgkmcnt(4)
    v_mfma_f32_16x16x32_bf16 v[160:163], a[4:7], v[32:35], v[160:163]
    ds_read_b64_tr_b16 a[0:1], v11 offset:16640
    v_cvt_pk_bf16_f32 v68, v132, v133
    v_mfma_f32_16x16x32_bf16 v[164:167], a[4:7], v[36:39], v[164:167]
    ds_read_b64_tr_b16 a[2:3], v11 offset:18688
    v_cvt_pk_bf16_f32 v69, v134, v135
    v_mfma_f32_16x16x32_bf16 v[168:171], a[8:11], v[32:35], v[168:171]
    ds_read_b64_tr_b16 a[4:5], v12 offset:16640
    v_cvt_pk_bf16_f32 v66, v136, v137
    v_mfma_f32_16x16x32_bf16 v[172:175], a[8:11], v[36:39], v[172:175]
    ds_read_b64_tr_b16 a[6:7], v12 offset:18688
    s_waitcnt lgkmcnt(4)
    v_mfma_f32_16x16x32_bf16 v[176:179], a[12:15], v[32:35], v[176:179]
    ds_read_b64_tr_b16 a[8:9], v13 offset:16640
    v_cvt_pk_bf16_f32 v67, v138, v139
    v_mfma_f32_16x16x32_bf16 v[180:183], a[12:15], v[36:39], v[180:183]
    ds_read_b64_tr_b16 a[10:11], v13 offset:18688
    v_cvt_pk_bf16_f32 v70, v140, v141
    v_mfma_f32_16x16x32_bf16 v[184:187], a[16:19], v[32:35], v[184:187]
    ds_read_b64_tr_b16 a[12:13], v14 offset:16640
    v_cvt_pk_bf16_f32 v71, v142, v143
    v_mfma_f32_16x16x32_bf16 v[188:191], a[16:19], v[36:39], v[188:191]
    ds_read_b64_tr_b16 a[14:15], v14 offset:18688
    s_waitcnt lgkmcnt(4)
    v_mfma_f32_16x16x32_bf16 v[192:195], a[0:3], v[32:35], v[192:195]
    ds_read_b64_tr_b16 a[16:17], v15 offset:16640
    v_cvt_pk_bf16_f32 v72, v144, v145
    v_mfma_f32_16x16x32_bf16 v[196:199], a[0:3], v[36:39], v[196:199]
    ds_read_b64_tr_b16 a[18:19], v15 offset:18688
    v_cvt_pk_bf16_f32 v73, v146, v147
    v_mfma_f32_16x16x32_bf16 v[200:203], a[4:7], v[32:35], v[200:203]
    ds_read_b64_tr_b16 a[0:1], v16 offset:16640
    v_cvt_pk_bf16_f32 v76, v148, v149
    v_mfma_f32_16x16x32_bf16 v[204:207], a[4:7], v[36:39], v[204:207]
    ds_read_b64_tr_b16 a[2:3], v16 offset:18688
    s_waitcnt lgkmcnt(4)
    v_mfma_f32_16x16x32_bf16 v[208:211], a[8:11], v[32:35], v[208:211]
    ds_read_b64_tr_b16 a[4:5], v17 offset:16640
    v_cvt_pk_bf16_f32 v77, v150, v151
    v_mfma_f32_16x16x32_bf16 v[212:215], a[8:11], v[36:39], v[212:215]
    ds_read_b64_tr_b16 a[6:7], v17 offset:18688
    v_cvt_pk_bf16_f32 v74, v152, v153
    v_mfma_f32_16x16x32_bf16 v[216:219], a[12:15], v[32:35], v[216:219]
    ds_read_b64_tr_b16 a[8:9], v18 offset:16640
    v_cvt_pk_bf16_f32 v75, v154, v155
    v_mfma_f32_16x16x32_bf16 v[220:223], a[12:15], v[36:39], v[220:223]
    ds_read_b64_tr_b16 a[10:11], v18 offset:18688
    s_waitcnt lgkmcnt(4)
    v_mfma_f32_16x16x32_bf16 v[224:227], a[16:19], v[32:35], v[224:227]
    v_cvt_pk_bf16_f32 v78, v156, v157
    v_cvt_pk_bf16_f32 v79, v158, v159
    v_mfma_f32_16x16x32_bf16 v[228:231], a[16:19], v[36:39], v[228:231]
    v_cvt_pk_bf16_f32 v80, v160, v161
    v_cvt_pk_bf16_f32 v81, v162, v163
    v_mfma_f32_16x16x32_bf16 v[232:235], a[0:3], v[32:35], v[232:235]
    v_cvt_pk_bf16_f32 v84, v164, v165
    v_cvt_pk_bf16_f32 v85, v166, v167
    v_mfma_f32_16x16x32_bf16 v[236:239], a[0:3], v[36:39], v[236:239]
    v_cvt_pk_bf16_f32 v82, v168, v169
    s_waitcnt lgkmcnt(0)
    v_mfma_f32_16x16x32_bf16 v[240:243], a[4:7], v[32:35], v[240:243]
    v_cvt_pk_bf16_f32 v83, v170, v171
    v_cvt_pk_bf16_f32 v86, v172, v173
    v_mfma_f32_16x16x32_bf16 v[244:247], a[4:7], v[36:39], v[244:247]
    v_cvt_pk_bf16_f32 v87, v174, v175
    v_cvt_pk_bf16_f32 v88, v176, v177
    v_mfma_f32_16x16x32_bf16 v[248:251], a[8:11], v[32:35], v[248:251]
    v_cvt_pk_bf16_f32 v89, v178, v179
    v_cvt_pk_bf16_f32 v92, v180, v181
    v_cvt_pk_bf16_f32 v106, v216, v217
    v_mfma_f32_16x16x32_bf16 v[252:255], a[8:11], v[36:39], v[252:255]
    v_cvt_pk_bf16_f32 v93, v182, v183
    v_cvt_pk_bf16_f32 v90, v184, v185
    v_cvt_pk_bf16_f32 v107, v218, v219
    v_mfma_f32_16x16x32_bf16 v[128:131], a[32:35], v[64:67], 0
    v_cvt_pk_bf16_f32 v91, v186, v187
    v_cvt_pk_bf16_f32 v94, v188, v189
    v_cvt_pk_bf16_f32 v110, v220, v221
    ds_write_b64 v7, v[64:65] offset:0
    v_mfma_f32_16x16x32_bf16 v[132:135], a[32:35], v[68:71], 0
    v_cvt_pk_bf16_f32 v95, v190, v191
    v_cvt_pk_bf16_f32 v96, v192, v193
    v_cvt_pk_bf16_f32 v111, v222, v223
    v_mfma_f32_16x16x32_bf16 v[128:131], a[36:39], v[72:75], v[128:131]
    v_cvt_pk_bf16_f32 v97, v194, v195
    v_cvt_pk_bf16_f32 v100, v196, v197
    v_cvt_pk_bf16_f32 v114, v232, v233
    ds_write_b64 v7, v[66:67] offset:512
    v_mfma_f32_16x16x32_bf16 v[132:135], a[36:39], v[76:79], v[132:135]
    v_cvt_pk_bf16_f32 v101, v198, v199
    v_cvt_pk_bf16_f32 v98, v200, v201
    v_cvt_pk_bf16_f32 v115, v234, v235
    v_mfma_f32_16x16x32_bf16 v[128:131], a[40:43], v[80:83], v[128:131]
    v_cvt_pk_bf16_f32 v99, v202, v203
    v_cvt_pk_bf16_f32 v102, v204, v205
    v_cvt_pk_bf16_f32 v118, v236, v237
    ds_write_b64 v7, v[68:69] offset:1024
    v_mfma_f32_16x16x32_bf16 v[132:135], a[40:43], v[84:87], v[132:135]
    v_cvt_pk_bf16_f32 v103, v206, v207
    v_cvt_pk_bf16_f32 v104, v208, v209
    v_cvt_pk_bf16_f32 v119, v238, v239
    v_mfma_f32_16x16x32_bf16 v[128:131], a[44:47], v[88:91], v[128:131]
    v_cvt_pk_bf16_f32 v105, v210, v211
    v_cvt_pk_bf16_f32 v108, v212, v213
    v_cvt_pk_bf16_f32 v122, v248, v249
    ds_write_b64 v7, v[70:71] offset:1536
    v_mfma_f32_16x16x32_bf16 v[132:135], a[44:47], v[92:95], v[132:135]
    v_cvt_pk_bf16_f32 v109, v214, v215
    v_cvt_pk_bf16_f32 v112, v224, v225
    v_cvt_pk_bf16_f32 v123, v250, v251
    v_mfma_f32_16x16x32_bf16 v[128:131], a[48:51], v[96:99], v[128:131]
    v_cvt_pk_bf16_f32 v113, v226, v227
    v_cvt_pk_bf16_f32 v116, v228, v229
    v_cvt_pk_bf16_f32 v126, v252, v253
    ds_write_b64 v7, v[72:73] offset:2048
    v_mfma_f32_16x16x32_bf16 v[132:135], a[48:51], v[100:103], v[132:135]
    v_cvt_pk_bf16_f32 v117, v230, v231
    v_cvt_pk_bf16_f32 v120, v240, v241
    v_cvt_pk_bf16_f32 v127, v254, v255
    v_mfma_f32_16x16x32_bf16 v[128:131], a[52:55], v[104:107], v[128:131]
    v_cvt_pk_bf16_f32 v121, v242, v243
    v_cvt_pk_bf16_f32 v124, v244, v245
    ds_write_b64 v7, v[74:75] offset:2560
    v_mfma_f32_16x16x32_bf16 v[132:135], a[52:55], v[108:111], v[132:135]
    v_cvt_pk_bf16_f32 v125, v246, v247
    v_accvgpr_read_b32 v152, a20
    v_mfma_f32_16x16x32_bf16 v[128:131], a[56:59], v[112:115], v[128:131]
    v_accvgpr_read_b32 v153, a24
    ds_write_b64 v7, v[76:77] offset:3072
    v_mfma_f32_16x16x32_bf16 v[132:135], a[56:59], v[116:119], v[132:135]
    v_rcp_f32 v152, v152
    v_mfma_f32_16x16x32_bf16 v[128:131], a[60:63], v[120:123], v[128:131]
    v_rcp_f32 v153, v153
    ds_write_b64 v7, v[78:79] offset:3584
    v_mfma_f32_16x16x32_bf16 v[132:135], a[60:63], v[124:127], v[132:135]
    v_mfma_f32_16x16x32_bf16 v[136:139], a[64:67], v[64:67], 0
    ds_write_b64 v7, v[80:81] offset:4096
    v_mfma_f32_16x16x32_bf16 v[140:143], a[64:67], v[68:71], 0
    v_mfma_f32_16x16x32_bf16 v[136:139], a[68:71], v[72:75], v[136:139]
    ds_write_b64 v7, v[82:83] offset:4608
    v_mfma_f32_16x16x32_bf16 v[140:143], a[68:71], v[76:79], v[140:143]
    v_mfma_f32_16x16x32_bf16 v[136:139], a[72:75], v[80:83], v[136:139]
    ds_write_b64 v7, v[84:85] offset:5120
    v_mfma_f32_16x16x32_bf16 v[140:143], a[72:75], v[84:87], v[140:143]
    v_readfirstlane_b32 s86, v23
    v_mfma_f32_16x16x32_bf16 v[136:139], a[76:79], v[88:91], v[136:139]
    ds_write_b64 v7, v[86:87] offset:5632
    v_mfma_f32_16x16x32_bf16 v[140:143], a[76:79], v[92:95], v[140:143]
    v_mul_f32 v128, v152, v128
    v_mul_f32 v129, v152, v129
    v_mfma_f32_16x16x32_bf16 v[136:139], a[80:83], v[96:99], v[136:139]
    ds_write_b64 v7, v[88:89] offset:6144
    v_mfma_f32_16x16x32_bf16 v[140:143], a[80:83], v[100:103], v[140:143]
    v_cvt_pk_bf16_f32 v160, v128, v129
    v_mul_f32 v130, v152, v130
    v_mfma_f32_16x16x32_bf16 v[136:139], a[84:87], v[104:107], v[136:139]
    ds_write_b64 v7, v[90:91] offset:6656
    v_mfma_f32_16x16x32_bf16 v[140:143], a[84:87], v[108:111], v[140:143]
    v_mul_f32 v131, v152, v131
    v_cvt_pk_bf16_f32 v161, v130, v131
    v_mfma_f32_16x16x32_bf16 v[136:139], a[88:91], v[112:115], v[136:139]
    ds_write_b64 v7, v[92:93] offset:7168
    v_mfma_f32_16x16x32_bf16 v[140:143], a[88:91], v[116:119], v[140:143]
    v_mul_f32 v132, v153, v132
    v_mul_f32 v133, v153, v133
    v_mfma_f32_16x16x32_bf16 v[136:139], a[92:95], v[120:123], v[136:139]
    ds_write_b64 v7, v[94:95] offset:7680
    v_mfma_f32_16x16x32_bf16 v[140:143], a[92:95], v[124:127], v[140:143]
    v_cvt_pk_bf16_f32 v162, v132, v133
    v_mul_f32 v134, v153, v134
    v_mfma_f32_16x16x32_bf16 v[144:147], a[96:99], v[64:67], 0
    ds_write_b64 v7, v[96:97] offset:8192
    v_mfma_f32_16x16x32_bf16 v[148:151], a[96:99], v[68:71], 0
    v_mul_f32 v135, v153, v135
    v_cvt_pk_bf16_f32 v163, v134, v135
    v_mfma_f32_16x16x32_bf16 v[144:147], a[100:103], v[72:75], v[144:147]
    ds_write_b64 v7, v[98:99] offset:8704
    v_mfma_f32_16x16x32_bf16 v[148:151], a[100:103], v[76:79], v[148:151]
    s_cmp_eq_u32 s86, 0
    s_cbranch_scc1 L_notready
L_ready:
    v_mfma_f32_16x16x32_bf16 v[144:147], a[104:107], v[80:83], v[144:147]
    ds_write_b64 v7, v[100:101] offset:9216
    v_mfma_f32_16x16x32_bf16 v[148:151], a[104:107], v[84:87], v[148:151]
    s_mov_b32 s87, 0
    v_mfma_f32_16x16x32_bf16 v[144:147], a[108:111], v[88:91], v[144:147]
    ds_write_b64 v7, v[102:103] offset:9728
    v_mfma_f32_16x16x32_bf16 v[148:151], a[108:111], v[92:95], v[148:151]
    v_mul_f32 v136, v152, v136
    v_mul_f32 v137, v152, v137
    v_mfma_f32_16x16x32_bf16 v[144:147], a[112:115], v[96:99], v[144:147]
    ds_write_b64 v7, v[104:105] offset:10240
    v_mfma_f32_16x16x32_bf16 v[148:151], a[112:115], v[100:103], v[148:151]
    v_cvt_pk_bf16_f32 v164, v136, v137
    v_mul_f32 v138, v152, v138
    v_mfma_f32_16x16x32_bf16 v[144:147], a[116:119], v[104:107], v[144:147]
    ds_write_b64 v7, v[106:107] offset:10752
    v_mfma_f32_16x16x32_bf16 v[148:151], a[116:119], v[108:111], v[148:151]
    v_mul_f32 v139, v152, v139
    v_cvt_pk_bf16_f32 v165, v138, v139
    v_mfma_f32_16x16x32_bf16 v[144:147], a[120:123], v[112:115], v[144:147]
    ds_write_b64 v7, v[108:109] offset:11264
    v_mfma_f32_16x16x32_bf16 v[148:151], a[120:123], v[116:119], v[148:151]
    v_mul_f32 v140, v153, v140
    v_mul_f32 v141, v153, v141
    v_mfma_f32_16x16x32_bf16 v[144:147], a[124:127], v[120:123], v[144:147]
    ds_write_b64 v7, v[110:111] offset:11776
    v_mfma_f32_16x16x32_bf16 v[148:151], a[124:127], v[124:127], v[148:151]
    v_cvt_pk_bf16_f32 v166, v140, v141
    v_mul_f32 v142, v153, v142
    v_mfma_f32_16x16x32_bf16 v[128:131], a[128:131], v[64:67], 0
    ds_write_b64 v7, v[112:113] offset:12288
    v_mfma_f32_16x16x32_bf16 v[132:135], a[128:131], v[68:71], 0
    v_mul_f32 v143, v153, v143
    v_cvt_pk_bf16_f32 v167, v142, v143
    v_mfma_f32_16x16x32_bf16 v[128:131], a[132:135], v[72:75], v[128:131]
    ds_write_b64 v7, v[114:115] offset:12800
    v_mfma_f32_16x16x32_bf16 v[132:135], a[132:135], v[76:79], v[132:135]
    s_cmp_eq_u32 s60, 2
    s_cselect_b32 s87, 2048, s87
    v_mfma_f32_16x16x32_bf16 v[128:131], a[136:139], v[80:83], v[128:131]
    ds_write_b64 v7, v[116:117] offset:13312
    v_mfma_f32_16x16x32_bf16 v[132:135], a[136:139], v[84:87], v[132:135]
    s_cmp_eq_u32 s60, 3
    s_cselect_b32 s87, 4096, s87
    v_mfma_f32_16x16x32_bf16 v[128:131], a[140:143], v[88:91], v[128:131]
    ds_write_b64 v7, v[118:119] offset:13824
    v_mfma_f32_16x16x32_bf16 v[132:135], a[140:143], v[92:95], v[132:135]
    v_mul_f32 v144, v152, v144
    v_mul_f32 v145, v152, v145
    v_mfma_f32_16x16x32_bf16 v[128:131], a[144:147], v[96:99], v[128:131]
    ds_write_b64 v7, v[120:121] offset:14336
    v_mfma_f32_16x16x32_bf16 v[132:135], a[144:147], v[100:103], v[132:135]
    v_cvt_pk_bf16_f32 v168, v144, v145
    v_mul_f32 v146, v152, v146
    v_mfma_f32_16x16x32_bf16 v[128:131], a[148:151], v[104:107], v[128:131]
    ds_write_b64 v7, v[122:123] offset:14848
    v_mfma_f32_16x16x32_bf16 v[132:135], a[148:151], v[108:111], v[132:135]
    v_mul_f32 v147, v152, v147
    v_cvt_pk_bf16_f32 v169, v146, v147
    v_mfma_f32_16x16x32_bf16 v[128:131], a[152:155], v[112:115], v[128:131]
    ds_write_b64 v7, v[124:125] offset:15360
    v_mfma_f32_16x16x32_bf16 v[132:135], a[152:155], v[116:119], v[132:135]
    v_mul_f32 v148, v153, v148
    v_mul_f32 v149, v153, v149
    v_mfma_f32_16x16x32_bf16 v[128:131], a[156:159], v[120:123], v[128:131]
    ds_write_b64 v7, v[126:127] offset:15872
    v_mfma_f32_16x16x32_bf16 v[132:135], a[156:159], v[124:127], v[132:135]
    v_cvt_pk_bf16_f32 v170, v148, v149
    v_mul_f32 v150, v153, v150
    v_mfma_f32_16x16x32_bf16 v[136:139], a[160:163], v[64:67], 0
    v_mul_f32 v151, v153, v151
    v_cvt_pk_bf16_f32 v171, v150, v151
    v_mfma_f32_16x16x32_bf16 v[140:143], a[160:163], v[68:71], 0
    v_lshl_add_u32 v0, v21, 3, s62
    v_mfma_f32_16x16x32_bf16 v[136:139], a[164:167], v[72:75], v[136:139]
    ds_write_b64 v0, v[152:153]
    v_mfma_f32_16x16x32_bf16 v[140:143], a[164:167], v[76:79], v[140:143]
    s_cmp_eq_u32 s60, 4
    s_cselect_b32 s87, 6144, s87
    v_mfma_f32_16x16x32_bf16 v[136:139], a[168:171], v[80:83], v[136:139]
    v_and_b32 v20, 48, v21
    v_lshlrev_b32 v20, 10, v20
    v_mfma_f32_16x16x32_bf16 v[140:143], a[168:171], v[84:87], v[140:143]
    v_lshl_add_u32 v20, v21, 7, v20
    v_add_u32 v20, s87, v20
    v_mfma_f32_16x16x32_bf16 v[136:139], a[172:175], v[88:91], v[136:139]
    v_mul_f32 v128, v152, v128
    v_mul_f32 v129, v152, v129
    v_mfma_f32_16x16x32_bf16 v[140:143], a[172:175], v[92:95], v[140:143]
    s_waitcnt lgkmcnt(0)
    s_barrier
    v_mfma_f32_16x16x32_bf16 v[136:139], a[176:179], v[96:99], v[136:139]
    v_lshl_add_u32 v0, v21, 3, s63
    ds_read_b64 v[154:155], v0
    v_mfma_f32_16x16x32_bf16 v[140:143], a[176:179], v[100:103], v[140:143]
    v_cvt_pk_bf16_f32 v172, v128, v129
    v_mul_f32 v130, v152, v130
    v_mfma_f32_16x16x32_bf16 v[136:139], a[180:183], v[104:107], v[136:139]
    ds_read2st64_b64 v[192:195], v8 offset0:0 offset1:1
    v_mul_f32 v131, v152, v131
    v_mfma_f32_16x16x32_bf16 v[140:143], a[180:183], v[108:111], v[140:143]
    v_cvt_pk_bf16_f32 v173, v130, v131
    v_mul_f32 v132, v153, v132
    v_mfma_f32_16x16x32_bf16 v[136:139], a[184:187], v[112:115], v[136:139]
    ds_read2st64_b64 v[196:199], v8 offset0:2 offset1:3
    v_mul_f32 v133, v153, v133
    v_mfma_f32_16x16x32_bf16 v[140:143], a[184:187], v[116:119], v[140:143]
    v_cvt_pk_bf16_f32 v174, v132, v133
    v_mul_f32 v134, v153, v134
    v_mfma_f32_16x16x32_bf16 v[136:139], a[188:191], v[120:123], v[136:139]
    ds_read2st64_b64 v[200:203], v8 offset0:4 offset1:5
    v_mul_f32 v135, v153, v135
    v_mfma_f32_16x16x32_bf16 v[140:143], a[188:191], v[124:127], v[140:143]
    v_cvt_pk_bf16_f32 v175, v134, v135
    v_and_b32 v22, 32, v21
    v_mfma_f32_16x16x32_bf16 v[144:147], a[192:195], v[64:67], 0
    s_add_u32 s83, s56, 0
    buffer_store_dwordx4 v[160:163], v19, s[24:27], s83 offen sc1
    v_mfma_f32_16x16x32_bf16 v[148:151], a[192:195], v[68:71], 0
    ds_read2st64_b64 v[204:207], v8 offset0:6 offset1:7
    v_lshlrev_b32 v22, 9, v22
    v_mfma_f32_16x16x32_bf16 v[144:147], a[196:199], v[72:75], v[144:147]
    v_lshl_add_u32 v22, v21, 2, v22
    s_lshl_b32 s61, s34, 7
    v_mfma_f32_16x16x32_bf16 v[148:151], a[196:199], v[76:79], v[148:151]
    ds_read2st64_b64 v[208:211], v8 offset0:8 offset1:9
    v_mfma_f32_16x16x32_bf16 v[144:147], a[200:203], v[80:83], v[144:147]
    v_mfma_f32_16x16x32_bf16 v[148:151], a[200:203], v[84:87], v[148:151]
    ds_read2st64_b64 v[212:215], v8 offset0:10 offset1:11
    v_mfma_f32_16x16x32_bf16 v[144:147], a[204:207], v[88:91], v[144:147]
    v_mul_f32 v136, v152, v136
    v_mul_f32 v137, v152, v137
    v_mfma_f32_16x16x32_bf16 v[148:151], a[204:207], v[92:95], v[148:151]
    ds_read2st64_b64 v[216:219], v8 offset0:12 offset1:13
    v_cvt_pk_bf16_f32 v160, v136, v137
    v_mfma_f32_16x16x32_bf16 v[144:147], a[208:211], v[96:99], v[144:147]
    v_mul_f32 v138, v152, v138
    v_mul_f32 v139, v152, v139
    v_mfma_f32_16x16x32_bf16 v[148:151], a[208:211], v[100:103], v[148:151]
    ds_read2st64_b64 v[220:223], v8 offset0:14 offset1:15
    v_cvt_pk_bf16_f32 v161, v138, v139
    v_mfma_f32_16x16x32_bf16 v[144:147], a[212:215], v[104:107], v[144:147]
    v_mul_f32 v140, v153, v140
    v_mul_f32 v141, v153, v141
    v_mfma_f32_16x16x32_bf16 v[148:151], a[212:215], v[108:111], v[148:151]
    ds_read2st64_b64 v[224:227], v8 offset0:16 offset1:17
    v_cvt_pk_bf16_f32 v162, v140, v141
    v_mfma_f32_16x16x32_bf16 v[144:147], a[216:219], v[112:115], v[144:147]
    s_add_u32 s83, s56, 16384
    buffer_store_dwordx4 v[164:167], v19, s[24:27], s83 offen sc1
    v_mfma_f32_16x16x32_bf16 v[148:151], a[216:219], v[116:119], v[148:151]
    ds_read2st64_b64 v[228:231], v8 offset0:18 offset1:19
    v_mul_f32 v142, v153, v142
    v_mfma_f32_16x16x32_bf16 v[144:147], a[220:223], v[120:123], v[144:147]
    v_mul_f32 v143, v153, v143
    v_cvt_pk_bf16_f32 v163, v142, v143
    v_mfma_f32_16x16x32_bf16 v[148:151], a[220:223], v[124:127], v[148:151]
    ds_read2st64_b64 v[232:235], v8 offset0:20 offset1:21
    v_mfma_f32_16x16x32_bf16 v[128:131], a[224:227], v[64:67], 0
    v_mfma_f32_16x16x32_bf16 v[132:135], a[224:227], v[68:71], 0
    ds_read2st64_b64 v[236:239], v8 offset0:22 offset1:23
    v_mfma_f32_16x16x32_bf16 v[128:131], a[228:231], v[72:75], v[128:131]
    v_mfma_f32_16x16x32_bf16 v[132:135], a[228:231], v[76:79], v[132:135]
    ds_read2st64_b64 v[240:243], v8 offset0:24 offset1:25
    v_mfma_f32_16x16x32_bf16 v[128:131], a[232:235], v[80:83], v[128:131]
    v_mfma_f32_16x16x32_bf16 v[132:135], a[232:235], v[84:87], v[132:135]
    ds_read2st64_b64 v[244:247], v8 offset0:26 offset1:27
    v_mfma_f32_16x16x32_bf16 v[128:131], a[236:239], v[88:91], v[128:131]
    v_mul_f32 v144, v152, v144
    v_mul_f32 v145, v152, v145
    v_mfma_f32_16x16x32_bf16 v[132:135], a[236:239], v[92:95], v[132:135]
    ds_read2st64_b64 v[248:251], v8 offset0:28 offset1:29
    v_cvt_pk_bf16_f32 v164, v144, v145
    v_mfma_f32_16x16x32_bf16 v[128:131], a[240:243], v[96:99], v[128:131]
    v_mul_f32 v146, v152, v146
    v_mul_f32 v147, v152, v147
    v_mfma_f32_16x16x32_bf16 v[132:135], a[240:243], v[100:103], v[132:135]
    s_add_u32 s83, s56, 32768
    buffer_store_dwordx4 v[168:171], v19, s[24:27], s83 offen sc1
    v_mfma_f32_16x16x32_bf16 v[128:131], a[244:247], v[104:107], v[128:131]
    ds_read2st64_b64 v[252:255], v8 offset0:30 offset1:31
    v_cvt_pk_bf16_f32 v165, v146, v147
    v_mfma_f32_16x16x32_bf16 v[132:135], a[244:247], v[108:111], v[132:135]
    v_mul_f32 v148, v153, v148
    v_mul_f32 v149, v153, v149
    v_mfma_f32_16x16x32_bf16 v[128:131], a[248:251], v[112:115], v[128:131]
    v_cvt_pk_bf16_f32 v166, v148, v149
    v_mul_f32 v150, v153, v150
    v_mfma_f32_16x16x32_bf16 v[132:135], a[248:251], v[116:119], v[132:135]
    v_mul_f32 v151, v153, v151
    v_cvt_pk_bf16_f32 v167, v150, v151
    v_mfma_f32_16x16x32_bf16 v[128:131], a[252:255], v[120:123], v[128:131]
    v_mfma_f32_16x16x32_bf16 v[132:135], a[252:255], v[124:127], v[132:135]
    s_waitcnt lgkmcnt(0)
    v_mfma_f32_16x16x32_bf16 v[136:139], a[32:35], v[192:195], 0
    v_mfma_f32_16x16x32_bf16 v[140:143], a[32:35], v[196:199], 0
    v_mfma_f32_16x16x32_bf16 v[136:139], a[36:39], v[200:203], v[136:139]
    v_mfma_f32_16x16x32_bf16 v[140:143], a[36:39], v[204:207], v[140:143]
    v_mfma_f32_16x16x32_bf16 v[136:139], a[40:43], v[208:211], v[136:139]
    v_mfma_f32_16x16x32_bf16 v[140:143], a[40:43], v[212:215], v[140:143]
    v_mfma_f32_16x16x32_bf16 v[136:139], a[44:47], v[216:219], v[136:139]
    s_add_u32 s83, s56, 49152
    buffer_store_dwordx4 v[172:175], v19, s[24:27], s83 offen sc1
    v_mfma_f32_16x16x32_bf16 v[140:143], a[44:47], v[220:223], v[140:143]
    v_mul_f32 v128, v152, v128
    v_mul_f32 v129, v152, v129
    v_mfma_f32_16x16x32_bf16 v[136:139], a[48:51], v[224:227], v[136:139]
    v_cvt_pk_bf16_f32 v168, v128, v129
    v_mul_f32 v130, v152, v130
    v_mfma_f32_16x16x32_bf16 v[140:143], a[48:51], v[228:231], v[140:143]
    v_mul_f32 v131, v152, v131
    v_cvt_pk_bf16_f32 v169, v130, v131
    v_mfma_f32_16x16x32_bf16 v[136:139], a[52:55], v[232:235], v[136:139]
    v_mul_f32 v132, v153, v132
    v_mul_f32 v133, v153, v133
    v_mfma_f32_16x16x32_bf16 v[140:143], a[52:55], v[236:239], v[140:143]
    v_cvt_pk_bf16_f32 v170, v132, v133
    v_mul_f32 v134, v153, v134
    v_mfma_f32_16x16x32_bf16 v[136:139], a[56:59], v[240:243], v[136:139]
    v_mul_f32 v135, v153, v135
    v_cvt_pk_bf16_f32 v171, v134, v135
    v_mfma_f32_16x16x32_bf16 v[140:143], a[56:59], v[244:247], v[140:143]
    v_mfma_f32_16x16x32_bf16 v[136:139], a[60:63], v[248:251], v[136:139]
    v_mfma_f32_16x16x32_bf16 v[140:143], a[60:63], v[252:255], v[140:143]
    v_mfma_f32_16x16x32_bf16 v[144:147], a[64:67], v[192:195], 0
    v_lshl_add_u32 v0, v21, 3, s64
    ds_read_b64 v[156:157], v0
    v_mfma_f32_16x16x32_bf16 v[148:151], a[64:67], v[196:199], 0
    v_mfma_f32_16x16x32_bf16 v[144:147], a[68:71], v[200:203], v[144:147]
    v_mfma_f32_16x16x32_bf16 v[148:151], a[68:71], v[204:207], v[148:151]
    s_add_u32 s83, s56, 65536
    buffer_store_dwordx4 v[160:163], v19, s[24:27], s83 offen sc1
    v_mfma_f32_16x16x32_bf16 v[144:147], a[72:75], v[208:211], v[144:147]
    v_mfma_f32_16x16x32_bf16 v[148:151], a[72:75], v[212:215], v[148:151]
    ds_read2st64_b64 v[64:67], v9 offset0:0 offset1:1
    v_mfma_f32_16x16x32_bf16 v[144:147], a[76:79], v[216:219], v[144:147]
    v_mul_f32 v136, v154, v136
    v_mul_f32 v137, v154, v137
    v_mfma_f32_16x16x32_bf16 v[148:151], a[76:79], v[220:223], v[148:151]
    v_cvt_pk_bf16_f32 v172, v136, v137
    v_mul_f32 v138, v154, v138
    v_mfma_f32_16x16x32_bf16 v[144:147], a[80:83], v[224:227], v[144:147]
    v_mul_f32 v139, v154, v139
    v_cvt_pk_bf16_f32 v173, v138, v139
    v_mfma_f32_16x16x32_bf16 v[148:151], a[80:83], v[228:231], v[148:151]
    v_mul_f32 v140, v155, v140
    v_mul_f32 v141, v155, v141
    v_mfma_f32_16x16x32_bf16 v[144:147], a[84:87], v[232:235], v[144:147]
    ds_read2st64_b64 v[68:71], v9 offset0:2 offset1:3
    v_cvt_pk_bf16_f32 v174, v140, v141
    v_mfma_f32_16x16x32_bf16 v[148:151], a[84:87], v[236:239], v[148:151]
    v_mul_f32 v142, v155, v142
    v_mul_f32 v143, v155, v143
    v_mfma_f32_16x16x32_bf16 v[144:147], a[88:91], v[240:243], v[144:147]
    v_cvt_pk_bf16_f32 v175, v142, v143
    v_mfma_f32_16x16x32_bf16 v[148:151], a[88:91], v[244:247], v[148:151]
    v_mfma_f32_16x16x32_bf16 v[144:147], a[92:95], v[248:251], v[144:147]
    v_mfma_f32_16x16x32_bf16 v[148:151], a[92:95], v[252:255], v[148:151]
    ds_read2st64_b64 v[72:75], v9 offset0:4 offset1:5
    v_mfma_f32_16x16x32_bf16 v[128:131], a[96:99], v[192:195], 0
    s_add_u32 s83, s56, 81920
    buffer_store_dwordx4 v[164:167], v19, s[24:27], s83 offen sc1
    v_mfma_f32_16x16x32_bf16 v[132:135], a[96:99], v[196:199], 0
    v_mfma_f32_16x16x32_bf16 v[128:131], a[100:103], v[200:203], v[128:131]
    v_mfma_f32_16x16x32_bf16 v[132:135], a[100:103], v[204:207], v[132:135]
    v_mfma_f32_16x16x32_bf16 v[128:131], a[104:107], v[208:211], v[128:131]
    ds_read2st64_b64 v[76:79], v9 offset0:6 offset1:7
    v_mfma_f32_16x16x32_bf16 v[132:135], a[104:107], v[212:215], v[132:135]
    v_mfma_f32_16x16x32_bf16 v[128:131], a[108:111], v[216:219], v[128:131]
    v_mul_f32 v144, v154, v144
    v_mul_f32 v145, v154, v145
    v_mfma_f32_16x16x32_bf16 v[132:135], a[108:111], v[220:223], v[132:135]
    v_cvt_pk_bf16_f32 v160, v144, v145
    v_mul_f32 v146, v154, v146
    v_mfma_f32_16x16x32_bf16 v[128:131], a[112:115], v[224:227], v[128:131]
    v_mul_f32 v147, v154, v147
    v_cvt_pk_bf16_f32 v161, v146, v147
    v_mfma_f32_16x16x32_bf16 v[132:135], a[112:115], v[228:231], v[132:135]
    ds_read2st64_b64 v[80:83], v9 offset0:8 offset1:9
    v_mul_f32 v148, v155, v148
    v_mfma_f32_16x16x32_bf16 v[128:131], a[116:119], v[232:235], v[128:131]
    v_mul_f32 v149, v155, v149
    v_cvt_pk_bf16_f32 v162, v148, v149
    v_mfma_f32_16x16x32_bf16 v[132:135], a[116:119], v[236:239], v[132:135]
    v_mul_f32 v150, v155, v150
    v_mul_f32 v151, v155, v151
    v_mfma_f32_16x16x32_bf16 v[128:131], a[120:123], v[240:243], v[128:131]
    v_cvt_pk_bf16_f32 v163, v150, v151
    v_mfma_f32_16x16x32_bf16 v[132:135], a[120:123], v[244:247], v[132:135]
    s_add_u32 s83, s56, 98304
    buffer_store_dwordx4 v[168:171], v19, s[24:27], s83 offen sc1
    v_mfma_f32_16x16x32_bf16 v[128:131], a[124:127], v[248:251], v[128:131]
    ds_read2st64_b64 v[84:87], v9 offset0:10 offset1:11
    v_mfma_f32_16x16x32_bf16 v[132:135], a[124:127], v[252:255], v[132:135]
    v_mfma_f32_16x16x32_bf16 v[136:139], a[128:131], v[192:195], 0
    v_mfma_f32_16x16x32_bf16 v[140:143], a[128:131], v[196:199], 0
    v_mfma_f32_16x16x32_bf16 v[136:139], a[132:135], v[200:203], v[136:139]
    v_mfma_f32_16x16x32_bf16 v[140:143], a[132:135], v[204:207], v[140:143]
    ds_read2st64_b64 v[88:91], v9 offset0:12 offset1:13
    v_mfma_f32_16x16x32_bf16 v[136:139], a[136:139], v[208:211], v[136:139]
    v_mfma_f32_16x16x32_bf16 v[140:143], a[136:139], v[212:215], v[140:143]
    v_mfma_f32_16x16x32_bf16 v[136:139], a[140:143], v[216:219], v[136:139]
    v_mul_f32 v128, v154, v128
    v_mul_f32 v129, v154, v129
    v_mfma_f32_16x16x32_bf16 v[140:143], a[140:143], v[220:223], v[140:143]
    v_cvt_pk_bf16_f32 v164, v128, v129
    v_mul_f32 v130, v154, v130
    v_mfma_f32_16x16x32_bf16 v[136:139], a[144:147], v[224:227], v[136:139]
    ds_read2st64_b64 v[92:95], v9 offset0:14 offset1:15
    v_mul_f32 v131, v154, v131
    v_mfma_f32_16x16x32_bf16 v[140:143], a[144:147], v[228:231], v[140:143]
    v_cvt_pk_bf16_f32 v165, v130, v131
    v_mul_f32 v132, v155, v132
    v_mfma_f32_16x16x32_bf16 v[136:139], a[148:151], v[232:235], v[136:139]
    s_add_u32 s83, s57, 0
    buffer_store_dwordx4 v[172:175], v19, s[24:27], s83 offen sc1
    v_mfma_f32_16x16x32_bf16 v[140:143], a[148:151], v[236:239], v[140:143]
    v_mul_f32 v133, v155, v133
    v_cvt_pk_bf16_f32 v166, v132, v133
    v_mfma_f32_16x16x32_bf16 v[136:139], a[152:155], v[240:243], v[136:139]
    v_mul_f32 v134, v155, v134
    v_mul_f32 v135, v155, v135
    v_mfma_f32_16x16x32_bf16 v[140:143], a[152:155], v[244:247], v[140:143]
    ds_read2st64_b64 v[96:99], v9 offset0:16 offset1:17
    v_cvt_pk_bf16_f32 v167, v134, v135
    v_mfma_f32_16x16x32_bf16 v[136:139], a[156:159], v[248:251], v[136:139]
    v_mfma_f32_16x16x32_bf16 v[140:143], a[156:159], v[252:255], v[140:143]
    s_branch L_pg1
.p2align 12
L_pg1:
    s_cbranch_execz L_pgb1
    v_mfma_f32_16x16x32_bf16 v[144:147], a[160:163], v[192:195], 0
    v_mfma_f32_16x16x32_bf16 v[148:151], a[160:163], v[196:199], 0
    v_mfma_f32_16x16x32_bf16 v[144:147], a[164:167], v[200:203], v[144:147]
    ds_read2st64_b64 v[100:103], v9 offset0:18 offset1:19
    v_mfma_f32_16x16x32_bf16 v[148:151], a[164:167], v[204:207], v[148:151]
    v_mfma_f32_16x16x32_bf16 v[144:147], a[168:171], v[208:211], v[144:147]
    v_mfma_f32_16x16x32_bf16 v[148:151], a[168:171], v[212:215], v[148:151]
    v_mfma_f32_16x16x32_bf16 v[144:147], a[172:175], v[216:219], v[144:147]
    v_mul_f32 v136, v154, v136
    v_mul_f32 v137, v154, v137
    v_mfma_f32_16x16x32_bf16 v[148:151], a[172:175], v[220:223], v[148:151]
    s_add_u32 s83, s57, 16384
    buffer_store_dwordx4 v[160:163], v19, s[24:27], s83 offen sc1
    v_mfma_f32_16x16x32_bf16 v[144:147], a[176:179], v[224:227], v[144:147]
    ds_read2st64_b64 v[104:107], v9 offset0:20 offset1:21
    v_cvt_pk_bf16_f32 v168, v136, v137
    v_mfma_f32_16x16x32_bf16 v[148:151], a[176:179], v[228:231], v[148:151]
    v_mul_f32 v138, v154, v138
    v_mul_f32 v139, v154, v139
    v_mfma_f32_16x16x32_bf16 v[144:147], a[180:183], v[232:235], v[144:147]
    v_cvt_pk_bf16_f32 v169, v138, v139
    v_mul_f32 v140, v155, v140
    v_mfma_f32_16x16x32_bf16 v[148:151], a[180:183], v[236:239], v[148:151]
    v_mul_f32 v141, v155, v141
    v_cvt_pk_bf16_f32 v170, v140, v141
    v_mfma_f32_16x16x32_bf16 v[144:147], a[184:187], v[240:243], v[144:147]
    ds_read2st64_b64 v[108:111], v9 offset0:22 offset1:23
    v_mul_f32 v142, v155, v142
    v_mfma_f32_16x16x32_bf16 v[148:151], a[184:187], v[244:247], v[148:151]
    v_mul_f32 v143, v155, v143
    v_cvt_pk_bf16_f32 v171, v142, v143
    v_mfma_f32_16x16x32_bf16 v[144:147], a[188:191], v[248:251], v[144:147]
    v_mfma_f32_16x16x32_bf16 v[148:151], a[188:191], v[252:255], v[148:151]
    v_mfma_f32_16x16x32_bf16 v[128:131], a[192:195], v[192:195], 0
    v_mfma_f32_16x16x32_bf16 v[132:135], a[192:195], v[196:199], 0
    ds_read2st64_b64 v[112:115], v9 offset0:24 offset1:25
    v_mfma_f32_16x16x32_bf16 v[128:131], a[196:199], v[200:203], v[128:131]
    v_mfma_f32_16x16x32_bf16 v[132:135], a[196:199], v[204:207], v[132:135]
    v_mfma_f32_16x16x32_bf16 v[128:131], a[200:203], v[208:211], v[128:131]
    s_add_u32 s83, s57, 32768
    buffer_store_dwordx4 v[164:167], v19, s[24:27], s83 offen sc1
    v_mfma_f32_16x16x32_bf16 v[132:135], a[200:203], v[212:215], v[132:135]
    v_mfma_f32_16x16x32_bf16 v[128:131], a[204:207], v[216:219], v[128:131]
    ds_read2st64_b64 v[116:119], v9 offset0:26 offset1:27
    v_mul_f32 v144, v154, v144
    v_mfma_f32_16x16x32_bf16 v[132:135], a[204:207], v[220:223], v[132:135]
    v_mul_f32 v145, v154, v145
    v_cvt_pk_bf16_f32 v172, v144, v145
    v_mfma_f32_16x16x32_bf16 v[128:131], a[208:211], v[224:227], v[128:131]
    v_mul_f32 v146, v154, v146
    v_mul_f32 v147, v154, v147
    v_mfma_f32_16x16x32_bf16 v[132:135], a[208:211], v[228:231], v[132:135]
    v_cvt_pk_bf16_f32 v173, v146, v147
    v_mul_f32 v148, v155, v148
    v_mfma_f32_16x16x32_bf16 v[128:131], a[212:215], v[232:235], v[128:131]
    v_mul_f32 v149, v155, v149
    v_cvt_pk_bf16_f32 v174, v148, v149
    v_mfma_f32_16x16x32_bf16 v[132:135], a[212:215], v[236:239], v[132:135]
    ds_read2st64_b64 v[120:123], v9 offset0:28 offset1:29
    v_mul_f32 v150, v155, v150
    v_mfma_f32_16x16x32_bf16 v[128:131], a[216:219], v[240:243], v[128:131]
    v_mul_f32 v151, v155, v151
    v_cvt_pk_bf16_f32 v175, v150, v151
    v_mfma_f32_16x16x32_bf16 v[132:135], a[216:219], v[244:247], v[132:135]
    v_mfma_f32_16x16x32_bf16 v[128:131], a[220:223], v[248:251], v[128:131]
    v_mfma_f32_16x16x32_bf16 v[132:135], a[220:223], v[252:255], v[132:135]
    v_mfma_f32_16x16x32_bf16 v[136:139], a[224:227], v[192:195], 0
    ds_read2st64_b64 v[124:127], v9 offset0:30 offset1:31
    v_mfma_f32_16x16x32_bf16 v[140:143], a[224:227], v[196:199], 0
    s_add_u32 s83, s57, 49152
    buffer_store_dwordx4 v[168:171], v19, s[24:27], s83 offen sc1
    v_mfma_f32_16x16x32_bf16 v[136:139], a[228:231], v[200:203], v[136:139]
    v_mfma_f32_16x16x32_bf16 v[140:143], a[228:231], v[204:207], v[140:143]
    v_mfma_f32_16x16x32_bf16 v[136:139], a[232:235], v[208:211], v[136:139]
    v_mfma_f32_16x16x32_bf16 v[140:143], a[232:235], v[212:215], v[140:143]
    v_mfma_f32_16x16x32_bf16 v[136:139], a[236:239], v[216:219], v[136:139]
    v_mul_f32 v128, v154, v128
    v_mul_f32 v129, v154, v129
    v_mfma_f32_16x16x32_bf16 v[140:143], a[236:239], v[220:223], v[140:143]
    v_cvt_pk_bf16_f32 v160, v128, v129
    v_mul_f32 v130, v154, v130
    v_mfma_f32_16x16x32_bf16 v[136:139], a[240:243], v[224:227], v[136:139]
    v_mul_f32 v131, v154, v131
    v_cvt_pk_bf16_f32 v161, v130, v131
    v_mfma_f32_16x16x32_bf16 v[140:143], a[240:243], v[228:231], v[140:143]
    v_mul_f32 v132, v155, v132
    v_mul_f32 v133, v155, v133
    v_mfma_f32_16x16x32_bf16 v[136:139], a[244:247], v[232:235], v[136:139]
    v_cvt_pk_bf16_f32 v162, v132, v133
    v_mul_f32 v134, v155, v134
    v_mfma_f32_16x16x32_bf16 v[140:143], a[244:247], v[236:239], v[140:143]
    v_mul_f32 v135, v155, v135
    v_cvt_pk_bf16_f32 v163, v134, v135
    v_mfma_f32_16x16x32_bf16 v[136:139], a[248:251], v[240:243], v[136:139]
    v_mfma_f32_16x16x32_bf16 v[140:143], a[248:251], v[244:247], v[140:143]
    v_mov_b32 v3, 4
    s_add_u32 s100, s61, 0
    v_mfma_f32_16x16x32_bf16 v[136:139], a[252:255], v[248:251], v[136:139]
    s_add_u32 s83, s57, 65536
    buffer_store_dwordx4 v[172:175], v19, s[24:27], s83 offen sc1
    v_mfma_f32_16x16x32_bf16 v[140:143], a[252:255], v[252:255], v[140:143]
    s_waitcnt vmcnt(5)
    buffer_store_dword v3, v22, s[92:95], s100 offen sc1
    s_waitcnt lgkmcnt(0)
    v_mfma_f32_16x16x32_bf16 v[144:147], a[32:35], v[64:67], 0
    v_mfma_f32_16x16x32_bf16 v[148:151], a[32:35], v[68:71], 0
    v_mfma_f32_16x16x32_bf16 v[144:147], a[36:39], v[72:75], v[144:147]
    v_mfma_f32_16x16x32_bf16 v[148:151], a[36:39], v[76:79], v[148:151]
    v_mfma_f32_16x16x32_bf16 v[144:147], a[40:43], v[80:83], v[144:147]
    v_mfma_f32_16x16x32_bf16 v[148:151], a[40:43], v[84:87], v[148:151]
    v_mfma_f32_16x16x32_bf16 v[144:147], a[44:47], v[88:91], v[144:147]
    v_mul_f32 v136, v154, v136
    v_mul_f32 v137, v154, v137
    v_mfma_f32_16x16x32_bf16 v[148:151], a[44:47], v[92:95], v[148:151]
    v_cvt_pk_bf16_f32 v164, v136, v137
    v_mul_f32 v138, v154, v138
    v_mfma_f32_16x16x32_bf16 v[144:147], a[48:51], v[96:99], v[144:147]
    v_mul_f32 v139, v154, v139
    v_cvt_pk_bf16_f32 v165, v138, v139
    v_mfma_f32_16x16x32_bf16 v[148:151], a[48:51], v[100:103], v[148:151]
    v_mul_f32 v140, v155, v140
    v_mul_f32 v141, v155, v141
    v_mfma_f32_16x16x32_bf16 v[144:147], a[52:55], v[104:107], v[144:147]
    v_cvt_pk_bf16_f32 v166, v140, v141
    v_mul_f32 v142, v155, v142
    v_mfma_f32_16x16x32_bf16 v[148:151], a[52:55], v[108:111], v[148:151]
    s_add_u32 s83, s57, 81920
    buffer_store_dwordx4 v[160:163], v19, s[24:27], s83 offen sc1
    v_mfma_f32_16x16x32_bf16 v[144:147], a[56:59], v[112:115], v[144:147]
    v_mul_f32 v143, v155, v143
    v_cvt_pk_bf16_f32 v167, v142, v143
    v_mfma_f32_16x16x32_bf16 v[148:151], a[56:59], v[116:119], v[148:151]
    v_mfma_f32_16x16x32_bf16 v[144:147], a[60:63], v[120:123], v[144:147]
    v_mfma_f32_16x16x32_bf16 v[148:151], a[60:63], v[124:127], v[148:151]
    v_mfma_f32_16x16x32_bf16 v[128:131], a[64:67], v[64:67], 0
    v_lshl_add_u32 v0, v21, 3, s65
    ds_read_b64 v[158:159], v0
    v_mfma_f32_16x16x32_bf16 v[132:135], a[64:67], v[68:71], 0
    v_mfma_f32_16x16x32_bf16 v[128:131], a[68:71], v[72:75], v[128:131]
    v_mfma_f32_16x16x32_bf16 v[132:135], a[68:71], v[76:79], v[132:135]
    v_mfma_f32_16x16x32_bf16 v[128:131], a[72:75], v[80:83], v[128:131]
    v_mfma_f32_16x16x32_bf16 v[132:135], a[72:75], v[84:87], v[132:135]
    ds_read2st64_b64 v[192:195], v10 offset0:0 offset1:1
    v_mfma_f32_16x16x32_bf16 v[128:131], a[76:79], v[88:91], v[128:131]
    v_mul_f32 v144, v156, v144
    v_mul_f32 v145, v156, v145
    v_mfma_f32_16x16x32_bf16 v[132:135], a[76:79], v[92:95], v[132:135]
    v_cvt_pk_bf16_f32 v168, v144, v145
    v_mul_f32 v146, v156, v146
    v_mfma_f32_16x16x32_bf16 v[128:131], a[80:83], v[96:99], v[128:131]
    s_add_u32 s83, s57, 98304
    buffer_store_dwordx4 v[164:167], v19, s[24:27], s83 offen sc1
    v_mfma_f32_16x16x32_bf16 v[132:135], a[80:83], v[100:103], v[132:135]
    v_mul_f32 v147, v156, v147
    v_cvt_pk_bf16_f32 v169, v146, v147
    v_mfma_f32_16x16x32_bf16 v[128:131], a[84:87], v[104:107], v[128:131]
    ds_read2st64_b64 v[196:199], v10 offset0:2 offset1:3
    v_mul_f32 v148, v157, v148
    v_mfma_f32_16x16x32_bf16 v[132:135], a[84:87], v[108:111], v[132:135]
    v_mul_f32 v149, v157, v149
    v_cvt_pk_bf16_f32 v170, v148, v149
    v_mfma_f32_16x16x32_bf16 v[128:131], a[88:91], v[112:115], v[128:131]
    v_mul_f32 v150, v157, v150
    v_mul_f32 v151, v157, v151
    v_mfma_f32_16x16x32_bf16 v[132:135], a[88:91], v[116:119], v[132:135]
    v_cvt_pk_bf16_f32 v171, v150, v151
    v_mfma_f32_16x16x32_bf16 v[128:131], a[92:95], v[120:123], v[128:131]
    v_mfma_f32_16x16x32_bf16 v[132:135], a[92:95], v[124:127], v[132:135]
    ds_read2st64_b64 v[200:203], v10 offset0:4 offset1:5
    v_mfma_f32_16x16x32_bf16 v[136:139], a[96:99], v[64:67], 0
    v_mfma_f32_16x16x32_bf16 v[140:143], a[96:99], v[68:71], 0
    v_mfma_f32_16x16x32_bf16 v[136:139], a[100:103], v[72:75], v[136:139]
    v_mfma_f32_16x16x32_bf16 v[140:143], a[100:103], v[76:79], v[140:143]
    v_mfma_f32_16x16x32_bf16 v[136:139], a[104:107], v[80:83], v[136:139]
    ds_read2st64_b64 v[204:207], v10 offset0:6 offset1:7
    v_mfma_f32_16x16x32_bf16 v[140:143], a[104:107], v[84:87], v[140:143]
    v_mfma_f32_16x16x32_bf16 v[136:139], a[108:111], v[88:91], v[136:139]
    s_add_u32 s83, s58, 0
    buffer_store_dwordx4 v[168:171], v19, s[24:27], s83 offen sc1
    v_mfma_f32_16x16x32_bf16 v[140:143], a[108:111], v[92:95], v[140:143]
    v_mul_f32 v128, v156, v128
    v_mul_f32 v129, v156, v129
    v_mfma_f32_16x16x32_bf16 v[136:139], a[112:115], v[96:99], v[136:139]
    v_cvt_pk_bf16_f32 v172, v128, v129
    v_mul_f32 v130, v156, v130
    v_mfma_f32_16x16x32_bf16 v[140:143], a[112:115], v[100:103], v[140:143]
    ds_read2st64_b64 v[208:211], v10 offset0:8 offset1:9
    v_mul_f32 v131, v156, v131
    v_mfma_f32_16x16x32_bf16 v[136:139], a[116:119], v[104:107], v[136:139]
    v_cvt_pk_bf16_f32 v173, v130, v131
    v_mul_f32 v132, v157, v132
    v_mfma_f32_16x16x32_bf16 v[140:143], a[116:119], v[108:111], v[140:143]
    v_mul_f32 v133, v157, v133
    v_cvt_pk_bf16_f32 v174, v132, v133
    v_mfma_f32_16x16x32_bf16 v[136:139], a[120:123], v[112:115], v[136:139]
    v_mul_f32 v134, v157, v134
    v_mul_f32 v135, v157, v135
    v_mfma_f32_16x16x32_bf16 v[140:143], a[120:123], v[116:119], v[140:143]
    v_cvt_pk_bf16_f32 v175, v134, v135
    v_mfma_f32_16x16x32_bf16 v[136:139], a[124:127], v[120:123], v[136:139]
    ds_read2st64_b64 v[212:215], v10 offset0:10 offset1:11
    v_mfma_f32_16x16x32_bf16 v[140:143], a[124:127], v[124:127], v[140:143]
    v_mfma_f32_16x16x32_bf16 v[144:147], a[128:131], v[64:67], 0
    v_mfma_f32_16x16x32_bf16 v[148:151], a[128:131], v[68:71], 0
    v_mfma_f32_16x16x32_bf16 v[144:147], a[132:135], v[72:75], v[144:147]
    v_mfma_f32_16x16x32_bf16 v[148:151], a[132:135], v[76:79], v[148:151]
    ds_read2st64_b64 v[216:219], v10 offset0:12 offset1:13
    v_mfma_f32_16x16x32_bf16 v[144:147], a[136:139], v[80:83], v[144:147]
    v_mfma_f32_16x16x32_bf16 v[148:151], a[136:139], v[84:87], v[148:151]
    v_mfma_f32_16x16x32_bf16 v[144:147], a[140:143], v[88:91], v[144:147]
    s_add_u32 s83, s58, 16384
    buffer_store_dwordx4 v[172:175], v19, s[24:27], s83 offen sc1
    v_mfma_f32_16x16x32_bf16 v[148:151], a[140:143], v[92:95], v[148:151]
    v_mul_f32 v136, v156, v136
    v_mul_f32 v137, v156, v137
    v_mfma_f32_16x16x32_bf16 v[144:147], a[144:147], v[96:99], v[144:147]
    ds_read2st64_b64 v[220:223], v10 offset0:14 offset1:15
    v_cvt_pk_bf16_f32 v160, v136, v137
    v_mfma_f32_16x16x32_bf16 v[148:151], a[144:147], v[100:103], v[148:151]
    v_mul_f32 v138, v156, v138
    v_mul_f32 v139, v156, v139
    v_mfma_f32_16x16x32_bf16 v[144:147], a[148:151], v[104:107], v[144:147]
    v_cvt_pk_bf16_f32 v161, v138, v139
    v_mul_f32 v140, v157, v140
    v_mfma_f32_16x16x32_bf16 v[148:151], a[148:151], v[108:111], v[148:151]
    v_mul_f32 v141, v157, v141
    v_cvt_pk_bf16_f32 v162, v140, v141
    v_mfma_f32_16x16x32_bf16 v[144:147], a[152:155], v[112:115], v[144:147]
    v_mul_f32 v142, v157, v142
    v_mul_f32 v143, v157, v143
    v_mfma_f32_16x16x32_bf16 v[148:151], a[152:155], v[116:119], v[148:151]
    ds_read2st64_b64 v[224:227], v10 offset0:16 offset1:17
    v_cvt_pk_bf16_f32 v163, v142, v143
    v_mfma_f32_16x16x32_bf16 v[144:147], a[156:159], v[120:123], v[144:147]
    v_mfma_f32_16x16x32_bf16 v[148:151], a[156:159], v[124:127], v[148:151]
    v_mfma_f32_16x16x32_bf16 v[128:131], a[160:163], v[64:67], 0
    v_mfma_f32_16x16x32_bf16 v[132:135], a[160:163], v[68:71], 0
    v_mfma_f32_16x16x32_bf16 v[128:131], a[164:167], v[72:75], v[128:131]
    ds_read2st64_b64 v[228:231], v10 offset0:18 offset1:19
    v_mfma_f32_16x16x32_bf16 v[132:135], a[164:167], v[76:79], v[132:135]
    v_mfma_f32_16x16x32_bf16 v[128:131], a[168:171], v[80:83], v[128:131]
    v_mfma_f32_16x16x32_bf16 v[132:135], a[168:171], v[84:87], v[132:135]
    v_mfma_f32_16x16x32_bf16 v[128:131], a[172:175], v[88:91], v[128:131]
    s_add_u32 s83, s58, 32768
    buffer_store_dwordx4 v[160:163], v19, s[24:27], s83 offen sc1
    v_mfma_f32_16x16x32_bf16 v[132:135], a[172:175], v[92:95], v[132:135]
    ds_read2st64_b64 v[232:235], v10 offset0:20 offset1:21
    v_mul_f32 v144, v156, v144
    v_mfma_f32_16x16x32_bf16 v[128:131], a[176:179], v[96:99], v[128:131]
    v_mul_f32 v145, v156, v145
    v_cvt_pk_bf16_f32 v164, v144, v145
    v_mfma_f32_16x16x32_bf16 v[132:135], a[176:179], v[100:103], v[132:135]
    v_mul_f32 v146, v156, v146
    v_mul_f32 v147, v156, v147
    v_mfma_f32_16x16x32_bf16 v[128:131], a[180:183], v[104:107], v[128:131]
    v_cvt_pk_bf16_f32 v165, v146, v147
    v_mul_f32 v148, v157, v148
    v_mfma_f32_16x16x32_bf16 v[132:135], a[180:183], v[108:111], v[132:135]
    v_mul_f32 v149, v157, v149
    v_cvt_pk_bf16_f32 v166, v148, v149
    v_mfma_f32_16x16x32_bf16 v[128:131], a[184:187], v[112:115], v[128:131]
    ds_read2st64_b64 v[236:239], v10 offset0:22 offset1:23
    v_mul_f32 v150, v157, v150
    v_mfma_f32_16x16x32_bf16 v[132:135], a[184:187], v[116:119], v[132:135]
    v_mul_f32 v151, v157, v151
    v_cvt_pk_bf16_f32 v167, v150, v151
    v_mfma_f32_16x16x32_bf16 v[128:131], a[188:191], v[120:123], v[128:131]
    s_and_b32 s86, s34, 3
    s_lshl_b32 s86, s86, 12
    v_mfma_f32_16x16x32_bf16 v[132:135], a[188:191], v[124:127], v[132:135]
    v_lshl_add_u32 v32, v21, 4, s86
    s_lshl_b32 s3, s36, 3
    v_mfma_f32_16x16x32_bf16 v[136:139], a[192:195], v[64:67], 0
    s_add_u32 s3, s3, s35
    s_lshl_b32 s3, s3, 2
    v_mfma_f32_16x16x32_bf16 v[140:143], a[192:195], v[68:71], 0
    ds_read2st64_b64 v[240:243], v10 offset0:24 offset1:25
    s_lshr_b32 s86, s34, 2
    v_mfma_f32_16x16x32_bf16 v[136:139], a[196:199], v[72:75], v[136:139]
    s_add_u32 s3, s3, s86
    s_lshl_b32 s3, s3, 2
    v_mfma_f32_16x16x32_bf16 v[140:143], a[196:199], v[76:79], v[140:143]
    s_add_u32 s3, s3, s28
    s_mul_i32 s3, s3, 114688
    v_mfma_f32_16x16x32_bf16 v[136:139], a[200:203], v[80:83], v[136:139]
    s_add_u32 s8, s54, s3
    s_addc_u32 s9, s55, 0
    v_mfma_f32_16x16x32_bf16 v[140:143], a[200:203], v[84:87], v[140:143]
    s_mov_b32 s10, 114688
    s_mov_b32 s11, 0x20000
    v_mfma_f32_16x16x32_bf16 v[136:139], a[204:207], v[88:91], v[136:139]
    s_add_u32 s83, s58, 49152
    buffer_store_dwordx4 v[164:167], v19, s[24:27], s83 offen sc1
    v_mfma_f32_16x16x32_bf16 v[140:143], a[204:207], v[92:95], v[140:143]
    ds_read2st64_b64 v[244:247], v10 offset0:26 offset1:27
    v_mul_f32 v128, v156, v128
    v_mfma_f32_16x16x32_bf16 v[136:139], a[208:211], v[96:99], v[136:139]
    v_mul_f32 v129, v156, v129
    v_cvt_pk_bf16_f32 v168, v128, v129
    v_mov_b32 v3, 4
    v_mfma_f32_16x16x32_bf16 v[140:143], a[208:211], v[100:103], v[140:143]
    v_mul_f32 v130, v156, v130
    v_mul_f32 v131, v156, v131
    s_add_u32 s100, s61, 2048
    v_mfma_f32_16x16x32_bf16 v[136:139], a[212:215], v[104:107], v[136:139]
    v_cvt_pk_bf16_f32 v169, v130, v131
    v_mul_f32 v132, v157, v132
    s_waitcnt vmcnt(4)
    v_mfma_f32_16x16x32_bf16 v[140:143], a[212:215], v[108:111], v[140:143]
    ds_read2st64_b64 v[248:251], v10 offset0:28 offset1:29
    v_mul_f32 v133, v157, v133
    buffer_store_dword v3, v22, s[92:95], s100 offen sc1
    v_mfma_f32_16x16x32_bf16 v[136:139], a[216:219], v[112:115], v[136:139]
    v_cvt_pk_bf16_f32 v170, v132, v133
    v_mul_f32 v134, v157, v134
    v_mfma_f32_16x16x32_bf16 v[140:143], a[216:219], v[116:119], v[140:143]
    v_mul_f32 v135, v157, v135
    v_cvt_pk_bf16_f32 v171, v134, v135
    v_mfma_f32_16x16x32_bf16 v[136:139], a[220:223], v[120:123], v[136:139]
    v_mfma_f32_16x16x32_bf16 v[140:143], a[220:223], v[124:127], v[140:143]
    v_mfma_f32_16x16x32_bf16 v[144:147], a[224:227], v[64:67], 0
    ds_read2st64_b64 v[252:255], v10 offset0:30 offset1:31
    v_mfma_f32_16x16x32_bf16 v[148:151], a[224:227], v[68:71], 0
    v_mfma_f32_16x16x32_bf16 v[144:147], a[228:231], v[72:75], v[144:147]
    v_mfma_f32_16x16x32_bf16 v[148:151], a[228:231], v[76:79], v[148:151]
    v_mfma_f32_16x16x32_bf16 v[144:147], a[232:235], v[80:83], v[144:147]
    v_mfma_f32_16x16x32_bf16 v[148:151], a[232:235], v[84:87], v[148:151]
    v_mfma_f32_16x16x32_bf16 v[144:147], a[236:239], v[88:91], v[144:147]
    s_add_u32 s83, s58, 65536
    buffer_store_dwordx4 v[168:171], v19, s[24:27], s83 offen sc1
    v_mfma_f32_16x16x32_bf16 v[148:151], a[236:239], v[92:95], v[148:151]
    v_mul_f32 v136, v156, v136
    v_mul_f32 v137, v156, v137
    v_mfma_f32_16x16x32_bf16 v[144:147], a[240:243], v[96:99], v[144:147]
    v_cvt_pk_bf16_f32 v172, v136, v137
    v_mul_f32 v138, v156, v138
    v_mfma_f32_16x16x32_bf16 v[148:151], a[240:243], v[100:103], v[148:151]
    v_mul_f32 v139, v156, v139
    v_cvt_pk_bf16_f32 v173, v138, v139
    v_mfma_f32_16x16x32_bf16 v[144:147], a[244:247], v[104:107], v[144:147]
    v_mul_f32 v140, v157, v140
    v_mul_f32 v141, v157, v141
    v_mfma_f32_16x16x32_bf16 v[148:151], a[244:247], v[108:111], v[148:151]
    v_cvt_pk_bf16_f32 v174, v140, v141
    v_mul_f32 v142, v157, v142
    v_mfma_f32_16x16x32_bf16 v[144:147], a[248:251], v[112:115], v[144:147]
    v_mul_f32 v143, v157, v143
    v_cvt_pk_bf16_f32 v175, v142, v143
    v_mfma_f32_16x16x32_bf16 v[148:151], a[248:251], v[116:119], v[148:151]
    v_mfma_f32_16x16x32_bf16 v[144:147], a[252:255], v[120:123], v[144:147]
    v_mfma_f32_16x16x32_bf16 v[148:151], a[252:255], v[124:127], v[148:151]
    s_waitcnt lgkmcnt(0)
    v_mfma_f32_16x16x32_bf16 v[128:131], a[32:35], v[192:195], 0
    v_mfma_f32_16x16x32_bf16 v[132:135], a[32:35], v[196:199], 0
    v_mfma_f32_16x16x32_bf16 v[128:131], a[36:39], v[200:203], v[128:131]
    v_mfma_f32_16x16x32_bf16 v[132:135], a[36:39], v[204:207], v[132:135]
    v_mfma_f32_16x16x32_bf16 v[128:131], a[40:43], v[208:211], v[128:131]
    v_mfma_f32_16x16x32_bf16 v[132:135], a[40:43], v[212:215], v[132:135]
    v_mfma_f32_16x16x32_bf16 v[128:131], a[44:47], v[216:219], v[128:131]
    s_add_u32 s83, s58, 81920
    buffer_store_dwordx4 v[172:175], v19, s[24:27], s83 offen sc1
    v_mfma_f32_16x16x32_bf16 v[132:135], a[44:47], v[220:223], v[132:135]
    v_mul_f32 v144, v156, v144
    v_mul_f32 v145, v156, v145
    v_mfma_f32_16x16x32_bf16 v[128:131], a[48:51], v[224:227], v[128:131]
    v_cvt_pk_bf16_f32 v160, v144, v145
    v_mul_f32 v146, v156, v146
    v_mfma_f32_16x16x32_bf16 v[132:135], a[48:51], v[228:231], v[132:135]
    v_mul_f32 v147, v156, v147
    v_cvt_pk_bf16_f32 v161, v146, v147
    v_mfma_f32_16x16x32_bf16 v[128:131], a[52:55], v[232:235], v[128:131]
    v_mul_f32 v148, v157, v148
    v_mul_f32 v149, v157, v149
    v_mfma_f32_16x16x32_bf16 v[132:135], a[52:55], v[236:239], v[132:135]
    v_cvt_pk_bf16_f32 v162, v148, v149
    v_mul_f32 v150, v157, v150
    v_mfma_f32_16x16x32_bf16 v[128:131], a[56:59], v[240:243], v[128:131]
    v_mul_f32 v151, v157, v151
    v_cvt_pk_bf16_f32 v163, v150, v151
    v_mfma_f32_16x16x32_bf16 v[132:135], a[56:59], v[244:247], v[132:135]
    v_mfma_f32_16x16x32_bf16 v[128:131], a[60:63], v[248:251], v[128:131]
    v_mfma_f32_16x16x32_bf16 v[132:135], a[60:63], v[252:255], v[132:135]
    v_mfma_f32_16x16x32_bf16 v[136:139], a[64:67], v[192:195], 0
    v_mfma_f32_16x16x32_bf16 v[140:143], a[64:67], v[196:199], 0
    v_mfma_f32_16x16x32_bf16 v[136:139], a[68:71], v[200:203], v[136:139]
    v_mfma_f32_16x16x32_bf16 v[140:143], a[68:71], v[204:207], v[140:143]
    v_mfma_f32_16x16x32_bf16 v[136:139], a[72:75], v[208:211], v[136:139]
    v_mfma_f32_16x16x32_bf16 v[140:143], a[72:75], v[212:215], v[140:143]
    v_mfma_f32_16x16x32_bf16 v[136:139], a[76:79], v[216:219], v[136:139]
    s_add_u32 s83, s58, 98304
    buffer_store_dwordx4 v[160:163], v19, s[24:27], s83 offen sc1
    v_mfma_f32_16x16x32_bf16 v[140:143], a[76:79], v[220:223], v[140:143]
    v_mul_f32 v128, v158, v128
    v_mul_f32 v129, v158, v129
    v_mfma_f32_16x16x32_bf16 v[136:139], a[80:83], v[224:227], v[136:139]
    v_cvt_pk_bf16_f32 v164, v128, v129
    v_mul_f32 v130, v158, v130
    v_mfma_f32_16x16x32_bf16 v[140:143], a[80:83], v[228:231], v[140:143]
    v_mul_f32 v131, v158, v131
    v_cvt_pk_bf16_f32 v165, v130, v131
    v_mfma_f32_16x16x32_bf16 v[136:139], a[84:87], v[232:235], v[136:139]
    v_mul_f32 v132, v159, v132
    v_mul_f32 v133, v159, v133
    v_mfma_f32_16x16x32_bf16 v[140:143], a[84:87], v[236:239], v[140:143]
    v_cvt_pk_bf16_f32 v166, v132, v133
    v_mul_f32 v134, v159, v134
    v_mfma_f32_16x16x32_bf16 v[136:139], a[88:91], v[240:243], v[136:139]
    v_mul_f32 v135, v159, v135
    v_cvt_pk_bf16_f32 v167, v134, v135
    v_mfma_f32_16x16x32_bf16 v[140:143], a[88:91], v[244:247], v[140:143]
    v_mfma_f32_16x16x32_bf16 v[136:139], a[92:95], v[248:251], v[136:139]
    v_mfma_f32_16x16x32_bf16 v[140:143], a[92:95], v[252:255], v[140:143]
    v_mfma_f32_16x16x32_bf16 v[144:147], a[96:99], v[192:195], 0
    v_mfma_f32_16x16x32_bf16 v[148:151], a[96:99], v[196:199], 0
    v_mfma_f32_16x16x32_bf16 v[144:147], a[100:103], v[200:203], v[144:147]
    v_mfma_f32_16x16x32_bf16 v[148:151], a[100:103], v[204:207], v[148:151]
    v_mfma_f32_16x16x32_bf16 v[144:147], a[104:107], v[208:211], v[144:147]
    v_mfma_f32_16x16x32_bf16 v[148:151], a[104:107], v[212:215], v[148:151]
    v_mfma_f32_16x16x32_bf16 v[144:147], a[108:111], v[216:219], v[144:147]
    s_add_u32 s83, s59, 0
    buffer_store_dwordx4 v[164:167], v19, s[24:27], s83 offen sc1
    v_mfma_f32_16x16x32_bf16 v[148:151], a[108:111], v[220:223], v[148:151]
    v_mul_f32 v136, v158, v136
    v_mul_f32 v137, v158, v137
    v_mfma_f32_16x16x32_bf16 v[144:147], a[112:115], v[224:227], v[144:147]
    v_cvt_pk_bf16_f32 v168, v136, v137
    v_mul_f32 v138, v158, v138
    v_mfma_f32_16x16x32_bf16 v[148:151], a[112:115], v[228:231], v[148:151]
    v_mul_f32 v139, v158, v139
    v_cvt_pk_bf16_f32 v169, v138, v139
    v_mfma_f32_16x16x32_bf16 v[144:147], a[116:119], v[232:235], v[144:147]
    v_mul_f32 v140, v159, v140
    v_mul_f32 v141, v159, v141
    v_mfma_f32_16x16x32_bf16 v[148:151], a[116:119], v[236:239], v[148:151]
    v_cvt_pk_bf16_f32 v170, v140, v141
    v_mul_f32 v142, v159, v142
    v_mfma_f32_16x16x32_bf16 v[144:147], a[120:123], v[240:243], v[144:147]
    v_mul_f32 v143, v159, v143
    v_cvt_pk_bf16_f32 v171, v142, v143
    v_mfma_f32_16x16x32_bf16 v[148:151], a[120:123], v[244:247], v[148:151]
    v_mfma_f32_16x16x32_bf16 v[144:147], a[124:127], v[248:251], v[144:147]
    v_mfma_f32_16x16x32_bf16 v[148:151], a[124:127], v[252:255], v[148:151]
    v_mfma_f32_16x16x32_bf16 v[128:131], a[128:131], v[192:195], 0
    v_mfma_f32_16x16x32_bf16 v[132:135], a[128:131], v[196:199], 0
    v_mfma_f32_16x16x32_bf16 v[128:131], a[132:135], v[200:203], v[128:131]
    v_mfma_f32_16x16x32_bf16 v[132:135], a[132:135], v[204:207], v[132:135]
    v_mfma_f32_16x16x32_bf16 v[128:131], a[136:139], v[208:211], v[128:131]
    v_mfma_f32_16x16x32_bf16 v[132:135], a[136:139], v[212:215], v[132:135]
    v_mfma_f32_16x16x32_bf16 v[128:131], a[140:143], v[216:219], v[128:131]
    s_add_u32 s83, s59, 16384
    buffer_store_dwordx4 v[168:171], v19, s[24:27], s83 offen sc1
    v_mfma_f32_16x16x32_bf16 v[132:135], a[140:143], v[220:223], v[132:135]
    v_mul_f32 v144, v158, v144
    v_mul_f32 v145, v158, v145
    v_mfma_f32_16x16x32_bf16 v[128:131], a[144:147], v[224:227], v[128:131]
    v_cvt_pk_bf16_f32 v172, v144, v145
    v_mul_f32 v146, v158, v146
    v_mfma_f32_16x16x32_bf16 v[132:135], a[144:147], v[228:231], v[132:135]
    v_mul_f32 v147, v158, v147
    v_cvt_pk_bf16_f32 v173, v146, v147
    v_mfma_f32_16x16x32_bf16 v[128:131], a[148:151], v[232:235], v[128:131]
    v_mul_f32 v148, v159, v148
    v_mul_f32 v149, v159, v149
    v_mfma_f32_16x16x32_bf16 v[132:135], a[148:151], v[236:239], v[132:135]
    v_cvt_pk_bf16_f32 v174, v148, v149
    v_mul_f32 v150, v159, v150
    v_mfma_f32_16x16x32_bf16 v[128:131], a[152:155], v[240:243], v[128:131]
    v_mul_f32 v151, v159, v151
    v_cvt_pk_bf16_f32 v175, v150, v151
    v_mfma_f32_16x16x32_bf16 v[132:135], a[152:155], v[244:247], v[132:135]
    v_mfma_f32_16x16x32_bf16 v[128:131], a[156:159], v[248:251], v[128:131]
    v_mfma_f32_16x16x32_bf16 v[132:135], a[156:159], v[252:255], v[132:135]
    v_mfma_f32_16x16x32_bf16 v[136:139], a[160:163], v[192:195], 0
    v_mfma_f32_16x16x32_bf16 v[140:143], a[160:163], v[196:199], 0
    v_mfma_f32_16x16x32_bf16 v[136:139], a[164:167], v[200:203], v[136:139]
    v_mfma_f32_16x16x32_bf16 v[140:143], a[164:167], v[204:207], v[140:143]
    v_mfma_f32_16x16x32_bf16 v[136:139], a[168:171], v[208:211], v[136:139]
    v_mfma_f32_16x16x32_bf16 v[140:143], a[168:171], v[212:215], v[140:143]
    v_mfma_f32_16x16x32_bf16 v[136:139], a[172:175], v[216:219], v[136:139]
    s_add_u32 s83, s59, 32768
    buffer_store_dwordx4 v[172:175], v19, s[24:27], s83 offen sc1
    v_mfma_f32_16x16x32_bf16 v[140:143], a[172:175], v[220:223], v[140:143]
    v_mul_f32 v128, v158, v128
    v_mul_f32 v129, v158, v129
    v_mfma_f32_16x16x32_bf16 v[136:139], a[176:179], v[224:227], v[136:139]
    v_cvt_pk_bf16_f32 v160, v128, v129
    v_mul_f32 v130, v158, v130
    v_mfma_f32_16x16x32_bf16 v[140:143], a[176:179], v[228:231], v[140:143]
    v_mul_f32 v131, v158, v131
    v_cvt_pk_bf16_f32 v161, v130, v131
    v_mfma_f32_16x16x32_bf16 v[136:139], a[180:183], v[232:235], v[136:139]
    v_mul_f32 v132, v159, v132
    v_mul_f32 v133, v159, v133
    v_mfma_f32_16x16x32_bf16 v[140:143], a[180:183], v[236:239], v[140:143]
    v_cvt_pk_bf16_f32 v162, v132, v133
    v_mul_f32 v134, v159, v134
    v_mfma_f32_16x16x32_bf16 v[136:139], a[184:187], v[240:243], v[136:139]
    v_mul_f32 v135, v159, v135
    v_cvt_pk_bf16_f32 v163, v134, v135
    v_mfma_f32_16x16x32_bf16 v[140:143], a[184:187], v[244:247], v[140:143]
    v_mfma_f32_16x16x32_bf16 v[136:139], a[188:191], v[248:251], v[136:139]
    v_mfma_f32_16x16x32_bf16 v[140:143], a[188:191], v[252:255], v[140:143]
    v_mfma_f32_16x16x32_bf16 v[144:147], a[192:195], v[192:195], 0
    v_mfma_f32_16x16x32_bf16 v[148:151], a[192:195], v[196:199], 0
    v_mfma_f32_16x16x32_bf16 v[144:147], a[196:199], v[200:203], v[144:147]
    v_mfma_f32_16x16x32_bf16 v[148:151], a[196:199], v[204:207], v[148:151]
    v_mfma_f32_16x16x32_bf16 v[144:147], a[200:203], v[208:211], v[144:147]
    v_mfma_f32_16x16x32_bf16 v[148:151], a[200:203], v[212:215], v[148:151]
    v_mfma_f32_16x16x32_bf16 v[144:147], a[204:207], v[216:219], v[144:147]
    s_add_u32 s83, s59, 49152
    buffer_store_dwordx4 v[160:163], v19, s[24:27], s83 offen sc1
    v_mov_b32 v3, 4
    v_mfma_f32_16x16x32_bf16 v[148:151], a[204:207], v[220:223], v[148:151]
    v_mul_f32 v136, v158, v136
    v_mul_f32 v137, v158, v137
    s_add_u32 s100, s61, 4096
    v_mfma_f32_16x16x32_bf16 v[144:147], a[208:211], v[224:227], v[144:147]
    v_cvt_pk_bf16_f32 v164, v136, v137
    v_mul_f32 v138, v158, v138
    s_waitcnt vmcnt(4)
    v_mfma_f32_16x16x32_bf16 v[148:151], a[208:211], v[228:231], v[148:151]
    v_mul_f32 v139, v158, v139
    v_cvt_pk_bf16_f32 v165, v138, v139
    buffer_store_dword v3, v22, s[92:95], s100 offen sc1
    v_mfma_f32_16x16x32_bf16 v[144:147], a[212:215], v[232:235], v[144:147]
    v_mul_f32 v140, v159, v140
    v_mul_f32 v141, v159, v141
    v_mfma_f32_16x16x32_bf16 v[148:151], a[212:215], v[236:239], v[148:151]
    v_cvt_pk_bf16_f32 v166, v140, v141
    v_mul_f32 v142, v159, v142
    v_mfma_f32_16x16x32_bf16 v[144:147], a[216:219], v[240:243], v[144:147]
    v_mul_f32 v143, v159, v143
    v_cvt_pk_bf16_f32 v167, v142, v143
    v_mfma_f32_16x16x32_bf16 v[148:151], a[216:219], v[244:247], v[148:151]
    v_mfma_f32_16x16x32_bf16 v[144:147], a[220:223], v[248:251], v[144:147]
    v_mfma_f32_16x16x32_bf16 v[148:151], a[220:223], v[252:255], v[148:151]
    s_add_u32 s83, s59, 65536
    buffer_store_dwordx4 v[164:167], v19, s[24:27], s83 offen sc1
    v_mfma_f32_16x16x32_bf16 v[128:131], a[224:227], v[192:195], 0
    v_mfma_f32_16x16x32_bf16 v[132:135], a[224:227], v[196:199], 0
    v_mfma_f32_16x16x32_bf16 v[128:131], a[228:231], v[200:203], v[128:131]
    v_mfma_f32_16x16x32_bf16 v[132:135], a[228:231], v[204:207], v[132:135]
    v_mfma_f32_16x16x32_bf16 v[128:131], a[232:235], v[208:211], v[128:131]
    v_mfma_f32_16x16x32_bf16 v[132:135], a[232:235], v[212:215], v[132:135]
    v_mfma_f32_16x16x32_bf16 v[128:131], a[236:239], v[216:219], v[128:131]
    v_mul_f32 v144, v158, v144
    v_mul_f32 v145, v158, v145
    v_mfma_f32_16x16x32_bf16 v[132:135], a[236:239], v[220:223], v[132:135]
    v_cvt_pk_bf16_f32 v168, v144, v145
    v_mul_f32 v146, v158, v146
    v_mfma_f32_16x16x32_bf16 v[128:131], a[240:243], v[224:227], v[128:131]
    v_mul_f32 v147, v158, v147
    v_cvt_pk_bf16_f32 v169, v146, v147
    v_mfma_f32_16x16x32_bf16 v[132:135], a[240:243], v[228:231], v[132:135]
    v_mul_f32 v148, v159, v148
    v_mul_f32 v149, v159, v149
    v_mfma_f32_16x16x32_bf16 v[128:131], a[244:247], v[232:235], v[128:131]
    v_cvt_pk_bf16_f32 v170, v148, v149
    v_mul_f32 v150, v159, v150
    v_mfma_f32_16x16x32_bf16 v[132:135], a[244:247], v[236:239], v[132:135]
    v_mul_f32 v151, v159, v151
    v_cvt_pk_bf16_f32 v171, v150, v151
    v_mfma_f32_16x16x32_bf16 v[128:131], a[248:251], v[240:243], v[128:131]
    v_mfma_f32_16x16x32_bf16 v[132:135], a[248:251], v[244:247], v[132:135]
    v_mfma_f32_16x16x32_bf16 v[128:131], a[252:255], v[248:251], v[128:131]
    v_mfma_f32_16x16x32_bf16 v[132:135], a[252:255], v[252:255], v[132:135]
    s_add_u32 s83, s59, 81920
    buffer_store_dwordx4 v[168:171], v19, s[24:27], s83 offen sc1
    s_nop 5
    v_mul_f32 v128, v158, v128
    v_mul_f32 v129, v158, v129
    v_cvt_pk_bf16_f32 v172, v128, v129
    v_mul_f32 v130, v158, v130
    v_mul_f32 v131, v158, v131
    v_cvt_pk_bf16_f32 v173, v130, v131
    v_mul_f32 v132, v159, v132
    v_mul_f32 v133, v159, v133
    v_cvt_pk_bf16_f32 v174, v132, v133
    v_mul_f32 v134, v159, v134
    v_mul_f32 v135, v159, v135
    v_cvt_pk_bf16_f32 v175, v134, v135
    s_add_u32 s83, s59, 98304
    buffer_store_dwordx4 v[172:175], v19, s[24:27], s83 offen sc1
    s_branch L_pg2
.p2align 12
L_pg2:
    s_cbranch_execz L_pgb2
    v_and_b32 v34, 15, v21
    v_lshrrev_b32 v35, 4, v21
    v_and_b32 v38, 1, v34
    v_lshlrev_b32 v38, 4, v38
    v_mov_b32 v36, 0x3f80
    v_lshlrev_b32 v36, v38, v36
    v_lshrrev_b32 v38, 1, v34
    v_cmp_eq_u32 s[62:63], 0, v38
    v_cmp_eq_u32 s[64:65], 1, v38
    v_cmp_eq_u32 s[66:67], 2, v38
    v_cmp_eq_u32 s[68:69], 3, v38
    v_cmp_eq_u32 s[70:71], 4, v38
    v_cmp_eq_u32 s[72:73], 5, v38
    v_cmp_eq_u32 s[74:75], 6, v38
    v_cmp_eq_u32 vcc, 7, v38
    v_cndmask_b32 v24, 0, v36, s[62:63]
    v_cndmask_b32 v25, 0, v36, s[64:65]
    v_cndmask_b32 v26, 0, v36, s[66:67]
    v_cndmask_b32 v27, 0, v36, s[68:69]
    v_cndmask_b32 v28, 0, v36, s[70:71]
    v_cndmask_b32 v29, 0, v36, s[72:73]
    v_cndmask_b32 v30, 0, v36, s[74:75]
    v_cndmask_b32 v31, 0, v36, vcc
    s_lshr_b32 s86, s34, 2
    s_lshl_b32 s86, s86, 5
    s_lshl_b32 s87, s35, 7
    s_add_u32 s86, s86, s87
    s_and_b32 s87, s34, 3
    s_lshl_b32 s87, s87, 2
    s_add_u32 s86, s86, s87
    s_mul_i32 s86, s86, 1792
    s_mul_i32 s87, s36, 896
    s_add_u32 s86, s86, s87
    s_lshl_b32 s87, s28, 5
    s_add_u32 s86, s86, s87
    v_lshrrev_b32 v36, 2, v34
    v_and_b32 v37, 1, v35
    v_lshl_add_u32 v36, v37, 4, v36
    v_mul_u32_u24 v36, 1792, v36
    v_and_b32 v37, 3, v34
    v_lshl_add_u32 v36, v37, 3, v36
    v_add_u32 v33, s86, v36
    v_cmp_gt_u32 vcc, 2, v35
    v_mov_b32 v36, s76
    v_mov_b32 v37, s77
    v_cndmask_b32 v36, v37, v36, vcc
    v_add_u32 v40, v33, v36
    v_mov_b32 v36, s78
    v_mov_b32 v37, s79
    v_cndmask_b32 v36, v37, v36, vcc
    v_add_u32 v41, v33, v36
    v_mov_b32 v36, s80
    v_mov_b32 v37, s81
    v_cndmask_b32 v36, v37, v36, vcc
    v_add_u32 v42, v33, v36
    v_mov_b32 v36, s82
    v_mov_b32 v37, 0x7f000000
    v_cndmask_b32 v36, v37, v36, vcc
    v_add_u32 v43, v33, v36
    s_mov_b32 s4, s50
    s_mov_b32 s5, s51
    s_mov_b32 s6, 1835008
    s_mov_b32 s7, 0x20000
    v_mov_b32 v3, 4
    s_add_u32 s100, s61, 6144
    s_waitcnt vmcnt(0)
    buffer_store_dword v3, v22, s[92:95], s100 offen sc1
    s_mov_b32 s86, 0
L_poll:
    buffer_load_dword v0, v20, s[92:95], 0 offen sc1
    s_add_u32 s86, s86, 1
    s_cmp_ge_u32 s86, 1048576
    s_cbranch_scc1 L_polled
    s_waitcnt vmcnt(0)
    v_cmp_le_u32 vcc, s60, v0
    s_nop 1
    s_cmp_eq_u32 vcc_lo, 0xffff
    s_cbranch_scc1 L_polled
    s_sleep 4
    s_branch L_poll
L_polled:
    s_mov_b32 s30, 0
    buffer_load_dwordx4 a[32:35], v32, s[8:11], s30 offen offset:0 sc1
    buffer_load_dwordx4 a[36:39], v32, s[8:11], s30 offen offset:1024 sc1
    buffer_load_dwordx4 a[40:43], v32, s[8:11], s30 offen offset:2048 sc1
    buffer_load_dwordx4 a[44:47], v32, s[8:11], s30 offen offset:3072 sc1
    s_mov_b32 s30, 16384
    buffer_load_dwordx4 a[48:51], v32, s[8:11], s30 offen offset:0 sc1
    buffer_load_dwordx4 a[52:55], v32, s[8:11], s30 offen offset:1024 sc1
    buffer_load_dwordx4 a[56:59], v32, s[8:11], s30 offen offset:2048 sc1
    buffer_load_dwordx4 a[60:63], v32, s[8:11], s30 offen offset:3072 sc1
    s_mov_b32 s30, 32768
    buffer_load_dwordx4 a[64:67], v32, s[8:11], s30 offen offset:0 sc1
    buffer_load_dwordx4 a[68:71], v32, s[8:11], s30 offen offset:1024 sc1
    buffer_load_dwordx4 a[72:75], v32, s[8:11], s30 offen offset:2048 sc1
    buffer_load_dwordx4 a[76:79], v32, s[8:11], s30 offen offset:3072 sc1
    s_mov_b32 s30, 49152
    buffer_load_dwordx4 a[80:83], v32, s[8:11], s30 offen offset:0 sc1
    buffer_load_dwordx4 a[84:87], v32, s[8:11], s30 offen offset:1024 sc1
    buffer_load_dwordx4 a[88:91], v32, s[8:11], s30 offen offset:2048 sc1
    buffer_load_dwordx4 a[92:95], v32, s[8:11], s30 offen offset:3072 sc1
    s_mov_b32 s30, 65536
    buffer_load_dwordx4 a[96:99], v32, s[8:11], s30 offen offset:0 sc1
    buffer_load_dwordx4 a[100:103], v32, s[8:11], s30 offen offset:1024 sc1
    buffer_load_dwordx4 a[104:107], v32, s[8:11], s30 offen offset:2048 sc1
    buffer_load_dwordx4 a[108:111], v32, s[8:11], s30 offen offset:3072 sc1
    s_mov_b32 s30, 81920
    buffer_load_dwordx4 a[112:115], v32, s[8:11], s30 offen offset:0 sc1
    buffer_load_dwordx4 a[116:119], v32, s[8:11], s30 offen offset:1024 sc1
    buffer_load_dwordx4 a[120:123], v32, s[8:11], s30 offen offset:2048 sc1
    buffer_load_dwordx4 a[124:127], v32, s[8:11], s30 offen offset:3072 sc1
    s_mov_b32 s30, 98304
    buffer_load_dwordx4 a[128:131], v32, s[8:11], s30 offen offset:0 sc1
    buffer_load_dwordx4 a[132:135], v32, s[8:11], s30 offen offset:1024 sc1
    buffer_load_dwordx4 a[136:139], v32, s[8:11], s30 offen offset:2048 sc1
    buffer_load_dwordx4 a[140:143], v32, s[8:11], s30 offen offset:3072 sc1
    s_waitcnt vmcnt(27)
    v_mfma_f32_16x16x32_bf16 v[44:47], v[24:27], a[32:35], 0
    s_waitcnt vmcnt(26)
    v_mfma_f32_16x16x32_bf16 v[44:47], v[24:27], a[36:39], v[44:47]
    s_waitcnt vmcnt(25)
    v_mfma_f32_16x16x32_bf16 v[44:47], v[24:27], a[40:43], v[44:47]
    s_waitcnt vmcnt(24)
    v_mfma_f32_16x16x32_bf16 v[44:47], v[24:27], a[44:47], v[44:47]
    s_waitcnt vmcnt(23)
    v_mfma_f32_16x16x32_bf16 v[44:47], v[28:31], a[48:51], v[44:47]
    s_waitcnt vmcnt(22)
    v_mfma_f32_16x16x32_bf16 v[44:47], v[28:31], a[52:55], v[44:47]
    s_waitcnt vmcnt(21)
    v_mfma_f32_16x16x32_bf16 v[44:47], v[28:31], a[56:59], v[44:47]
    s_waitcnt vmcnt(20)
    v_mfma_f32_16x16x32_bf16 v[44:47], v[28:31], a[60:63], v[44:47]
    s_waitcnt vmcnt(19)
    v_mfma_f32_16x16x32_bf16 v[48:51], v[24:27], a[64:67], 0
    s_waitcnt vmcnt(18)
    v_mfma_f32_16x16x32_bf16 v[48:51], v[24:27], a[68:71], v[48:51]
    s_waitcnt vmcnt(17)
    v_mfma_f32_16x16x32_bf16 v[48:51], v[24:27], a[72:75], v[48:51]
    s_waitcnt vmcnt(16)
    v_mfma_f32_16x16x32_bf16 v[48:51], v[24:27], a[76:79], v[48:51]
    s_waitcnt vmcnt(15)
    v_mfma_f32_16x16x32_bf16 v[48:51], v[28:31], a[80:83], v[48:51]
    s_waitcnt vmcnt(14)
    v_mfma_f32_16x16x32_bf16 v[48:51], v[28:31], a[84:87], v[48:51]
    s_waitcnt vmcnt(13)
    v_mfma_f32_16x16x32_bf16 v[48:51], v[28:31], a[88:91], v[48:51]
    s_waitcnt vmcnt(12)
    v_mfma_f32_16x16x32_bf16 v[48:51], v[28:31], a[92:95], v[48:51]
    s_waitcnt vmcnt(11)
    v_mfma_f32_16x16x32_bf16 v[52:55], v[24:27], a[96:99], 0
    s_waitcnt vmcnt(10)
    v_mfma_f32_16x16x32_bf16 v[52:55], v[24:27], a[100:103], v[52:55]
    s_waitcnt vmcnt(9)
    v_mfma_f32_16x16x32_bf16 v[52:55], v[24:27], a[104:107], v[52:55]
    s_waitcnt vmcnt(8)
    v_mfma_f32_16x16x32_bf16 v[52:55], v[24:27], a[108:111], v[52:55]
    s_waitcnt vmcnt(7)
    v_mfma_f32_16x16x32_bf16 v[52:55], v[28:31], a[112:115], v[52:55]
    s_waitcnt vmcnt(6)
    v_mfma_f32_16x16x32_bf16 v[52:55], v[28:31], a[116:119], v[52:55]
    s_waitcnt vmcnt(5)
    v_mfma_f32_16x16x32_bf16 v[52:55], v[28:31], a[120:123], v[52:55]
    s_waitcnt vmcnt(4)
    v_mfma_f32_16x16x32_bf16 v[52:55], v[28:31], a[124:127], v[52:55]
    s_waitcnt vmcnt(3)
    v_mfma_f32_16x16x32_bf16 v[56:59], v[24:27], a[128:131], 0
    s_waitcnt vmcnt(2)
    v_mfma_f32_16x16x32_bf16 v[56:59], v[24:27], a[132:135], v[56:59]
    s_waitcnt vmcnt(1)
    v_mfma_f32_16x16x32_bf16 v[56:59], v[24:27], a[136:139], v[56:59]
    s_waitcnt vmcnt(0)
    v_mfma_f32_16x16x32_bf16 v[56:59], v[24:27], a[140:143], v[56:59]
L_out:
    s_nop 7
    v_cvt_pk_bf16_f32 v32, v44, v45
    v_cvt_pk_bf16_f32 v33, v46, v47
    buffer_store_dwordx2 v[32:33], v40, s[4:7], 0 offen
    v_cvt_pk_bf16_f32 v34, v48, v49
    v_cvt_pk_bf16_f32 v35, v50, v51
    buffer_store_dwordx2 v[34:35], v41, s[4:7], 0 offen
    v_cvt_pk_bf16_f32 v36, v52, v53
    v_cvt_pk_bf16_f32 v37, v54, v55
    buffer_store_dwordx2 v[36:37], v42, s[4:7], 0 offen
    v_cvt_pk_bf16_f32 v38, v56, v57
    v_cvt_pk_bf16_f32 v39, v58, v59
    buffer_store_dwordx2 v[38:39], v43, s[4:7], 0 offen
L_end_main:
    s_endpgm
L_notready:
    s_mov_b32 s87, 0
L_notready2:
    buffer_load_dword v23, off, s[96:99], 0 sc1
    s_waitcnt vmcnt(0)
    s_add_u32 s87, s87, 1
    s_cmp_ge_u32 s87, 1048576
    s_cbranch_scc1 L_ready
    v_readfirstlane_b32 s86, v23
    s_cmp_eq_u32 s86, 0
    s_cbranch_scc1 L_notready2
    s_branch L_ready
L_up_0:
    s_call_b64 s[38:39], L_update
    s_branch L_upb_0
L_rs_0:
    s_call_b64 s[38:39], L_rescale
    s_branch L_rsb_0
L_up_1:
    s_call_b64 s[38:39], L_update
    s_branch L_upb_1
L_rs_1:
    s_call_b64 s[38:39], L_rescale
    s_branch L_rsb_1
L_up_2:
    s_call_b64 s[38:39], L_update
    s_branch L_upb_2
L_rs_2:
    s_call_b64 s[38:39], L_rescale
    s_branch L_rsb_2
L_up_3:
    s_call_b64 s[38:39], L_update
    s_branch L_upb_3
L_rs_3:
    s_call_b64 s[38:39], L_rescale
    s_branch L_rsb_3
L_up_4:
    s_call_b64 s[38:39], L_update
    s_branch L_upb_4
L_rs_4:
    s_call_b64 s[38:39], L_rescale
    s_branch L_rsb_4
L_up_5:
    s_call_b64 s[38:39], L_update
    s_branch L_upb_5
L_rs_5:
    s_call_b64 s[38:39], L_rescale
    s_branch L_rsb_5
L_up_6:
    s_call_b64 s[38:39], L_update
    s_branch L_upb_6
L_rs_6:
    s_call_b64 s[38:39], L_rescale
    s_branch L_rsb_6
L_up_7:
    s_call_b64 s[38:39], L_update
    s_branch L_upb_7
L_rs_7:
    s_call_b64 s[38:39], L_rescale
    s_branch L_rsb_7
L_up_8:
    s_call_b64 s[38:39], L_update
    s_branch L_upb_8
L_rs_8:
    s_call_b64 s[38:39], L_rescale
    s_branch L_rsb_8
L_up_9:
    s_call_b64 s[38:39], L_update
    s_branch L_upb_9
L_rs_9:
    s_call_b64 s[38:39], L_rescale
    s_branch L_rsb_9
L_up_10:
    s_call_b64 s[38:39], L_update
    s_branch L_upb_10
L_rs_10:
    s_call_b64 s[38:39], L_rescale
    s_branch L_rsb_10
L_up_11:
    s_call_b64 s[38:39], L_update
    s_branch L_upb_11
L_rs_11:
    s_call_b64 s[38:39], L_rescale
    s_branch L_rsb_11
L_up_12:
    s_call_b64 s[38:39], L_update
    s_branch L_upb_12
L_rs_12:
    s_call_b64 s[38:39], L_rescale
    s_branch L_rsb_12
L_up_13:
    s_call_b64 s[38:39], L_update
    s_branch L_upb_13
L_rs_13:
    s_call_b64 s[38:39], L_rescale
    s_branch L_rsb_13
L_up_14:
    s_call_b64 s[38:39], L_update
    s_branch L_upb_14
L_rs_14:
    s_call_b64 s[38:39], L_rescale
    s_branch L_rsb_14
L_up_15:
    s_call_b64 s[38:39], L_update
    s_branch L_upb_15
L_rs_15:
    s_call_b64 s[38:39], L_rescale
    s_branch L_rsb_15
L_up_16:
    s_call_b64 s[38:39], L_update
    s_branch L_upb_16
L_rs_16:
    s_call_b64 s[38:39], L_rescale
    s_branch L_rsb_16
L_up_17:
    s_call_b64 s[38:39], L_update
    s_branch L_upb_17
L_rs_17:
    s_call_b64 s[38:39], L_rescale
    s_branch L_rsb_17
L_up_18:
    s_call_b64 s[38:39], L_update
    s_branch L_upb_18
L_rs_18:
    s_call_b64 s[38:39], L_rescale
    s_branch L_rsb_18
L_up_19:
    s_call_b64 s[38:39], L_update
    s_branch L_upb_19
L_rs_19:
    s_call_b64 s[38:39], L_rescale
    s_branch L_rsb_19
L_up_20:
    s_call_b64 s[38:39], L_update
    s_branch L_upb_20
L_rs_20:
    s_call_b64 s[38:39], L_rescale
    s_branch L_rsb_20
L_up_21:
    s_call_b64 s[38:39], L_update
    s_branch L_upb_21
L_rs_21:
    s_call_b64 s[38:39], L_rescale
    s_branch L_rsb_21
L_up_22:
    s_call_b64 s[38:39], L_update
    s_branch L_upb_22
L_rs_22:
    s_call_b64 s[38:39], L_rescale
    s_branch L_rsb_22
L_up_23:
    s_call_b64 s[38:39], L_update
    s_branch L_upb_23
L_rs_23:
    s_call_b64 s[38:39], L_rescale
    s_branch L_rsb_23
L_up_24:
    s_call_b64 s[38:39], L_update
    s_branch L_upb_24
L_rs_24:
    s_call_b64 s[38:39], L_rescale
    s_branch L_rsb_24
L_up_25:
    s_call_b64 s[38:39], L_update
    s_branch L_upb_25
L_rs_25:
    s_call_b64 s[38:39], L_rescale
    s_branch L_rsb_25
L_up_26:
    s_call_b64 s[38:39], L_update
    s_branch L_upb_26
L_rs_26:
    s_call_b64 s[38:39], L_rescale
    s_branch L_rsb_26
L_up_27:
    s_call_b64 s[38:39], L_update
    s_branch L_upb_27
L_rs_27:
    s_call_b64 s[38:39], L_rescale
    s_branch L_rsb_27
L_up_28:
    s_call_b64 s[38:39], L_update
    s_branch L_upb_28
L_rs_28:
    s_call_b64 s[38:39], L_rescale
    s_branch L_rsb_28
L_up_29:
    s_call_b64 s[38:39], L_update
    s_branch L_upb_29
L_rs_29:
    s_call_b64 s[38:39], L_rescale
    s_branch L_rsb_29
L_up_30:
    s_call_b64 s[38:39], L_update
    s_branch L_upb_30
L_rs_30:
    s_call_b64 s[38:39], L_rescale
    s_branch L_rsb_30
L_update:
    v_max3_f32 v0, v40, v41, v42
    v_max3_f32 v1, v43, v48, v49
    v_max3_f32 v0, v0, v50, v51
    v_max_f32 v0, v0, v1
    v_mov_b32 v1, v0
    s_nop 1
    v_permlane32_swap_b32 v0, v1
    v_max_f32 v0, v0, v1
    v_mov_b32 v1, v0
    s_nop 1
    v_permlane16_swap_b32 v0, v1
    v_max_f32 v0, v0, v1
    v_cmp_lt_f32 s[86:87], s31, v0
    s_nop 1
    v_cndmask_b32 v0, 0, v0, s[86:87]
    v_exp_f32 v5, -v0
    v_sub_f32 v40, v40, v0
    v_sub_f32 v41, v41, v0
    v_sub_f32 v42, v42, v0
    v_sub_f32 v43, v43, v0
    v_sub_f32 v48, v48, v0
    v_sub_f32 v49, v49, v0
    v_sub_f32 v50, v50, v0
    v_sub_f32 v51, v51, v0
    v_sub_f32 v56, v56, v0
    v_sub_f32 v57, v57, v0
    v_sub_f32 v58, v58, v0
    v_sub_f32 v59, v59, v0
    v_max3_f32 v0, v44, v45, v46
    v_max3_f32 v1, v47, v52, v53
    v_max3_f32 v0, v0, v54, v55
    v_max_f32 v0, v0, v1
    v_mov_b32 v1, v0
    s_nop 1
    v_permlane32_swap_b32 v0, v1
    v_max_f32 v0, v0, v1
    v_mov_b32 v1, v0
    s_nop 1
    v_permlane16_swap_b32 v0, v1
    v_max_f32 v0, v0, v1
    v_cmp_lt_f32 s[86:87], s31, v0
    s_nop 1
    v_cndmask_b32 v0, 0, v0, s[86:87]
    v_exp_f32 v6, -v0
    v_sub_f32 v44, v44, v0
    v_sub_f32 v45, v45, v0
    v_sub_f32 v46, v46, v0
    v_sub_f32 v47, v47, v0
    v_sub_f32 v52, v52, v0
    v_sub_f32 v53, v53, v0
    v_sub_f32 v54, v54, v0
    v_sub_f32 v55, v55, v0
    v_sub_f32 v60, v60, v0
    v_sub_f32 v61, v61, v0
    v_sub_f32 v62, v62, v0
    v_sub_f32 v63, v63, v0
    s_setpc_b64 s[38:39]
L_rescale:
    s_nop 7
    v_mul_f32 v128, v5, v128
    v_mul_f32 v129, v5, v129
    v_mul_f32 v130, v5, v130
    v_mul_f32 v131, v5, v131
    v_mul_f32 v132, v6, v132
    v_mul_f32 v133, v6, v133
    v_mul_f32 v134, v6, v134
    v_mul_f32 v135, v6, v135
    v_mul_f32 v136, v5, v136
    v_mul_f32 v137, v5, v137
    v_mul_f32 v138, v5, v138
    v_mul_f32 v139, v5, v139
    v_mul_f32 v140, v6, v140
    v_mul_f32 v141, v6, v141
    v_mul_f32 v142, v6, v142
    v_mul_f32 v143, v6, v143
    v_mul_f32 v144, v5, v144
    v_mul_f32 v145, v5, v145
    v_mul_f32 v146, v5, v146
    v_mul_f32 v147, v5, v147
    v_mul_f32 v148, v6, v148
    v_mul_f32 v149, v6, v149
    v_mul_f32 v150, v6, v150
    v_mul_f32 v151, v6, v151
    v_mul_f32 v152, v5, v152
    v_mul_f32 v153, v5, v153
    v_mul_f32 v154, v5, v154
    v_mul_f32 v155, v5, v155
    v_mul_f32 v156, v6, v156
    v_mul_f32 v157, v6, v157
    v_mul_f32 v158, v6, v158
    v_mul_f32 v159, v6, v159
    v_mul_f32 v160, v5, v160
    v_mul_f32 v161, v5, v161
    v_mul_f32 v162, v5, v162
    v_mul_f32 v163, v5, v163
    v_mul_f32 v164, v6, v164
    v_mul_f32 v165, v6, v165
    v_mul_f32 v166, v6, v166
    v_mul_f32 v167, v6, v167
    v_mul_f32 v168, v5, v168
    v_mul_f32 v169, v5, v169
    v_mul_f32 v170, v5, v170
    v_mul_f32 v171, v5, v171
    v_mul_f32 v172, v6, v172
    v_mul_f32 v173, v6, v173
    v_mul_f32 v174, v6, v174
    v_mul_f32 v175, v6, v175
    v_mul_f32 v176, v5, v176
    v_mul_f32 v177, v5, v177
    v_mul_f32 v178, v5, v178
    v_mul_f32 v179, v5, v179
    v_mul_f32 v180, v6, v180
    v_mul_f32 v181, v6, v181
    v_mul_f32 v182, v6, v182
    v_mul_f32 v183, v6, v183
    v_mul_f32 v184, v5, v184
    v_mul_f32 v185, v5, v185
    v_mul_f32 v186, v5, v186
    v_mul_f32 v187, v5, v187
    v_mul_f32 v188, v6, v188
    v_mul_f32 v189, v6, v189
    v_mul_f32 v190, v6, v190
    v_mul_f32 v191, v6, v191
    v_mul_f32 v192, v5, v192
    v_mul_f32 v193, v5, v193
    v_mul_f32 v194, v5, v194
    v_mul_f32 v195, v5, v195
    v_mul_f32 v196, v6, v196
    v_mul_f32 v197, v6, v197
    v_mul_f32 v198, v6, v198
    v_mul_f32 v199, v6, v199
    v_mul_f32 v200, v5, v200
    v_mul_f32 v201, v5, v201
    v_mul_f32 v202, v5, v202
    v_mul_f32 v203, v5, v203
    v_mul_f32 v204, v6, v204
    v_mul_f32 v205, v6, v205
    v_mul_f32 v206, v6, v206
    v_mul_f32 v207, v6, v207
    v_mul_f32 v208, v5, v208
    v_mul_f32 v209, v5, v209
    v_mul_f32 v210, v5, v210
    v_mul_f32 v211, v5, v211
    v_mul_f32 v212, v6, v212
    v_mul_f32 v213, v6, v213
    v_mul_f32 v214, v6, v214
    v_mul_f32 v215, v6, v215
    v_mul_f32 v216, v5, v216
    v_mul_f32 v217, v5, v217
    v_mul_f32 v218, v5, v218
    v_mul_f32 v219, v5, v219
    v_mul_f32 v220, v6, v220
    v_mul_f32 v221, v6, v221
    v_mul_f32 v222, v6, v222
    v_mul_f32 v223, v6, v223
    v_mul_f32 v224, v5, v224
    v_mul_f32 v225, v5, v225
    v_mul_f32 v226, v5, v226
    v_mul_f32 v227, v5, v227
    v_mul_f32 v228, v6, v228
    v_mul_f32 v229, v6, v229
    v_mul_f32 v230, v6, v230
    v_mul_f32 v231, v6, v231
    v_mul_f32 v232, v5, v232
    v_mul_f32 v233, v5, v233
    v_mul_f32 v234, v5, v234
    v_mul_f32 v235, v5, v235
    v_mul_f32 v236, v6, v236
    v_mul_f32 v237, v6, v237
    v_mul_f32 v238, v6, v238
    v_mul_f32 v239, v6, v239
    v_mul_f32 v240, v5, v240
    v_mul_f32 v241, v5, v241
    v_mul_f32 v242, v5, v242
    v_mul_f32 v243, v5, v243
    v_mul_f32 v244, v6, v244
    v_mul_f32 v245, v6, v245
    v_mul_f32 v246, v6, v246
    v_mul_f32 v247, v6, v247
    v_mul_f32 v248, v5, v248
    v_mul_f32 v249, v5, v249
    v_mul_f32 v250, v5, v250
    v_mul_f32 v251, v5, v251
    v_mul_f32 v252, v6, v252
    v_mul_f32 v253, v6, v253
    v_mul_f32 v254, v6, v254
    v_mul_f32 v255, v6, v255
    v_accvgpr_read_b32 v0, a20
    v_mul_f32 v0, v5, v0
    v_accvgpr_write_b32 a20, v0
    v_accvgpr_read_b32 v0, a21
    v_mul_f32 v0, v5, v0
    v_accvgpr_write_b32 a21, v0
    v_accvgpr_read_b32 v0, a22
    v_mul_f32 v0, v5, v0
    v_accvgpr_write_b32 a22, v0
    v_accvgpr_read_b32 v0, a23
    v_mul_f32 v0, v5, v0
    v_accvgpr_write_b32 a23, v0
    v_accvgpr_read_b32 v0, a24
    v_mul_f32 v0, v6, v0
    v_accvgpr_write_b32 a24, v0
    v_accvgpr_read_b32 v0, a25
    v_mul_f32 v0, v6, v0
    v_accvgpr_write_b32 a25, v0
    v_accvgpr_read_b32 v0, a26
    v_mul_f32 v0, v6, v0
    v_accvgpr_write_b32 a26, v0
    v_accvgpr_read_b32 v0, a27
    v_mul_f32 v0, v6, v0
    v_accvgpr_write_b32 a27, v0
    s_nop 1
    s_setpc_b64 s[38:39]
L_code_end:
.section .rodata,"a"
.p2align 6
.amdhsa_kernel concat_heads__mha_block_cached__mha_block_cached__near_ridge_kernel
  .amdhsa_next_free_vgpr 512
  .amdhsa_next_free_sgpr 102
  .amdhsa_accum_offset 256
  .amdhsa_group_segment_fixed_size 0
  .amdhsa_kernarg_size 104
  .amdhsa_user_sgpr_count 2
  .amdhsa_user_sgpr_kernarg_segment_ptr 1
  .amdhsa_system_sgpr_workgroup_id_x 1
  .amdhsa_float_denorm_mode_32 3
.end_amdhsa_kernel
.text
```
